```python
import torch

def _softmax(x, axis=-1):
    return torch.softmax(x, dim=axis)

def _gelu(x):
    return torch.nn.functional.gelu(x, approximate='tanh')

def _silu(x):
    return torch.nn.functional.silu(x)

def _sigmoid(x):
    return torch.sigmoid(x)

def _layernorm(x, axis=-1, eps=1e-05):
    m = x.mean(dim=axis, keepdim=True)
    v = x.var(dim=axis, keepdim=True, unbiased=False)
    return (x - m) / torch.sqrt(v + eps)

def _scatter_add(tgt, idx, src, axis=0):
    return tgt.clone().index_add_(axis, idx, src)

def _segment_sum(src, seg, n):
    out = torch.zeros((n,) + src.shape[1:], dtype=src.dtype)
    return out.index_add_(0, seg, src)

def _pad(x, pw):
    flat = tuple((v for pair in reversed(pw) for v in pair))
    return torch.nn.functional.pad(x, flat)
kernel_name = 'recurrent_scan__memory_aug_recurrent_mem_tr__glu_gated_geglu__prompt'

def setup_inputs():

    _w = lambda a: (lambda t: t.to(torch.bfloat16) if t.is_floating_point() else t)(torch.as_tensor(a))

    def _A_setup():
        B, S, Dm = (1, 2048, 512)
        H, Dh = (32, 128)
        M, seg = (8, 32)
        seg = min(seg, S)
        S = S // seg * seg
        return {'x': _w((lambda *s: torch.randn(*s, dtype=torch.bfloat16) * 0.1)(B, S, Dm)), 'mem0': _w((lambda *s: torch.randn(*s, dtype=torch.bfloat16) * 1.6)(B, M, Dm)), 'Wq': _w((lambda *s: torch.randn(*s, dtype=torch.bfloat16) * 0.8)(Dm, H, Dh) * Dm ** (-0.5)), 'Wk': _w((lambda *s: torch.randn(*s, dtype=torch.bfloat16) * 0.8)(Dm, H, Dh) * Dm ** (-0.5)), 'Wv': _w((lambda *s: torch.randn(*s, dtype=torch.bfloat16) * 1.6)(Dm, H, Dh) * Dm ** (-0.5)), 'Wo': _w((lambda *s: torch.randn(*s, dtype=torch.bfloat16) * 1.6)(H, Dh, Dm) * (H * Dh) ** (-0.5)), 'seg_len': seg}
    _A_in = _A_setup()

    def _B_setup():
        B, S, Dm, Df = (1, 2048, 512, 1792)
        return {'x': _w((lambda *s: torch.randn(*s, dtype=torch.bfloat16) * 0.1)(B, S, Dm)), 'w_gate': _w((lambda *s: torch.randn(*s, dtype=torch.bfloat16) * 0.4)(Dm, Df) * Dm ** (-0.5)), 'w_up': _w((lambda *s: torch.randn(*s, dtype=torch.bfloat16) * 0.4)(Dm, Df) * Dm ** (-0.5)), 'w_down': _w((lambda *s: torch.randn(*s, dtype=torch.bfloat16) * 0.4)(Df, Dm) * Df ** (-0.5))}
    _B_in = _B_setup()
    return {'A_x': _A_in['x'], 'A_mem0': _A_in['mem0'], 'A_Wq': _A_in['Wq'], 'A_Wk': _A_in['Wk'], 'A_Wv': _A_in['Wv'], 'A_Wo': _A_in['Wo'], 'A_seg_len': _A_in['seg_len'], 'B_x': _B_in['x'], 'B_w_gate': _B_in['w_gate'], 'B_w_up': _B_in['w_up'], 'B_w_down': _B_in['w_down']}

def reference(A_x, A_mem0, A_Wq, A_Wk, A_Wv, A_Wo, A_seg_len, B_x, B_w_gate, B_w_up, B_w_down):

    def _A_ref(x, mem0, Wq, Wk, Wv, Wo, seg_len):
        B, S, Dm = x.shape
        H, Dh = (Wq.shape[1], Wq.shape[2])
        M = mem0.shape[1]
        scale = Dh ** (-0.5)
        n_seg = S // seg_len
        L = M + seg_len
        idx = torch.arange(L)
        mask = (idx[:, None] < M) | (idx[:, None] >= idx[None, :])
        mem = mem0
        outs = []
        for s in range(n_seg):
            xs = x[:, s * seg_len:(s + 1) * seg_len, :].clone()
            h = torch.concatenate([mem, xs], axis=1)
            q = torch.einsum('btd,dhe->bhte', h, Wq)
            k = torch.einsum('btd,dhe->bhte', h, Wk)
            v = torch.einsum('btd,dhe->bhte', h, Wv)
            scores = torch.einsum('bhqe,bhke->bhqk', q, k) * scale
            scores = torch.where(mask[None, None], scores, -1000000000.0)
            p = _softmax(scores, axis=-1)
            o = torch.einsum('bhqk,bhke->bhqe', p, v)
            o = torch.einsum('bhte,hed->btd', o, Wo)
            mem = o[:, :M, :].clone()
            outs.append(o[:, M:, :])
        return torch.concatenate(outs, axis=1)

    def _B_ref(x, w_gate, w_up, w_down):
        g = torch.einsum('bsd,df->bsf', x, w_gate)
        u = torch.einsum('bsd,df->bsf', x, w_up)
        h = _gelu(g) * u
        return torch.einsum('bsf,fd->bsd', h, w_down)
    x = A_x
    xn = _layernorm(x, axis=-1)
    s = _A_ref(xn, A_mem0, A_Wq, A_Wk, A_Wv, A_Wo, A_seg_len)
    g = _silu(_B_ref(xn, B_w_gate, B_w_up, B_w_down))
    return x + s * g
```

```asm
; @launch grid=(256,1,1) block=(256,1,1) lds=163840
.amdgcn_target "amdgcn-amd-amdhsa--gfx950"
.text
.globl recurrent_scan__memory_aug_recurrent_mem_tr__glu_gated_geglu__prompt_kernel
.p2align 8
.type recurrent_scan__memory_aug_recurrent_mem_tr__glu_gated_geglu__prompt_kernel,@function
recurrent_scan__memory_aug_recurrent_mem_tr__glu_gated_geglu__prompt_kernel:
    s_cmp_gt_u32 s2, 255
    s_cbranch_scc1 L_end
    s_load_dwordx2 s[40:41], s[0:1], 8
    s_load_dwordx4 s[44:47], s[0:1], 16
    s_load_dwordx4 s[48:51], s[0:1], 32
    s_load_dwordx2 s[4:5], s[0:1], 104
    s_load_dwordx2 s[6:7], s[0:1], 96
    s_getreg_b32 s35, hwreg(HW_REG_XCC_ID)
    s_and_b32 s35, s35, 7
    v_lshrrev_b32 v2, 6, v0
    s_nop 0
    v_readfirstlane_b32 s9, v2
    s_lshr_b32 s8, s2, 3
    s_and_b32 s3, s2, 7
    s_mov_b32 s27, 400000
    s_cmp_eq_u32 s3, 0
    s_cbranch_scc1 L_heads
    s_waitcnt lgkmcnt(0)
    s_cmp_eq_u32 s3, 1
    s_cbranch_scc1 L_ln
    s_cmp_lg_u32 s3, 2
    s_cbranch_scc1 L_role
    v_and_b32 v1, 63, v0
    s_lshl_b32 s40, s8, 2
    s_add_u32 s40, s40, s9
    v_mov_b64 v[8:9], 0
    v_mov_b64 v[10:11], 0
    v_mov_b64 v[12:13], -1
    v_mov_b64 v[14:15], -1
    s_lshl_b32 s41, s40, 10
    v_lshl_add_u32 v2, v1, 4, s41
    s_cmp_gt_u32 s40, 39
    s_cbranch_scc1 Lin_1
    v_add_u32 v3, 786432, v2
    global_store_dwordx4 v3, v[8:11], s[4:5] sc1
    s_cmp_gt_u32 s40, 15
    s_cbranch_scc1 Lin_1
    v_lshrrev_b32 v3, 1, v2
    v_add_u32 v3, 8192, v3
    global_store_dwordx2 v3, v[12:13], s[4:5] sc1
    v_lshrrev_b32 v3, 2, v2
    v_add_u32 v3, 16384, v3
    global_store_dword v3, v8, s[4:5] sc1
Lin_1:
    v_add_u32 v4, 65536, v2
    global_store_dwordx4 v4, v[12:15], s[4:5] sc1
    v_add_u32 v5, 196608, v2
    global_store_dwordx4 v5, v[12:15], s[4:5] sc1
    v_add_u32 v4, 327680, v2
    global_store_dwordx4 v4, v[12:15], s[4:5] sc1
    v_add_u32 v5, 458752, v2
    global_store_dwordx4 v5, v[12:15], s[4:5] sc1
    v_add_u32 v4, 589824, v2
    global_store_dwordx4 v4, v[12:15], s[4:5] sc1
    v_add_u32 v4, 51380224, v2
    global_store_dwordx4 v4, v[12:15], s[4:5] sc1
    v_add_u32 v5, 51511296, v2
    global_store_dwordx4 v5, v[12:15], s[4:5] sc1
    v_add_u32 v4, 51642368, v2
    global_store_dwordx4 v4, v[12:15], s[4:5] sc1
    v_add_u32 v5, 51773440, v2
    global_store_dwordx4 v5, v[12:15], s[4:5] sc1
    s_waitcnt vmcnt(0)
    s_barrier
    s_cmp_lg_u32 s9, 0
    s_cbranch_scc1 Llns_2
    v_mov_b32 v7, 128
    v_mov_b32 v8, 1
    s_mov_b64 exec, 1
    global_atomic_add v7, v8, s[6:7] sc1
    s_mov_b64 exec, -1
Llns_2:
    s_branch L_role
L_ln:
    s_load_dwordx2 s[40:41], s[0:1], 0
    v_and_b32 v1, 63, v0
    v_lshrrev_b32 v2, 4, v1
    v_and_b32 v3, 15, v1
    v_lshrrev_b32 v4, 2, v3
    v_and_b32 v5, 3, v1
    s_lshl_b32 s44, s8, 2
    s_add_u32 s44, s44, s9
    s_lshl_b32 s45, s44, 14
    v_lshlrev_b32 v6, 10, v3
    v_lshl_add_u32 v6, v2, 4, v6
    v_add_u32 v6, s45, v6
    s_waitcnt lgkmcnt(0)
    global_load_dwordx4 v[16:19], v6, s[40:41] offset:0
    global_load_dwordx4 v[20:23], v6, s[40:41] offset:64
    global_load_dwordx4 v[24:27], v6, s[40:41] offset:128
    global_load_dwordx4 v[28:31], v6, s[40:41] offset:192
    global_load_dwordx4 v[32:35], v6, s[40:41] offset:256
    global_load_dwordx4 v[36:39], v6, s[40:41] offset:320
    global_load_dwordx4 v[40:43], v6, s[40:41] offset:384
    global_load_dwordx4 v[44:47], v6, s[40:41] offset:448
    global_load_dwordx4 v[48:51], v6, s[40:41] offset:512
    global_load_dwordx4 v[52:55], v6, s[40:41] offset:576
    global_load_dwordx4 v[56:59], v6, s[40:41] offset:640
    global_load_dwordx4 v[60:63], v6, s[40:41] offset:704
    global_load_dwordx4 v[64:67], v6, s[40:41] offset:768
    global_load_dwordx4 v[68:71], v6, s[40:41] offset:832
    global_load_dwordx4 v[72:75], v6, s[40:41] offset:896
    global_load_dwordx4 v[76:79], v6, s[40:41] offset:960
    s_add_u32 s45, s45, 1048576
    v_lshlrev_b32 v9, 4, v1
    v_add_u32 v9, 4096, v9
    v_add_u32 v10, 8192, v9
    v_mov_b64 v[12:13], 0
    v_mov_b64 v[14:15], 0
    s_add_u32 s42, s4, s45
    s_addc_u32 s43, s5, 0
    s_waitcnt vmcnt(15)
    v_lshlrev_b32 v128, 16, v16
    v_and_b32 v129, 0xffff0000, v16
    v_pk_add_f32 v[12:13], v[12:13], v[128:129]
    v_lshlrev_b32 v130, 16, v17
    v_and_b32 v131, 0xffff0000, v17
    v_pk_add_f32 v[14:15], v[14:15], v[130:131]
    v_lshlrev_b32 v132, 16, v18
    v_and_b32 v133, 0xffff0000, v18
    v_pk_add_f32 v[12:13], v[12:13], v[132:133]
    v_lshlrev_b32 v134, 16, v19
    v_and_b32 v135, 0xffff0000, v19
    v_pk_add_f32 v[14:15], v[14:15], v[134:135]
    s_waitcnt vmcnt(14)
    v_lshlrev_b32 v136, 16, v20
    v_and_b32 v137, 0xffff0000, v20
    v_pk_add_f32 v[12:13], v[12:13], v[136:137]
    v_lshlrev_b32 v138, 16, v21
    v_and_b32 v139, 0xffff0000, v21
    v_pk_add_f32 v[14:15], v[14:15], v[138:139]
    v_lshlrev_b32 v140, 16, v22
    v_and_b32 v141, 0xffff0000, v22
    v_pk_add_f32 v[12:13], v[12:13], v[140:141]
    v_lshlrev_b32 v142, 16, v23
    v_and_b32 v143, 0xffff0000, v23
    v_pk_add_f32 v[14:15], v[14:15], v[142:143]
    s_waitcnt vmcnt(13)
    v_lshlrev_b32 v144, 16, v24
    v_and_b32 v145, 0xffff0000, v24
    v_pk_add_f32 v[12:13], v[12:13], v[144:145]
    v_lshlrev_b32 v146, 16, v25
    v_and_b32 v147, 0xffff0000, v25
    v_pk_add_f32 v[14:15], v[14:15], v[146:147]
    v_lshlrev_b32 v148, 16, v26
    v_and_b32 v149, 0xffff0000, v26
    v_pk_add_f32 v[12:13], v[12:13], v[148:149]
    v_lshlrev_b32 v150, 16, v27
    v_and_b32 v151, 0xffff0000, v27
    v_pk_add_f32 v[14:15], v[14:15], v[150:151]
    s_waitcnt vmcnt(12)
    v_lshlrev_b32 v152, 16, v28
    v_and_b32 v153, 0xffff0000, v28
    v_pk_add_f32 v[12:13], v[12:13], v[152:153]
    v_lshlrev_b32 v154, 16, v29
    v_and_b32 v155, 0xffff0000, v29
    v_pk_add_f32 v[14:15], v[14:15], v[154:155]
    v_lshlrev_b32 v156, 16, v30
    v_and_b32 v157, 0xffff0000, v30
    v_pk_add_f32 v[12:13], v[12:13], v[156:157]
    v_lshlrev_b32 v158, 16, v31
    v_and_b32 v159, 0xffff0000, v31
    v_pk_add_f32 v[14:15], v[14:15], v[158:159]
    s_waitcnt vmcnt(11)
    v_lshlrev_b32 v160, 16, v32
    v_and_b32 v161, 0xffff0000, v32
    v_pk_add_f32 v[12:13], v[12:13], v[160:161]
    v_lshlrev_b32 v162, 16, v33
    v_and_b32 v163, 0xffff0000, v33
    v_pk_add_f32 v[14:15], v[14:15], v[162:163]
    v_lshlrev_b32 v164, 16, v34
    v_and_b32 v165, 0xffff0000, v34
    v_pk_add_f32 v[12:13], v[12:13], v[164:165]
    v_lshlrev_b32 v166, 16, v35
    v_and_b32 v167, 0xffff0000, v35
    v_pk_add_f32 v[14:15], v[14:15], v[166:167]
    s_waitcnt vmcnt(10)
    v_lshlrev_b32 v168, 16, v36
    v_and_b32 v169, 0xffff0000, v36
    v_pk_add_f32 v[12:13], v[12:13], v[168:169]
    v_lshlrev_b32 v170, 16, v37
    v_and_b32 v171, 0xffff0000, v37
    v_pk_add_f32 v[14:15], v[14:15], v[170:171]
    v_lshlrev_b32 v172, 16, v38
    v_and_b32 v173, 0xffff0000, v38
    v_pk_add_f32 v[12:13], v[12:13], v[172:173]
    v_lshlrev_b32 v174, 16, v39
    v_and_b32 v175, 0xffff0000, v39
    v_pk_add_f32 v[14:15], v[14:15], v[174:175]
    s_waitcnt vmcnt(9)
    v_lshlrev_b32 v176, 16, v40
    v_and_b32 v177, 0xffff0000, v40
    v_pk_add_f32 v[12:13], v[12:13], v[176:177]
    v_lshlrev_b32 v178, 16, v41
    v_and_b32 v179, 0xffff0000, v41
    v_pk_add_f32 v[14:15], v[14:15], v[178:179]
    v_lshlrev_b32 v180, 16, v42
    v_and_b32 v181, 0xffff0000, v42
    v_pk_add_f32 v[12:13], v[12:13], v[180:181]
    v_lshlrev_b32 v182, 16, v43
    v_and_b32 v183, 0xffff0000, v43
    v_pk_add_f32 v[14:15], v[14:15], v[182:183]
    s_waitcnt vmcnt(8)
    v_lshlrev_b32 v184, 16, v44
    v_and_b32 v185, 0xffff0000, v44
    v_pk_add_f32 v[12:13], v[12:13], v[184:185]
    v_lshlrev_b32 v186, 16, v45
    v_and_b32 v187, 0xffff0000, v45
    v_pk_add_f32 v[14:15], v[14:15], v[186:187]
    v_lshlrev_b32 v188, 16, v46
    v_and_b32 v189, 0xffff0000, v46
    v_pk_add_f32 v[12:13], v[12:13], v[188:189]
    v_lshlrev_b32 v190, 16, v47
    v_and_b32 v191, 0xffff0000, v47
    v_pk_add_f32 v[14:15], v[14:15], v[190:191]
    s_waitcnt vmcnt(7)
    v_lshlrev_b32 v192, 16, v48
    v_and_b32 v193, 0xffff0000, v48
    v_pk_add_f32 v[12:13], v[12:13], v[192:193]
    v_lshlrev_b32 v194, 16, v49
    v_and_b32 v195, 0xffff0000, v49
    v_pk_add_f32 v[14:15], v[14:15], v[194:195]
    v_lshlrev_b32 v196, 16, v50
    v_and_b32 v197, 0xffff0000, v50
    v_pk_add_f32 v[12:13], v[12:13], v[196:197]
    v_lshlrev_b32 v198, 16, v51
    v_and_b32 v199, 0xffff0000, v51
    v_pk_add_f32 v[14:15], v[14:15], v[198:199]
    s_waitcnt vmcnt(6)
    v_lshlrev_b32 v200, 16, v52
    v_and_b32 v201, 0xffff0000, v52
    v_pk_add_f32 v[12:13], v[12:13], v[200:201]
    v_lshlrev_b32 v202, 16, v53
    v_and_b32 v203, 0xffff0000, v53
    v_pk_add_f32 v[14:15], v[14:15], v[202:203]
    v_lshlrev_b32 v204, 16, v54
    v_and_b32 v205, 0xffff0000, v54
    v_pk_add_f32 v[12:13], v[12:13], v[204:205]
    v_lshlrev_b32 v206, 16, v55
    v_and_b32 v207, 0xffff0000, v55
    v_pk_add_f32 v[14:15], v[14:15], v[206:207]
    s_waitcnt vmcnt(5)
    v_lshlrev_b32 v208, 16, v56
    v_and_b32 v209, 0xffff0000, v56
    v_pk_add_f32 v[12:13], v[12:13], v[208:209]
    v_lshlrev_b32 v210, 16, v57
    v_and_b32 v211, 0xffff0000, v57
    v_pk_add_f32 v[14:15], v[14:15], v[210:211]
    v_lshlrev_b32 v212, 16, v58
    v_and_b32 v213, 0xffff0000, v58
    v_pk_add_f32 v[12:13], v[12:13], v[212:213]
    v_lshlrev_b32 v214, 16, v59
    v_and_b32 v215, 0xffff0000, v59
    v_pk_add_f32 v[14:15], v[14:15], v[214:215]
    s_waitcnt vmcnt(4)
    v_lshlrev_b32 v216, 16, v60
    v_and_b32 v217, 0xffff0000, v60
    v_pk_add_f32 v[12:13], v[12:13], v[216:217]
    v_lshlrev_b32 v218, 16, v61
    v_and_b32 v219, 0xffff0000, v61
    v_pk_add_f32 v[14:15], v[14:15], v[218:219]
    v_lshlrev_b32 v220, 16, v62
    v_and_b32 v221, 0xffff0000, v62
    v_pk_add_f32 v[12:13], v[12:13], v[220:221]
    v_lshlrev_b32 v222, 16, v63
    v_and_b32 v223, 0xffff0000, v63
    v_pk_add_f32 v[14:15], v[14:15], v[222:223]
    s_waitcnt vmcnt(3)
    v_lshlrev_b32 v224, 16, v64
    v_and_b32 v225, 0xffff0000, v64
    v_pk_add_f32 v[12:13], v[12:13], v[224:225]
    v_lshlrev_b32 v226, 16, v65
    v_and_b32 v227, 0xffff0000, v65
    v_pk_add_f32 v[14:15], v[14:15], v[226:227]
    v_lshlrev_b32 v228, 16, v66
    v_and_b32 v229, 0xffff0000, v66
    v_pk_add_f32 v[12:13], v[12:13], v[228:229]
    v_lshlrev_b32 v230, 16, v67
    v_and_b32 v231, 0xffff0000, v67
    v_pk_add_f32 v[14:15], v[14:15], v[230:231]
    s_waitcnt vmcnt(2)
    v_lshlrev_b32 v232, 16, v68
    v_and_b32 v233, 0xffff0000, v68
    v_pk_add_f32 v[12:13], v[12:13], v[232:233]
    v_lshlrev_b32 v234, 16, v69
    v_and_b32 v235, 0xffff0000, v69
    v_pk_add_f32 v[14:15], v[14:15], v[234:235]
    v_lshlrev_b32 v236, 16, v70
    v_and_b32 v237, 0xffff0000, v70
    v_pk_add_f32 v[12:13], v[12:13], v[236:237]
    v_lshlrev_b32 v238, 16, v71
    v_and_b32 v239, 0xffff0000, v71
    v_pk_add_f32 v[14:15], v[14:15], v[238:239]
    s_waitcnt vmcnt(1)
    v_lshlrev_b32 v240, 16, v72
    v_and_b32 v241, 0xffff0000, v72
    v_pk_add_f32 v[12:13], v[12:13], v[240:241]
    v_lshlrev_b32 v242, 16, v73
    v_and_b32 v243, 0xffff0000, v73
    v_pk_add_f32 v[14:15], v[14:15], v[242:243]
    v_lshlrev_b32 v244, 16, v74
    v_and_b32 v245, 0xffff0000, v74
    v_pk_add_f32 v[12:13], v[12:13], v[244:245]
    v_lshlrev_b32 v246, 16, v75
    v_and_b32 v247, 0xffff0000, v75
    v_pk_add_f32 v[14:15], v[14:15], v[246:247]
    s_waitcnt vmcnt(0)
    v_lshlrev_b32 v248, 16, v76
    v_and_b32 v249, 0xffff0000, v76
    v_pk_add_f32 v[12:13], v[12:13], v[248:249]
    v_lshlrev_b32 v250, 16, v77
    v_and_b32 v251, 0xffff0000, v77
    v_pk_add_f32 v[14:15], v[14:15], v[250:251]
    v_lshlrev_b32 v252, 16, v78
    v_and_b32 v253, 0xffff0000, v78
    v_pk_add_f32 v[12:13], v[12:13], v[252:253]
    v_lshlrev_b32 v254, 16, v79
    v_and_b32 v255, 0xffff0000, v79
    v_pk_add_f32 v[14:15], v[14:15], v[254:255]
    v_pk_add_f32 v[12:13], v[12:13], v[14:15]
    v_add_f32 v12, v12, v13
    v_mov_b32 v14, v12
    v_mov_b32 v15, v12
    s_nop 1
    v_permlane16_swap_b32 v14, v15
    v_add_f32 v14, v14, v15
    v_mov_b32 v15, v14
    s_nop 1
    v_permlane32_swap_b32 v14, v15
    v_add_f32 v12, v14, v15
    v_mul_f32 v12, 0xbb000000, v12
    v_mov_b32 v11, v12
    v_cvt_pk_bf16_f32 v11, v11, v11
    v_and_b32 v11, 0xffff0000, v11
    v_mov_b64 v[14:15], 0
    v_mov_b64 v[80:81], 0
    v_pk_add_f32 v[84:85], v[128:129], v[12:13] op_sel_hi:[1,0]
    v_pk_fma_f32 v[14:15], v[84:85], v[84:85], v[14:15]
    v_pk_add_f32 v[86:87], v[130:131], v[12:13] op_sel_hi:[1,0]
    v_pk_fma_f32 v[80:81], v[86:87], v[86:87], v[80:81]
    v_pk_add_f32 v[88:89], v[132:133], v[12:13] op_sel_hi:[1,0]
    v_pk_fma_f32 v[14:15], v[88:89], v[88:89], v[14:15]
    v_pk_add_f32 v[90:91], v[134:135], v[12:13] op_sel_hi:[1,0]
    v_pk_fma_f32 v[80:81], v[90:91], v[90:91], v[80:81]
    v_pk_add_f32 v[84:85], v[136:137], v[12:13] op_sel_hi:[1,0]
    v_pk_fma_f32 v[14:15], v[84:85], v[84:85], v[14:15]
    v_pk_add_f32 v[86:87], v[138:139], v[12:13] op_sel_hi:[1,0]
    v_pk_fma_f32 v[80:81], v[86:87], v[86:87], v[80:81]
    v_pk_add_f32 v[88:89], v[140:141], v[12:13] op_sel_hi:[1,0]
    v_pk_fma_f32 v[14:15], v[88:89], v[88:89], v[14:15]
    v_pk_add_f32 v[90:91], v[142:143], v[12:13] op_sel_hi:[1,0]
    v_pk_fma_f32 v[80:81], v[90:91], v[90:91], v[80:81]
    v_pk_add_f32 v[84:85], v[144:145], v[12:13] op_sel_hi:[1,0]
    v_pk_fma_f32 v[14:15], v[84:85], v[84:85], v[14:15]
    v_pk_add_f32 v[86:87], v[146:147], v[12:13] op_sel_hi:[1,0]
    v_pk_fma_f32 v[80:81], v[86:87], v[86:87], v[80:81]
    v_pk_add_f32 v[88:89], v[148:149], v[12:13] op_sel_hi:[1,0]
    v_pk_fma_f32 v[14:15], v[88:89], v[88:89], v[14:15]
    v_pk_add_f32 v[90:91], v[150:151], v[12:13] op_sel_hi:[1,0]
    v_pk_fma_f32 v[80:81], v[90:91], v[90:91], v[80:81]
    v_pk_add_f32 v[84:85], v[152:153], v[12:13] op_sel_hi:[1,0]
    v_pk_fma_f32 v[14:15], v[84:85], v[84:85], v[14:15]
    v_pk_add_f32 v[86:87], v[154:155], v[12:13] op_sel_hi:[1,0]
    v_pk_fma_f32 v[80:81], v[86:87], v[86:87], v[80:81]
    v_pk_add_f32 v[88:89], v[156:157], v[12:13] op_sel_hi:[1,0]
    v_pk_fma_f32 v[14:15], v[88:89], v[88:89], v[14:15]
    v_pk_add_f32 v[90:91], v[158:159], v[12:13] op_sel_hi:[1,0]
    v_pk_fma_f32 v[80:81], v[90:91], v[90:91], v[80:81]
    v_pk_add_f32 v[84:85], v[160:161], v[12:13] op_sel_hi:[1,0]
    v_pk_fma_f32 v[14:15], v[84:85], v[84:85], v[14:15]
    v_pk_add_f32 v[86:87], v[162:163], v[12:13] op_sel_hi:[1,0]
    v_pk_fma_f32 v[80:81], v[86:87], v[86:87], v[80:81]
    v_pk_add_f32 v[88:89], v[164:165], v[12:13] op_sel_hi:[1,0]
    v_pk_fma_f32 v[14:15], v[88:89], v[88:89], v[14:15]
    v_pk_add_f32 v[90:91], v[166:167], v[12:13] op_sel_hi:[1,0]
    v_pk_fma_f32 v[80:81], v[90:91], v[90:91], v[80:81]
    v_pk_add_f32 v[84:85], v[168:169], v[12:13] op_sel_hi:[1,0]
    v_pk_fma_f32 v[14:15], v[84:85], v[84:85], v[14:15]
    v_pk_add_f32 v[86:87], v[170:171], v[12:13] op_sel_hi:[1,0]
    v_pk_fma_f32 v[80:81], v[86:87], v[86:87], v[80:81]
    v_pk_add_f32 v[88:89], v[172:173], v[12:13] op_sel_hi:[1,0]
    v_pk_fma_f32 v[14:15], v[88:89], v[88:89], v[14:15]
    v_pk_add_f32 v[90:91], v[174:175], v[12:13] op_sel_hi:[1,0]
    v_pk_fma_f32 v[80:81], v[90:91], v[90:91], v[80:81]
    v_pk_add_f32 v[84:85], v[176:177], v[12:13] op_sel_hi:[1,0]
    v_pk_fma_f32 v[14:15], v[84:85], v[84:85], v[14:15]
    v_pk_add_f32 v[86:87], v[178:179], v[12:13] op_sel_hi:[1,0]
    v_pk_fma_f32 v[80:81], v[86:87], v[86:87], v[80:81]
    v_pk_add_f32 v[88:89], v[180:181], v[12:13] op_sel_hi:[1,0]
    v_pk_fma_f32 v[14:15], v[88:89], v[88:89], v[14:15]
    v_pk_add_f32 v[90:91], v[182:183], v[12:13] op_sel_hi:[1,0]
    v_pk_fma_f32 v[80:81], v[90:91], v[90:91], v[80:81]
    v_pk_add_f32 v[84:85], v[184:185], v[12:13] op_sel_hi:[1,0]
    v_pk_fma_f32 v[14:15], v[84:85], v[84:85], v[14:15]
    v_pk_add_f32 v[86:87], v[186:187], v[12:13] op_sel_hi:[1,0]
    v_pk_fma_f32 v[80:81], v[86:87], v[86:87], v[80:81]
    v_pk_add_f32 v[88:89], v[188:189], v[12:13] op_sel_hi:[1,0]
    v_pk_fma_f32 v[14:15], v[88:89], v[88:89], v[14:15]
    v_pk_add_f32 v[90:91], v[190:191], v[12:13] op_sel_hi:[1,0]
    v_pk_fma_f32 v[80:81], v[90:91], v[90:91], v[80:81]
    v_pk_add_f32 v[84:85], v[192:193], v[12:13] op_sel_hi:[1,0]
    v_pk_fma_f32 v[14:15], v[84:85], v[84:85], v[14:15]
    v_pk_add_f32 v[86:87], v[194:195], v[12:13] op_sel_hi:[1,0]
    v_pk_fma_f32 v[80:81], v[86:87], v[86:87], v[80:81]
    v_pk_add_f32 v[88:89], v[196:197], v[12:13] op_sel_hi:[1,0]
    v_pk_fma_f32 v[14:15], v[88:89], v[88:89], v[14:15]
    v_pk_add_f32 v[90:91], v[198:199], v[12:13] op_sel_hi:[1,0]
    v_pk_fma_f32 v[80:81], v[90:91], v[90:91], v[80:81]
    v_pk_add_f32 v[84:85], v[200:201], v[12:13] op_sel_hi:[1,0]
    v_pk_fma_f32 v[14:15], v[84:85], v[84:85], v[14:15]
    v_pk_add_f32 v[86:87], v[202:203], v[12:13] op_sel_hi:[1,0]
    v_pk_fma_f32 v[80:81], v[86:87], v[86:87], v[80:81]
    v_pk_add_f32 v[88:89], v[204:205], v[12:13] op_sel_hi:[1,0]
    v_pk_fma_f32 v[14:15], v[88:89], v[88:89], v[14:15]
    v_pk_add_f32 v[90:91], v[206:207], v[12:13] op_sel_hi:[1,0]
    v_pk_fma_f32 v[80:81], v[90:91], v[90:91], v[80:81]
    v_pk_add_f32 v[84:85], v[208:209], v[12:13] op_sel_hi:[1,0]
    v_pk_fma_f32 v[14:15], v[84:85], v[84:85], v[14:15]
    v_pk_add_f32 v[86:87], v[210:211], v[12:13] op_sel_hi:[1,0]
    v_pk_fma_f32 v[80:81], v[86:87], v[86:87], v[80:81]
    v_pk_add_f32 v[88:89], v[212:213], v[12:13] op_sel_hi:[1,0]
    v_pk_fma_f32 v[14:15], v[88:89], v[88:89], v[14:15]
    v_pk_add_f32 v[90:91], v[214:215], v[12:13] op_sel_hi:[1,0]
    v_pk_fma_f32 v[80:81], v[90:91], v[90:91], v[80:81]
    v_pk_add_f32 v[84:85], v[216:217], v[12:13] op_sel_hi:[1,0]
    v_pk_fma_f32 v[14:15], v[84:85], v[84:85], v[14:15]
    v_pk_add_f32 v[86:87], v[218:219], v[12:13] op_sel_hi:[1,0]
    v_pk_fma_f32 v[80:81], v[86:87], v[86:87], v[80:81]
    v_pk_add_f32 v[88:89], v[220:221], v[12:13] op_sel_hi:[1,0]
    v_pk_fma_f32 v[14:15], v[88:89], v[88:89], v[14:15]
    v_pk_add_f32 v[90:91], v[222:223], v[12:13] op_sel_hi:[1,0]
    v_pk_fma_f32 v[80:81], v[90:91], v[90:91], v[80:81]
    v_pk_add_f32 v[84:85], v[224:225], v[12:13] op_sel_hi:[1,0]
    v_pk_fma_f32 v[14:15], v[84:85], v[84:85], v[14:15]
    v_pk_add_f32 v[86:87], v[226:227], v[12:13] op_sel_hi:[1,0]
    v_pk_fma_f32 v[80:81], v[86:87], v[86:87], v[80:81]
    v_pk_add_f32 v[88:89], v[228:229], v[12:13] op_sel_hi:[1,0]
    v_pk_fma_f32 v[14:15], v[88:89], v[88:89], v[14:15]
    v_pk_add_f32 v[90:91], v[230:231], v[12:13] op_sel_hi:[1,0]
    v_pk_fma_f32 v[80:81], v[90:91], v[90:91], v[80:81]
    v_pk_add_f32 v[84:85], v[232:233], v[12:13] op_sel_hi:[1,0]
    v_pk_fma_f32 v[14:15], v[84:85], v[84:85], v[14:15]
    v_pk_add_f32 v[86:87], v[234:235], v[12:13] op_sel_hi:[1,0]
    v_pk_fma_f32 v[80:81], v[86:87], v[86:87], v[80:81]
    v_pk_add_f32 v[88:89], v[236:237], v[12:13] op_sel_hi:[1,0]
    v_pk_fma_f32 v[14:15], v[88:89], v[88:89], v[14:15]
    v_pk_add_f32 v[90:91], v[238:239], v[12:13] op_sel_hi:[1,0]
    v_pk_fma_f32 v[80:81], v[90:91], v[90:91], v[80:81]
    v_pk_add_f32 v[84:85], v[240:241], v[12:13] op_sel_hi:[1,0]
    v_pk_fma_f32 v[14:15], v[84:85], v[84:85], v[14:15]
    v_pk_add_f32 v[86:87], v[242:243], v[12:13] op_sel_hi:[1,0]
    v_pk_fma_f32 v[80:81], v[86:87], v[86:87], v[80:81]
    v_pk_add_f32 v[88:89], v[244:245], v[12:13] op_sel_hi:[1,0]
    v_pk_fma_f32 v[14:15], v[88:89], v[88:89], v[14:15]
    v_pk_add_f32 v[90:91], v[246:247], v[12:13] op_sel_hi:[1,0]
    v_pk_fma_f32 v[80:81], v[90:91], v[90:91], v[80:81]
    v_pk_add_f32 v[84:85], v[248:249], v[12:13] op_sel_hi:[1,0]
    v_pk_fma_f32 v[14:15], v[84:85], v[84:85], v[14:15]
    v_pk_add_f32 v[86:87], v[250:251], v[12:13] op_sel_hi:[1,0]
    v_pk_fma_f32 v[80:81], v[86:87], v[86:87], v[80:81]
    v_pk_add_f32 v[88:89], v[252:253], v[12:13] op_sel_hi:[1,0]
    v_pk_fma_f32 v[14:15], v[88:89], v[88:89], v[14:15]
    v_pk_add_f32 v[90:91], v[254:255], v[12:13] op_sel_hi:[1,0]
    v_pk_fma_f32 v[80:81], v[90:91], v[90:91], v[80:81]
    v_pk_add_f32 v[14:15], v[14:15], v[80:81]
    v_add_f32 v14, v14, v15
    v_mov_b32 v80, v14
    v_mov_b32 v81, v14
    s_nop 1
    v_permlane16_swap_b32 v80, v81
    v_add_f32 v80, v80, v81
    v_mov_b32 v81, v80
    s_nop 1
    v_permlane32_swap_b32 v80, v81
    v_add_f32 v14, v80, v81
    v_mul_f32 v14, 0x3b000000, v14
    v_cvt_pk_bf16_f32 v14, v14, v14
    v_and_b32 v14, 0xffff0000, v14
    v_add_f32 v14, 0x3727c5ac, v14
    v_cvt_pk_bf16_f32 v14, v14, v14
    v_and_b32 v14, 0xffff0000, v14
    v_sqrt_f32 v14, v14
    s_nop 0
    v_cvt_pk_bf16_f32 v14, v14, v14
    v_and_b32 v14, 0xffff0000, v14
    v_rcp_f32 v14, v14
    v_mov_b32 v12, v11
    v_pk_add_f32 v[128:129], v[128:129], v[12:13] op_sel_hi:[1,0]
    v_cvt_pk_bf16_f32 v129, v128, v129
    v_lshlrev_b32 v128, 16, v129
    v_and_b32 v129, 0xffff0000, v129
    v_pk_mul_f32 v[128:129], v[128:129], v[14:15] op_sel_hi:[1,0]
    v_cvt_pk_bf16_f32 v16, v128, v129
    v_pk_add_f32 v[130:131], v[130:131], v[12:13] op_sel_hi:[1,0]
    v_cvt_pk_bf16_f32 v131, v130, v131
    v_lshlrev_b32 v130, 16, v131
    v_and_b32 v131, 0xffff0000, v131
    v_pk_mul_f32 v[130:131], v[130:131], v[14:15] op_sel_hi:[1,0]
    v_cvt_pk_bf16_f32 v17, v130, v131
    v_pk_add_f32 v[132:133], v[132:133], v[12:13] op_sel_hi:[1,0]
    v_cvt_pk_bf16_f32 v133, v132, v133
    v_lshlrev_b32 v132, 16, v133
    v_and_b32 v133, 0xffff0000, v133
    v_pk_mul_f32 v[132:133], v[132:133], v[14:15] op_sel_hi:[1,0]
    v_cvt_pk_bf16_f32 v18, v132, v133
    v_pk_add_f32 v[134:135], v[134:135], v[12:13] op_sel_hi:[1,0]
    v_cvt_pk_bf16_f32 v135, v134, v135
    v_lshlrev_b32 v134, 16, v135
    v_and_b32 v135, 0xffff0000, v135
    v_pk_mul_f32 v[134:135], v[134:135], v[14:15] op_sel_hi:[1,0]
    v_cvt_pk_bf16_f32 v19, v134, v135
    global_store_dwordx4 v9, v[16:19], s[42:43] offset:-4096 sc1
    v_pk_add_f32 v[136:137], v[136:137], v[12:13] op_sel_hi:[1,0]
    v_cvt_pk_bf16_f32 v137, v136, v137
    v_lshlrev_b32 v136, 16, v137
    v_and_b32 v137, 0xffff0000, v137
    v_pk_mul_f32 v[136:137], v[136:137], v[14:15] op_sel_hi:[1,0]
    v_cvt_pk_bf16_f32 v20, v136, v137
    v_pk_add_f32 v[138:139], v[138:139], v[12:13] op_sel_hi:[1,0]
    v_cvt_pk_bf16_f32 v139, v138, v139
    v_lshlrev_b32 v138, 16, v139
    v_and_b32 v139, 0xffff0000, v139
    v_pk_mul_f32 v[138:139], v[138:139], v[14:15] op_sel_hi:[1,0]
    v_cvt_pk_bf16_f32 v21, v138, v139
    v_pk_add_f32 v[140:141], v[140:141], v[12:13] op_sel_hi:[1,0]
    v_cvt_pk_bf16_f32 v141, v140, v141
    v_lshlrev_b32 v140, 16, v141
    v_and_b32 v141, 0xffff0000, v141
    v_pk_mul_f32 v[140:141], v[140:141], v[14:15] op_sel_hi:[1,0]
    v_cvt_pk_bf16_f32 v22, v140, v141
    v_pk_add_f32 v[142:143], v[142:143], v[12:13] op_sel_hi:[1,0]
    v_cvt_pk_bf16_f32 v143, v142, v143
    v_lshlrev_b32 v142, 16, v143
    v_and_b32 v143, 0xffff0000, v143
    v_pk_mul_f32 v[142:143], v[142:143], v[14:15] op_sel_hi:[1,0]
    v_cvt_pk_bf16_f32 v23, v142, v143
    global_store_dwordx4 v9, v[20:23], s[42:43] offset:-3072 sc1
    v_pk_add_f32 v[144:145], v[144:145], v[12:13] op_sel_hi:[1,0]
    v_cvt_pk_bf16_f32 v145, v144, v145
    v_lshlrev_b32 v144, 16, v145
    v_and_b32 v145, 0xffff0000, v145
    v_pk_mul_f32 v[144:145], v[144:145], v[14:15] op_sel_hi:[1,0]
    v_cvt_pk_bf16_f32 v24, v144, v145
    v_pk_add_f32 v[146:147], v[146:147], v[12:13] op_sel_hi:[1,0]
    v_cvt_pk_bf16_f32 v147, v146, v147
    v_lshlrev_b32 v146, 16, v147
    v_and_b32 v147, 0xffff0000, v147
    v_pk_mul_f32 v[146:147], v[146:147], v[14:15] op_sel_hi:[1,0]
    v_cvt_pk_bf16_f32 v25, v146, v147
    v_pk_add_f32 v[148:149], v[148:149], v[12:13] op_sel_hi:[1,0]
    v_cvt_pk_bf16_f32 v149, v148, v149
    v_lshlrev_b32 v148, 16, v149
    v_and_b32 v149, 0xffff0000, v149
    v_pk_mul_f32 v[148:149], v[148:149], v[14:15] op_sel_hi:[1,0]
    v_cvt_pk_bf16_f32 v26, v148, v149
    v_pk_add_f32 v[150:151], v[150:151], v[12:13] op_sel_hi:[1,0]
    v_cvt_pk_bf16_f32 v151, v150, v151
    v_lshlrev_b32 v150, 16, v151
    v_and_b32 v151, 0xffff0000, v151
    v_pk_mul_f32 v[150:151], v[150:151], v[14:15] op_sel_hi:[1,0]
    v_cvt_pk_bf16_f32 v27, v150, v151
    global_store_dwordx4 v9, v[24:27], s[42:43] offset:-2048 sc1
    v_pk_add_f32 v[152:153], v[152:153], v[12:13] op_sel_hi:[1,0]
    v_cvt_pk_bf16_f32 v153, v152, v153
    v_lshlrev_b32 v152, 16, v153
    v_and_b32 v153, 0xffff0000, v153
    v_pk_mul_f32 v[152:153], v[152:153], v[14:15] op_sel_hi:[1,0]
    v_cvt_pk_bf16_f32 v28, v152, v153
    v_pk_add_f32 v[154:155], v[154:155], v[12:13] op_sel_hi:[1,0]
    v_cvt_pk_bf16_f32 v155, v154, v155
    v_lshlrev_b32 v154, 16, v155
    v_and_b32 v155, 0xffff0000, v155
    v_pk_mul_f32 v[154:155], v[154:155], v[14:15] op_sel_hi:[1,0]
    v_cvt_pk_bf16_f32 v29, v154, v155
    v_pk_add_f32 v[156:157], v[156:157], v[12:13] op_sel_hi:[1,0]
    v_cvt_pk_bf16_f32 v157, v156, v157
    v_lshlrev_b32 v156, 16, v157
    v_and_b32 v157, 0xffff0000, v157
    v_pk_mul_f32 v[156:157], v[156:157], v[14:15] op_sel_hi:[1,0]
    v_cvt_pk_bf16_f32 v30, v156, v157
    v_pk_add_f32 v[158:159], v[158:159], v[12:13] op_sel_hi:[1,0]
    v_cvt_pk_bf16_f32 v159, v158, v159
    v_lshlrev_b32 v158, 16, v159
    v_and_b32 v159, 0xffff0000, v159
    v_pk_mul_f32 v[158:159], v[158:159], v[14:15] op_sel_hi:[1,0]
    v_cvt_pk_bf16_f32 v31, v158, v159
    global_store_dwordx4 v9, v[28:31], s[42:43] offset:-1024 sc1
    v_pk_add_f32 v[160:161], v[160:161], v[12:13] op_sel_hi:[1,0]
    v_cvt_pk_bf16_f32 v161, v160, v161
    v_lshlrev_b32 v160, 16, v161
    v_and_b32 v161, 0xffff0000, v161
    v_pk_mul_f32 v[160:161], v[160:161], v[14:15] op_sel_hi:[1,0]
    v_cvt_pk_bf16_f32 v32, v160, v161
    v_pk_add_f32 v[162:163], v[162:163], v[12:13] op_sel_hi:[1,0]
    v_cvt_pk_bf16_f32 v163, v162, v163
    v_lshlrev_b32 v162, 16, v163
    v_and_b32 v163, 0xffff0000, v163
    v_pk_mul_f32 v[162:163], v[162:163], v[14:15] op_sel_hi:[1,0]
    v_cvt_pk_bf16_f32 v33, v162, v163
    v_pk_add_f32 v[164:165], v[164:165], v[12:13] op_sel_hi:[1,0]
    v_cvt_pk_bf16_f32 v165, v164, v165
    v_lshlrev_b32 v164, 16, v165
    v_and_b32 v165, 0xffff0000, v165
    v_pk_mul_f32 v[164:165], v[164:165], v[14:15] op_sel_hi:[1,0]
    v_cvt_pk_bf16_f32 v34, v164, v165
    v_pk_add_f32 v[166:167], v[166:167], v[12:13] op_sel_hi:[1,0]
    v_cvt_pk_bf16_f32 v167, v166, v167
    v_lshlrev_b32 v166, 16, v167
    v_and_b32 v167, 0xffff0000, v167
    v_pk_mul_f32 v[166:167], v[166:167], v[14:15] op_sel_hi:[1,0]
    v_cvt_pk_bf16_f32 v35, v166, v167
    global_store_dwordx4 v9, v[32:35], s[42:43] offset:0 sc1
    v_pk_add_f32 v[168:169], v[168:169], v[12:13] op_sel_hi:[1,0]
    v_cvt_pk_bf16_f32 v169, v168, v169
    v_lshlrev_b32 v168, 16, v169
    v_and_b32 v169, 0xffff0000, v169
    v_pk_mul_f32 v[168:169], v[168:169], v[14:15] op_sel_hi:[1,0]
    v_cvt_pk_bf16_f32 v36, v168, v169
    v_pk_add_f32 v[170:171], v[170:171], v[12:13] op_sel_hi:[1,0]
    v_cvt_pk_bf16_f32 v171, v170, v171
    v_lshlrev_b32 v170, 16, v171
    v_and_b32 v171, 0xffff0000, v171
    v_pk_mul_f32 v[170:171], v[170:171], v[14:15] op_sel_hi:[1,0]
    v_cvt_pk_bf16_f32 v37, v170, v171
    v_pk_add_f32 v[172:173], v[172:173], v[12:13] op_sel_hi:[1,0]
    v_cvt_pk_bf16_f32 v173, v172, v173
    v_lshlrev_b32 v172, 16, v173
    v_and_b32 v173, 0xffff0000, v173
    v_pk_mul_f32 v[172:173], v[172:173], v[14:15] op_sel_hi:[1,0]
    v_cvt_pk_bf16_f32 v38, v172, v173
    v_pk_add_f32 v[174:175], v[174:175], v[12:13] op_sel_hi:[1,0]
    v_cvt_pk_bf16_f32 v175, v174, v175
    v_lshlrev_b32 v174, 16, v175
    v_and_b32 v175, 0xffff0000, v175
    v_pk_mul_f32 v[174:175], v[174:175], v[14:15] op_sel_hi:[1,0]
    v_cvt_pk_bf16_f32 v39, v174, v175
    global_store_dwordx4 v9, v[36:39], s[42:43] offset:1024 sc1
    v_pk_add_f32 v[176:177], v[176:177], v[12:13] op_sel_hi:[1,0]
    v_cvt_pk_bf16_f32 v177, v176, v177
    v_lshlrev_b32 v176, 16, v177
    v_and_b32 v177, 0xffff0000, v177
    v_pk_mul_f32 v[176:177], v[176:177], v[14:15] op_sel_hi:[1,0]
    v_cvt_pk_bf16_f32 v40, v176, v177
    v_pk_add_f32 v[178:179], v[178:179], v[12:13] op_sel_hi:[1,0]
    v_cvt_pk_bf16_f32 v179, v178, v179
    v_lshlrev_b32 v178, 16, v179
    v_and_b32 v179, 0xffff0000, v179
    v_pk_mul_f32 v[178:179], v[178:179], v[14:15] op_sel_hi:[1,0]
    v_cvt_pk_bf16_f32 v41, v178, v179
    v_pk_add_f32 v[180:181], v[180:181], v[12:13] op_sel_hi:[1,0]
    v_cvt_pk_bf16_f32 v181, v180, v181
    v_lshlrev_b32 v180, 16, v181
    v_and_b32 v181, 0xffff0000, v181
    v_pk_mul_f32 v[180:181], v[180:181], v[14:15] op_sel_hi:[1,0]
    v_cvt_pk_bf16_f32 v42, v180, v181
    v_pk_add_f32 v[182:183], v[182:183], v[12:13] op_sel_hi:[1,0]
    v_cvt_pk_bf16_f32 v183, v182, v183
    v_lshlrev_b32 v182, 16, v183
    v_and_b32 v183, 0xffff0000, v183
    v_pk_mul_f32 v[182:183], v[182:183], v[14:15] op_sel_hi:[1,0]
    v_cvt_pk_bf16_f32 v43, v182, v183
    global_store_dwordx4 v9, v[40:43], s[42:43] offset:2048 sc1
    v_pk_add_f32 v[184:185], v[184:185], v[12:13] op_sel_hi:[1,0]
    v_cvt_pk_bf16_f32 v185, v184, v185
    v_lshlrev_b32 v184, 16, v185
    v_and_b32 v185, 0xffff0000, v185
    v_pk_mul_f32 v[184:185], v[184:185], v[14:15] op_sel_hi:[1,0]
    v_cvt_pk_bf16_f32 v44, v184, v185
    v_pk_add_f32 v[186:187], v[186:187], v[12:13] op_sel_hi:[1,0]
    v_cvt_pk_bf16_f32 v187, v186, v187
    v_lshlrev_b32 v186, 16, v187
    v_and_b32 v187, 0xffff0000, v187
    v_pk_mul_f32 v[186:187], v[186:187], v[14:15] op_sel_hi:[1,0]
    v_cvt_pk_bf16_f32 v45, v186, v187
    v_pk_add_f32 v[188:189], v[188:189], v[12:13] op_sel_hi:[1,0]
    v_cvt_pk_bf16_f32 v189, v188, v189
    v_lshlrev_b32 v188, 16, v189
    v_and_b32 v189, 0xffff0000, v189
    v_pk_mul_f32 v[188:189], v[188:189], v[14:15] op_sel_hi:[1,0]
    v_cvt_pk_bf16_f32 v46, v188, v189
    v_pk_add_f32 v[190:191], v[190:191], v[12:13] op_sel_hi:[1,0]
    v_cvt_pk_bf16_f32 v191, v190, v191
    v_lshlrev_b32 v190, 16, v191
    v_and_b32 v191, 0xffff0000, v191
    v_pk_mul_f32 v[190:191], v[190:191], v[14:15] op_sel_hi:[1,0]
    v_cvt_pk_bf16_f32 v47, v190, v191
    global_store_dwordx4 v9, v[44:47], s[42:43] offset:3072 sc1
    v_pk_add_f32 v[192:193], v[192:193], v[12:13] op_sel_hi:[1,0]
    v_cvt_pk_bf16_f32 v193, v192, v193
    v_lshlrev_b32 v192, 16, v193
    v_and_b32 v193, 0xffff0000, v193
    v_pk_mul_f32 v[192:193], v[192:193], v[14:15] op_sel_hi:[1,0]
    v_cvt_pk_bf16_f32 v48, v192, v193
    v_pk_add_f32 v[194:195], v[194:195], v[12:13] op_sel_hi:[1,0]
    v_cvt_pk_bf16_f32 v195, v194, v195
    v_lshlrev_b32 v194, 16, v195
    v_and_b32 v195, 0xffff0000, v195
    v_pk_mul_f32 v[194:195], v[194:195], v[14:15] op_sel_hi:[1,0]
    v_cvt_pk_bf16_f32 v49, v194, v195
    v_pk_add_f32 v[196:197], v[196:197], v[12:13] op_sel_hi:[1,0]
    v_cvt_pk_bf16_f32 v197, v196, v197
    v_lshlrev_b32 v196, 16, v197
    v_and_b32 v197, 0xffff0000, v197
    v_pk_mul_f32 v[196:197], v[196:197], v[14:15] op_sel_hi:[1,0]
    v_cvt_pk_bf16_f32 v50, v196, v197
    v_pk_add_f32 v[198:199], v[198:199], v[12:13] op_sel_hi:[1,0]
    v_cvt_pk_bf16_f32 v199, v198, v199
    v_lshlrev_b32 v198, 16, v199
    v_and_b32 v199, 0xffff0000, v199
    v_pk_mul_f32 v[198:199], v[198:199], v[14:15] op_sel_hi:[1,0]
    v_cvt_pk_bf16_f32 v51, v198, v199
    global_store_dwordx4 v10, v[48:51], s[42:43] offset:-4096 sc1
    v_pk_add_f32 v[200:201], v[200:201], v[12:13] op_sel_hi:[1,0]
    v_cvt_pk_bf16_f32 v201, v200, v201
    v_lshlrev_b32 v200, 16, v201
    v_and_b32 v201, 0xffff0000, v201
    v_pk_mul_f32 v[200:201], v[200:201], v[14:15] op_sel_hi:[1,0]
    v_cvt_pk_bf16_f32 v52, v200, v201
    v_pk_add_f32 v[202:203], v[202:203], v[12:13] op_sel_hi:[1,0]
    v_cvt_pk_bf16_f32 v203, v202, v203
    v_lshlrev_b32 v202, 16, v203
    v_and_b32 v203, 0xffff0000, v203
    v_pk_mul_f32 v[202:203], v[202:203], v[14:15] op_sel_hi:[1,0]
    v_cvt_pk_bf16_f32 v53, v202, v203
    v_pk_add_f32 v[204:205], v[204:205], v[12:13] op_sel_hi:[1,0]
    v_cvt_pk_bf16_f32 v205, v204, v205
    v_lshlrev_b32 v204, 16, v205
    v_and_b32 v205, 0xffff0000, v205
    v_pk_mul_f32 v[204:205], v[204:205], v[14:15] op_sel_hi:[1,0]
    v_cvt_pk_bf16_f32 v54, v204, v205
    v_pk_add_f32 v[206:207], v[206:207], v[12:13] op_sel_hi:[1,0]
    v_cvt_pk_bf16_f32 v207, v206, v207
    v_lshlrev_b32 v206, 16, v207
    v_and_b32 v207, 0xffff0000, v207
    v_pk_mul_f32 v[206:207], v[206:207], v[14:15] op_sel_hi:[1,0]
    v_cvt_pk_bf16_f32 v55, v206, v207
    global_store_dwordx4 v10, v[52:55], s[42:43] offset:-3072 sc1
    v_pk_add_f32 v[208:209], v[208:209], v[12:13] op_sel_hi:[1,0]
    v_cvt_pk_bf16_f32 v209, v208, v209
    v_lshlrev_b32 v208, 16, v209
    v_and_b32 v209, 0xffff0000, v209
    v_pk_mul_f32 v[208:209], v[208:209], v[14:15] op_sel_hi:[1,0]
    v_cvt_pk_bf16_f32 v56, v208, v209
    v_pk_add_f32 v[210:211], v[210:211], v[12:13] op_sel_hi:[1,0]
    v_cvt_pk_bf16_f32 v211, v210, v211
    v_lshlrev_b32 v210, 16, v211
    v_and_b32 v211, 0xffff0000, v211
    v_pk_mul_f32 v[210:211], v[210:211], v[14:15] op_sel_hi:[1,0]
    v_cvt_pk_bf16_f32 v57, v210, v211
    v_pk_add_f32 v[212:213], v[212:213], v[12:13] op_sel_hi:[1,0]
    v_cvt_pk_bf16_f32 v213, v212, v213
    v_lshlrev_b32 v212, 16, v213
    v_and_b32 v213, 0xffff0000, v213
    v_pk_mul_f32 v[212:213], v[212:213], v[14:15] op_sel_hi:[1,0]
    v_cvt_pk_bf16_f32 v58, v212, v213
    v_pk_add_f32 v[214:215], v[214:215], v[12:13] op_sel_hi:[1,0]
    v_cvt_pk_bf16_f32 v215, v214, v215
    v_lshlrev_b32 v214, 16, v215
    v_and_b32 v215, 0xffff0000, v215
    v_pk_mul_f32 v[214:215], v[214:215], v[14:15] op_sel_hi:[1,0]
    v_cvt_pk_bf16_f32 v59, v214, v215
    global_store_dwordx4 v10, v[56:59], s[42:43] offset:-2048 sc1
    v_pk_add_f32 v[216:217], v[216:217], v[12:13] op_sel_hi:[1,0]
    v_cvt_pk_bf16_f32 v217, v216, v217
    v_lshlrev_b32 v216, 16, v217
    v_and_b32 v217, 0xffff0000, v217
    v_pk_mul_f32 v[216:217], v[216:217], v[14:15] op_sel_hi:[1,0]
    v_cvt_pk_bf16_f32 v60, v216, v217
    v_pk_add_f32 v[218:219], v[218:219], v[12:13] op_sel_hi:[1,0]
    v_cvt_pk_bf16_f32 v219, v218, v219
    v_lshlrev_b32 v218, 16, v219
    v_and_b32 v219, 0xffff0000, v219
    v_pk_mul_f32 v[218:219], v[218:219], v[14:15] op_sel_hi:[1,0]
    v_cvt_pk_bf16_f32 v61, v218, v219
    v_pk_add_f32 v[220:221], v[220:221], v[12:13] op_sel_hi:[1,0]
    v_cvt_pk_bf16_f32 v221, v220, v221
    v_lshlrev_b32 v220, 16, v221
    v_and_b32 v221, 0xffff0000, v221
    v_pk_mul_f32 v[220:221], v[220:221], v[14:15] op_sel_hi:[1,0]
    v_cvt_pk_bf16_f32 v62, v220, v221
    v_pk_add_f32 v[222:223], v[222:223], v[12:13] op_sel_hi:[1,0]
    v_cvt_pk_bf16_f32 v223, v222, v223
    v_lshlrev_b32 v222, 16, v223
    v_and_b32 v223, 0xffff0000, v223
    v_pk_mul_f32 v[222:223], v[222:223], v[14:15] op_sel_hi:[1,0]
    v_cvt_pk_bf16_f32 v63, v222, v223
    global_store_dwordx4 v10, v[60:63], s[42:43] offset:-1024 sc1
    v_pk_add_f32 v[224:225], v[224:225], v[12:13] op_sel_hi:[1,0]
    v_cvt_pk_bf16_f32 v225, v224, v225
    v_lshlrev_b32 v224, 16, v225
    v_and_b32 v225, 0xffff0000, v225
    v_pk_mul_f32 v[224:225], v[224:225], v[14:15] op_sel_hi:[1,0]
    v_cvt_pk_bf16_f32 v64, v224, v225
    v_pk_add_f32 v[226:227], v[226:227], v[12:13] op_sel_hi:[1,0]
    v_cvt_pk_bf16_f32 v227, v226, v227
    v_lshlrev_b32 v226, 16, v227
    v_and_b32 v227, 0xffff0000, v227
    v_pk_mul_f32 v[226:227], v[226:227], v[14:15] op_sel_hi:[1,0]
    v_cvt_pk_bf16_f32 v65, v226, v227
    v_pk_add_f32 v[228:229], v[228:229], v[12:13] op_sel_hi:[1,0]
    v_cvt_pk_bf16_f32 v229, v228, v229
    v_lshlrev_b32 v228, 16, v229
    v_and_b32 v229, 0xffff0000, v229
    v_pk_mul_f32 v[228:229], v[228:229], v[14:15] op_sel_hi:[1,0]
    v_cvt_pk_bf16_f32 v66, v228, v229
    v_pk_add_f32 v[230:231], v[230:231], v[12:13] op_sel_hi:[1,0]
    v_cvt_pk_bf16_f32 v231, v230, v231
    v_lshlrev_b32 v230, 16, v231
    v_and_b32 v231, 0xffff0000, v231
    v_pk_mul_f32 v[230:231], v[230:231], v[14:15] op_sel_hi:[1,0]
    v_cvt_pk_bf16_f32 v67, v230, v231
    global_store_dwordx4 v10, v[64:67], s[42:43] offset:0 sc1
    v_pk_add_f32 v[232:233], v[232:233], v[12:13] op_sel_hi:[1,0]
    v_cvt_pk_bf16_f32 v233, v232, v233
    v_lshlrev_b32 v232, 16, v233
    v_and_b32 v233, 0xffff0000, v233
    v_pk_mul_f32 v[232:233], v[232:233], v[14:15] op_sel_hi:[1,0]
    v_cvt_pk_bf16_f32 v68, v232, v233
    v_pk_add_f32 v[234:235], v[234:235], v[12:13] op_sel_hi:[1,0]
    v_cvt_pk_bf16_f32 v235, v234, v235
    v_lshlrev_b32 v234, 16, v235
    v_and_b32 v235, 0xffff0000, v235
    v_pk_mul_f32 v[234:235], v[234:235], v[14:15] op_sel_hi:[1,0]
    v_cvt_pk_bf16_f32 v69, v234, v235
    v_pk_add_f32 v[236:237], v[236:237], v[12:13] op_sel_hi:[1,0]
    v_cvt_pk_bf16_f32 v237, v236, v237
    v_lshlrev_b32 v236, 16, v237
    v_and_b32 v237, 0xffff0000, v237
    v_pk_mul_f32 v[236:237], v[236:237], v[14:15] op_sel_hi:[1,0]
    v_cvt_pk_bf16_f32 v70, v236, v237
    v_pk_add_f32 v[238:239], v[238:239], v[12:13] op_sel_hi:[1,0]
    v_cvt_pk_bf16_f32 v239, v238, v239
    v_lshlrev_b32 v238, 16, v239
    v_and_b32 v239, 0xffff0000, v239
    v_pk_mul_f32 v[238:239], v[238:239], v[14:15] op_sel_hi:[1,0]
    v_cvt_pk_bf16_f32 v71, v238, v239
    global_store_dwordx4 v10, v[68:71], s[42:43] offset:1024 sc1
    v_pk_add_f32 v[240:241], v[240:241], v[12:13] op_sel_hi:[1,0]
    v_cvt_pk_bf16_f32 v241, v240, v241
    v_lshlrev_b32 v240, 16, v241
    v_and_b32 v241, 0xffff0000, v241
    v_pk_mul_f32 v[240:241], v[240:241], v[14:15] op_sel_hi:[1,0]
    v_cvt_pk_bf16_f32 v72, v240, v241
    v_pk_add_f32 v[242:243], v[242:243], v[12:13] op_sel_hi:[1,0]
    v_cvt_pk_bf16_f32 v243, v242, v243
    v_lshlrev_b32 v242, 16, v243
    v_and_b32 v243, 0xffff0000, v243
    v_pk_mul_f32 v[242:243], v[242:243], v[14:15] op_sel_hi:[1,0]
    v_cvt_pk_bf16_f32 v73, v242, v243
    v_pk_add_f32 v[244:245], v[244:245], v[12:13] op_sel_hi:[1,0]
    v_cvt_pk_bf16_f32 v245, v244, v245
    v_lshlrev_b32 v244, 16, v245
    v_and_b32 v245, 0xffff0000, v245
    v_pk_mul_f32 v[244:245], v[244:245], v[14:15] op_sel_hi:[1,0]
    v_cvt_pk_bf16_f32 v74, v244, v245
    v_pk_add_f32 v[246:247], v[246:247], v[12:13] op_sel_hi:[1,0]
    v_cvt_pk_bf16_f32 v247, v246, v247
    v_lshlrev_b32 v246, 16, v247
    v_and_b32 v247, 0xffff0000, v247
    v_pk_mul_f32 v[246:247], v[246:247], v[14:15] op_sel_hi:[1,0]
    v_cvt_pk_bf16_f32 v75, v246, v247
    global_store_dwordx4 v10, v[72:75], s[42:43] offset:2048 sc1
    v_pk_add_f32 v[248:249], v[248:249], v[12:13] op_sel_hi:[1,0]
    v_cvt_pk_bf16_f32 v249, v248, v249
    v_lshlrev_b32 v248, 16, v249
    v_and_b32 v249, 0xffff0000, v249
    v_pk_mul_f32 v[248:249], v[248:249], v[14:15] op_sel_hi:[1,0]
    v_cvt_pk_bf16_f32 v76, v248, v249
    v_pk_add_f32 v[250:251], v[250:251], v[12:13] op_sel_hi:[1,0]
    v_cvt_pk_bf16_f32 v251, v250, v251
    v_lshlrev_b32 v250, 16, v251
    v_and_b32 v251, 0xffff0000, v251
    v_pk_mul_f32 v[250:251], v[250:251], v[14:15] op_sel_hi:[1,0]
    v_cvt_pk_bf16_f32 v77, v250, v251
    v_pk_add_f32 v[252:253], v[252:253], v[12:13] op_sel_hi:[1,0]
    v_cvt_pk_bf16_f32 v253, v252, v253
    v_lshlrev_b32 v252, 16, v253
    v_and_b32 v253, 0xffff0000, v253
    v_pk_mul_f32 v[252:253], v[252:253], v[14:15] op_sel_hi:[1,0]
    v_cvt_pk_bf16_f32 v78, v252, v253
    v_pk_add_f32 v[254:255], v[254:255], v[12:13] op_sel_hi:[1,0]
    v_cvt_pk_bf16_f32 v255, v254, v255
    v_lshlrev_b32 v254, 16, v255
    v_and_b32 v255, 0xffff0000, v255
    v_pk_mul_f32 v[254:255], v[254:255], v[14:15] op_sel_hi:[1,0]
    v_cvt_pk_bf16_f32 v79, v254, v255
    global_store_dwordx4 v10, v[76:79], s[42:43] offset:3072 sc1
    s_waitcnt vmcnt(0)
    s_barrier
    s_cmp_lg_u32 s9, 0
    s_cbranch_scc1 Llns_3
    v_mov_b32 v7, 128
    v_mov_b32 v8, 1
    s_mov_b64 exec, 1
    global_atomic_add v7, v8, s[6:7] sc1
    s_mov_b64 exec, -1
Llns_3:
L_role:
    s_lshl_b32 s36, s3, 2
    s_lshr_b32 s36, 0x49382100, s36
    s_and_b32 s36, s36, 15
    s_cmp_gt_u32 s36, 7
    s_cbranch_scc1 L_qkv
    s_cmp_eq_u32 s36, 3
    s_cbranch_scc1 L_attn
    s_cmp_eq_u32 s36, 4
    s_cbranch_scc1 L_ffn
L_final:
    s_load_dwordx2 s[40:41], s[0:1], 40
    s_load_dwordx2 s[42:43], s[0:1], 80
    s_load_dwordx2 s[44:45], s[0:1], 0
    s_load_dwordx2 s[46:47], s[0:1], 88
    v_and_b32 v1, 63, v0
    v_lshrrev_b32 v2, 4, v1
    v_and_b32 v3, 15, v1
    v_lshrrev_b32 v4, 2, v3
    v_and_b32 v5, 3, v1
    s_lshl_b32 s48, s9, 15
    s_and_b32 s56, s8, 15
    s_lshl_b32 s56, s56, 6
    v_mov_b32 v6, s56
    s_lshl_b32 s57, s9, 20
    s_mul_i32 s58, s9, 458752
    s_waitcnt lgkmcnt(0)
    s_add_u32 s40, s40, s57
    s_addc_u32 s41, s41, 0
    s_add_u32 s42, s42, s58
    s_addc_u32 s43, s43, 0
    s_cmp_lg_u32 s9, 0
    s_cbranch_scc1 Lgs_5
    v_mov_b32 v21, 160
Lgo_4:
    global_load_dword v20, v21, s[6:7] sc1
    s_sub_u32 s27, s27, 1
    s_cbranch_scc1 L_fin
    s_waitcnt vmcnt(0)
    v_cmp_gt_u32 vcc, 1, v20
    s_cbranch_vccnz Lgo_4
Lgs_5:
    s_barrier
    v_lshrrev_b32 v7, 2, v1
    v_mul_u32_u24 v7, 1024, v7
    v_add_u32 v6, v6, v7
    v_lshl_add_u32 v6, v5, 4, v6
    v_lshl_add_u32 v7, v2, 3, v4
    v_lshlrev_b32 v7, 6, v7
    v_add_u32 v7, s48, v7
    v_lshl_add_u32 v8, v5, 3, v7
    v_lshl_add_u32 v9, v5, 4, v7
    s_add_u32 m0, s48, 0
    v_add_u32 v7, 0, v6
    global_load_lds_dwordx4 v7, s[42:43]
    s_add_u32 m0, s48, 1024
    v_add_u32 v7, 16384, v6
    global_load_lds_dwordx4 v7, s[42:43]
    s_add_u32 m0, s48, 2048
    v_add_u32 v7, 32768, v6
    global_load_lds_dwordx4 v7, s[42:43]
    s_add_u32 m0, s48, 3072
    v_add_u32 v7, 49152, v6
    global_load_lds_dwordx4 v7, s[42:43]
    s_add_u32 m0, s48, 4096
    v_add_u32 v7, 65536, v6
    global_load_lds_dwordx4 v7, s[42:43]
    s_add_u32 m0, s48, 5120
    v_add_u32 v7, 81920, v6
    global_load_lds_dwordx4 v7, s[42:43]
    s_add_u32 m0, s48, 6144
    v_add_u32 v7, 98304, v6
    global_load_lds_dwordx4 v7, s[42:43]
    s_add_u32 m0, s48, 7168
    v_add_u32 v7, 114688, v6
    global_load_lds_dwordx4 v7, s[42:43]
    s_add_u32 m0, s48, 8192
    v_add_u32 v7, 131072, v6
    global_load_lds_dwordx4 v7, s[42:43]
    s_add_u32 m0, s48, 9216
    v_add_u32 v7, 147456, v6
    global_load_lds_dwordx4 v7, s[42:43]
    s_add_u32 m0, s48, 10240
    v_add_u32 v7, 163840, v6
    global_load_lds_dwordx4 v7, s[42:43]
    s_add_u32 m0, s48, 11264
    v_add_u32 v7, 180224, v6
    global_load_lds_dwordx4 v7, s[42:43]
    s_add_u32 m0, s48, 12288
    v_add_u32 v7, 196608, v6
    global_load_lds_dwordx4 v7, s[42:43]
    s_add_u32 m0, s48, 13312
    v_add_u32 v7, 212992, v6
    global_load_lds_dwordx4 v7, s[42:43]
    s_add_u32 m0, s48, 14336
    v_add_u32 v7, 229376, v6
    global_load_lds_dwordx4 v7, s[42:43]
    s_add_u32 m0, s48, 15360
    v_add_u32 v7, 245760, v6
    global_load_lds_dwordx4 v7, s[42:43]
    s_add_u32 m0, s48, 16384
    v_add_u32 v7, 262144, v6
    global_load_lds_dwordx4 v7, s[42:43]
    s_add_u32 m0, s48, 17408
    v_add_u32 v7, 278528, v6
    global_load_lds_dwordx4 v7, s[42:43]
    s_add_u32 m0, s48, 18432
    v_add_u32 v7, 294912, v6
    global_load_lds_dwordx4 v7, s[42:43]
    s_add_u32 m0, s48, 19456
    v_add_u32 v7, 311296, v6
    global_load_lds_dwordx4 v7, s[42:43]
    s_add_u32 m0, s48, 20480
    v_add_u32 v7, 327680, v6
    global_load_lds_dwordx4 v7, s[42:43]
    s_add_u32 m0, s48, 21504
    v_add_u32 v7, 344064, v6
    global_load_lds_dwordx4 v7, s[42:43]
    s_add_u32 m0, s48, 22528
    v_add_u32 v7, 360448, v6
    global_load_lds_dwordx4 v7, s[42:43]
    s_add_u32 m0, s48, 23552
    v_add_u32 v7, 376832, v6
    global_load_lds_dwordx4 v7, s[42:43]
    s_add_u32 m0, s48, 24576
    v_add_u32 v7, 393216, v6
    global_load_lds_dwordx4 v7, s[42:43]
    s_add_u32 m0, s48, 25600
    v_add_u32 v7, 409600, v6
    global_load_lds_dwordx4 v7, s[42:43]
    s_add_u32 m0, s48, 26624
    v_add_u32 v7, 425984, v6
    global_load_lds_dwordx4 v7, s[42:43]
    s_add_u32 m0, s48, 27648
    v_add_u32 v7, 442368, v6
    global_load_lds_dwordx4 v7, s[42:43]
    s_add_u32 m0, s48, 28672
    v_add_u32 v7, 0, v6
    global_load_lds_dwordx4 v7, s[40:41]
    s_add_u32 m0, s48, 29696
    v_add_u32 v7, 16384, v6
    global_load_lds_dwordx4 v7, s[40:41]
    s_add_u32 m0, s48, 30720
    v_add_u32 v7, 32768, v6
    global_load_lds_dwordx4 v7, s[40:41]
    s_add_u32 m0, s48, 31744
    v_add_u32 v7, 49152, v6
    global_load_lds_dwordx4 v7, s[40:41]
    s_waitcnt vmcnt(28)
    ds_read_b64_tr_b16 v[144:145], v9 offset:0
    ds_read_b64_tr_b16 v[146:147], v9 offset:256
    ds_read_b64_tr_b16 v[148:149], v9 offset:2048
    ds_read_b64_tr_b16 v[150:151], v9 offset:2304
    ds_read_b64_tr_b16 v[200:201], v9 offset:8
    ds_read_b64_tr_b16 v[202:203], v9 offset:264
    ds_read_b64_tr_b16 v[204:205], v9 offset:2056
    ds_read_b64_tr_b16 v[206:207], v9 offset:2312
    s_waitcnt lgkmcnt(0)
    s_add_u32 m0, s48, 0
    v_add_u32 v7, 65536, v6
    global_load_lds_dwordx4 v7, s[40:41]
    s_add_u32 m0, s48, 1024
    v_add_u32 v7, 81920, v6
    global_load_lds_dwordx4 v7, s[40:41]
    s_add_u32 m0, s48, 2048
    v_add_u32 v7, 98304, v6
    global_load_lds_dwordx4 v7, s[40:41]
    s_add_u32 m0, s48, 3072
    v_add_u32 v7, 114688, v6
    global_load_lds_dwordx4 v7, s[40:41]
    s_waitcnt vmcnt(28)
    ds_read_b64_tr_b16 v[152:153], v9 offset:4096
    ds_read_b64_tr_b16 v[154:155], v9 offset:4352
    ds_read_b64_tr_b16 v[156:157], v9 offset:6144
    ds_read_b64_tr_b16 v[158:159], v9 offset:6400
    ds_read_b64_tr_b16 v[208:209], v9 offset:4104
    ds_read_b64_tr_b16 v[210:211], v9 offset:4360
    ds_read_b64_tr_b16 v[212:213], v9 offset:6152
    ds_read_b64_tr_b16 v[214:215], v9 offset:6408
    s_waitcnt lgkmcnt(0)
    s_add_u32 m0, s48, 4096
    v_add_u32 v7, 131072, v6
    global_load_lds_dwordx4 v7, s[40:41]
    s_add_u32 m0, s48, 5120
    v_add_u32 v7, 147456, v6
    global_load_lds_dwordx4 v7, s[40:41]
    s_add_u32 m0, s48, 6144
    v_add_u32 v7, 163840, v6
    global_load_lds_dwordx4 v7, s[40:41]
    s_add_u32 m0, s48, 7168
    v_add_u32 v7, 180224, v6
    global_load_lds_dwordx4 v7, s[40:41]
    s_waitcnt vmcnt(28)
    ds_read_b64_tr_b16 v[160:161], v9 offset:8192
    ds_read_b64_tr_b16 v[162:163], v9 offset:8448
    ds_read_b64_tr_b16 v[164:165], v9 offset:10240
    ds_read_b64_tr_b16 v[166:167], v9 offset:10496
    ds_read_b64_tr_b16 v[216:217], v9 offset:8200
    ds_read_b64_tr_b16 v[218:219], v9 offset:8456
    ds_read_b64_tr_b16 v[220:221], v9 offset:10248
    ds_read_b64_tr_b16 v[222:223], v9 offset:10504
    s_waitcnt lgkmcnt(0)
    s_add_u32 m0, s48, 8192
    v_add_u32 v7, 196608, v6
    global_load_lds_dwordx4 v7, s[40:41]
    s_add_u32 m0, s48, 9216
    v_add_u32 v7, 212992, v6
    global_load_lds_dwordx4 v7, s[40:41]
    s_add_u32 m0, s48, 10240
    v_add_u32 v7, 229376, v6
    global_load_lds_dwordx4 v7, s[40:41]
    s_add_u32 m0, s48, 11264
    v_add_u32 v7, 245760, v6
    global_load_lds_dwordx4 v7, s[40:41]
    s_waitcnt vmcnt(28)
    ds_read_b64_tr_b16 v[168:169], v9 offset:12288
    ds_read_b64_tr_b16 v[170:171], v9 offset:12544
    ds_read_b64_tr_b16 v[172:173], v9 offset:14336
    ds_read_b64_tr_b16 v[174:175], v9 offset:14592
    ds_read_b64_tr_b16 v[224:225], v9 offset:12296
    ds_read_b64_tr_b16 v[226:227], v9 offset:12552
    ds_read_b64_tr_b16 v[228:229], v9 offset:14344
    ds_read_b64_tr_b16 v[230:231], v9 offset:14600
    s_waitcnt lgkmcnt(0)
    s_add_u32 m0, s48, 12288
    v_add_u32 v7, 262144, v6
    global_load_lds_dwordx4 v7, s[40:41]
    s_add_u32 m0, s48, 13312
    v_add_u32 v7, 278528, v6
    global_load_lds_dwordx4 v7, s[40:41]
    s_add_u32 m0, s48, 14336
    v_add_u32 v7, 294912, v6
    global_load_lds_dwordx4 v7, s[40:41]
    s_add_u32 m0, s48, 15360
    v_add_u32 v7, 311296, v6
    global_load_lds_dwordx4 v7, s[40:41]
    s_waitcnt vmcnt(28)
    ds_read_b64_tr_b16 v[176:177], v9 offset:16384
    ds_read_b64_tr_b16 v[178:179], v9 offset:16640
    ds_read_b64_tr_b16 v[180:181], v9 offset:18432
    ds_read_b64_tr_b16 v[182:183], v9 offset:18688
    ds_read_b64_tr_b16 v[232:233], v9 offset:16392
    ds_read_b64_tr_b16 v[234:235], v9 offset:16648
    ds_read_b64_tr_b16 v[236:237], v9 offset:18440
    ds_read_b64_tr_b16 v[238:239], v9 offset:18696
    s_waitcnt lgkmcnt(0)
    s_add_u32 m0, s48, 16384
    v_add_u32 v7, 327680, v6
    global_load_lds_dwordx4 v7, s[40:41]
    s_add_u32 m0, s48, 17408
    v_add_u32 v7, 344064, v6
    global_load_lds_dwordx4 v7, s[40:41]
    s_add_u32 m0, s48, 18432
    v_add_u32 v7, 360448, v6
    global_load_lds_dwordx4 v7, s[40:41]
    s_add_u32 m0, s48, 19456
    v_add_u32 v7, 376832, v6
    global_load_lds_dwordx4 v7, s[40:41]
    s_waitcnt vmcnt(28)
    ds_read_b64_tr_b16 v[184:185], v9 offset:20480
    ds_read_b64_tr_b16 v[186:187], v9 offset:20736
    ds_read_b64_tr_b16 v[188:189], v9 offset:22528
    ds_read_b64_tr_b16 v[190:191], v9 offset:22784
    ds_read_b64_tr_b16 v[240:241], v9 offset:20488
    ds_read_b64_tr_b16 v[242:243], v9 offset:20744
    ds_read_b64_tr_b16 v[244:245], v9 offset:22536
    ds_read_b64_tr_b16 v[246:247], v9 offset:22792
    s_waitcnt lgkmcnt(0)
    s_add_u32 m0, s48, 20480
    v_add_u32 v7, 393216, v6
    global_load_lds_dwordx4 v7, s[40:41]
    s_add_u32 m0, s48, 21504
    v_add_u32 v7, 409600, v6
    global_load_lds_dwordx4 v7, s[40:41]
    s_add_u32 m0, s48, 22528
    v_add_u32 v7, 425984, v6
    global_load_lds_dwordx4 v7, s[40:41]
    s_add_u32 m0, s48, 23552
    v_add_u32 v7, 442368, v6
    global_load_lds_dwordx4 v7, s[40:41]
    s_waitcnt vmcnt(28)
    ds_read_b64_tr_b16 v[192:193], v9 offset:24576
    ds_read_b64_tr_b16 v[194:195], v9 offset:24832
    ds_read_b64_tr_b16 v[196:197], v9 offset:26624
    ds_read_b64_tr_b16 v[198:199], v9 offset:26880
    ds_read_b64_tr_b16 v[248:249], v9 offset:24584
    ds_read_b64_tr_b16 v[250:251], v9 offset:24840
    ds_read_b64_tr_b16 v[252:253], v9 offset:26632
    ds_read_b64_tr_b16 v[254:255], v9 offset:26888
    s_waitcnt lgkmcnt(0)
    s_add_u32 m0, s48, 24576
    v_add_u32 v7, 458752, v6
    global_load_lds_dwordx4 v7, s[40:41]
    s_add_u32 m0, s48, 25600
    v_add_u32 v7, 475136, v6
    global_load_lds_dwordx4 v7, s[40:41]
    s_add_u32 m0, s48, 26624
    v_add_u32 v7, 491520, v6
    global_load_lds_dwordx4 v7, s[40:41]
    s_add_u32 m0, s48, 27648
    v_add_u32 v7, 507904, v6
    global_load_lds_dwordx4 v7, s[40:41]
    s_waitcnt vmcnt(28)
    ds_read_b64_tr_b16 a[0:1], v9 offset:28672
    ds_read_b64_tr_b16 a[2:3], v9 offset:28928
    ds_read_b64_tr_b16 a[4:5], v9 offset:30720
    ds_read_b64_tr_b16 a[6:7], v9 offset:30976
    ds_read_b64_tr_b16 a[128:129], v9 offset:28680
    ds_read_b64_tr_b16 a[130:131], v9 offset:28936
    ds_read_b64_tr_b16 a[132:133], v9 offset:30728
    ds_read_b64_tr_b16 a[134:135], v9 offset:30984
    s_waitcnt lgkmcnt(0)
    s_add_u32 m0, s48, 28672
    v_add_u32 v7, 524288, v6
    global_load_lds_dwordx4 v7, s[40:41]
    s_add_u32 m0, s48, 29696
    v_add_u32 v7, 540672, v6
    global_load_lds_dwordx4 v7, s[40:41]
    s_add_u32 m0, s48, 30720
    v_add_u32 v7, 557056, v6
    global_load_lds_dwordx4 v7, s[40:41]
    s_add_u32 m0, s48, 31744
    v_add_u32 v7, 573440, v6
    global_load_lds_dwordx4 v7, s[40:41]
    s_waitcnt vmcnt(28)
    ds_read_b64_tr_b16 a[8:9], v9 offset:0
    ds_read_b64_tr_b16 a[10:11], v9 offset:256
    ds_read_b64_tr_b16 a[12:13], v9 offset:2048
    ds_read_b64_tr_b16 a[14:15], v9 offset:2304
    ds_read_b64_tr_b16 a[136:137], v9 offset:8
    ds_read_b64_tr_b16 a[138:139], v9 offset:264
    ds_read_b64_tr_b16 a[140:141], v9 offset:2056
    ds_read_b64_tr_b16 a[142:143], v9 offset:2312
    s_waitcnt lgkmcnt(0)
    s_add_u32 m0, s48, 0
    v_add_u32 v7, 589824, v6
    global_load_lds_dwordx4 v7, s[40:41]
    s_add_u32 m0, s48, 1024
    v_add_u32 v7, 606208, v6
    global_load_lds_dwordx4 v7, s[40:41]
    s_add_u32 m0, s48, 2048
    v_add_u32 v7, 622592, v6
    global_load_lds_dwordx4 v7, s[40:41]
    s_add_u32 m0, s48, 3072
    v_add_u32 v7, 638976, v6
    global_load_lds_dwordx4 v7, s[40:41]
    s_waitcnt vmcnt(28)
    ds_read_b64_tr_b16 a[16:17], v9 offset:4096
    ds_read_b64_tr_b16 a[18:19], v9 offset:4352
    ds_read_b64_tr_b16 a[20:21], v9 offset:6144
    ds_read_b64_tr_b16 a[22:23], v9 offset:6400
    ds_read_b64_tr_b16 a[144:145], v9 offset:4104
    ds_read_b64_tr_b16 a[146:147], v9 offset:4360
    ds_read_b64_tr_b16 a[148:149], v9 offset:6152
    ds_read_b64_tr_b16 a[150:151], v9 offset:6408
    s_waitcnt lgkmcnt(0)
    s_add_u32 m0, s48, 4096
    v_add_u32 v7, 655360, v6
    global_load_lds_dwordx4 v7, s[40:41]
    s_add_u32 m0, s48, 5120
    v_add_u32 v7, 671744, v6
    global_load_lds_dwordx4 v7, s[40:41]
    s_add_u32 m0, s48, 6144
    v_add_u32 v7, 688128, v6
    global_load_lds_dwordx4 v7, s[40:41]
    s_add_u32 m0, s48, 7168
    v_add_u32 v7, 704512, v6
    global_load_lds_dwordx4 v7, s[40:41]
    s_waitcnt vmcnt(28)
    ds_read_b64_tr_b16 a[24:25], v9 offset:8192
    ds_read_b64_tr_b16 a[26:27], v9 offset:8448
    ds_read_b64_tr_b16 a[28:29], v9 offset:10240
    ds_read_b64_tr_b16 a[30:31], v9 offset:10496
    ds_read_b64_tr_b16 a[152:153], v9 offset:8200
    ds_read_b64_tr_b16 a[154:155], v9 offset:8456
    ds_read_b64_tr_b16 a[156:157], v9 offset:10248
    ds_read_b64_tr_b16 a[158:159], v9 offset:10504
    s_waitcnt lgkmcnt(0)
    s_add_u32 m0, s48, 8192
    v_add_u32 v7, 720896, v6
    global_load_lds_dwordx4 v7, s[40:41]
    s_add_u32 m0, s48, 9216
    v_add_u32 v7, 737280, v6
    global_load_lds_dwordx4 v7, s[40:41]
    s_add_u32 m0, s48, 10240
    v_add_u32 v7, 753664, v6
    global_load_lds_dwordx4 v7, s[40:41]
    s_add_u32 m0, s48, 11264
    v_add_u32 v7, 770048, v6
    global_load_lds_dwordx4 v7, s[40:41]
    s_waitcnt vmcnt(28)
    ds_read_b64_tr_b16 a[32:33], v9 offset:12288
    ds_read_b64_tr_b16 a[34:35], v9 offset:12544
    ds_read_b64_tr_b16 a[36:37], v9 offset:14336
    ds_read_b64_tr_b16 a[38:39], v9 offset:14592
    ds_read_b64_tr_b16 a[160:161], v9 offset:12296
    ds_read_b64_tr_b16 a[162:163], v9 offset:12552
    ds_read_b64_tr_b16 a[164:165], v9 offset:14344
    ds_read_b64_tr_b16 a[166:167], v9 offset:14600
    s_waitcnt lgkmcnt(0)
    s_add_u32 m0, s48, 12288
    v_add_u32 v7, 786432, v6
    global_load_lds_dwordx4 v7, s[40:41]
    s_add_u32 m0, s48, 13312
    v_add_u32 v7, 802816, v6
    global_load_lds_dwordx4 v7, s[40:41]
    s_add_u32 m0, s48, 14336
    v_add_u32 v7, 819200, v6
    global_load_lds_dwordx4 v7, s[40:41]
    s_add_u32 m0, s48, 15360
    v_add_u32 v7, 835584, v6
    global_load_lds_dwordx4 v7, s[40:41]
    s_waitcnt vmcnt(28)
    ds_read_b64_tr_b16 a[40:41], v9 offset:16384
    ds_read_b64_tr_b16 a[42:43], v9 offset:16640
    ds_read_b64_tr_b16 a[44:45], v9 offset:18432
    ds_read_b64_tr_b16 a[46:47], v9 offset:18688
    ds_read_b64_tr_b16 a[168:169], v9 offset:16392
    ds_read_b64_tr_b16 a[170:171], v9 offset:16648
    ds_read_b64_tr_b16 a[172:173], v9 offset:18440
    ds_read_b64_tr_b16 a[174:175], v9 offset:18696
    s_waitcnt lgkmcnt(0)
    s_add_u32 m0, s48, 16384
    v_add_u32 v7, 851968, v6
    global_load_lds_dwordx4 v7, s[40:41]
    s_add_u32 m0, s48, 17408
    v_add_u32 v7, 868352, v6
    global_load_lds_dwordx4 v7, s[40:41]
    s_add_u32 m0, s48, 18432
    v_add_u32 v7, 884736, v6
    global_load_lds_dwordx4 v7, s[40:41]
    s_add_u32 m0, s48, 19456
    v_add_u32 v7, 901120, v6
    global_load_lds_dwordx4 v7, s[40:41]
    s_waitcnt vmcnt(28)
    ds_read_b64_tr_b16 a[48:49], v9 offset:20480
    ds_read_b64_tr_b16 a[50:51], v9 offset:20736
    ds_read_b64_tr_b16 a[52:53], v9 offset:22528
    ds_read_b64_tr_b16 a[54:55], v9 offset:22784
    ds_read_b64_tr_b16 a[176:177], v9 offset:20488
    ds_read_b64_tr_b16 a[178:179], v9 offset:20744
    ds_read_b64_tr_b16 a[180:181], v9 offset:22536
    ds_read_b64_tr_b16 a[182:183], v9 offset:22792
    s_waitcnt lgkmcnt(0)
    s_add_u32 m0, s48, 20480
    v_add_u32 v7, 917504, v6
    global_load_lds_dwordx4 v7, s[40:41]
    s_add_u32 m0, s48, 21504
    v_add_u32 v7, 933888, v6
    global_load_lds_dwordx4 v7, s[40:41]
    s_add_u32 m0, s48, 22528
    v_add_u32 v7, 950272, v6
    global_load_lds_dwordx4 v7, s[40:41]
    s_add_u32 m0, s48, 23552
    v_add_u32 v7, 966656, v6
    global_load_lds_dwordx4 v7, s[40:41]
    s_waitcnt vmcnt(28)
    ds_read_b64_tr_b16 a[56:57], v9 offset:24576
    ds_read_b64_tr_b16 a[58:59], v9 offset:24832
    ds_read_b64_tr_b16 a[60:61], v9 offset:26624
    ds_read_b64_tr_b16 a[62:63], v9 offset:26880
    ds_read_b64_tr_b16 a[184:185], v9 offset:24584
    ds_read_b64_tr_b16 a[186:187], v9 offset:24840
    ds_read_b64_tr_b16 a[188:189], v9 offset:26632
    ds_read_b64_tr_b16 a[190:191], v9 offset:26888
    s_waitcnt lgkmcnt(0)
    s_add_u32 m0, s48, 24576
    v_add_u32 v7, 983040, v6
    global_load_lds_dwordx4 v7, s[40:41]
    s_add_u32 m0, s48, 25600
    v_add_u32 v7, 999424, v6
    global_load_lds_dwordx4 v7, s[40:41]
    s_add_u32 m0, s48, 26624
    v_add_u32 v7, 1015808, v6
    global_load_lds_dwordx4 v7, s[40:41]
    s_add_u32 m0, s48, 27648
    v_add_u32 v7, 1032192, v6
    global_load_lds_dwordx4 v7, s[40:41]
    s_waitcnt vmcnt(28)
    ds_read_b64_tr_b16 a[64:65], v9 offset:28672
    ds_read_b64_tr_b16 a[66:67], v9 offset:28928
    ds_read_b64_tr_b16 a[68:69], v9 offset:30720
    ds_read_b64_tr_b16 a[70:71], v9 offset:30976
    ds_read_b64_tr_b16 a[192:193], v9 offset:28680
    ds_read_b64_tr_b16 a[194:195], v9 offset:28936
    ds_read_b64_tr_b16 a[196:197], v9 offset:30728
    ds_read_b64_tr_b16 a[198:199], v9 offset:30984
    s_waitcnt vmcnt(24)
    ds_read_b64_tr_b16 a[72:73], v9 offset:0
    ds_read_b64_tr_b16 a[74:75], v9 offset:256
    ds_read_b64_tr_b16 a[76:77], v9 offset:2048
    ds_read_b64_tr_b16 a[78:79], v9 offset:2304
    ds_read_b64_tr_b16 a[200:201], v9 offset:8
    ds_read_b64_tr_b16 a[202:203], v9 offset:264
    ds_read_b64_tr_b16 a[204:205], v9 offset:2056
    ds_read_b64_tr_b16 a[206:207], v9 offset:2312
    s_waitcnt vmcnt(20)
    ds_read_b64_tr_b16 a[80:81], v9 offset:4096
    ds_read_b64_tr_b16 a[82:83], v9 offset:4352
    ds_read_b64_tr_b16 a[84:85], v9 offset:6144
    ds_read_b64_tr_b16 a[86:87], v9 offset:6400
    ds_read_b64_tr_b16 a[208:209], v9 offset:4104
    ds_read_b64_tr_b16 a[210:211], v9 offset:4360
    ds_read_b64_tr_b16 a[212:213], v9 offset:6152
    ds_read_b64_tr_b16 a[214:215], v9 offset:6408
    s_waitcnt vmcnt(16)
    ds_read_b64_tr_b16 a[88:89], v9 offset:8192
    ds_read_b64_tr_b16 a[90:91], v9 offset:8448
    ds_read_b64_tr_b16 a[92:93], v9 offset:10240
    ds_read_b64_tr_b16 a[94:95], v9 offset:10496
    ds_read_b64_tr_b16 a[216:217], v9 offset:8200
    ds_read_b64_tr_b16 a[218:219], v9 offset:8456
    ds_read_b64_tr_b16 a[220:221], v9 offset:10248
    ds_read_b64_tr_b16 a[222:223], v9 offset:10504
    s_waitcnt vmcnt(12)
    ds_read_b64_tr_b16 a[96:97], v9 offset:12288
    ds_read_b64_tr_b16 a[98:99], v9 offset:12544
    ds_read_b64_tr_b16 a[100:101], v9 offset:14336
    ds_read_b64_tr_b16 a[102:103], v9 offset:14592
    ds_read_b64_tr_b16 a[224:225], v9 offset:12296
    ds_read_b64_tr_b16 a[226:227], v9 offset:12552
    ds_read_b64_tr_b16 a[228:229], v9 offset:14344
    ds_read_b64_tr_b16 a[230:231], v9 offset:14600
    s_waitcnt vmcnt(8)
    ds_read_b64_tr_b16 a[104:105], v9 offset:16384
    ds_read_b64_tr_b16 a[106:107], v9 offset:16640
    ds_read_b64_tr_b16 a[108:109], v9 offset:18432
    ds_read_b64_tr_b16 a[110:111], v9 offset:18688
    ds_read_b64_tr_b16 a[232:233], v9 offset:16392
    ds_read_b64_tr_b16 a[234:235], v9 offset:16648
    ds_read_b64_tr_b16 a[236:237], v9 offset:18440
    ds_read_b64_tr_b16 a[238:239], v9 offset:18696
    s_waitcnt vmcnt(4)
    ds_read_b64_tr_b16 a[112:113], v9 offset:20480
    ds_read_b64_tr_b16 a[114:115], v9 offset:20736
    ds_read_b64_tr_b16 a[116:117], v9 offset:22528
    ds_read_b64_tr_b16 a[118:119], v9 offset:22784
    ds_read_b64_tr_b16 a[240:241], v9 offset:20488
    ds_read_b64_tr_b16 a[242:243], v9 offset:20744
    ds_read_b64_tr_b16 a[244:245], v9 offset:22536
    ds_read_b64_tr_b16 a[246:247], v9 offset:22792
    s_waitcnt vmcnt(0)
    ds_read_b64_tr_b16 a[120:121], v9 offset:24576
    ds_read_b64_tr_b16 a[122:123], v9 offset:24832
    ds_read_b64_tr_b16 a[124:125], v9 offset:26624
    ds_read_b64_tr_b16 a[126:127], v9 offset:26880
    ds_read_b64_tr_b16 a[248:249], v9 offset:24584
    ds_read_b64_tr_b16 a[250:251], v9 offset:24840
    ds_read_b64_tr_b16 a[252:253], v9 offset:26632
    ds_read_b64_tr_b16 a[254:255], v9 offset:26888
    s_waitcnt lgkmcnt(0)
    v_lshlrev_b32 v14, 4, v1
    v_add_u32 v6, 4096, v14
    v_add_u32 v7, 8192, v6
    v_add_u32 v8, 8192, v7
    v_add_u32 v9, 8192, v8
    s_lshl_b32 s57, s9, 11
    v_add_u32 v13, s57, v14
    s_lshr_b32 s57, s8, 4
    s_lshl_b32 s58, s57, 14
    s_add_u32 s58, s58, s56
    s_lshl_b32 s59, s36, 15
    s_add_u32 s58, s58, s59
    v_lshlrev_b32 v10, 10, v3
    v_lshl_add_u32 v10, v2, 4, v10
    v_add_u32 v10, s58, v10
    s_lshl_b32 s58, s36, 1
    s_add_u32 s58, s58, s57
    s_lshl_b32 s59, s58, 17
    s_lshl_b32 s60, s9, 15
    s_add_u32 s59, s59, s60
    s_add_u32 s59, s59, 83886080
    s_add_u32 s50, s4, s59
    s_addc_u32 s51, s5, 0
    s_lshl_b32 s59, s58, 16
    s_mul_i32 s60, s9, 14336
    s_add_u32 s59, s59, s60
    s_add_u32 s59, s59, 101711872
    s_add_u32 s52, s4, s59
    s_addc_u32 s53, s5, 0
    v_min_u32 v11, 13, v3
    v_lshlrev_b32 v11, 7, v11
    s_mul_i32 s60, s9, 1792
    s_add_u32 s60, s60, 794624
    v_add_u32 v11, s60, v11
    v_and_b32 v12, 7, v1
    v_lshlrev_b32 v12, 7, v12
    s_lshl_b32 s60, s9, 10
    s_add_u32 s60, s60, 811008
    v_add_u32 v12, s60, v12
    s_mov_b32 s49, s36
    s_barrier
    v_mov_b32 v2, 128
Lln_6:
    global_load_dword v1, v2, s[6:7] sc1
    s_sub_u32 s27, s27, 1
    s_cbranch_scc1 L_fin
    s_waitcnt vmcnt(0)
    v_cmp_gt_u32 vcc, 64, v1
    s_cbranch_vccnz Lln_6
Lfi_7:
    s_and_b32 s56, s49, 1
    s_lshl_b32 s56, s56, 13
    v_add_u32 v2, s56, v11
    s_lshr_b32 s54, s49, 1
    s_add_u32 s54, s54, 1
    global_load_dwordx4 v[16:19], v10, s[44:45]
    s_mov_b64 exec, 0xffff
Lpf_8:
    global_load_dword v1, v2, s[4:5] sc1
    s_sub_u32 s27, s27, 1
    s_cbranch_scc1 L_fin
    s_waitcnt vmcnt(0)
    v_cmp_gt_u32 vcc, s54, v1
    s_cbranch_vccnz Lpf_8
    s_mov_b64 exec, -1
    global_load_dwordx4 v[36:39], v6, s[52:53] offset:-4096 sc1
    global_load_dwordx4 v[40:43], v6, s[52:53] offset:-3072 sc1
    global_load_dwordx4 v[44:47], v6, s[52:53] offset:-2048 sc1
    global_load_dwordx4 v[48:51], v6, s[52:53] offset:-1024 sc1
    global_load_dwordx4 v[52:55], v6, s[52:53] offset:0 sc1
    global_load_dwordx4 v[56:59], v6, s[52:53] offset:1024 sc1
    global_load_dwordx4 v[60:63], v6, s[52:53] offset:2048 sc1
    global_load_dwordx4 v[64:67], v6, s[52:53] offset:3072 sc1
    global_load_dwordx4 v[68:71], v7, s[52:53] offset:-4096 sc1
    global_load_dwordx4 v[72:75], v7, s[52:53] offset:-3072 sc1
    global_load_dwordx4 v[76:79], v7, s[52:53] offset:-2048 sc1
    global_load_dwordx4 v[80:83], v7, s[52:53] offset:-1024 sc1
    global_load_dwordx4 v[84:87], v7, s[52:53] offset:0 sc1
    global_load_dwordx4 v[88:91], v7, s[52:53] offset:1024 sc1
    s_waitcnt vmcnt(13)
    v_mfma_f32_16x16x32_bf16 v[28:31], v[144:147], v[36:39], 0
    v_mfma_f32_16x16x32_bf16 v[32:35], v[200:203], v[36:39], 0
    s_waitcnt vmcnt(12)
    v_mfma_f32_16x16x32_bf16 v[28:31], v[148:151], v[40:43], v[28:31]
    v_mfma_f32_16x16x32_bf16 v[32:35], v[204:207], v[40:43], v[32:35]
    s_waitcnt vmcnt(11)
    v_mfma_f32_16x16x32_bf16 v[28:31], v[152:155], v[44:47], v[28:31]
    v_mfma_f32_16x16x32_bf16 v[32:35], v[208:211], v[44:47], v[32:35]
    s_waitcnt vmcnt(10)
    v_mfma_f32_16x16x32_bf16 v[28:31], v[156:159], v[48:51], v[28:31]
    v_mfma_f32_16x16x32_bf16 v[32:35], v[212:215], v[48:51], v[32:35]
    s_waitcnt vmcnt(9)
    v_mfma_f32_16x16x32_bf16 v[28:31], v[160:163], v[52:55], v[28:31]
    v_mfma_f32_16x16x32_bf16 v[32:35], v[216:219], v[52:55], v[32:35]
    s_waitcnt vmcnt(8)
    v_mfma_f32_16x16x32_bf16 v[28:31], v[164:167], v[56:59], v[28:31]
    v_mfma_f32_16x16x32_bf16 v[32:35], v[220:223], v[56:59], v[32:35]
    s_waitcnt vmcnt(7)
    v_mfma_f32_16x16x32_bf16 v[28:31], v[168:171], v[60:63], v[28:31]
    v_mfma_f32_16x16x32_bf16 v[32:35], v[224:227], v[60:63], v[32:35]
    s_waitcnt vmcnt(6)
    v_mfma_f32_16x16x32_bf16 v[28:31], v[172:175], v[64:67], v[28:31]
    v_mfma_f32_16x16x32_bf16 v[32:35], v[228:231], v[64:67], v[32:35]
    s_waitcnt vmcnt(5)
    v_mfma_f32_16x16x32_bf16 v[28:31], v[176:179], v[68:71], v[28:31]
    v_mfma_f32_16x16x32_bf16 v[32:35], v[232:235], v[68:71], v[32:35]
    s_waitcnt vmcnt(4)
    v_mfma_f32_16x16x32_bf16 v[28:31], v[180:183], v[72:75], v[28:31]
    v_mfma_f32_16x16x32_bf16 v[32:35], v[236:239], v[72:75], v[32:35]
    s_waitcnt vmcnt(3)
    v_mfma_f32_16x16x32_bf16 v[28:31], v[184:187], v[76:79], v[28:31]
    v_mfma_f32_16x16x32_bf16 v[32:35], v[240:243], v[76:79], v[32:35]
    s_waitcnt vmcnt(2)
    v_mfma_f32_16x16x32_bf16 v[28:31], v[188:191], v[80:83], v[28:31]
    v_mfma_f32_16x16x32_bf16 v[32:35], v[244:247], v[80:83], v[32:35]
    s_waitcnt vmcnt(1)
    v_mfma_f32_16x16x32_bf16 v[28:31], v[192:195], v[84:87], v[28:31]
    v_mfma_f32_16x16x32_bf16 v[32:35], v[248:251], v[84:87], v[32:35]
    s_waitcnt vmcnt(0)
    v_mfma_f32_16x16x32_bf16 v[28:31], v[196:199], v[88:91], v[28:31]
    v_mfma_f32_16x16x32_bf16 v[32:35], v[252:255], v[88:91], v[32:35]
    s_nop 3
    ds_write_b128 v13, v[28:31] offset:0
    s_nop 2
    ds_write_b128 v13, v[32:35] offset:1024
    s_waitcnt lgkmcnt(0)
    s_barrier
    s_cmp_lg_u32 s9, 0
    s_cbranch_scc1 Lf1_9
    ds_read_b128 v[36:39], v14 offset:2048
    ds_read_b128 v[40:43], v14 offset:3072
    ds_read_b128 v[44:47], v14 offset:4096
    ds_read_b128 v[48:51], v14 offset:5120
    ds_read_b128 v[52:55], v14 offset:6144
    ds_read_b128 v[56:59], v14 offset:7168
    s_waitcnt lgkmcnt(4)
    v_pk_add_f32 v[28:29], v[28:29], v[36:37]
    v_pk_add_f32 v[30:31], v[30:31], v[38:39]
    v_pk_add_f32 v[32:33], v[32:33], v[40:41]
    v_pk_add_f32 v[34:35], v[34:35], v[42:43]
    s_waitcnt lgkmcnt(2)
    v_pk_add_f32 v[28:29], v[28:29], v[44:45]
    v_pk_add_f32 v[30:31], v[30:31], v[46:47]
    v_pk_add_f32 v[32:33], v[32:33], v[48:49]
    v_pk_add_f32 v[34:35], v[34:35], v[50:51]
    s_waitcnt lgkmcnt(0)
    v_pk_add_f32 v[28:29], v[28:29], v[52:53]
    v_pk_add_f32 v[30:31], v[30:31], v[54:55]
    v_pk_add_f32 v[32:33], v[32:33], v[56:57]
    v_pk_add_f32 v[34:35], v[34:35], v[58:59]
    v_cvt_pk_bf16_f32 v29, v28, v29
    v_lshlrev_b32 v28, 16, v29
    v_and_b32 v29, 0xffff0000, v29
    v_cvt_pk_bf16_f32 v31, v30, v31
    v_lshlrev_b32 v30, 16, v31
    v_and_b32 v31, 0xffff0000, v31
    v_cvt_pk_bf16_f32 v33, v32, v33
    v_lshlrev_b32 v32, 16, v33
    v_and_b32 v33, 0xffff0000, v33
    v_cvt_pk_bf16_f32 v35, v34, v35
    v_lshlrev_b32 v34, 16, v35
    v_and_b32 v35, 0xffff0000, v35
    v_mul_f32 v20, 0xbfb8aa3b, v28
    v_mul_f32 v21, 0xbfb8aa3b, v29
    v_mul_f32 v22, 0xbfb8aa3b, v30
    v_mul_f32 v23, 0xbfb8aa3b, v31
    v_mul_f32 v24, 0xbfb8aa3b, v32
    v_mul_f32 v25, 0xbfb8aa3b, v33
    v_mul_f32 v26, 0xbfb8aa3b, v34
    v_mul_f32 v27, 0xbfb8aa3b, v35
    v_exp_f32 v20, v20
    v_exp_f32 v21, v21
    v_exp_f32 v22, v22
    v_exp_f32 v23, v23
    v_exp_f32 v24, v24
    v_exp_f32 v25, v25
    v_exp_f32 v26, v26
    v_exp_f32 v27, v27
    v_add_f32 v20, 1.0, v20
    v_add_f32 v21, 1.0, v21
    v_add_f32 v22, 1.0, v22
    v_add_f32 v23, 1.0, v23
    v_add_f32 v24, 1.0, v24
    v_add_f32 v25, 1.0, v25
    v_add_f32 v26, 1.0, v26
    v_add_f32 v27, 1.0, v27
    v_rcp_f32 v20, v20
    v_rcp_f32 v21, v21
    v_rcp_f32 v22, v22
    v_rcp_f32 v23, v23
    v_rcp_f32 v24, v24
    v_rcp_f32 v25, v25
    v_rcp_f32 v26, v26
    v_rcp_f32 v27, v27
    v_mul_f32 v20, v20, v28
    v_mul_f32 v21, v21, v29
    v_mul_f32 v22, v22, v30
    v_mul_f32 v23, v23, v31
    v_mul_f32 v24, v24, v32
    v_mul_f32 v25, v25, v33
    v_mul_f32 v26, v26, v34
    v_mul_f32 v27, v27, v35
    v_cvt_pk_bf16_f32 v21, v20, v21
    v_lshlrev_b32 v20, 16, v21
    v_and_b32 v21, 0xffff0000, v21
    v_cvt_pk_bf16_f32 v23, v22, v23
    v_lshlrev_b32 v22, 16, v23
    v_and_b32 v23, 0xffff0000, v23
    v_cvt_pk_bf16_f32 v25, v24, v25
    v_lshlrev_b32 v24, 16, v25
    v_and_b32 v25, 0xffff0000, v25
    v_cvt_pk_bf16_f32 v27, v26, v27
    v_lshlrev_b32 v26, 16, v27
    v_and_b32 v27, 0xffff0000, v27
Lf1_9:
    s_and_b32 s56, s49, 3
    s_lshl_b32 s56, s56, 12
    v_add_u32 v2, s56, v12
    s_lshr_b32 s54, s49, 2
    s_add_u32 s54, s54, 1
    s_mov_b64 exec, 0xffff
Lpf_11:
    global_load_dword v1, v2, s[4:5] sc1
    s_sub_u32 s27, s27, 1
    s_cbranch_scc1 L_fin
    s_waitcnt vmcnt(0)
    v_cmp_gt_u32 vcc, s54, v1
    s_cbranch_vccnz Lpf_11
    s_mov_b64 exec, -1
    global_load_dwordx4 v[36:39], v6, s[50:51] offset:-4096 sc1
    global_load_dwordx4 v[40:43], v6, s[50:51] offset:-3072 sc1
    global_load_dwordx4 v[44:47], v6, s[50:51] offset:-2048 sc1
    global_load_dwordx4 v[48:51], v6, s[50:51] offset:-1024 sc1
    global_load_dwordx4 v[52:55], v6, s[50:51] offset:0 sc1
    global_load_dwordx4 v[56:59], v6, s[50:51] offset:1024 sc1
    global_load_dwordx4 v[60:63], v6, s[50:51] offset:2048 sc1
    global_load_dwordx4 v[64:67], v6, s[50:51] offset:3072 sc1
    global_load_dwordx4 v[68:71], v7, s[50:51] offset:-4096 sc1
    global_load_dwordx4 v[72:75], v7, s[50:51] offset:-3072 sc1
    global_load_dwordx4 v[76:79], v7, s[50:51] offset:-2048 sc1
    global_load_dwordx4 v[80:83], v7, s[50:51] offset:-1024 sc1
    global_load_dwordx4 v[84:87], v7, s[50:51] offset:0 sc1
    global_load_dwordx4 v[88:91], v7, s[50:51] offset:1024 sc1
    global_load_dwordx4 v[92:95], v7, s[50:51] offset:2048 sc1
    global_load_dwordx4 v[96:99], v7, s[50:51] offset:3072 sc1
    global_load_dwordx4 v[100:103], v8, s[50:51] offset:-4096 sc1
    global_load_dwordx4 v[104:107], v8, s[50:51] offset:-3072 sc1
    global_load_dwordx4 v[108:111], v8, s[50:51] offset:-2048 sc1
    global_load_dwordx4 v[112:115], v8, s[50:51] offset:-1024 sc1
    global_load_dwordx4 v[116:119], v8, s[50:51] offset:0 sc1
    global_load_dwordx4 v[120:123], v8, s[50:51] offset:1024 sc1
    global_load_dwordx4 v[124:127], v8, s[50:51] offset:2048 sc1
    global_load_dwordx4 v[128:131], v8, s[50:51] offset:3072 sc1
    global_load_dwordx4 v[132:135], v9, s[50:51] offset:-4096 sc1
    global_load_dwordx4 v[136:139], v9, s[50:51] offset:-3072 sc1
    global_load_dwordx4 v[140:143], v9, s[50:51] offset:-2048 sc1
    s_waitcnt vmcnt(26)
    v_mfma_f32_16x16x32_bf16 v[28:31], a[0:3], v[36:39], 0
    v_mfma_f32_16x16x32_bf16 v[32:35], a[128:131], v[36:39], 0
    global_load_dwordx4 v[36:39], v9, s[50:51] offset:-1024 sc1
    s_waitcnt vmcnt(26)
    v_mfma_f32_16x16x32_bf16 v[28:31], a[4:7], v[40:43], v[28:31]
    v_mfma_f32_16x16x32_bf16 v[32:35], a[132:135], v[40:43], v[32:35]
    global_load_dwordx4 v[40:43], v9, s[50:51] offset:0 sc1
    s_waitcnt vmcnt(26)
    v_mfma_f32_16x16x32_bf16 v[28:31], a[8:11], v[44:47], v[28:31]
    v_mfma_f32_16x16x32_bf16 v[32:35], a[136:139], v[44:47], v[32:35]
    global_load_dwordx4 v[44:47], v9, s[50:51] offset:1024 sc1
    s_waitcnt vmcnt(26)
    v_mfma_f32_16x16x32_bf16 v[28:31], a[12:15], v[48:51], v[28:31]
    v_mfma_f32_16x16x32_bf16 v[32:35], a[140:143], v[48:51], v[32:35]
    global_load_dwordx4 v[48:51], v9, s[50:51] offset:2048 sc1
    s_waitcnt vmcnt(26)
    v_mfma_f32_16x16x32_bf16 v[28:31], a[16:19], v[52:55], v[28:31]
    v_mfma_f32_16x16x32_bf16 v[32:35], a[144:147], v[52:55], v[32:35]
    global_load_dwordx4 v[52:55], v9, s[50:51] offset:3072 sc1
    s_waitcnt vmcnt(26)
    v_mfma_f32_16x16x32_bf16 v[28:31], a[20:23], v[56:59], v[28:31]
    v_mfma_f32_16x16x32_bf16 v[32:35], a[148:151], v[56:59], v[32:35]
    s_waitcnt vmcnt(25)
    v_mfma_f32_16x16x32_bf16 v[28:31], a[24:27], v[60:63], v[28:31]
    v_mfma_f32_16x16x32_bf16 v[32:35], a[152:155], v[60:63], v[32:35]
    s_waitcnt vmcnt(24)
    v_mfma_f32_16x16x32_bf16 v[28:31], a[28:31], v[64:67], v[28:31]
    v_mfma_f32_16x16x32_bf16 v[32:35], a[156:159], v[64:67], v[32:35]
    s_waitcnt vmcnt(23)
    v_mfma_f32_16x16x32_bf16 v[28:31], a[32:35], v[68:71], v[28:31]
    v_mfma_f32_16x16x32_bf16 v[32:35], a[160:163], v[68:71], v[32:35]
    s_waitcnt vmcnt(22)
    v_mfma_f32_16x16x32_bf16 v[28:31], a[36:39], v[72:75], v[28:31]
    v_mfma_f32_16x16x32_bf16 v[32:35], a[164:167], v[72:75], v[32:35]
    s_waitcnt vmcnt(21)
    v_mfma_f32_16x16x32_bf16 v[28:31], a[40:43], v[76:79], v[28:31]
    v_mfma_f32_16x16x32_bf16 v[32:35], a[168:171], v[76:79], v[32:35]
    s_waitcnt vmcnt(20)
    v_mfma_f32_16x16x32_bf16 v[28:31], a[44:47], v[80:83], v[28:31]
    v_mfma_f32_16x16x32_bf16 v[32:35], a[172:175], v[80:83], v[32:35]
    s_waitcnt vmcnt(19)
    v_mfma_f32_16x16x32_bf16 v[28:31], a[48:51], v[84:87], v[28:31]
    v_mfma_f32_16x16x32_bf16 v[32:35], a[176:179], v[84:87], v[32:35]
    s_waitcnt vmcnt(18)
    v_mfma_f32_16x16x32_bf16 v[28:31], a[52:55], v[88:91], v[28:31]
    v_mfma_f32_16x16x32_bf16 v[32:35], a[180:183], v[88:91], v[32:35]
    s_waitcnt vmcnt(17)
    v_mfma_f32_16x16x32_bf16 v[28:31], a[56:59], v[92:95], v[28:31]
    v_mfma_f32_16x16x32_bf16 v[32:35], a[184:187], v[92:95], v[32:35]
    s_waitcnt vmcnt(16)
    v_mfma_f32_16x16x32_bf16 v[28:31], a[60:63], v[96:99], v[28:31]
    v_mfma_f32_16x16x32_bf16 v[32:35], a[188:191], v[96:99], v[32:35]
    s_waitcnt vmcnt(15)
    v_mfma_f32_16x16x32_bf16 v[28:31], a[64:67], v[100:103], v[28:31]
    v_mfma_f32_16x16x32_bf16 v[32:35], a[192:195], v[100:103], v[32:35]
    s_waitcnt vmcnt(14)
    v_mfma_f32_16x16x32_bf16 v[28:31], a[68:71], v[104:107], v[28:31]
    v_mfma_f32_16x16x32_bf16 v[32:35], a[196:199], v[104:107], v[32:35]
    s_waitcnt vmcnt(13)
    v_mfma_f32_16x16x32_bf16 v[28:31], a[72:75], v[108:111], v[28:31]
    v_mfma_f32_16x16x32_bf16 v[32:35], a[200:203], v[108:111], v[32:35]
    s_waitcnt vmcnt(12)
    v_mfma_f32_16x16x32_bf16 v[28:31], a[76:79], v[112:115], v[28:31]
    v_mfma_f32_16x16x32_bf16 v[32:35], a[204:207], v[112:115], v[32:35]
    s_waitcnt vmcnt(11)
    v_mfma_f32_16x16x32_bf16 v[28:31], a[80:83], v[116:119], v[28:31]
    v_mfma_f32_16x16x32_bf16 v[32:35], a[208:211], v[116:119], v[32:35]
    s_waitcnt vmcnt(10)
    v_mfma_f32_16x16x32_bf16 v[28:31], a[84:87], v[120:123], v[28:31]
    v_mfma_f32_16x16x32_bf16 v[32:35], a[212:215], v[120:123], v[32:35]
    s_waitcnt vmcnt(9)
    v_mfma_f32_16x16x32_bf16 v[28:31], a[88:91], v[124:127], v[28:31]
    v_mfma_f32_16x16x32_bf16 v[32:35], a[216:219], v[124:127], v[32:35]
    s_waitcnt vmcnt(8)
    v_mfma_f32_16x16x32_bf16 v[28:31], a[92:95], v[128:131], v[28:31]
    v_mfma_f32_16x16x32_bf16 v[32:35], a[220:223], v[128:131], v[32:35]
    s_waitcnt vmcnt(7)
    v_mfma_f32_16x16x32_bf16 v[28:31], a[96:99], v[132:135], v[28:31]
    v_mfma_f32_16x16x32_bf16 v[32:35], a[224:227], v[132:135], v[32:35]
    s_waitcnt vmcnt(6)
    v_mfma_f32_16x16x32_bf16 v[28:31], a[100:103], v[136:139], v[28:31]
    v_mfma_f32_16x16x32_bf16 v[32:35], a[228:231], v[136:139], v[32:35]
    s_waitcnt vmcnt(5)
    v_mfma_f32_16x16x32_bf16 v[28:31], a[104:107], v[140:143], v[28:31]
    v_mfma_f32_16x16x32_bf16 v[32:35], a[232:235], v[140:143], v[32:35]
    s_waitcnt vmcnt(4)
    v_mfma_f32_16x16x32_bf16 v[28:31], a[108:111], v[36:39], v[28:31]
    v_mfma_f32_16x16x32_bf16 v[32:35], a[236:239], v[36:39], v[32:35]
    s_waitcnt vmcnt(3)
    v_mfma_f32_16x16x32_bf16 v[28:31], a[112:115], v[40:43], v[28:31]
    v_mfma_f32_16x16x32_bf16 v[32:35], a[240:243], v[40:43], v[32:35]
    s_waitcnt vmcnt(2)
    v_mfma_f32_16x16x32_bf16 v[28:31], a[116:119], v[44:47], v[28:31]
    v_mfma_f32_16x16x32_bf16 v[32:35], a[244:247], v[44:47], v[32:35]
    s_waitcnt vmcnt(1)
    v_mfma_f32_16x16x32_bf16 v[28:31], a[120:123], v[48:51], v[28:31]
    v_mfma_f32_16x16x32_bf16 v[32:35], a[248:251], v[48:51], v[32:35]
    s_waitcnt vmcnt(0)
    v_mfma_f32_16x16x32_bf16 v[28:31], a[124:127], v[52:55], v[28:31]
    v_mfma_f32_16x16x32_bf16 v[32:35], a[252:255], v[52:55], v[32:35]
    s_nop 3
    ds_write_b128 v13, v[28:31] offset:8192
    s_nop 2
    ds_write_b128 v13, v[32:35] offset:9216
    s_waitcnt lgkmcnt(0)
    s_barrier
    s_cmp_lg_u32 s9, 0
    s_cbranch_scc1 Lf2_10
    ds_read_b128 v[36:39], v14 offset:10240
    ds_read_b128 v[40:43], v14 offset:11264
    ds_read_b128 v[44:47], v14 offset:12288
    ds_read_b128 v[48:51], v14 offset:13312
    ds_read_b128 v[52:55], v14 offset:14336
    ds_read_b128 v[56:59], v14 offset:15360
    s_waitcnt lgkmcnt(4)
    v_pk_add_f32 v[28:29], v[28:29], v[36:37]
    v_pk_add_f32 v[30:31], v[30:31], v[38:39]
    v_pk_add_f32 v[32:33], v[32:33], v[40:41]
    v_pk_add_f32 v[34:35], v[34:35], v[42:43]
    s_waitcnt lgkmcnt(2)
    v_pk_add_f32 v[28:29], v[28:29], v[44:45]
    v_pk_add_f32 v[30:31], v[30:31], v[46:47]
    v_pk_add_f32 v[32:33], v[32:33], v[48:49]
    v_pk_add_f32 v[34:35], v[34:35], v[50:51]
    s_waitcnt lgkmcnt(0)
    v_pk_add_f32 v[28:29], v[28:29], v[52:53]
    v_pk_add_f32 v[30:31], v[30:31], v[54:55]
    v_pk_add_f32 v[32:33], v[32:33], v[56:57]
    v_pk_add_f32 v[34:35], v[34:35], v[58:59]
    v_cvt_pk_bf16_f32 v29, v28, v29
    v_lshlrev_b32 v28, 16, v29
    v_and_b32 v29, 0xffff0000, v29
    v_cvt_pk_bf16_f32 v31, v30, v31
    v_lshlrev_b32 v30, 16, v31
    v_and_b32 v31, 0xffff0000, v31
    v_cvt_pk_bf16_f32 v33, v32, v33
    v_lshlrev_b32 v32, 16, v33
    v_and_b32 v33, 0xffff0000, v33
    v_cvt_pk_bf16_f32 v35, v34, v35
    v_lshlrev_b32 v34, 16, v35
    v_and_b32 v35, 0xffff0000, v35
    v_pk_mul_f32 v[28:29], v[28:29], v[20:21]
    v_pk_mul_f32 v[30:31], v[30:31], v[22:23]
    v_pk_mul_f32 v[32:33], v[32:33], v[24:25]
    v_pk_mul_f32 v[34:35], v[34:35], v[26:27]
    v_cvt_pk_bf16_f32 v29, v28, v29
    v_lshlrev_b32 v28, 16, v29
    v_and_b32 v29, 0xffff0000, v29
    v_cvt_pk_bf16_f32 v31, v30, v31
    v_lshlrev_b32 v30, 16, v31
    v_and_b32 v31, 0xffff0000, v31
    v_cvt_pk_bf16_f32 v33, v32, v33
    v_lshlrev_b32 v32, 16, v33
    v_and_b32 v33, 0xffff0000, v33
    v_cvt_pk_bf16_f32 v35, v34, v35
    v_lshlrev_b32 v34, 16, v35
    v_and_b32 v35, 0xffff0000, v35
    v_lshlrev_b32 v20, 16, v16
    v_and_b32 v21, 0xffff0000, v16
    v_pk_add_f32 v[28:29], v[28:29], v[20:21]
    v_cvt_pk_bf16_f32 v36, v28, v29
    v_lshlrev_b32 v22, 16, v17
    v_and_b32 v23, 0xffff0000, v17
    v_pk_add_f32 v[30:31], v[30:31], v[22:23]
    v_cvt_pk_bf16_f32 v37, v30, v31
    v_lshlrev_b32 v24, 16, v18
    v_and_b32 v25, 0xffff0000, v18
    v_pk_add_f32 v[32:33], v[32:33], v[24:25]
    v_cvt_pk_bf16_f32 v38, v32, v33
    v_lshlrev_b32 v26, 16, v19
    v_and_b32 v27, 0xffff0000, v19
    v_pk_add_f32 v[34:35], v[34:35], v[26:27]
    v_cvt_pk_bf16_f32 v39, v34, v35
    global_store_dwordx4 v10, v[36:39], s[46:47]
Lf2_10:
    s_cmp_lt_u32 s49, 36
    s_cselect_b32 s56, 3, 4
    s_add_u32 s49, s49, s56
    s_lshl_b32 s56, s56, 15
    v_add_u32 v10, s56, v10
    s_lshl_b32 s57, s56, 2
    s_lshl_b32 s56, s56, 3
    s_add_u32 s50, s50, s56
    s_addc_u32 s51, s51, 0
    s_add_u32 s52, s52, s57
    s_addc_u32 s53, s53, 0
    s_cmp_lt_u32 s49, 64
    s_cbranch_scc1 Lfi_7
    s_branch L_fin
L_qkv:
    s_sub_u32 s36, s36, 8
    s_lshl_b32 s36, s36, 5
    s_add_u32 s36, s36, s8
    s_load_dwordx4 s[40:43], s[0:1], 16
    s_load_dwordx2 s[44:45], s[0:1], 32
    v_and_b32 v1, 63, v0
    v_lshrrev_b32 v2, 4, v1
    v_and_b32 v3, 15, v1
    v_lshrrev_b32 v4, 2, v3
    v_and_b32 v5, 3, v1
    s_lshr_b32 s47, s36, 1
    s_and_b32 s48, s36, 1
    s_lshl_b32 s46, s9, 15
    s_add_u32 s46, s46, 0x8000
    s_lshl_b32 s64, s47, 8
    v_mov_b32 v6, s64
    s_waitcnt lgkmcnt(0)
    v_lshlrev_b32 v104, 4, v1
    v_mov_b32 v105, v104
    s_lshl_b32 s64, s48, 15
    s_lshl_b32 s65, s9, 13
    s_add_u32 s64, s64, s65
    s_add_u32 s64, s64, 1048576
    s_mov_b32 s62, s65
    s_mov_b32 s49, 0
    s_add_u32 s50, s4, s64
    s_addc_u32 s51, s5, 0
    s_lshl_b32 s64, s48, 19
    s_lshl_b32 s65, s47, 14
    s_add_u32 s64, s64, s65
    s_lshr_b32 s66, s64, 1
    s_add_u32 s64, s64, 15728640
    s_add_u32 s66, s66, 66584576
    s_add_u32 s56, s4, s64
    s_addc_u32 s57, s5, 0
    s_add_u32 s58, s4, s66
    s_addc_u32 s59, s5, 0
    s_add_u32 s52, s56, 1048576
    s_addc_u32 s53, s57, 0
    s_add_u32 s54, s58, 524288
    s_addc_u32 s55, s59, 0
    s_lshr_b32 s64, s9, 1
    s_lshl_b32 s64, s64, 7
    s_and_b32 s65, s9, 1
    s_lshl_b32 s65, s65, 10
    s_add_u32 s64, s64, s65
    v_lshrrev_b32 v108, 3, v3
    v_mul_u32_u24 v108, 3968, v108
    v_add3_u32 v108, v108, s64, v104
    v_add_u32 v111, 8192, v108
    s_lshl_b32 s64, s9, 12
    v_add_u32 v109, s64, v104
    s_lshl_b32 s64, s9, 10
    s_add_u32 s64, s64, 2048
    v_add_u32 v110, s64, v104
    s_lshl_b32 s64, s47, 7
    s_lshl_b32 s65, s48, 4
    s_add_u32 s64, s64, s65
    s_lshl_b32 s65, s9, 2
    s_add_u32 s64, s64, s65
    s_add_u32 s64, s64, 786432
    v_mov_b32 v106, s64
    v_add_u32 v107, 4096, v104
    s_mul_i32 s64, s9, 131072
    v_mul_u32_u24 v7, 8192, v2
    v_add3_u32 v6, v6, v7, s64
    v_lshlrev_b32 v7, 2, v2
    v_xor_b32 v7, v7, v3
    v_lshl_add_u32 v6, v7, 4, v6
    v_and_b32 v7, 1, v2
    v_lshl_add_u32 v7, v7, 3, v4
    v_lshlrev_b32 v7, 8, v7
    v_lshrrev_b32 v8, 1, v2
    v_lshl_add_u32 v7, v8, 15, v7
    v_xor_b32 v8, s9, v4
    v_lshl_add_u32 v7, v8, 6, v7
    v_add_u32 v7, 32768, v7
    v_lshl_add_u32 v8, v5, 3, v7
    v_lshl_add_u32 v10, v5, 4, v7
    v_add_u32 v9, 0x10000, v8
    v_add_u32 v11, 0x10000, v10
    s_add_u32 m0, s46, 0
    v_add_u32 v7, 0, v6
    global_load_lds_dwordx4 v7, s[40:41]
    s_add_u32 m0, s46, 1024
    v_add_u32 v7, 32768, v6
    global_load_lds_dwordx4 v7, s[40:41]
    s_add_u32 m0, s46, 2048
    v_add_u32 v7, 65536, v6
    global_load_lds_dwordx4 v7, s[40:41]
    s_add_u32 m0, s46, 3072
    v_add_u32 v7, 98304, v6
    global_load_lds_dwordx4 v7, s[40:41]
    s_add_u32 m0, s46, 4096
    v_add_u32 v7, 0, v6
    global_load_lds_dwordx4 v7, s[42:43]
    s_add_u32 m0, s46, 5120
    v_add_u32 v7, 32768, v6
    global_load_lds_dwordx4 v7, s[42:43]
    s_add_u32 m0, s46, 6144
    v_add_u32 v7, 65536, v6
    global_load_lds_dwordx4 v7, s[42:43]
    s_add_u32 m0, s46, 7168
    v_add_u32 v7, 98304, v6
    global_load_lds_dwordx4 v7, s[42:43]
    s_add_u32 m0, s46, 8192
    v_add_u32 v7, 0, v6
    global_load_lds_dwordx4 v7, s[44:45]
    s_add_u32 m0, s46, 9216
    v_add_u32 v7, 32768, v6
    global_load_lds_dwordx4 v7, s[44:45]
    s_add_u32 m0, s46, 10240
    v_add_u32 v7, 65536, v6
    global_load_lds_dwordx4 v7, s[44:45]
    s_add_u32 m0, s46, 11264
    v_add_u32 v7, 98304, v6
    global_load_lds_dwordx4 v7, s[44:45]
    s_add_u32 m0, s46, 12288
    v_add_u32 v7, 524288, v6
    global_load_lds_dwordx4 v7, s[40:41]
    s_add_u32 m0, s46, 13312
    v_add_u32 v7, 557056, v6
    global_load_lds_dwordx4 v7, s[40:41]
    s_add_u32 m0, s46, 14336
    v_add_u32 v7, 589824, v6
    global_load_lds_dwordx4 v7, s[40:41]
    s_add_u32 m0, s46, 15360
    v_add_u32 v7, 622592, v6
    global_load_lds_dwordx4 v7, s[40:41]
    s_add_u32 m0, s46, 16384
    v_add_u32 v7, 524288, v6
    global_load_lds_dwordx4 v7, s[42:43]
    s_add_u32 m0, s46, 17408
    v_add_u32 v7, 557056, v6
    global_load_lds_dwordx4 v7, s[42:43]
    s_add_u32 m0, s46, 18432
    v_add_u32 v7, 589824, v6
    global_load_lds_dwordx4 v7, s[42:43]
    s_add_u32 m0, s46, 19456
    v_add_u32 v7, 622592, v6
    global_load_lds_dwordx4 v7, s[42:43]
    s_add_u32 m0, s46, 20480
    v_add_u32 v7, 524288, v6
    global_load_lds_dwordx4 v7, s[44:45]
    s_add_u32 m0, s46, 21504
    v_add_u32 v7, 557056, v6
    global_load_lds_dwordx4 v7, s[44:45]
    s_add_u32 m0, s46, 22528
    v_add_u32 v7, 589824, v6
    global_load_lds_dwordx4 v7, s[44:45]
    s_add_u32 m0, s46, 23552
    v_add_u32 v7, 622592, v6
    global_load_lds_dwordx4 v7, s[44:45]
    s_add_u32 m0, s46, 24576
    v_add_u32 v7, 1048576, v6
    global_load_lds_dwordx4 v7, s[40:41]
    s_add_u32 m0, s46, 25600
    v_add_u32 v7, 1081344, v6
    global_load_lds_dwordx4 v7, s[40:41]
    s_add_u32 m0, s46, 26624
    v_add_u32 v7, 1114112, v6
    global_load_lds_dwordx4 v7, s[40:41]
    s_add_u32 m0, s46, 27648
    v_add_u32 v7, 1146880, v6
    global_load_lds_dwordx4 v7, s[40:41]
    s_add_u32 m0, s46, 28672
    v_add_u32 v7, 1048576, v6
    global_load_lds_dwordx4 v7, s[42:43]
    s_add_u32 m0, s46, 29696
    v_add_u32 v7, 1081344, v6
    global_load_lds_dwordx4 v7, s[42:43]
    s_add_u32 m0, s46, 30720
    v_add_u32 v7, 1114112, v6
    global_load_lds_dwordx4 v7, s[42:43]
    s_add_u32 m0, s46, 31744
    v_add_u32 v7, 1146880, v6
    global_load_lds_dwordx4 v7, s[42:43]
    s_waitcnt vmcnt(28)
    s_barrier
    ds_read_b64_tr_b16 a[0:1], v8 offset:0
    ds_read_b64_tr_b16 a[2:3], v8 offset:1024
    ds_read_b64_tr_b16 a[4:5], v9 offset:0
    ds_read_b64_tr_b16 a[6:7], v9 offset:1024
    ds_read_b64_tr_b16 a[64:65], v8 offset:32
    ds_read_b64_tr_b16 a[66:67], v8 offset:1056
    ds_read_b64_tr_b16 a[68:69], v9 offset:32
    ds_read_b64_tr_b16 a[70:71], v9 offset:1056
    s_waitcnt lgkmcnt(0)
    s_waitcnt vmcnt(24)
    s_barrier
    ds_read_b64_tr_b16 a[128:129], v8 offset:4096
    ds_read_b64_tr_b16 a[130:131], v8 offset:5120
    ds_read_b64_tr_b16 a[132:133], v9 offset:4096
    ds_read_b64_tr_b16 a[134:135], v9 offset:5120
    ds_read_b64_tr_b16 a[192:193], v8 offset:4128
    ds_read_b64_tr_b16 a[194:195], v8 offset:5152
    ds_read_b64_tr_b16 a[196:197], v9 offset:4128
    ds_read_b64_tr_b16 a[198:199], v9 offset:5152
    s_add_u32 m0, s46, 0
    v_add_u32 v7, 1048576, v6
    global_load_lds_dwordx4 v7, s[44:45]
    s_add_u32 m0, s46, 1024
    v_add_u32 v7, 1081344, v6
    global_load_lds_dwordx4 v7, s[44:45]
    s_add_u32 m0, s46, 2048
    v_add_u32 v7, 1114112, v6
    global_load_lds_dwordx4 v7, s[44:45]
    s_add_u32 m0, s46, 3072
    v_add_u32 v7, 1146880, v6
    global_load_lds_dwordx4 v7, s[44:45]
    s_waitcnt lgkmcnt(0)
    s_waitcnt vmcnt(24)
    s_barrier
    ds_read_b64_tr_b16 v[128:129], v10 offset:8192
    ds_read_b64_tr_b16 v[130:131], v10 offset:9216
    ds_read_b64_tr_b16 v[132:133], v11 offset:8192
    ds_read_b64_tr_b16 v[134:135], v11 offset:9216
    ds_read_b64_tr_b16 v[192:193], v10 offset:8200
    ds_read_b64_tr_b16 v[194:195], v10 offset:9224
    ds_read_b64_tr_b16 v[196:197], v11 offset:8200
    ds_read_b64_tr_b16 v[198:199], v11 offset:9224
    s_add_u32 m0, s46, 4096
    v_add_u32 v7, 1572864, v6
    global_load_lds_dwordx4 v7, s[40:41]
    s_add_u32 m0, s46, 5120
    v_add_u32 v7, 1605632, v6
    global_load_lds_dwordx4 v7, s[40:41]
    s_add_u32 m0, s46, 6144
    v_add_u32 v7, 1638400, v6
    global_load_lds_dwordx4 v7, s[40:41]
    s_add_u32 m0, s46, 7168
    v_add_u32 v7, 1671168, v6
    global_load_lds_dwordx4 v7, s[40:41]
    s_waitcnt lgkmcnt(0)
    s_waitcnt vmcnt(24)
    s_barrier
    ds_read_b64_tr_b16 a[8:9], v8 offset:12288
    ds_read_b64_tr_b16 a[10:11], v8 offset:13312
    ds_read_b64_tr_b16 a[12:13], v9 offset:12288
    ds_read_b64_tr_b16 a[14:15], v9 offset:13312
    ds_read_b64_tr_b16 a[72:73], v8 offset:12320
    ds_read_b64_tr_b16 a[74:75], v8 offset:13344
    ds_read_b64_tr_b16 a[76:77], v9 offset:12320
    ds_read_b64_tr_b16 a[78:79], v9 offset:13344
    s_add_u32 m0, s46, 8192
    v_add_u32 v7, 1572864, v6
    global_load_lds_dwordx4 v7, s[42:43]
    s_add_u32 m0, s46, 9216
    v_add_u32 v7, 1605632, v6
    global_load_lds_dwordx4 v7, s[42:43]
    s_add_u32 m0, s46, 10240
    v_add_u32 v7, 1638400, v6
    global_load_lds_dwordx4 v7, s[42:43]
    s_add_u32 m0, s46, 11264
    v_add_u32 v7, 1671168, v6
    global_load_lds_dwordx4 v7, s[42:43]
    s_waitcnt lgkmcnt(0)
    s_waitcnt vmcnt(24)
    s_barrier
    ds_read_b64_tr_b16 a[136:137], v8 offset:16384
    ds_read_b64_tr_b16 a[138:139], v8 offset:17408
    ds_read_b64_tr_b16 a[140:141], v9 offset:16384
    ds_read_b64_tr_b16 a[142:143], v9 offset:17408
    ds_read_b64_tr_b16 a[200:201], v8 offset:16416
    ds_read_b64_tr_b16 a[202:203], v8 offset:17440
    ds_read_b64_tr_b16 a[204:205], v9 offset:16416
    ds_read_b64_tr_b16 a[206:207], v9 offset:17440
    s_add_u32 m0, s46, 12288
    v_add_u32 v7, 1572864, v6
    global_load_lds_dwordx4 v7, s[44:45]
    s_add_u32 m0, s46, 13312
    v_add_u32 v7, 1605632, v6
    global_load_lds_dwordx4 v7, s[44:45]
    s_add_u32 m0, s46, 14336
    v_add_u32 v7, 1638400, v6
    global_load_lds_dwordx4 v7, s[44:45]
    s_add_u32 m0, s46, 15360
    v_add_u32 v7, 1671168, v6
    global_load_lds_dwordx4 v7, s[44:45]
    s_waitcnt lgkmcnt(0)
    s_waitcnt vmcnt(24)
    s_barrier
    ds_read_b64_tr_b16 v[136:137], v10 offset:20480
    ds_read_b64_tr_b16 v[138:139], v10 offset:21504
    ds_read_b64_tr_b16 v[140:141], v11 offset:20480
    ds_read_b64_tr_b16 v[142:143], v11 offset:21504
    ds_read_b64_tr_b16 v[200:201], v10 offset:20488
    ds_read_b64_tr_b16 v[202:203], v10 offset:21512
    ds_read_b64_tr_b16 v[204:205], v11 offset:20488
    ds_read_b64_tr_b16 v[206:207], v11 offset:21512
    s_add_u32 m0, s46, 16384
    v_add_u32 v7, 2097152, v6
    global_load_lds_dwordx4 v7, s[40:41]
    s_add_u32 m0, s46, 17408
    v_add_u32 v7, 2129920, v6
    global_load_lds_dwordx4 v7, s[40:41]
    s_add_u32 m0, s46, 18432
    v_add_u32 v7, 2162688, v6
    global_load_lds_dwordx4 v7, s[40:41]
    s_add_u32 m0, s46, 19456
    v_add_u32 v7, 2195456, v6
    global_load_lds_dwordx4 v7, s[40:41]
    s_waitcnt lgkmcnt(0)
    s_waitcnt vmcnt(24)
    s_barrier
    ds_read_b64_tr_b16 a[16:17], v8 offset:24576
    ds_read_b64_tr_b16 a[18:19], v8 offset:25600
    ds_read_b64_tr_b16 a[20:21], v9 offset:24576
    ds_read_b64_tr_b16 a[22:23], v9 offset:25600
    ds_read_b64_tr_b16 a[80:81], v8 offset:24608
    ds_read_b64_tr_b16 a[82:83], v8 offset:25632
    ds_read_b64_tr_b16 a[84:85], v9 offset:24608
    ds_read_b64_tr_b16 a[86:87], v9 offset:25632
    s_add_u32 m0, s46, 20480
    v_add_u32 v7, 2097152, v6
    global_load_lds_dwordx4 v7, s[42:43]
    s_add_u32 m0, s46, 21504
    v_add_u32 v7, 2129920, v6
    global_load_lds_dwordx4 v7, s[42:43]
    s_add_u32 m0, s46, 22528
    v_add_u32 v7, 2162688, v6
    global_load_lds_dwordx4 v7, s[42:43]
    s_add_u32 m0, s46, 23552
    v_add_u32 v7, 2195456, v6
    global_load_lds_dwordx4 v7, s[42:43]
    s_waitcnt lgkmcnt(0)
    s_waitcnt vmcnt(24)
    s_barrier
    ds_read_b64_tr_b16 a[144:145], v8 offset:28672
    ds_read_b64_tr_b16 a[146:147], v8 offset:29696
    ds_read_b64_tr_b16 a[148:149], v9 offset:28672
    ds_read_b64_tr_b16 a[150:151], v9 offset:29696
    ds_read_b64_tr_b16 a[208:209], v8 offset:28704
    ds_read_b64_tr_b16 a[210:211], v8 offset:29728
    ds_read_b64_tr_b16 a[212:213], v9 offset:28704
    ds_read_b64_tr_b16 a[214:215], v9 offset:29728
    s_add_u32 m0, s46, 24576
    v_add_u32 v7, 2097152, v6
    global_load_lds_dwordx4 v7, s[44:45]
    s_add_u32 m0, s46, 25600
    v_add_u32 v7, 2129920, v6
    global_load_lds_dwordx4 v7, s[44:45]
    s_add_u32 m0, s46, 26624
    v_add_u32 v7, 2162688, v6
    global_load_lds_dwordx4 v7, s[44:45]
    s_add_u32 m0, s46, 27648
    v_add_u32 v7, 2195456, v6
    global_load_lds_dwordx4 v7, s[44:45]
    s_waitcnt lgkmcnt(0)
    s_waitcnt vmcnt(24)
    s_barrier
    ds_read_b64_tr_b16 v[144:145], v10 offset:0
    ds_read_b64_tr_b16 v[146:147], v10 offset:1024
    ds_read_b64_tr_b16 v[148:149], v11 offset:0
    ds_read_b64_tr_b16 v[150:151], v11 offset:1024
    ds_read_b64_tr_b16 v[208:209], v10 offset:8
    ds_read_b64_tr_b16 v[210:211], v10 offset:1032
    ds_read_b64_tr_b16 v[212:213], v11 offset:8
    ds_read_b64_tr_b16 v[214:215], v11 offset:1032
    s_add_u32 m0, s46, 28672
    v_add_u32 v7, 2621440, v6
    global_load_lds_dwordx4 v7, s[40:41]
    s_add_u32 m0, s46, 29696
    v_add_u32 v7, 2654208, v6
    global_load_lds_dwordx4 v7, s[40:41]
    s_add_u32 m0, s46, 30720
    v_add_u32 v7, 2686976, v6
    global_load_lds_dwordx4 v7, s[40:41]
    s_add_u32 m0, s46, 31744
    v_add_u32 v7, 2719744, v6
    global_load_lds_dwordx4 v7, s[40:41]
    s_waitcnt lgkmcnt(0)
    s_waitcnt vmcnt(24)
    s_barrier
    ds_read_b64_tr_b16 a[24:25], v8 offset:4096
    ds_read_b64_tr_b16 a[26:27], v8 offset:5120
    ds_read_b64_tr_b16 a[28:29], v9 offset:4096
    ds_read_b64_tr_b16 a[30:31], v9 offset:5120
    ds_read_b64_tr_b16 a[88:89], v8 offset:4128
    ds_read_b64_tr_b16 a[90:91], v8 offset:5152
    ds_read_b64_tr_b16 a[92:93], v9 offset:4128
    ds_read_b64_tr_b16 a[94:95], v9 offset:5152
    s_add_u32 m0, s46, 0
    v_add_u32 v7, 2621440, v6
    global_load_lds_dwordx4 v7, s[42:43]
    s_add_u32 m0, s46, 1024
    v_add_u32 v7, 2654208, v6
    global_load_lds_dwordx4 v7, s[42:43]
    s_add_u32 m0, s46, 2048
    v_add_u32 v7, 2686976, v6
    global_load_lds_dwordx4 v7, s[42:43]
    s_add_u32 m0, s46, 3072
    v_add_u32 v7, 2719744, v6
    global_load_lds_dwordx4 v7, s[42:43]
    s_waitcnt lgkmcnt(0)
    s_waitcnt vmcnt(24)
    s_barrier
    ds_read_b64_tr_b16 a[152:153], v8 offset:8192
    ds_read_b64_tr_b16 a[154:155], v8 offset:9216
    ds_read_b64_tr_b16 a[156:157], v9 offset:8192
    ds_read_b64_tr_b16 a[158:159], v9 offset:9216
    ds_read_b64_tr_b16 a[216:217], v8 offset:8224
    ds_read_b64_tr_b16 a[218:219], v8 offset:9248
    ds_read_b64_tr_b16 a[220:221], v9 offset:8224
    ds_read_b64_tr_b16 a[222:223], v9 offset:9248
    s_add_u32 m0, s46, 4096
    v_add_u32 v7, 2621440, v6
    global_load_lds_dwordx4 v7, s[44:45]
    s_add_u32 m0, s46, 5120
    v_add_u32 v7, 2654208, v6
    global_load_lds_dwordx4 v7, s[44:45]
    s_add_u32 m0, s46, 6144
    v_add_u32 v7, 2686976, v6
    global_load_lds_dwordx4 v7, s[44:45]
    s_add_u32 m0, s46, 7168
    v_add_u32 v7, 2719744, v6
    global_load_lds_dwordx4 v7, s[44:45]
    s_waitcnt lgkmcnt(0)
    s_waitcnt vmcnt(24)
    s_barrier
    ds_read_b64_tr_b16 v[152:153], v10 offset:12288
    ds_read_b64_tr_b16 v[154:155], v10 offset:13312
    ds_read_b64_tr_b16 v[156:157], v11 offset:12288
    ds_read_b64_tr_b16 v[158:159], v11 offset:13312
    ds_read_b64_tr_b16 v[216:217], v10 offset:12296
    ds_read_b64_tr_b16 v[218:219], v10 offset:13320
    ds_read_b64_tr_b16 v[220:221], v11 offset:12296
    ds_read_b64_tr_b16 v[222:223], v11 offset:13320
    s_add_u32 m0, s46, 8192
    v_add_u32 v7, 3145728, v6
    global_load_lds_dwordx4 v7, s[40:41]
    s_add_u32 m0, s46, 9216
    v_add_u32 v7, 3178496, v6
    global_load_lds_dwordx4 v7, s[40:41]
    s_add_u32 m0, s46, 10240
    v_add_u32 v7, 3211264, v6
    global_load_lds_dwordx4 v7, s[40:41]
    s_add_u32 m0, s46, 11264
    v_add_u32 v7, 3244032, v6
    global_load_lds_dwordx4 v7, s[40:41]
    s_waitcnt lgkmcnt(0)
    s_waitcnt vmcnt(24)
    s_barrier
    ds_read_b64_tr_b16 a[32:33], v8 offset:16384
    ds_read_b64_tr_b16 a[34:35], v8 offset:17408
    ds_read_b64_tr_b16 a[36:37], v9 offset:16384
    ds_read_b64_tr_b16 a[38:39], v9 offset:17408
    ds_read_b64_tr_b16 a[96:97], v8 offset:16416
    ds_read_b64_tr_b16 a[98:99], v8 offset:17440
    ds_read_b64_tr_b16 a[100:101], v9 offset:16416
    ds_read_b64_tr_b16 a[102:103], v9 offset:17440
    s_add_u32 m0, s46, 12288
    v_add_u32 v7, 3145728, v6
    global_load_lds_dwordx4 v7, s[42:43]
    s_add_u32 m0, s46, 13312
    v_add_u32 v7, 3178496, v6
    global_load_lds_dwordx4 v7, s[42:43]
    s_add_u32 m0, s46, 14336
    v_add_u32 v7, 3211264, v6
    global_load_lds_dwordx4 v7, s[42:43]
    s_add_u32 m0, s46, 15360
    v_add_u32 v7, 3244032, v6
    global_load_lds_dwordx4 v7, s[42:43]
    s_waitcnt lgkmcnt(0)
    s_waitcnt vmcnt(24)
    s_barrier
    ds_read_b64_tr_b16 a[160:161], v8 offset:20480
    ds_read_b64_tr_b16 a[162:163], v8 offset:21504
    ds_read_b64_tr_b16 a[164:165], v9 offset:20480
    ds_read_b64_tr_b16 a[166:167], v9 offset:21504
    ds_read_b64_tr_b16 a[224:225], v8 offset:20512
    ds_read_b64_tr_b16 a[226:227], v8 offset:21536
    ds_read_b64_tr_b16 a[228:229], v9 offset:20512
    ds_read_b64_tr_b16 a[230:231], v9 offset:21536
    s_add_u32 m0, s46, 16384
    v_add_u32 v7, 3145728, v6
    global_load_lds_dwordx4 v7, s[44:45]
    s_add_u32 m0, s46, 17408
    v_add_u32 v7, 3178496, v6
    global_load_lds_dwordx4 v7, s[44:45]
    s_add_u32 m0, s46, 18432
    v_add_u32 v7, 3211264, v6
    global_load_lds_dwordx4 v7, s[44:45]
    s_add_u32 m0, s46, 19456
    v_add_u32 v7, 3244032, v6
    global_load_lds_dwordx4 v7, s[44:45]
    v_mov_b32 v21, 128
    global_load_dword v20, v21, s[6:7] sc1
    s_waitcnt lgkmcnt(0)
    s_waitcnt vmcnt(24)
    s_barrier
    ds_read_b64_tr_b16 v[160:161], v10 offset:24576
    ds_read_b64_tr_b16 v[162:163], v10 offset:25600
    ds_read_b64_tr_b16 v[164:165], v11 offset:24576
    ds_read_b64_tr_b16 v[166:167], v11 offset:25600
    ds_read_b64_tr_b16 v[224:225], v10 offset:24584
    ds_read_b64_tr_b16 v[226:227], v10 offset:25608
    ds_read_b64_tr_b16 v[228:229], v11 offset:24584
    ds_read_b64_tr_b16 v[230:231], v11 offset:25608
    s_add_u32 m0, s46, 20480
    v_add_u32 v7, 3670016, v6
    global_load_lds_dwordx4 v7, s[40:41]
    s_add_u32 m0, s46, 21504
    v_add_u32 v7, 3702784, v6
    global_load_lds_dwordx4 v7, s[40:41]
    s_add_u32 m0, s46, 22528
    v_add_u32 v7, 3735552, v6
    global_load_lds_dwordx4 v7, s[40:41]
    s_add_u32 m0, s46, 23552
    v_add_u32 v7, 3768320, v6
    global_load_lds_dwordx4 v7, s[40:41]
    s_waitcnt lgkmcnt(0)
    s_waitcnt vmcnt(24)
    s_barrier
    ds_read_b64_tr_b16 a[40:41], v8 offset:28672
    ds_read_b64_tr_b16 a[42:43], v8 offset:29696
    ds_read_b64_tr_b16 a[44:45], v9 offset:28672
    ds_read_b64_tr_b16 a[46:47], v9 offset:29696
    ds_read_b64_tr_b16 a[104:105], v8 offset:28704
    ds_read_b64_tr_b16 a[106:107], v8 offset:29728
    ds_read_b64_tr_b16 a[108:109], v9 offset:28704
    ds_read_b64_tr_b16 a[110:111], v9 offset:29728
    s_add_u32 m0, s46, 24576
    v_add_u32 v7, 3670016, v6
    global_load_lds_dwordx4 v7, s[42:43]
    s_add_u32 m0, s46, 25600
    v_add_u32 v7, 3702784, v6
    global_load_lds_dwordx4 v7, s[42:43]
    s_add_u32 m0, s46, 26624
    v_add_u32 v7, 3735552, v6
    global_load_lds_dwordx4 v7, s[42:43]
    s_add_u32 m0, s46, 27648
    v_add_u32 v7, 3768320, v6
    global_load_lds_dwordx4 v7, s[42:43]
    s_waitcnt lgkmcnt(0)
    s_waitcnt vmcnt(24)
    s_barrier
    ds_read_b64_tr_b16 a[168:169], v8 offset:0
    ds_read_b64_tr_b16 a[170:171], v8 offset:1024
    ds_read_b64_tr_b16 a[172:173], v9 offset:0
    ds_read_b64_tr_b16 a[174:175], v9 offset:1024
    ds_read_b64_tr_b16 a[232:233], v8 offset:32
    ds_read_b64_tr_b16 a[234:235], v8 offset:1056
    ds_read_b64_tr_b16 a[236:237], v9 offset:32
    ds_read_b64_tr_b16 a[238:239], v9 offset:1056
    s_add_u32 m0, s46, 28672
    v_add_u32 v7, 3670016, v6
    global_load_lds_dwordx4 v7, s[44:45]
    s_add_u32 m0, s46, 29696
    v_add_u32 v7, 3702784, v6
    global_load_lds_dwordx4 v7, s[44:45]
    s_add_u32 m0, s46, 30720
    v_add_u32 v7, 3735552, v6
    global_load_lds_dwordx4 v7, s[44:45]
    s_add_u32 m0, s46, 31744
    v_add_u32 v7, 3768320, v6
    global_load_lds_dwordx4 v7, s[44:45]
    s_waitcnt lgkmcnt(0)
    s_waitcnt vmcnt(24)
    s_barrier
    ds_read_b64_tr_b16 v[168:169], v10 offset:4096
    ds_read_b64_tr_b16 v[170:171], v10 offset:5120
    ds_read_b64_tr_b16 v[172:173], v11 offset:4096
    ds_read_b64_tr_b16 v[174:175], v11 offset:5120
    ds_read_b64_tr_b16 v[232:233], v10 offset:4104
    ds_read_b64_tr_b16 v[234:235], v10 offset:5128
    ds_read_b64_tr_b16 v[236:237], v11 offset:4104
    ds_read_b64_tr_b16 v[238:239], v11 offset:5128
    s_waitcnt lgkmcnt(0)
    s_waitcnt vmcnt(20)
    s_barrier
    ds_read_b64_tr_b16 a[48:49], v8 offset:8192
    ds_read_b64_tr_b16 a[50:51], v8 offset:9216
    ds_read_b64_tr_b16 a[52:53], v9 offset:8192
    ds_read_b64_tr_b16 a[54:55], v9 offset:9216
    ds_read_b64_tr_b16 a[112:113], v8 offset:8224
    ds_read_b64_tr_b16 a[114:115], v8 offset:9248
    ds_read_b64_tr_b16 a[116:117], v9 offset:8224
    ds_read_b64_tr_b16 a[118:119], v9 offset:9248
    s_waitcnt lgkmcnt(0)
    s_waitcnt vmcnt(16)
    s_barrier
    ds_read_b64_tr_b16 a[176:177], v8 offset:12288
    ds_read_b64_tr_b16 a[178:179], v8 offset:13312
    ds_read_b64_tr_b16 a[180:181], v9 offset:12288
    ds_read_b64_tr_b16 a[182:183], v9 offset:13312
    ds_read_b64_tr_b16 a[240:241], v8 offset:12320
    ds_read_b64_tr_b16 a[242:243], v8 offset:13344
    ds_read_b64_tr_b16 a[244:245], v9 offset:12320
    ds_read_b64_tr_b16 a[246:247], v9 offset:13344
    s_waitcnt lgkmcnt(0)
    s_waitcnt vmcnt(12)
    s_barrier
    ds_read_b64_tr_b16 v[176:177], v10 offset:16384
    ds_read_b64_tr_b16 v[178:179], v10 offset:17408
    ds_read_b64_tr_b16 v[180:181], v11 offset:16384
    ds_read_b64_tr_b16 v[182:183], v11 offset:17408
    ds_read_b64_tr_b16 v[240:241], v10 offset:16392
    ds_read_b64_tr_b16 v[242:243], v10 offset:17416
    ds_read_b64_tr_b16 v[244:245], v11 offset:16392
    ds_read_b64_tr_b16 v[246:247], v11 offset:17416
    s_waitcnt lgkmcnt(0)
    s_waitcnt vmcnt(8)
    s_barrier
    ds_read_b64_tr_b16 a[56:57], v8 offset:20480
    ds_read_b64_tr_b16 a[58:59], v8 offset:21504
    ds_read_b64_tr_b16 a[60:61], v9 offset:20480
    ds_read_b64_tr_b16 a[62:63], v9 offset:21504
    ds_read_b64_tr_b16 a[120:121], v8 offset:20512
    ds_read_b64_tr_b16 a[122:123], v8 offset:21536
    ds_read_b64_tr_b16 a[124:125], v9 offset:20512
    ds_read_b64_tr_b16 a[126:127], v9 offset:21536
    v_cmp_gt_u32 vcc, 64, v20
    s_cbranch_vccz Llo_12
    v_mov_b32 v21, 128
Lln_13:
    global_load_dword v20, v21, s[6:7] sc1
    s_sub_u32 s27, s27, 1
    s_cbranch_scc1 L_fin
    s_waitcnt vmcnt(0)
    v_cmp_gt_u32 vcc, 64, v20
    s_cbranch_vccnz Lln_13
Llo_12:
    s_add_u32 m0, s62, 0
    s_nop 0
    global_load_lds_dwordx4 v104, s[50:51] offset:0 sc1
    global_load_lds_dwordx4 v104, s[50:51] offset:1024 sc1
    global_load_lds_dwordx4 v104, s[50:51] offset:2048 sc1
    global_load_lds_dwordx4 v104, s[50:51] offset:3072 sc1
    s_add_u32 m0, s62, 4096
    s_nop 0
    global_load_lds_dwordx4 v107, s[50:51] offset:0 sc1
    global_load_lds_dwordx4 v107, s[50:51] offset:1024 sc1
    global_load_lds_dwordx4 v107, s[50:51] offset:2048 sc1
    global_load_lds_dwordx4 v107, s[50:51] offset:3072 sc1
    s_waitcnt lgkmcnt(0)
    s_waitcnt vmcnt(12)
    s_barrier
    ds_read_b64_tr_b16 a[184:185], v8 offset:24576
    ds_read_b64_tr_b16 a[186:187], v8 offset:25600
    ds_read_b64_tr_b16 a[188:189], v9 offset:24576
    ds_read_b64_tr_b16 a[190:191], v9 offset:25600
    ds_read_b64_tr_b16 a[248:249], v8 offset:24608
    ds_read_b64_tr_b16 a[250:251], v8 offset:25632
    ds_read_b64_tr_b16 a[252:253], v9 offset:24608
    ds_read_b64_tr_b16 a[254:255], v9 offset:25632
    s_waitcnt lgkmcnt(0)
    s_waitcnt vmcnt(8)
    s_barrier
    ds_read_b64_tr_b16 v[184:185], v10 offset:28672
    ds_read_b64_tr_b16 v[186:187], v10 offset:29696
    ds_read_b64_tr_b16 v[188:189], v11 offset:28672
    ds_read_b64_tr_b16 v[190:191], v11 offset:29696
    ds_read_b64_tr_b16 v[248:249], v10 offset:28680
    ds_read_b64_tr_b16 v[250:251], v10 offset:29704
    ds_read_b64_tr_b16 v[252:253], v11 offset:28680
    ds_read_b64_tr_b16 v[254:255], v11 offset:29704
    s_waitcnt lgkmcnt(0)
    v_mov_b64 v[0:1], 0
    v_mov_b64 v[2:3], 0
    v_mov_b64 v[4:5], 0
    v_mov_b64 v[6:7], 0
    v_mov_b64 v[8:9], 0
    v_mov_b64 v[10:11], 0
    v_mov_b64 v[12:13], 0
    v_mov_b64 v[14:15], 0
    v_mov_b64 v[16:17], 0
    v_mov_b64 v[18:19], 0
    v_mov_b64 v[20:21], 0
    v_mov_b64 v[22:23], 0
    v_mov_b64 v[24:25], 0
    v_mov_b64 v[26:27], 0
    v_mov_b64 v[28:29], 0
    v_mov_b64 v[30:31], 0
    v_mov_b64 v[32:33], 0
    v_mov_b64 v[34:35], 0
    v_mov_b64 v[36:37], 0
    v_mov_b64 v[38:39], 0
    v_mov_b64 v[40:41], 0
    v_mov_b64 v[42:43], 0
    v_mov_b64 v[44:45], 0
    v_mov_b64 v[46:47], 0
    s_waitcnt vmcnt(0)
    v_mov_b32 v113, 0
Lst_14:
    s_barrier
    global_store_dword v106, v113, s[4:5] sc1
    ds_read_b128 v[48:51], v105 offset:0
    ds_read_b128 v[52:55], v105 offset:1024
    ds_read_b128 v[56:59], v105 offset:2048
    ds_read_b128 v[60:63], v105 offset:3072
    s_add_u32 s50, s50, 65536
    s_addc_u32 s51, s51, 0
    s_xor_b32 s62, s62, 0x8000
    ds_read_b128 v[64:67], v105 offset:4096
    s_waitcnt lgkmcnt(4)
    v_mfma_f32_16x16x32_bf16 v[0:3], a[0:3], v[48:51], 0
    v_mfma_f32_16x16x32_bf16 v[4:7], a[64:67], v[48:51], 0
    v_mfma_f32_16x16x32_bf16 v[8:11], a[128:131], v[48:51], 0
    v_cvt_pk_bf16_f32 v80, v24, v25
    v_mfma_f32_16x16x32_bf16 v[12:15], a[192:195], v[48:51], 0
    v_cvt_pk_bf16_f32 v81, v26, v27
    v_mfma_f32_16x16x32_bf16 v[16:19], v[48:51], v[128:131], 0
    v_cvt_pk_bf16_f32 v82, v28, v29
    v_mfma_f32_16x16x32_bf16 v[20:23], v[48:51], v[192:195], 0
    s_add_u32 m0, s62, 0
    ds_read_b128 v[68:71], v105 offset:5120
    s_waitcnt lgkmcnt(4)
    v_mfma_f32_16x16x32_bf16 v[0:3], a[4:7], v[52:55], v[0:3]
    v_cvt_pk_bf16_f32 v83, v30, v31
    v_mfma_f32_16x16x32_bf16 v[4:7], a[68:71], v[52:55], v[4:7]
    global_store_dwordx4 v110, v[80:83], s[58:59] offset:2048 sc1
    v_mfma_f32_16x16x32_bf16 v[8:11], a[132:135], v[52:55], v[8:11]
    v_cvt_pk_bf16_f32 v84, v32, v33
    v_mfma_f32_16x16x32_bf16 v[12:15], a[196:199], v[52:55], v[12:15]
    v_cvt_pk_bf16_f32 v85, v34, v35
    v_mfma_f32_16x16x32_bf16 v[16:19], v[52:55], v[132:135], v[16:19]
    v_cvt_pk_bf16_f32 v86, v36, v37
    v_mfma_f32_16x16x32_bf16 v[20:23], v[52:55], v[196:199], v[20:23]
    global_load_lds_dwordx4 v104, s[50:51] offset:0 sc1
    ds_read_b128 v[72:75], v105 offset:6144
    s_waitcnt lgkmcnt(4)
    v_mfma_f32_16x16x32_bf16 v[0:3], a[8:11], v[56:59], v[0:3]
    v_cvt_pk_bf16_f32 v87, v38, v39
    v_mfma_f32_16x16x32_bf16 v[4:7], a[72:75], v[56:59], v[4:7]
    global_store_dwordx4 v111, v[84:87], s[56:57] sc1
    v_mfma_f32_16x16x32_bf16 v[8:11], a[136:139], v[56:59], v[8:11]
    v_cvt_pk_bf16_f32 v90, v40, v41
    v_mfma_f32_16x16x32_bf16 v[12:15], a[200:203], v[56:59], v[12:15]
    v_cvt_pk_bf16_f32 v91, v42, v43
    v_mfma_f32_16x16x32_bf16 v[16:19], v[56:59], v[136:139], v[16:19]
    global_store_dwordx4 v109, v[88:91], s[56:57] offset:2048 sc1
    v_mfma_f32_16x16x32_bf16 v[20:23], v[56:59], v[200:203], v[20:23]
    global_load_lds_dwordx4 v104, s[50:51] offset:1024 sc1
    ds_read_b128 v[76:79], v105 offset:7168
    s_waitcnt lgkmcnt(4)
    v_mfma_f32_16x16x32_bf16 v[0:3], a[12:15], v[60:63], v[0:3]
    v_cvt_pk_bf16_f32 v94, v44, v45
    v_mfma_f32_16x16x32_bf16 v[4:7], a[76:79], v[60:63], v[4:7]
    v_cvt_pk_bf16_f32 v95, v46, v47
    v_mfma_f32_16x16x32_bf16 v[8:11], a[140:143], v[60:63], v[8:11]
    global_store_dwordx4 v109, v[92:95], s[56:57] offset:3072 sc1
    v_mfma_f32_16x16x32_bf16 v[12:15], a[204:207], v[60:63], v[12:15]
    v_mfma_f32_16x16x32_bf16 v[16:19], v[60:63], v[140:143], v[16:19]
    v_mfma_f32_16x16x32_bf16 v[20:23], v[60:63], v[204:207], v[20:23]
    global_load_lds_dwordx4 v104, s[50:51] offset:2048 sc1
    ds_read_b128 v[48:51], v105 offset:8192
    s_waitcnt lgkmcnt(4)
    v_mfma_f32_16x16x32_bf16 v[0:3], a[16:19], v[64:67], v[0:3]
    v_mfma_f32_16x16x32_bf16 v[4:7], a[80:83], v[64:67], v[4:7]
    v_mfma_f32_16x16x32_bf16 v[8:11], a[144:147], v[64:67], v[8:11]
    v_mfma_f32_16x16x32_bf16 v[12:15], a[208:211], v[64:67], v[12:15]
    v_mfma_f32_16x16x32_bf16 v[16:19], v[64:67], v[144:147], v[16:19]
    v_mfma_f32_16x16x32_bf16 v[20:23], v[64:67], v[208:211], v[20:23]
    global_load_lds_dwordx4 v104, s[50:51] offset:3072 sc1
    ds_read_b128 v[52:55], v105 offset:9216
    s_waitcnt lgkmcnt(4)
    v_mfma_f32_16x16x32_bf16 v[0:3], a[20:23], v[68:71], v[0:3]
    v_mfma_f32_16x16x32_bf16 v[4:7], a[84:87], v[68:71], v[4:7]
    v_mfma_f32_16x16x32_bf16 v[8:11], a[148:151], v[68:71], v[8:11]
    v_mfma_f32_16x16x32_bf16 v[12:15], a[212:215], v[68:71], v[12:15]
    v_mfma_f32_16x16x32_bf16 v[16:19], v[68:71], v[148:151], v[16:19]
    v_mfma_f32_16x16x32_bf16 v[20:23], v[68:71], v[212:215], v[20:23]
    s_add_u32 m0, s62, 4096
    ds_read_b128 v[56:59], v105 offset:10240
    s_waitcnt lgkmcnt(4)
    v_mfma_f32_16x16x32_bf16 v[0:3], a[24:27], v[72:75], v[0:3]
    v_mfma_f32_16x16x32_bf16 v[4:7], a[88:91], v[72:75], v[4:7]
    v_mfma_f32_16x16x32_bf16 v[8:11], a[152:155], v[72:75], v[8:11]
    v_mfma_f32_16x16x32_bf16 v[12:15], a[216:219], v[72:75], v[12:15]
    v_mfma_f32_16x16x32_bf16 v[16:19], v[72:75], v[152:155], v[16:19]
    v_mfma_f32_16x16x32_bf16 v[20:23], v[72:75], v[216:219], v[20:23]
    global_load_lds_dwordx4 v107, s[50:51] offset:0 sc1
    ds_read_b128 v[60:63], v105 offset:11264
    s_waitcnt lgkmcnt(4)
    v_mfma_f32_16x16x32_bf16 v[0:3], a[28:31], v[76:79], v[0:3]
    v_mfma_f32_16x16x32_bf16 v[4:7], a[92:95], v[76:79], v[4:7]
    v_mfma_f32_16x16x32_bf16 v[8:11], a[156:159], v[76:79], v[8:11]
    v_mfma_f32_16x16x32_bf16 v[12:15], a[220:223], v[76:79], v[12:15]
    v_mfma_f32_16x16x32_bf16 v[16:19], v[76:79], v[156:159], v[16:19]
    v_mfma_f32_16x16x32_bf16 v[20:23], v[76:79], v[220:223], v[20:23]
    global_load_lds_dwordx4 v107, s[50:51] offset:1024 sc1
    ds_read_b128 v[64:67], v105 offset:12288
    s_waitcnt lgkmcnt(4)
    v_mfma_f32_16x16x32_bf16 v[0:3], a[32:35], v[48:51], v[0:3]
    v_mfma_f32_16x16x32_bf16 v[4:7], a[96:99], v[48:51], v[4:7]
    v_mfma_f32_16x16x32_bf16 v[8:11], a[160:163], v[48:51], v[8:11]
    v_mfma_f32_16x16x32_bf16 v[12:15], a[224:227], v[48:51], v[12:15]
    v_mfma_f32_16x16x32_bf16 v[16:19], v[48:51], v[160:163], v[16:19]
    v_mfma_f32_16x16x32_bf16 v[20:23], v[48:51], v[224:227], v[20:23]
    global_load_lds_dwordx4 v107, s[50:51] offset:2048 sc1
    ds_read_b128 v[68:71], v105 offset:13312
    s_waitcnt lgkmcnt(4)
    v_mfma_f32_16x16x32_bf16 v[0:3], a[36:39], v[52:55], v[0:3]
    v_mfma_f32_16x16x32_bf16 v[4:7], a[100:103], v[52:55], v[4:7]
    v_mfma_f32_16x16x32_bf16 v[8:11], a[164:167], v[52:55], v[8:11]
    v_mfma_f32_16x16x32_bf16 v[12:15], a[228:231], v[52:55], v[12:15]
    v_mfma_f32_16x16x32_bf16 v[16:19], v[52:55], v[164:167], v[16:19]
    v_mfma_f32_16x16x32_bf16 v[20:23], v[52:55], v[228:231], v[20:23]
    global_load_lds_dwordx4 v107, s[50:51] offset:3072 sc1
    ds_read_b128 v[72:75], v105 offset:14336
    s_waitcnt lgkmcnt(4)
    v_mfma_f32_16x16x32_bf16 v[0:3], a[40:43], v[56:59], v[0:3]
    v_mfma_f32_16x16x32_bf16 v[4:7], a[104:107], v[56:59], v[4:7]
    v_mfma_f32_16x16x32_bf16 v[8:11], a[168:171], v[56:59], v[8:11]
    v_mfma_f32_16x16x32_bf16 v[12:15], a[232:235], v[56:59], v[12:15]
    v_mfma_f32_16x16x32_bf16 v[16:19], v[56:59], v[168:171], v[16:19]
    v_mfma_f32_16x16x32_bf16 v[20:23], v[56:59], v[232:235], v[20:23]
    ds_read_b128 v[76:79], v105 offset:15360
    s_waitcnt lgkmcnt(4)
    v_mfma_f32_16x16x32_bf16 v[0:3], a[44:47], v[60:63], v[0:3]
    v_mfma_f32_16x16x32_bf16 v[4:7], a[108:111], v[60:63], v[4:7]
    v_mfma_f32_16x16x32_bf16 v[8:11], a[172:175], v[60:63], v[8:11]
    v_mfma_f32_16x16x32_bf16 v[12:15], a[236:239], v[60:63], v[12:15]
    v_mfma_f32_16x16x32_bf16 v[16:19], v[60:63], v[172:175], v[16:19]
    v_mfma_f32_16x16x32_bf16 v[20:23], v[60:63], v[236:239], v[20:23]
    ds_read_b128 v[48:51], v105 offset:16384
    s_waitcnt lgkmcnt(4)
    v_mfma_f32_16x16x32_bf16 v[0:3], a[48:51], v[64:67], v[0:3]
    v_mfma_f32_16x16x32_bf16 v[4:7], a[112:115], v[64:67], v[4:7]
    v_mfma_f32_16x16x32_bf16 v[8:11], a[176:179], v[64:67], v[8:11]
    v_mfma_f32_16x16x32_bf16 v[12:15], a[240:243], v[64:67], v[12:15]
    v_mfma_f32_16x16x32_bf16 v[16:19], v[64:67], v[176:179], v[16:19]
    v_mfma_f32_16x16x32_bf16 v[20:23], v[64:67], v[240:243], v[20:23]
    ds_read_b128 v[52:55], v105 offset:17408
    s_waitcnt lgkmcnt(4)
    v_mfma_f32_16x16x32_bf16 v[0:3], a[52:55], v[68:71], v[0:3]
    v_mfma_f32_16x16x32_bf16 v[4:7], a[116:119], v[68:71], v[4:7]
    v_mfma_f32_16x16x32_bf16 v[8:11], a[180:183], v[68:71], v[8:11]
    v_mfma_f32_16x16x32_bf16 v[12:15], a[244:247], v[68:71], v[12:15]
    v_mfma_f32_16x16x32_bf16 v[16:19], v[68:71], v[180:183], v[16:19]
    v_mfma_f32_16x16x32_bf16 v[20:23], v[68:71], v[244:247], v[20:23]
    ds_read_b128 v[56:59], v105 offset:18432
    s_waitcnt lgkmcnt(4)
    v_mfma_f32_16x16x32_bf16 v[0:3], a[56:59], v[72:75], v[0:3]
    v_mfma_f32_16x16x32_bf16 v[4:7], a[120:123], v[72:75], v[4:7]
    v_mfma_f32_16x16x32_bf16 v[8:11], a[184:187], v[72:75], v[8:11]
    v_mfma_f32_16x16x32_bf16 v[12:15], a[248:251], v[72:75], v[12:15]
    v_mfma_f32_16x16x32_bf16 v[16:19], v[72:75], v[184:187], v[16:19]
    v_mfma_f32_16x16x32_bf16 v[20:23], v[72:75], v[248:251], v[20:23]
    ds_read_b128 v[60:63], v105 offset:19456
    s_waitcnt lgkmcnt(4)
    v_mfma_f32_16x16x32_bf16 v[0:3], a[60:63], v[76:79], v[0:3]
    v_mfma_f32_16x16x32_bf16 v[4:7], a[124:127], v[76:79], v[4:7]
    v_mfma_f32_16x16x32_bf16 v[8:11], a[188:191], v[76:79], v[8:11]
    v_mfma_f32_16x16x32_bf16 v[12:15], a[252:255], v[76:79], v[12:15]
    v_mfma_f32_16x16x32_bf16 v[16:19], v[76:79], v[188:191], v[16:19]
    v_mfma_f32_16x16x32_bf16 v[20:23], v[76:79], v[252:255], v[20:23]
    ds_read_b128 v[64:67], v105 offset:20480
    s_waitcnt lgkmcnt(4)
    v_mfma_f32_16x16x32_bf16 v[24:27], a[0:3], v[48:51], 0
    v_mfma_f32_16x16x32_bf16 v[28:31], a[64:67], v[48:51], 0
    v_mfma_f32_16x16x32_bf16 v[32:35], a[128:131], v[48:51], 0
    v_cvt_pk_bf16_f32 v80, v0, v1
    v_mfma_f32_16x16x32_bf16 v[36:39], a[192:195], v[48:51], 0
    v_cvt_pk_bf16_f32 v81, v2, v3
    v_mfma_f32_16x16x32_bf16 v[40:43], v[48:51], v[128:131], 0
    v_cvt_pk_bf16_f32 v82, v4, v5
    v_mfma_f32_16x16x32_bf16 v[44:47], v[48:51], v[192:195], 0
    v_cvt_pk_bf16_f32 v83, v6, v7
    ds_read_b128 v[68:71], v105 offset:21504
    s_waitcnt lgkmcnt(4)
    v_mfma_f32_16x16x32_bf16 v[24:27], a[4:7], v[52:55], v[24:27]
    global_store_dwordx4 v110, v[80:83], s[54:55] offset:-2048 sc1
    v_mfma_f32_16x16x32_bf16 v[28:31], a[68:71], v[52:55], v[28:31]
    v_cvt_pk_bf16_f32 v84, v8, v9
    v_mfma_f32_16x16x32_bf16 v[32:35], a[132:135], v[52:55], v[32:35]
    v_cvt_pk_bf16_f32 v85, v10, v11
    v_mfma_f32_16x16x32_bf16 v[36:39], a[196:199], v[52:55], v[36:39]
    v_cvt_pk_bf16_f32 v86, v12, v13
    v_mfma_f32_16x16x32_bf16 v[40:43], v[52:55], v[132:135], v[40:43]
    v_cvt_pk_bf16_f32 v87, v14, v15
    v_mfma_f32_16x16x32_bf16 v[44:47], v[52:55], v[196:199], v[44:47]
    global_store_dwordx4 v108, v[84:87], s[52:53] sc1
    ds_read_b128 v[72:75], v105 offset:22528
    s_waitcnt lgkmcnt(4)
    v_mfma_f32_16x16x32_bf16 v[24:27], a[8:11], v[56:59], v[24:27]
    v_cvt_pk_bf16_f32 v88, v16, v17
    v_mfma_f32_16x16x32_bf16 v[28:31], a[72:75], v[56:59], v[28:31]
    v_cvt_pk_bf16_f32 v89, v18, v19
    v_mfma_f32_16x16x32_bf16 v[32:35], a[136:139], v[56:59], v[32:35]
    v_cvt_pk_bf16_f32 v92, v20, v21
    v_mfma_f32_16x16x32_bf16 v[36:39], a[200:203], v[56:59], v[36:39]
    v_cvt_pk_bf16_f32 v93, v22, v23
    v_mfma_f32_16x16x32_bf16 v[40:43], v[56:59], v[136:139], v[40:43]
    v_mfma_f32_16x16x32_bf16 v[44:47], v[56:59], v[200:203], v[44:47]
    ds_read_b128 v[76:79], v105 offset:23552
    s_waitcnt lgkmcnt(4)
    v_mfma_f32_16x16x32_bf16 v[24:27], a[12:15], v[60:63], v[24:27]
    v_mfma_f32_16x16x32_bf16 v[28:31], a[76:79], v[60:63], v[28:31]
    v_mfma_f32_16x16x32_bf16 v[32:35], a[140:143], v[60:63], v[32:35]
    v_mfma_f32_16x16x32_bf16 v[36:39], a[204:207], v[60:63], v[36:39]
    v_mfma_f32_16x16x32_bf16 v[40:43], v[60:63], v[140:143], v[40:43]
    v_mfma_f32_16x16x32_bf16 v[44:47], v[60:63], v[204:207], v[44:47]
    ds_read_b128 v[48:51], v105 offset:24576
    s_waitcnt lgkmcnt(4)
    v_mfma_f32_16x16x32_bf16 v[24:27], a[16:19], v[64:67], v[24:27]
    v_mfma_f32_16x16x32_bf16 v[28:31], a[80:83], v[64:67], v[28:31]
    v_mfma_f32_16x16x32_bf16 v[32:35], a[144:147], v[64:67], v[32:35]
    v_mfma_f32_16x16x32_bf16 v[36:39], a[208:211], v[64:67], v[36:39]
    v_mfma_f32_16x16x32_bf16 v[40:43], v[64:67], v[144:147], v[40:43]
    v_mfma_f32_16x16x32_bf16 v[44:47], v[64:67], v[208:211], v[44:47]
    ds_read_b128 v[52:55], v105 offset:25600
    s_waitcnt lgkmcnt(4)
    v_mfma_f32_16x16x32_bf16 v[24:27], a[20:23], v[68:71], v[24:27]
    v_mfma_f32_16x16x32_bf16 v[28:31], a[84:87], v[68:71], v[28:31]
    v_mfma_f32_16x16x32_bf16 v[32:35], a[148:151], v[68:71], v[32:35]
    v_mfma_f32_16x16x32_bf16 v[36:39], a[212:215], v[68:71], v[36:39]
    v_mfma_f32_16x16x32_bf16 v[40:43], v[68:71], v[148:151], v[40:43]
    v_mfma_f32_16x16x32_bf16 v[44:47], v[68:71], v[212:215], v[44:47]
    ds_read_b128 v[56:59], v105 offset:26624
    s_waitcnt lgkmcnt(4)
    v_mfma_f32_16x16x32_bf16 v[24:27], a[24:27], v[72:75], v[24:27]
    v_mfma_f32_16x16x32_bf16 v[28:31], a[88:91], v[72:75], v[28:31]
    v_mfma_f32_16x16x32_bf16 v[32:35], a[152:155], v[72:75], v[32:35]
    v_mfma_f32_16x16x32_bf16 v[36:39], a[216:219], v[72:75], v[36:39]
    v_mfma_f32_16x16x32_bf16 v[40:43], v[72:75], v[152:155], v[40:43]
    v_mfma_f32_16x16x32_bf16 v[44:47], v[72:75], v[216:219], v[44:47]
    ds_read_b128 v[60:63], v105 offset:27648
    s_waitcnt lgkmcnt(4)
    v_mfma_f32_16x16x32_bf16 v[24:27], a[28:31], v[76:79], v[24:27]
    v_mfma_f32_16x16x32_bf16 v[28:31], a[92:95], v[76:79], v[28:31]
    v_mfma_f32_16x16x32_bf16 v[32:35], a[156:159], v[76:79], v[32:35]
    v_mfma_f32_16x16x32_bf16 v[36:39], a[220:223], v[76:79], v[36:39]
    v_mfma_f32_16x16x32_bf16 v[40:43], v[76:79], v[156:159], v[40:43]
    v_mfma_f32_16x16x32_bf16 v[44:47], v[76:79], v[220:223], v[44:47]
    ds_read_b128 v[64:67], v105 offset:28672
    s_waitcnt lgkmcnt(4)
    v_mfma_f32_16x16x32_bf16 v[24:27], a[32:35], v[48:51], v[24:27]
    v_mfma_f32_16x16x32_bf16 v[28:31], a[96:99], v[48:51], v[28:31]
    v_mfma_f32_16x16x32_bf16 v[32:35], a[160:163], v[48:51], v[32:35]
    v_mfma_f32_16x16x32_bf16 v[36:39], a[224:227], v[48:51], v[36:39]
    v_mfma_f32_16x16x32_bf16 v[40:43], v[48:51], v[160:163], v[40:43]
    v_mfma_f32_16x16x32_bf16 v[44:47], v[48:51], v[224:227], v[44:47]
    ds_read_b128 v[68:71], v105 offset:29696
    s_waitcnt lgkmcnt(4)
    v_mfma_f32_16x16x32_bf16 v[24:27], a[36:39], v[52:55], v[24:27]
    v_mfma_f32_16x16x32_bf16 v[28:31], a[100:103], v[52:55], v[28:31]
    v_mfma_f32_16x16x32_bf16 v[32:35], a[164:167], v[52:55], v[32:35]
    v_mfma_f32_16x16x32_bf16 v[36:39], a[228:231], v[52:55], v[36:39]
    v_mfma_f32_16x16x32_bf16 v[40:43], v[52:55], v[164:167], v[40:43]
    v_mfma_f32_16x16x32_bf16 v[44:47], v[52:55], v[228:231], v[44:47]
    ds_read_b128 v[72:75], v105 offset:30720
    s_waitcnt lgkmcnt(4)
    v_mfma_f32_16x16x32_bf16 v[24:27], a[40:43], v[56:59], v[24:27]
    v_mfma_f32_16x16x32_bf16 v[28:31], a[104:107], v[56:59], v[28:31]
    v_mfma_f32_16x16x32_bf16 v[32:35], a[168:171], v[56:59], v[32:35]
    v_mfma_f32_16x16x32_bf16 v[36:39], a[232:235], v[56:59], v[36:39]
    v_mfma_f32_16x16x32_bf16 v[40:43], v[56:59], v[168:171], v[40:43]
    v_mfma_f32_16x16x32_bf16 v[44:47], v[56:59], v[232:235], v[44:47]
    ds_read_b128 v[76:79], v105 offset:31744
    s_waitcnt lgkmcnt(4)
    v_mfma_f32_16x16x32_bf16 v[24:27], a[44:47], v[60:63], v[24:27]
    v_mfma_f32_16x16x32_bf16 v[28:31], a[108:111], v[60:63], v[28:31]
    v_mfma_f32_16x16x32_bf16 v[32:35], a[172:175], v[60:63], v[32:35]
    v_mfma_f32_16x16x32_bf16 v[36:39], a[236:239], v[60:63], v[36:39]
    v_mfma_f32_16x16x32_bf16 v[40:43], v[60:63], v[172:175], v[40:43]
    v_mfma_f32_16x16x32_bf16 v[44:47], v[60:63], v[236:239], v[44:47]
    s_waitcnt lgkmcnt(3)
    v_mfma_f32_16x16x32_bf16 v[24:27], a[48:51], v[64:67], v[24:27]
    v_mfma_f32_16x16x32_bf16 v[28:31], a[112:115], v[64:67], v[28:31]
    v_mfma_f32_16x16x32_bf16 v[32:35], a[176:179], v[64:67], v[32:35]
    v_mfma_f32_16x16x32_bf16 v[36:39], a[240:243], v[64:67], v[36:39]
    v_mfma_f32_16x16x32_bf16 v[40:43], v[64:67], v[176:179], v[40:43]
    v_mfma_f32_16x16x32_bf16 v[44:47], v[64:67], v[240:243], v[44:47]
    s_waitcnt lgkmcnt(2)
    v_mfma_f32_16x16x32_bf16 v[24:27], a[52:55], v[68:71], v[24:27]
    v_mfma_f32_16x16x32_bf16 v[28:31], a[116:119], v[68:71], v[28:31]
    v_mfma_f32_16x16x32_bf16 v[32:35], a[180:183], v[68:71], v[32:35]
    v_mfma_f32_16x16x32_bf16 v[36:39], a[244:247], v[68:71], v[36:39]
    v_mfma_f32_16x16x32_bf16 v[40:43], v[68:71], v[180:183], v[40:43]
    v_mfma_f32_16x16x32_bf16 v[44:47], v[68:71], v[244:247], v[44:47]
    s_waitcnt lgkmcnt(1)
    v_mfma_f32_16x16x32_bf16 v[24:27], a[56:59], v[72:75], v[24:27]
    v_mfma_f32_16x16x32_bf16 v[28:31], a[120:123], v[72:75], v[28:31]
    v_mfma_f32_16x16x32_bf16 v[32:35], a[184:187], v[72:75], v[32:35]
    v_mfma_f32_16x16x32_bf16 v[36:39], a[248:251], v[72:75], v[36:39]
    v_mfma_f32_16x16x32_bf16 v[40:43], v[72:75], v[184:187], v[40:43]
    v_mfma_f32_16x16x32_bf16 v[44:47], v[72:75], v[248:251], v[44:47]
    s_waitcnt lgkmcnt(0)
    v_mfma_f32_16x16x32_bf16 v[24:27], a[60:63], v[76:79], v[24:27]
    v_mfma_f32_16x16x32_bf16 v[28:31], a[124:127], v[76:79], v[28:31]
    v_mfma_f32_16x16x32_bf16 v[32:35], a[188:191], v[76:79], v[32:35]
    v_mfma_f32_16x16x32_bf16 v[36:39], a[252:255], v[76:79], v[36:39]
    v_mfma_f32_16x16x32_bf16 v[40:43], v[76:79], v[188:191], v[40:43]
    v_mfma_f32_16x16x32_bf16 v[44:47], v[76:79], v[252:255], v[44:47]
    v_mov_b32 v113, s49
    s_waitcnt vmcnt(2)
    v_xor_b32 v105, 0x8000, v105
    s_mov_b64 s[56:57], s[52:53]
    s_mov_b64 s[58:59], s[54:55]
    s_add_u32 s52, s52, 1048576
    s_addc_u32 s53, s53, 0
    s_add_u32 s54, s54, 524288
    s_addc_u32 s55, s55, 0
    s_add_u32 s49, s49, 1
    s_cmp_lg_u32 s49, 1
    s_cbranch_scc1 Lx_15
    v_cvt_pk_bf16_f32 v80, v24, v25
    v_cvt_pk_bf16_f32 v81, v26, v27
    v_cvt_pk_bf16_f32 v82, v28, v29
    v_cvt_pk_bf16_f32 v83, v30, v31
    global_store_dwordx4 v110, v[80:83], s[58:59] offset:2048 sc1
    v_cvt_pk_bf16_f32 v84, v32, v33
    v_cvt_pk_bf16_f32 v85, v34, v35
    v_cvt_pk_bf16_f32 v86, v36, v37
    v_cvt_pk_bf16_f32 v87, v38, v39
    global_store_dwordx4 v111, v[84:87], s[56:57] sc1
    v_cvt_pk_bf16_f32 v90, v40, v41
    v_cvt_pk_bf16_f32 v91, v42, v43
    global_store_dwordx4 v109, v[88:91], s[56:57] offset:2048 sc1
    v_cvt_pk_bf16_f32 v94, v44, v45
    v_cvt_pk_bf16_f32 v95, v46, v47
    global_store_dwordx4 v109, v[92:95], s[56:57] offset:3072 sc1
    v_mov_b32 v113, 1
    s_waitcnt vmcnt(0)
Lx_15:
    s_cmp_lt_u32 s49, 32
    s_cbranch_scc1 Lst_14
    v_cvt_pk_bf16_f32 v80, v24, v25
    v_cvt_pk_bf16_f32 v81, v26, v27
    v_cvt_pk_bf16_f32 v82, v28, v29
    v_cvt_pk_bf16_f32 v83, v30, v31
    global_store_dwordx4 v110, v[80:83], s[58:59] offset:2048 sc1
    v_cvt_pk_bf16_f32 v84, v32, v33
    v_cvt_pk_bf16_f32 v85, v34, v35
    v_cvt_pk_bf16_f32 v86, v36, v37
    v_cvt_pk_bf16_f32 v87, v38, v39
    global_store_dwordx4 v111, v[84:87], s[56:57] sc1
    v_cvt_pk_bf16_f32 v90, v40, v41
    v_cvt_pk_bf16_f32 v91, v42, v43
    global_store_dwordx4 v109, v[88:91], s[56:57] offset:2048 sc1
    v_cvt_pk_bf16_f32 v94, v44, v45
    v_cvt_pk_bf16_f32 v95, v46, v47
    global_store_dwordx4 v109, v[92:95], s[56:57] offset:3072 sc1
    v_mov_b32 v113, 32
    s_waitcnt vmcnt(0)
    s_barrier
    global_store_dword v106, v113, s[4:5] sc1
    s_branch L_fin
L_ffn:
    s_mov_b32 s36, s8
    s_cmp_gt_u32 s8, 27
    s_cbranch_scc1 L_more
    s_load_dwordx4 s[40:43], s[0:1], 64
    v_and_b32 v1, 63, v0
    v_lshrrev_b32 v2, 4, v1
    v_and_b32 v3, 15, v1
    v_lshrrev_b32 v4, 2, v3
    v_and_b32 v5, 3, v1
    s_lshr_b32 s47, s36, 1
    s_and_b32 s48, s36, 1
    s_lshl_b32 s46, s9, 15
    s_add_u32 s46, s46, 0x8000
    s_lshl_b32 s64, s47, 8
    v_mov_b32 v6, s64
    s_waitcnt lgkmcnt(0)
    v_lshlrev_b32 v104, 4, v1
    v_mov_b32 v105, v104
    s_lshl_b32 s64, s48, 15
    s_lshl_b32 s65, s9, 13
    s_add_u32 s64, s64, s65
    s_add_u32 s64, s64, 1048576
    s_mov_b32 s62, s65
    s_mov_b32 s49, 0
    s_add_u32 s50, s4, s64
    s_addc_u32 s51, s5, 0
    s_lshl_b32 s64, s48, 17
    s_lshl_b32 s65, s47, 2
    s_add_u32 s65, s65, s9
    s_lshl_b32 s66, s65, 10
    s_add_u32 s64, s64, s66
    s_add_u32 s64, s64, 101515264
    s_add_u32 s56, s4, s64
    s_addc_u32 s57, s5, 0
    s_add_u32 s52, s56, 196608
    s_addc_u32 s53, s57, 0
    s_lshl_b32 s64, s48, 13
    s_lshl_b32 s65, s65, 7
    s_add_u32 s64, s64, s65
    s_add_u32 s64, s64, 794624
    v_mov_b32 v106, s64
    v_add_u32 v107, 4096, v104
    s_cmp_lg_u32 s9, 0
    s_cbranch_scc1 Lgs_17
    v_mov_b32 v21, 160
Lgo_16:
    global_load_dword v20, v21, s[6:7] sc1
    s_sub_u32 s27, s27, 1
    s_cbranch_scc1 L_fin
    s_waitcnt vmcnt(0)
    v_cmp_gt_u32 vcc, 1, v20
    s_cbranch_vccnz Lgo_16
Lgs_17:
    s_barrier
    s_mul_i32 s64, s9, 57344
    v_mul_u32_u24 v7, 3584, v2
    v_add3_u32 v6, v6, v7, s64
    v_lshlrev_b32 v7, 2, v2
    v_xor_b32 v7, v7, v3
    v_lshl_add_u32 v6, v7, 4, v6
    v_and_b32 v7, 1, v2
    v_lshl_add_u32 v7, v7, 3, v4
    v_lshlrev_b32 v7, 8, v7
    v_lshrrev_b32 v8, 1, v2
    v_lshl_add_u32 v7, v8, 15, v7
    v_xor_b32 v8, s9, v4
    v_lshl_add_u32 v7, v8, 6, v7
    v_add_u32 v7, 32768, v7
    v_lshl_add_u32 v8, v5, 3, v7
    v_lshl_add_u32 v10, v5, 4, v7
    v_add_u32 v9, 0x10000, v8
    v_add_u32 v11, 0x10000, v10
    s_add_u32 m0, s46, 0
    v_add_u32 v7, 0, v6
    global_load_lds_dwordx4 v7, s[40:41]
    s_add_u32 m0, s46, 1024
    v_add_u32 v7, 14336, v6
    global_load_lds_dwordx4 v7, s[40:41]
    s_add_u32 m0, s46, 2048
    v_add_u32 v7, 28672, v6
    global_load_lds_dwordx4 v7, s[40:41]
    s_add_u32 m0, s46, 3072
    v_add_u32 v7, 43008, v6
    global_load_lds_dwordx4 v7, s[40:41]
    s_add_u32 m0, s46, 4096
    v_add_u32 v7, 0, v6
    global_load_lds_dwordx4 v7, s[42:43]
    s_add_u32 m0, s46, 5120
    v_add_u32 v7, 14336, v6
    global_load_lds_dwordx4 v7, s[42:43]
    s_add_u32 m0, s46, 6144
    v_add_u32 v7, 28672, v6
    global_load_lds_dwordx4 v7, s[42:43]
    s_add_u32 m0, s46, 7168
    v_add_u32 v7, 43008, v6
    global_load_lds_dwordx4 v7, s[42:43]
    s_add_u32 m0, s46, 8192
    v_add_u32 v7, 229376, v6
    global_load_lds_dwordx4 v7, s[40:41]
    s_add_u32 m0, s46, 9216
    v_add_u32 v7, 243712, v6
    global_load_lds_dwordx4 v7, s[40:41]
    s_add_u32 m0, s46, 10240
    v_add_u32 v7, 258048, v6
    global_load_lds_dwordx4 v7, s[40:41]
    s_add_u32 m0, s46, 11264
    v_add_u32 v7, 272384, v6
    global_load_lds_dwordx4 v7, s[40:41]
    s_add_u32 m0, s46, 12288
    v_add_u32 v7, 229376, v6
    global_load_lds_dwordx4 v7, s[42:43]
    s_add_u32 m0, s46, 13312
    v_add_u32 v7, 243712, v6
    global_load_lds_dwordx4 v7, s[42:43]
    s_add_u32 m0, s46, 14336
    v_add_u32 v7, 258048, v6
    global_load_lds_dwordx4 v7, s[42:43]
    s_add_u32 m0, s46, 15360
    v_add_u32 v7, 272384, v6
    global_load_lds_dwordx4 v7, s[42:43]
    s_add_u32 m0, s46, 16384
    v_add_u32 v7, 458752, v6
    global_load_lds_dwordx4 v7, s[40:41]
    s_add_u32 m0, s46, 17408
    v_add_u32 v7, 473088, v6
    global_load_lds_dwordx4 v7, s[40:41]
    s_add_u32 m0, s46, 18432
    v_add_u32 v7, 487424, v6
    global_load_lds_dwordx4 v7, s[40:41]
    s_add_u32 m0, s46, 19456
    v_add_u32 v7, 501760, v6
    global_load_lds_dwordx4 v7, s[40:41]
    s_add_u32 m0, s46, 20480
    v_add_u32 v7, 458752, v6
    global_load_lds_dwordx4 v7, s[42:43]
    s_add_u32 m0, s46, 21504
    v_add_u32 v7, 473088, v6
    global_load_lds_dwordx4 v7, s[42:43]
    s_add_u32 m0, s46, 22528
    v_add_u32 v7, 487424, v6
    global_load_lds_dwordx4 v7, s[42:43]
    s_add_u32 m0, s46, 23552
    v_add_u32 v7, 501760, v6
    global_load_lds_dwordx4 v7, s[42:43]
    s_add_u32 m0, s46, 24576
    v_add_u32 v7, 688128, v6
    global_load_lds_dwordx4 v7, s[40:41]
    s_add_u32 m0, s46, 25600
    v_add_u32 v7, 702464, v6
    global_load_lds_dwordx4 v7, s[40:41]
    s_add_u32 m0, s46, 26624
    v_add_u32 v7, 716800, v6
    global_load_lds_dwordx4 v7, s[40:41]
    s_add_u32 m0, s46, 27648
    v_add_u32 v7, 731136, v6
    global_load_lds_dwordx4 v7, s[40:41]
    s_add_u32 m0, s46, 28672
    v_add_u32 v7, 688128, v6
    global_load_lds_dwordx4 v7, s[42:43]
    s_add_u32 m0, s46, 29696
    v_add_u32 v7, 702464, v6
    global_load_lds_dwordx4 v7, s[42:43]
    s_add_u32 m0, s46, 30720
    v_add_u32 v7, 716800, v6
    global_load_lds_dwordx4 v7, s[42:43]
    s_add_u32 m0, s46, 31744
    v_add_u32 v7, 731136, v6
    global_load_lds_dwordx4 v7, s[42:43]
    s_waitcnt vmcnt(28)
    s_barrier
    ds_read_b64_tr_b16 a[0:1], v10 offset:0
    ds_read_b64_tr_b16 a[2:3], v10 offset:1024
    ds_read_b64_tr_b16 a[4:5], v11 offset:0
    ds_read_b64_tr_b16 a[6:7], v11 offset:1024
    ds_read_b64_tr_b16 a[64:65], v10 offset:8
    ds_read_b64_tr_b16 a[66:67], v10 offset:1032
    ds_read_b64_tr_b16 a[68:69], v11 offset:8
    ds_read_b64_tr_b16 a[70:71], v11 offset:1032
    s_waitcnt lgkmcnt(0)
    s_waitcnt vmcnt(24)
    s_barrier
    ds_read_b64_tr_b16 a[128:129], v10 offset:4096
    ds_read_b64_tr_b16 a[130:131], v10 offset:5120
    ds_read_b64_tr_b16 a[132:133], v11 offset:4096
    ds_read_b64_tr_b16 a[134:135], v11 offset:5120
    ds_read_b64_tr_b16 a[192:193], v10 offset:4104
    ds_read_b64_tr_b16 a[194:195], v10 offset:5128
    ds_read_b64_tr_b16 a[196:197], v11 offset:4104
    ds_read_b64_tr_b16 a[198:199], v11 offset:5128
    s_add_u32 m0, s46, 0
    v_add_u32 v7, 917504, v6
    global_load_lds_dwordx4 v7, s[40:41]
    s_add_u32 m0, s46, 1024
    v_add_u32 v7, 931840, v6
    global_load_lds_dwordx4 v7, s[40:41]
    s_add_u32 m0, s46, 2048
    v_add_u32 v7, 946176, v6
    global_load_lds_dwordx4 v7, s[40:41]
    s_add_u32 m0, s46, 3072
    v_add_u32 v7, 960512, v6
    global_load_lds_dwordx4 v7, s[40:41]
    s_waitcnt lgkmcnt(0)
    s_waitcnt vmcnt(24)
    s_barrier
    ds_read_b64_tr_b16 a[8:9], v10 offset:8192
    ds_read_b64_tr_b16 a[10:11], v10 offset:9216
    ds_read_b64_tr_b16 a[12:13], v11 offset:8192
    ds_read_b64_tr_b16 a[14:15], v11 offset:9216
    ds_read_b64_tr_b16 a[72:73], v10 offset:8200
    ds_read_b64_tr_b16 a[74:75], v10 offset:9224
    ds_read_b64_tr_b16 a[76:77], v11 offset:8200
    ds_read_b64_tr_b16 a[78:79], v11 offset:9224
    s_add_u32 m0, s46, 4096
    v_add_u32 v7, 917504, v6
    global_load_lds_dwordx4 v7, s[42:43]
    s_add_u32 m0, s46, 5120
    v_add_u32 v7, 931840, v6
    global_load_lds_dwordx4 v7, s[42:43]
    s_add_u32 m0, s46, 6144
    v_add_u32 v7, 946176, v6
    global_load_lds_dwordx4 v7, s[42:43]
    s_add_u32 m0, s46, 7168
    v_add_u32 v7, 960512, v6
    global_load_lds_dwordx4 v7, s[42:43]
    s_waitcnt lgkmcnt(0)
    s_waitcnt vmcnt(24)
    s_barrier
    ds_read_b64_tr_b16 a[136:137], v10 offset:12288
    ds_read_b64_tr_b16 a[138:139], v10 offset:13312
    ds_read_b64_tr_b16 a[140:141], v11 offset:12288
    ds_read_b64_tr_b16 a[142:143], v11 offset:13312
    ds_read_b64_tr_b16 a[200:201], v10 offset:12296
    ds_read_b64_tr_b16 a[202:203], v10 offset:13320
    ds_read_b64_tr_b16 a[204:205], v11 offset:12296
    ds_read_b64_tr_b16 a[206:207], v11 offset:13320
    s_add_u32 m0, s46, 8192
    v_add_u32 v7, 1146880, v6
    global_load_lds_dwordx4 v7, s[40:41]
    s_add_u32 m0, s46, 9216
    v_add_u32 v7, 1161216, v6
    global_load_lds_dwordx4 v7, s[40:41]
    s_add_u32 m0, s46, 10240
    v_add_u32 v7, 1175552, v6
    global_load_lds_dwordx4 v7, s[40:41]
    s_add_u32 m0, s46, 11264
    v_add_u32 v7, 1189888, v6
    global_load_lds_dwordx4 v7, s[40:41]
    s_waitcnt lgkmcnt(0)
    s_waitcnt vmcnt(24)
    s_barrier
    ds_read_b64_tr_b16 a[16:17], v10 offset:16384
    ds_read_b64_tr_b16 a[18:19], v10 offset:17408
    ds_read_b64_tr_b16 a[20:21], v11 offset:16384
    ds_read_b64_tr_b16 a[22:23], v11 offset:17408
    ds_read_b64_tr_b16 a[80:81], v10 offset:16392
    ds_read_b64_tr_b16 a[82:83], v10 offset:17416
    ds_read_b64_tr_b16 a[84:85], v11 offset:16392
    ds_read_b64_tr_b16 a[86:87], v11 offset:17416
    s_add_u32 m0, s46, 12288
    v_add_u32 v7, 1146880, v6
    global_load_lds_dwordx4 v7, s[42:43]
    s_add_u32 m0, s46, 13312
    v_add_u32 v7, 1161216, v6
    global_load_lds_dwordx4 v7, s[42:43]
    s_add_u32 m0, s46, 14336
    v_add_u32 v7, 1175552, v6
    global_load_lds_dwordx4 v7, s[42:43]
    s_add_u32 m0, s46, 15360
    v_add_u32 v7, 1189888, v6
    global_load_lds_dwordx4 v7, s[42:43]
    s_waitcnt lgkmcnt(0)
    s_waitcnt vmcnt(24)
    s_barrier
    ds_read_b64_tr_b16 a[144:145], v10 offset:20480
    ds_read_b64_tr_b16 a[146:147], v10 offset:21504
    ds_read_b64_tr_b16 a[148:149], v11 offset:20480
    ds_read_b64_tr_b16 a[150:151], v11 offset:21504
    ds_read_b64_tr_b16 a[208:209], v10 offset:20488
    ds_read_b64_tr_b16 a[210:211], v10 offset:21512
    ds_read_b64_tr_b16 a[212:213], v11 offset:20488
    ds_read_b64_tr_b16 a[214:215], v11 offset:21512
    s_add_u32 m0, s46, 16384
    v_add_u32 v7, 1376256, v6
    global_load_lds_dwordx4 v7, s[40:41]
    s_add_u32 m0, s46, 17408
    v_add_u32 v7, 1390592, v6
    global_load_lds_dwordx4 v7, s[40:41]
    s_add_u32 m0, s46, 18432
    v_add_u32 v7, 1404928, v6
    global_load_lds_dwordx4 v7, s[40:41]
    s_add_u32 m0, s46, 19456
    v_add_u32 v7, 1419264, v6
    global_load_lds_dwordx4 v7, s[40:41]
    v_mov_b32 v21, 128
    global_load_dword v20, v21, s[6:7] sc1
    s_waitcnt lgkmcnt(0)
    s_waitcnt vmcnt(24)
    s_barrier
    ds_read_b64_tr_b16 a[24:25], v10 offset:24576
    ds_read_b64_tr_b16 a[26:27], v10 offset:25600
    ds_read_b64_tr_b16 a[28:29], v11 offset:24576
    ds_read_b64_tr_b16 a[30:31], v11 offset:25600
    ds_read_b64_tr_b16 a[88:89], v10 offset:24584
    ds_read_b64_tr_b16 a[90:91], v10 offset:25608
    ds_read_b64_tr_b16 a[92:93], v11 offset:24584
    ds_read_b64_tr_b16 a[94:95], v11 offset:25608
    s_add_u32 m0, s46, 20480
    v_add_u32 v7, 1376256, v6
    global_load_lds_dwordx4 v7, s[42:43]
    s_add_u32 m0, s46, 21504
    v_add_u32 v7, 1390592, v6
    global_load_lds_dwordx4 v7, s[42:43]
    s_add_u32 m0, s46, 22528
    v_add_u32 v7, 1404928, v6
    global_load_lds_dwordx4 v7, s[42:43]
    s_add_u32 m0, s46, 23552
    v_add_u32 v7, 1419264, v6
    global_load_lds_dwordx4 v7, s[42:43]
    s_waitcnt lgkmcnt(0)
    s_waitcnt vmcnt(24)
    s_barrier
    ds_read_b64_tr_b16 a[152:153], v10 offset:28672
    ds_read_b64_tr_b16 a[154:155], v10 offset:29696
    ds_read_b64_tr_b16 a[156:157], v11 offset:28672
    ds_read_b64_tr_b16 a[158:159], v11 offset:29696
    ds_read_b64_tr_b16 a[216:217], v10 offset:28680
    ds_read_b64_tr_b16 a[218:219], v10 offset:29704
    ds_read_b64_tr_b16 a[220:221], v11 offset:28680
    ds_read_b64_tr_b16 a[222:223], v11 offset:29704
    s_add_u32 m0, s46, 24576
    v_add_u32 v7, 1605632, v6
    global_load_lds_dwordx4 v7, s[40:41]
    s_add_u32 m0, s46, 25600
    v_add_u32 v7, 1619968, v6
    global_load_lds_dwordx4 v7, s[40:41]
    s_add_u32 m0, s46, 26624
    v_add_u32 v7, 1634304, v6
    global_load_lds_dwordx4 v7, s[40:41]
    s_add_u32 m0, s46, 27648
    v_add_u32 v7, 1648640, v6
    global_load_lds_dwordx4 v7, s[40:41]
    s_waitcnt lgkmcnt(0)
    s_waitcnt vmcnt(24)
    s_barrier
    ds_read_b64_tr_b16 a[32:33], v10 offset:0
    ds_read_b64_tr_b16 a[34:35], v10 offset:1024
    ds_read_b64_tr_b16 a[36:37], v11 offset:0
    ds_read_b64_tr_b16 a[38:39], v11 offset:1024
    ds_read_b64_tr_b16 a[96:97], v10 offset:8
    ds_read_b64_tr_b16 a[98:99], v10 offset:1032
    ds_read_b64_tr_b16 a[100:101], v11 offset:8
    ds_read_b64_tr_b16 a[102:103], v11 offset:1032
    s_add_u32 m0, s46, 28672
    v_add_u32 v7, 1605632, v6
    global_load_lds_dwordx4 v7, s[42:43]
    s_add_u32 m0, s46, 29696
    v_add_u32 v7, 1619968, v6
    global_load_lds_dwordx4 v7, s[42:43]
    s_add_u32 m0, s46, 30720
    v_add_u32 v7, 1634304, v6
    global_load_lds_dwordx4 v7, s[42:43]
    s_add_u32 m0, s46, 31744
    v_add_u32 v7, 1648640, v6
    global_load_lds_dwordx4 v7, s[42:43]
    s_waitcnt lgkmcnt(0)
    s_waitcnt vmcnt(24)
    s_barrier
    ds_read_b64_tr_b16 a[160:161], v10 offset:4096
    ds_read_b64_tr_b16 a[162:163], v10 offset:5120
    ds_read_b64_tr_b16 a[164:165], v11 offset:4096
    ds_read_b64_tr_b16 a[166:167], v11 offset:5120
    ds_read_b64_tr_b16 a[224:225], v10 offset:4104
    ds_read_b64_tr_b16 a[226:227], v10 offset:5128
    ds_read_b64_tr_b16 a[228:229], v11 offset:4104
    ds_read_b64_tr_b16 a[230:231], v11 offset:5128
    s_waitcnt lgkmcnt(0)
    s_waitcnt vmcnt(20)
    s_barrier
    ds_read_b64_tr_b16 a[40:41], v10 offset:8192
    ds_read_b64_tr_b16 a[42:43], v10 offset:9216
    ds_read_b64_tr_b16 a[44:45], v11 offset:8192
    ds_read_b64_tr_b16 a[46:47], v11 offset:9216
    ds_read_b64_tr_b16 a[104:105], v10 offset:8200
    ds_read_b64_tr_b16 a[106:107], v10 offset:9224
    ds_read_b64_tr_b16 a[108:109], v11 offset:8200
    ds_read_b64_tr_b16 a[110:111], v11 offset:9224
    s_waitcnt lgkmcnt(0)
    s_waitcnt vmcnt(16)
    s_barrier
    ds_read_b64_tr_b16 a[168:169], v10 offset:12288
    ds_read_b64_tr_b16 a[170:171], v10 offset:13312
    ds_read_b64_tr_b16 a[172:173], v11 offset:12288
    ds_read_b64_tr_b16 a[174:175], v11 offset:13312
    ds_read_b64_tr_b16 a[232:233], v10 offset:12296
    ds_read_b64_tr_b16 a[234:235], v10 offset:13320
    ds_read_b64_tr_b16 a[236:237], v11 offset:12296
    ds_read_b64_tr_b16 a[238:239], v11 offset:13320
    s_waitcnt lgkmcnt(0)
    s_waitcnt vmcnt(12)
    s_barrier
    ds_read_b64_tr_b16 a[48:49], v10 offset:16384
    ds_read_b64_tr_b16 a[50:51], v10 offset:17408
    ds_read_b64_tr_b16 a[52:53], v11 offset:16384
    ds_read_b64_tr_b16 a[54:55], v11 offset:17408
    ds_read_b64_tr_b16 a[112:113], v10 offset:16392
    ds_read_b64_tr_b16 a[114:115], v10 offset:17416
    ds_read_b64_tr_b16 a[116:117], v11 offset:16392
    ds_read_b64_tr_b16 a[118:119], v11 offset:17416
    s_waitcnt lgkmcnt(0)
    s_waitcnt vmcnt(8)
    s_barrier
    ds_read_b64_tr_b16 a[176:177], v10 offset:20480
    ds_read_b64_tr_b16 a[178:179], v10 offset:21504
    ds_read_b64_tr_b16 a[180:181], v11 offset:20480
    ds_read_b64_tr_b16 a[182:183], v11 offset:21504
    ds_read_b64_tr_b16 a[240:241], v10 offset:20488
    ds_read_b64_tr_b16 a[242:243], v10 offset:21512
    ds_read_b64_tr_b16 a[244:245], v11 offset:20488
    ds_read_b64_tr_b16 a[246:247], v11 offset:21512
    v_cmp_gt_u32 vcc, 64, v20
    s_cbranch_vccz Llo_18
    v_mov_b32 v21, 128
Lln_19:
    global_load_dword v20, v21, s[6:7] sc1
    s_sub_u32 s27, s27, 1
    s_cbranch_scc1 L_fin
    s_waitcnt vmcnt(0)
    v_cmp_gt_u32 vcc, 64, v20
    s_cbranch_vccnz Lln_19
Llo_18:
    s_add_u32 m0, s62, 0
    s_nop 0
    global_load_lds_dwordx4 v104, s[50:51] offset:0 sc1
    global_load_lds_dwordx4 v104, s[50:51] offset:1024 sc1
    global_load_lds_dwordx4 v104, s[50:51] offset:2048 sc1
    global_load_lds_dwordx4 v104, s[50:51] offset:3072 sc1
    s_add_u32 m0, s62, 4096
    s_nop 0
    global_load_lds_dwordx4 v107, s[50:51] offset:0 sc1
    global_load_lds_dwordx4 v107, s[50:51] offset:1024 sc1
    global_load_lds_dwordx4 v107, s[50:51] offset:2048 sc1
    global_load_lds_dwordx4 v107, s[50:51] offset:3072 sc1
    s_waitcnt lgkmcnt(0)
    s_waitcnt vmcnt(12)
    s_barrier
    ds_read_b64_tr_b16 a[56:57], v10 offset:24576
    ds_read_b64_tr_b16 a[58:59], v10 offset:25600
    ds_read_b64_tr_b16 a[60:61], v11 offset:24576
    ds_read_b64_tr_b16 a[62:63], v11 offset:25600
    ds_read_b64_tr_b16 a[120:121], v10 offset:24584
    ds_read_b64_tr_b16 a[122:123], v10 offset:25608
    ds_read_b64_tr_b16 a[124:125], v11 offset:24584
    ds_read_b64_tr_b16 a[126:127], v11 offset:25608
    s_waitcnt lgkmcnt(0)
    s_waitcnt vmcnt(8)
    s_barrier
    ds_read_b64_tr_b16 a[184:185], v10 offset:28672
    ds_read_b64_tr_b16 a[186:187], v10 offset:29696
    ds_read_b64_tr_b16 a[188:189], v11 offset:28672
    ds_read_b64_tr_b16 a[190:191], v11 offset:29696
    ds_read_b64_tr_b16 a[248:249], v10 offset:28680
    ds_read_b64_tr_b16 a[250:251], v10 offset:29704
    ds_read_b64_tr_b16 a[252:253], v11 offset:28680
    ds_read_b64_tr_b16 a[254:255], v11 offset:29704
    s_waitcnt lgkmcnt(0)
    v_mov_b64 v[0:1], 0
    v_mov_b64 v[2:3], 0
    v_mov_b64 v[4:5], 0
    v_mov_b64 v[6:7], 0
    v_mov_b64 v[8:9], 0
    v_mov_b64 v[10:11], 0
    v_mov_b64 v[12:13], 0
    v_mov_b64 v[14:15], 0
    v_mov_b64 v[16:17], 0
    v_mov_b64 v[18:19], 0
    v_mov_b64 v[20:21], 0
    v_mov_b64 v[22:23], 0
    v_mov_b64 v[24:25], 0
    v_mov_b64 v[26:27], 0
    v_mov_b64 v[28:29], 0
    v_mov_b64 v[30:31], 0
    v_mov_b64 v[32:33], 0
    v_mov_b64 v[34:35], 0
    v_mov_b64 v[36:37], 0
    v_mov_b64 v[38:39], 0
    v_mov_b64 v[40:41], 0
    v_mov_b64 v[42:43], 0
    v_mov_b64 v[44:45], 0
    v_mov_b64 v[46:47], 0
    s_waitcnt vmcnt(0)
    v_mov_b32 v112, 0xbdd2d3e8
    v_mov_b32 v113, 0
Lst_20:
    s_barrier
    ds_read_b128 v[48:51], v105 offset:0
    ds_read_b128 v[52:55], v105 offset:1024
    ds_read_b128 v[56:59], v105 offset:2048
    ds_read_b128 v[60:63], v105 offset:3072
    s_add_u32 s50, s50, 65536
    s_addc_u32 s51, s51, 0
    s_xor_b32 s62, s62, 0x8000
    ds_read_b128 v[64:67], v105 offset:4096
    s_waitcnt lgkmcnt(4)
    v_mfma_f32_16x16x32_bf16 v[0:3], a[0:3], v[48:51], 0
    v_mfma_f32_16x16x32_bf16 v[4:7], a[64:67], v[48:51], 0
    v_mfma_f32_16x16x32_bf16 v[8:11], a[128:131], v[48:51], 0
    v_mul_f32 v88, v16, v16
    v_mul_f32 v24, v24, v16
    v_mfma_f32_16x16x32_bf16 v[12:15], a[192:195], v[48:51], 0
    s_add_u32 m0, s62, 0
    ds_read_b128 v[68:71], v105 offset:5120
    s_waitcnt lgkmcnt(4)
    v_mfma_f32_16x16x32_bf16 v[0:3], a[4:7], v[52:55], v[0:3]
    v_fmaak_f32 v88, v88, v112, 0xc0135761
    v_mul_f32 v88, v88, v16
    v_mfma_f32_16x16x32_bf16 v[4:7], a[68:71], v[52:55], v[4:7]
    v_exp_f32 v88, v88
    v_mul_f32 v89, v17, v17
    v_mfma_f32_16x16x32_bf16 v[8:11], a[132:135], v[52:55], v[8:11]
    v_mul_f32 v25, v25, v17
    v_fmaak_f32 v89, v89, v112, 0xc0135761
    v_mfma_f32_16x16x32_bf16 v[12:15], a[196:199], v[52:55], v[12:15]
    global_load_lds_dwordx4 v104, s[50:51] offset:0 sc1
    ds_read_b128 v[72:75], v105 offset:6144
    s_waitcnt lgkmcnt(4)
    v_mfma_f32_16x16x32_bf16 v[0:3], a[8:11], v[56:59], v[0:3]
    v_mul_f32 v89, v89, v17
    v_exp_f32 v89, v89
    v_mfma_f32_16x16x32_bf16 v[4:7], a[72:75], v[56:59], v[4:7]
    v_mul_f32 v90, v18, v18
    v_mul_f32 v26, v26, v18
    v_mfma_f32_16x16x32_bf16 v[8:11], a[136:139], v[56:59], v[8:11]
    v_fmaak_f32 v90, v90, v112, 0xc0135761
    v_mul_f32 v90, v90, v18
    v_mfma_f32_16x16x32_bf16 v[12:15], a[200:203], v[56:59], v[12:15]
    global_load_lds_dwordx4 v104, s[50:51] offset:1024 sc1
    ds_read_b128 v[76:79], v105 offset:7168
    s_waitcnt lgkmcnt(4)
    v_mfma_f32_16x16x32_bf16 v[0:3], a[12:15], v[60:63], v[0:3]
    v_exp_f32 v90, v90
    v_mul_f32 v91, v19, v19
    v_mfma_f32_16x16x32_bf16 v[4:7], a[76:79], v[60:63], v[4:7]
    v_mul_f32 v27, v27, v19
    v_fmaak_f32 v91, v91, v112, 0xc0135761
    v_mfma_f32_16x16x32_bf16 v[8:11], a[140:143], v[60:63], v[8:11]
    v_mul_f32 v91, v91, v19
    v_exp_f32 v91, v91
    v_mfma_f32_16x16x32_bf16 v[12:15], a[204:207], v[60:63], v[12:15]
    global_load_lds_dwordx4 v104, s[50:51] offset:2048 sc1
    ds_read_b128 v[48:51], v105 offset:8192
    s_waitcnt lgkmcnt(4)
    v_mfma_f32_16x16x32_bf16 v[0:3], a[16:19], v[64:67], v[0:3]
    v_mul_f32 v92, v20, v20
    v_mul_f32 v28, v28, v20
    v_mfma_f32_16x16x32_bf16 v[4:7], a[80:83], v[64:67], v[4:7]
    v_fmaak_f32 v92, v92, v112, 0xc0135761
    v_mul_f32 v92, v92, v20
    v_mfma_f32_16x16x32_bf16 v[8:11], a[144:147], v[64:67], v[8:11]
    v_exp_f32 v92, v92
    v_mul_f32 v93, v21, v21
    v_mfma_f32_16x16x32_bf16 v[12:15], a[208:211], v[64:67], v[12:15]
    global_load_lds_dwordx4 v104, s[50:51] offset:3072 sc1
    ds_read_b128 v[52:55], v105 offset:9216
    s_waitcnt lgkmcnt(4)
    v_mfma_f32_16x16x32_bf16 v[0:3], a[20:23], v[68:71], v[0:3]
    v_mul_f32 v29, v29, v21
    v_fmaak_f32 v93, v93, v112, 0xc0135761
    v_mfma_f32_16x16x32_bf16 v[4:7], a[84:87], v[68:71], v[4:7]
    v_mul_f32 v93, v93, v21
    v_exp_f32 v93, v93
    v_mfma_f32_16x16x32_bf16 v[8:11], a[148:151], v[68:71], v[8:11]
    v_mul_f32 v94, v22, v22
    v_mul_f32 v30, v30, v22
    v_mfma_f32_16x16x32_bf16 v[12:15], a[212:215], v[68:71], v[12:15]
    s_add_u32 m0, s62, 4096
    ds_read_b128 v[56:59], v105 offset:10240
    s_waitcnt lgkmcnt(4)
    v_mfma_f32_16x16x32_bf16 v[0:3], a[24:27], v[72:75], v[0:3]
    v_fmaak_f32 v94, v94, v112, 0xc0135761
    v_mul_f32 v94, v94, v22
    v_mfma_f32_16x16x32_bf16 v[4:7], a[88:91], v[72:75], v[4:7]
    v_exp_f32 v94, v94
    v_mul_f32 v95, v23, v23
    v_mfma_f32_16x16x32_bf16 v[8:11], a[152:155], v[72:75], v[8:11]
    v_mul_f32 v31, v31, v23
    v_fmaak_f32 v95, v95, v112, 0xc0135761
    v_mfma_f32_16x16x32_bf16 v[12:15], a[216:219], v[72:75], v[12:15]
    global_load_lds_dwordx4 v107, s[50:51] offset:0 sc1
    ds_read_b128 v[60:63], v105 offset:11264
    s_waitcnt lgkmcnt(4)
    v_mfma_f32_16x16x32_bf16 v[0:3], a[28:31], v[76:79], v[0:3]
    v_mul_f32 v95, v95, v23
    v_exp_f32 v95, v95
    v_mfma_f32_16x16x32_bf16 v[4:7], a[92:95], v[76:79], v[4:7]
    v_add_f32 v88, 1.0, v88
    v_add_f32 v89, 1.0, v89
    v_mfma_f32_16x16x32_bf16 v[8:11], a[156:159], v[76:79], v[8:11]
    v_add_f32 v90, 1.0, v90
    v_add_f32 v91, 1.0, v91
    v_mfma_f32_16x16x32_bf16 v[12:15], a[220:223], v[76:79], v[12:15]
    global_load_lds_dwordx4 v107, s[50:51] offset:1024 sc1
    ds_read_b128 v[64:67], v105 offset:12288
    s_waitcnt lgkmcnt(4)
    v_mfma_f32_16x16x32_bf16 v[0:3], a[32:35], v[48:51], v[0:3]
    v_add_f32 v92, 1.0, v92
    v_add_f32 v93, 1.0, v93
    v_mfma_f32_16x16x32_bf16 v[4:7], a[96:99], v[48:51], v[4:7]
    v_add_f32 v94, 1.0, v94
    v_add_f32 v95, 1.0, v95
    v_mfma_f32_16x16x32_bf16 v[8:11], a[160:163], v[48:51], v[8:11]
    v_rcp_f32 v88, v88
    v_rcp_f32 v89, v89
    v_mfma_f32_16x16x32_bf16 v[12:15], a[224:227], v[48:51], v[12:15]
    global_load_lds_dwordx4 v107, s[50:51] offset:2048 sc1
    ds_read_b128 v[68:71], v105 offset:13312
    s_waitcnt lgkmcnt(4)
    v_mfma_f32_16x16x32_bf16 v[0:3], a[36:39], v[52:55], v[0:3]
    v_rcp_f32 v90, v90
    v_rcp_f32 v91, v91
    v_mfma_f32_16x16x32_bf16 v[4:7], a[100:103], v[52:55], v[4:7]
    v_rcp_f32 v92, v92
    v_rcp_f32 v93, v93
    v_mfma_f32_16x16x32_bf16 v[8:11], a[164:167], v[52:55], v[8:11]
    v_rcp_f32 v94, v94
    v_rcp_f32 v95, v95
    v_mfma_f32_16x16x32_bf16 v[12:15], a[228:231], v[52:55], v[12:15]
    global_load_lds_dwordx4 v107, s[50:51] offset:3072 sc1
    ds_read_b128 v[72:75], v105 offset:14336
    s_waitcnt lgkmcnt(4)
    v_mfma_f32_16x16x32_bf16 v[0:3], a[40:43], v[56:59], v[0:3]
    v_mul_f32 v88, v88, v24
    v_mul_f32 v89, v89, v25
    v_mfma_f32_16x16x32_bf16 v[4:7], a[104:107], v[56:59], v[4:7]
    v_mul_f32 v90, v90, v26
    v_mul_f32 v91, v91, v27
    v_mfma_f32_16x16x32_bf16 v[8:11], a[168:171], v[56:59], v[8:11]
    v_mul_f32 v92, v92, v28
    v_mul_f32 v93, v93, v29
    v_mfma_f32_16x16x32_bf16 v[12:15], a[232:235], v[56:59], v[12:15]
    v_mul_f32 v94, v94, v30
    v_mul_f32 v95, v95, v31
    ds_read_b128 v[76:79], v105 offset:15360
    s_waitcnt lgkmcnt(4)
    v_mfma_f32_16x16x32_bf16 v[0:3], a[44:47], v[60:63], v[0:3]
    v_cvt_pk_bf16_f32 v84, v88, v89
    v_cvt_pk_bf16_f32 v85, v90, v91
    v_mfma_f32_16x16x32_bf16 v[4:7], a[108:111], v[60:63], v[4:7]
    v_cvt_pk_bf16_f32 v86, v92, v93
    v_cvt_pk_bf16_f32 v87, v94, v95
    v_mfma_f32_16x16x32_bf16 v[8:11], a[172:175], v[60:63], v[8:11]
    global_store_dwordx4 v104, v[84:87], s[56:57] sc1
    v_mfma_f32_16x16x32_bf16 v[12:15], a[236:239], v[60:63], v[12:15]
    ds_read_b128 v[48:51], v105 offset:16384
    s_waitcnt lgkmcnt(4)
    v_mfma_f32_16x16x32_bf16 v[0:3], a[48:51], v[64:67], v[0:3]
    v_mfma_f32_16x16x32_bf16 v[4:7], a[112:115], v[64:67], v[4:7]
    v_mfma_f32_16x16x32_bf16 v[8:11], a[176:179], v[64:67], v[8:11]
    v_mfma_f32_16x16x32_bf16 v[12:15], a[240:243], v[64:67], v[12:15]
    ds_read_b128 v[52:55], v105 offset:17408
    s_waitcnt lgkmcnt(4)
    v_mfma_f32_16x16x32_bf16 v[0:3], a[52:55], v[68:71], v[0:3]
    v_mfma_f32_16x16x32_bf16 v[4:7], a[116:119], v[68:71], v[4:7]
    v_mfma_f32_16x16x32_bf16 v[8:11], a[180:183], v[68:71], v[8:11]
    v_mfma_f32_16x16x32_bf16 v[12:15], a[244:247], v[68:71], v[12:15]
    ds_read_b128 v[56:59], v105 offset:18432
    s_waitcnt lgkmcnt(4)
    v_mfma_f32_16x16x32_bf16 v[0:3], a[56:59], v[72:75], v[0:3]
    v_mfma_f32_16x16x32_bf16 v[4:7], a[120:123], v[72:75], v[4:7]
    v_mfma_f32_16x16x32_bf16 v[8:11], a[184:187], v[72:75], v[8:11]
    v_mfma_f32_16x16x32_bf16 v[12:15], a[248:251], v[72:75], v[12:15]
    ds_read_b128 v[60:63], v105 offset:19456
    s_waitcnt lgkmcnt(4)
    v_mfma_f32_16x16x32_bf16 v[0:3], a[60:63], v[76:79], v[0:3]
    v_mfma_f32_16x16x32_bf16 v[4:7], a[124:127], v[76:79], v[4:7]
    v_mfma_f32_16x16x32_bf16 v[8:11], a[188:191], v[76:79], v[8:11]
    v_mfma_f32_16x16x32_bf16 v[12:15], a[252:255], v[76:79], v[12:15]
    ds_read_b128 v[64:67], v105 offset:20480
    s_waitcnt lgkmcnt(4)
    v_mfma_f32_16x16x32_bf16 v[16:19], a[0:3], v[48:51], 0
    v_mfma_f32_16x16x32_bf16 v[20:23], a[64:67], v[48:51], 0
    v_mfma_f32_16x16x32_bf16 v[24:27], a[128:131], v[48:51], 0
    v_mul_f32 v88, v0, v0
    v_mul_f32 v8, v8, v0
    v_mfma_f32_16x16x32_bf16 v[28:31], a[192:195], v[48:51], 0
    v_fmaak_f32 v88, v88, v112, 0xc0135761
    v_mul_f32 v88, v88, v0
    ds_read_b128 v[68:71], v105 offset:21504
    s_waitcnt lgkmcnt(4)
    v_mfma_f32_16x16x32_bf16 v[16:19], a[4:7], v[52:55], v[16:19]
    v_exp_f32 v88, v88
    v_mul_f32 v89, v1, v1
    v_mfma_f32_16x16x32_bf16 v[20:23], a[68:71], v[52:55], v[20:23]
    v_mul_f32 v9, v9, v1
    v_fmaak_f32 v89, v89, v112, 0xc0135761
    v_mfma_f32_16x16x32_bf16 v[24:27], a[132:135], v[52:55], v[24:27]
    v_mul_f32 v89, v89, v1
    v_exp_f32 v89, v89
    v_mfma_f32_16x16x32_bf16 v[28:31], a[196:199], v[52:55], v[28:31]
    v_mul_f32 v90, v2, v2
    v_mul_f32 v10, v10, v2
    ds_read_b128 v[72:75], v105 offset:22528
    s_waitcnt lgkmcnt(4)
    v_mfma_f32_16x16x32_bf16 v[16:19], a[8:11], v[56:59], v[16:19]
    v_fmaak_f32 v90, v90, v112, 0xc0135761
    v_mul_f32 v90, v90, v2
    v_mfma_f32_16x16x32_bf16 v[20:23], a[72:75], v[56:59], v[20:23]
    v_exp_f32 v90, v90
    v_mul_f32 v91, v3, v3
    v_mfma_f32_16x16x32_bf16 v[24:27], a[136:139], v[56:59], v[24:27]
    v_mul_f32 v11, v11, v3
    v_fmaak_f32 v91, v91, v112, 0xc0135761
    v_mfma_f32_16x16x32_bf16 v[28:31], a[200:203], v[56:59], v[28:31]
    v_mul_f32 v91, v91, v3
    v_exp_f32 v91, v91
    ds_read_b128 v[76:79], v105 offset:23552
    s_waitcnt lgkmcnt(4)
    v_mfma_f32_16x16x32_bf16 v[16:19], a[12:15], v[60:63], v[16:19]
    v_mul_f32 v92, v4, v4
    v_mul_f32 v12, v12, v4
    v_mfma_f32_16x16x32_bf16 v[20:23], a[76:79], v[60:63], v[20:23]
    v_fmaak_f32 v92, v92, v112, 0xc0135761
    v_mul_f32 v92, v92, v4
    v_mfma_f32_16x16x32_bf16 v[24:27], a[140:143], v[60:63], v[24:27]
    v_exp_f32 v92, v92
    v_mul_f32 v93, v5, v5
    v_mfma_f32_16x16x32_bf16 v[28:31], a[204:207], v[60:63], v[28:31]
    v_mul_f32 v13, v13, v5
    v_fmaak_f32 v93, v93, v112, 0xc0135761
    ds_read_b128 v[48:51], v105 offset:24576
    s_waitcnt lgkmcnt(4)
    v_mfma_f32_16x16x32_bf16 v[16:19], a[16:19], v[64:67], v[16:19]
    v_mul_f32 v93, v93, v5
    v_exp_f32 v93, v93
    v_mfma_f32_16x16x32_bf16 v[20:23], a[80:83], v[64:67], v[20:23]
    v_mul_f32 v94, v6, v6
    v_mul_f32 v14, v14, v6
    v_mfma_f32_16x16x32_bf16 v[24:27], a[144:147], v[64:67], v[24:27]
    v_fmaak_f32 v94, v94, v112, 0xc0135761
    v_mul_f32 v94, v94, v6
    v_mfma_f32_16x16x32_bf16 v[28:31], a[208:211], v[64:67], v[28:31]
    v_exp_f32 v94, v94
    v_mul_f32 v95, v7, v7
    ds_read_b128 v[52:55], v105 offset:25600
    s_waitcnt lgkmcnt(4)
    v_mfma_f32_16x16x32_bf16 v[16:19], a[20:23], v[68:71], v[16:19]
    v_mul_f32 v15, v15, v7
    v_fmaak_f32 v95, v95, v112, 0xc0135761
    v_mfma_f32_16x16x32_bf16 v[20:23], a[84:87], v[68:71], v[20:23]
    v_mul_f32 v95, v95, v7
    v_exp_f32 v95, v95
    v_mfma_f32_16x16x32_bf16 v[24:27], a[148:151], v[68:71], v[24:27]
    v_add_f32 v88, 1.0, v88
    v_add_f32 v89, 1.0, v89
    v_mfma_f32_16x16x32_bf16 v[28:31], a[212:215], v[68:71], v[28:31]
    v_add_f32 v90, 1.0, v90
    v_add_f32 v91, 1.0, v91
    ds_read_b128 v[56:59], v105 offset:26624
    s_waitcnt lgkmcnt(4)
    v_mfma_f32_16x16x32_bf16 v[16:19], a[24:27], v[72:75], v[16:19]
    v_add_f32 v92, 1.0, v92
    v_add_f32 v93, 1.0, v93
    v_mfma_f32_16x16x32_bf16 v[20:23], a[88:91], v[72:75], v[20:23]
    v_add_f32 v94, 1.0, v94
    v_add_f32 v95, 1.0, v95
    v_mfma_f32_16x16x32_bf16 v[24:27], a[152:155], v[72:75], v[24:27]
    v_rcp_f32 v88, v88
    v_rcp_f32 v89, v89
    v_mfma_f32_16x16x32_bf16 v[28:31], a[216:219], v[72:75], v[28:31]
    v_rcp_f32 v90, v90
    v_rcp_f32 v91, v91
    ds_read_b128 v[60:63], v105 offset:27648
    s_waitcnt lgkmcnt(4)
    v_mfma_f32_16x16x32_bf16 v[16:19], a[28:31], v[76:79], v[16:19]
    v_rcp_f32 v92, v92
    v_rcp_f32 v93, v93
    v_mfma_f32_16x16x32_bf16 v[20:23], a[92:95], v[76:79], v[20:23]
    v_rcp_f32 v94, v94
    v_rcp_f32 v95, v95
    v_mfma_f32_16x16x32_bf16 v[24:27], a[156:159], v[76:79], v[24:27]
    v_mul_f32 v88, v88, v8
    v_mul_f32 v89, v89, v9
    v_mfma_f32_16x16x32_bf16 v[28:31], a[220:223], v[76:79], v[28:31]
    v_mul_f32 v90, v90, v10
    v_mul_f32 v91, v91, v11
    ds_read_b128 v[64:67], v105 offset:28672
    s_waitcnt lgkmcnt(4)
    v_mfma_f32_16x16x32_bf16 v[16:19], a[32:35], v[48:51], v[16:19]
    v_mul_f32 v92, v92, v12
    v_mul_f32 v93, v93, v13
    v_mfma_f32_16x16x32_bf16 v[20:23], a[96:99], v[48:51], v[20:23]
    v_mul_f32 v94, v94, v14
    v_mul_f32 v95, v95, v15
    v_mfma_f32_16x16x32_bf16 v[24:27], a[160:163], v[48:51], v[24:27]
    v_cvt_pk_bf16_f32 v80, v88, v89
    v_cvt_pk_bf16_f32 v81, v90, v91
    v_mfma_f32_16x16x32_bf16 v[28:31], a[224:227], v[48:51], v[28:31]
    v_cvt_pk_bf16_f32 v82, v92, v93
    v_cvt_pk_bf16_f32 v83, v94, v95
    ds_read_b128 v[68:71], v105 offset:29696
    s_waitcnt lgkmcnt(4)
    v_mfma_f32_16x16x32_bf16 v[16:19], a[36:39], v[52:55], v[16:19]
    global_store_dwordx4 v104, v[80:83], s[52:53] sc1
    v_mfma_f32_16x16x32_bf16 v[20:23], a[100:103], v[52:55], v[20:23]
    v_mfma_f32_16x16x32_bf16 v[24:27], a[164:167], v[52:55], v[24:27]
    v_mfma_f32_16x16x32_bf16 v[28:31], a[228:231], v[52:55], v[28:31]
    ds_read_b128 v[72:75], v105 offset:30720
    s_waitcnt lgkmcnt(4)
    v_mfma_f32_16x16x32_bf16 v[16:19], a[40:43], v[56:59], v[16:19]
    v_mfma_f32_16x16x32_bf16 v[20:23], a[104:107], v[56:59], v[20:23]
    v_mfma_f32_16x16x32_bf16 v[24:27], a[168:171], v[56:59], v[24:27]
    v_mfma_f32_16x16x32_bf16 v[28:31], a[232:235], v[56:59], v[28:31]
    ds_read_b128 v[76:79], v105 offset:31744
    s_waitcnt lgkmcnt(4)
    v_mfma_f32_16x16x32_bf16 v[16:19], a[44:47], v[60:63], v[16:19]
    v_mfma_f32_16x16x32_bf16 v[20:23], a[108:111], v[60:63], v[20:23]
    v_mfma_f32_16x16x32_bf16 v[24:27], a[172:175], v[60:63], v[24:27]
    v_mfma_f32_16x16x32_bf16 v[28:31], a[236:239], v[60:63], v[28:31]
    s_waitcnt lgkmcnt(3)
    v_mfma_f32_16x16x32_bf16 v[16:19], a[48:51], v[64:67], v[16:19]
    v_mfma_f32_16x16x32_bf16 v[20:23], a[112:115], v[64:67], v[20:23]
    v_mfma_f32_16x16x32_bf16 v[24:27], a[176:179], v[64:67], v[24:27]
    v_mfma_f32_16x16x32_bf16 v[28:31], a[240:243], v[64:67], v[28:31]
    s_waitcnt lgkmcnt(2)
    v_mfma_f32_16x16x32_bf16 v[16:19], a[52:55], v[68:71], v[16:19]
    v_mfma_f32_16x16x32_bf16 v[20:23], a[116:119], v[68:71], v[20:23]
    v_mfma_f32_16x16x32_bf16 v[24:27], a[180:183], v[68:71], v[24:27]
    v_mfma_f32_16x16x32_bf16 v[28:31], a[244:247], v[68:71], v[28:31]
    s_waitcnt lgkmcnt(1)
    v_mfma_f32_16x16x32_bf16 v[16:19], a[56:59], v[72:75], v[16:19]
    v_mfma_f32_16x16x32_bf16 v[20:23], a[120:123], v[72:75], v[20:23]
    v_mfma_f32_16x16x32_bf16 v[24:27], a[184:187], v[72:75], v[24:27]
    v_mfma_f32_16x16x32_bf16 v[28:31], a[248:251], v[72:75], v[28:31]
    s_waitcnt lgkmcnt(0)
    v_mfma_f32_16x16x32_bf16 v[16:19], a[60:63], v[76:79], v[16:19]
    v_mfma_f32_16x16x32_bf16 v[20:23], a[124:127], v[76:79], v[20:23]
    v_mfma_f32_16x16x32_bf16 v[24:27], a[188:191], v[76:79], v[24:27]
    v_mfma_f32_16x16x32_bf16 v[28:31], a[252:255], v[76:79], v[28:31]
    v_mov_b32 v113, s49
    s_waitcnt vmcnt(1)
    v_xor_b32 v105, 0x8000, v105
    global_store_dword v106, v113, s[4:5] sc1
    s_add_u32 s56, s52, 65536
    s_addc_u32 s57, s53, 0
    s_add_u32 s52, s52, 262144
    s_addc_u32 s53, s53, 0
    s_add_u32 s49, s49, 1
    s_cmp_lt_u32 s49, 32
    s_cbranch_scc1 Lst_20
    v_mul_f32 v88, v16, v16
    v_mul_f32 v24, v24, v16
    v_fmaak_f32 v88, v88, v112, 0xc0135761
    v_mul_f32 v88, v88, v16
    v_exp_f32 v88, v88
    v_mul_f32 v89, v17, v17
    v_mul_f32 v25, v25, v17
    v_fmaak_f32 v89, v89, v112, 0xc0135761
    v_mul_f32 v89, v89, v17
    v_exp_f32 v89, v89
    v_mul_f32 v90, v18, v18
    v_mul_f32 v26, v26, v18
    v_fmaak_f32 v90, v90, v112, 0xc0135761
    v_mul_f32 v90, v90, v18
    v_exp_f32 v90, v90
    v_mul_f32 v91, v19, v19
    v_mul_f32 v27, v27, v19
    v_fmaak_f32 v91, v91, v112, 0xc0135761
    v_mul_f32 v91, v91, v19
    v_exp_f32 v91, v91
    v_mul_f32 v92, v20, v20
    v_mul_f32 v28, v28, v20
    v_fmaak_f32 v92, v92, v112, 0xc0135761
    v_mul_f32 v92, v92, v20
    v_exp_f32 v92, v92
    v_mul_f32 v93, v21, v21
    v_mul_f32 v29, v29, v21
    v_fmaak_f32 v93, v93, v112, 0xc0135761
    v_mul_f32 v93, v93, v21
    v_exp_f32 v93, v93
    v_mul_f32 v94, v22, v22
    v_mul_f32 v30, v30, v22
    v_fmaak_f32 v94, v94, v112, 0xc0135761
    v_mul_f32 v94, v94, v22
    v_exp_f32 v94, v94
    v_mul_f32 v95, v23, v23
    v_mul_f32 v31, v31, v23
    v_fmaak_f32 v95, v95, v112, 0xc0135761
    v_mul_f32 v95, v95, v23
    v_exp_f32 v95, v95
    v_add_f32 v88, 1.0, v88
    v_add_f32 v89, 1.0, v89
    v_add_f32 v90, 1.0, v90
    v_add_f32 v91, 1.0, v91
    v_add_f32 v92, 1.0, v92
    v_add_f32 v93, 1.0, v93
    v_add_f32 v94, 1.0, v94
    v_add_f32 v95, 1.0, v95
    v_rcp_f32 v88, v88
    v_rcp_f32 v89, v89
    v_rcp_f32 v90, v90
    v_rcp_f32 v91, v91
    v_rcp_f32 v92, v92
    v_rcp_f32 v93, v93
    v_rcp_f32 v94, v94
    v_rcp_f32 v95, v95
    v_mul_f32 v88, v88, v24
    v_mul_f32 v89, v89, v25
    v_mul_f32 v90, v90, v26
    v_mul_f32 v91, v91, v27
    v_mul_f32 v92, v92, v28
    v_mul_f32 v93, v93, v29
    v_mul_f32 v94, v94, v30
    v_mul_f32 v95, v95, v31
    v_cvt_pk_bf16_f32 v84, v88, v89
    v_cvt_pk_bf16_f32 v85, v90, v91
    v_cvt_pk_bf16_f32 v86, v92, v93
    v_cvt_pk_bf16_f32 v87, v94, v95
    global_store_dwordx4 v104, v[84:87], s[56:57] sc1
    v_mov_b32 v113, 32
    s_waitcnt vmcnt(0)
    s_barrier
    global_store_dword v106, v113, s[4:5] sc1
    s_branch L_more
L_more:
    v_mbcnt_lo_u32_b32 v0, -1, 0
    v_mbcnt_hi_u32_b32 v0, -1, v0
    s_mov_b32 s36, 39
    s_branch L_final
L_attn:
    v_and_b32 v1, 63, v0
    v_lshrrev_b32 v2, 4, v1
    v_and_b32 v3, 15, v1
    v_lshrrev_b32 v4, 2, v3
    v_and_b32 v5, 3, v1
    s_load_dwordx4 s[68:71], s[0:1], 24
    s_lshl_b32 s54, s9, 15
    s_lshl_b32 s52, s8, 8
    v_mov_b32 v6, s52
    s_waitcnt lgkmcnt(0)
    s_cmp_lg_u32 s9, 0
    s_cbranch_scc1 Lgs_22
    v_mov_b32 v21, 160
Lgo_21:
    global_load_dword v20, v21, s[6:7] sc1
    s_sub_u32 s27, s27, 1
    s_cbranch_scc1 L_fin
    s_waitcnt vmcnt(0)
    v_cmp_gt_u32 vcc, 1, v20
    s_cbranch_vccnz Lgo_21
Lgs_22:
    s_barrier
    s_mul_i32 s52, s9, 131072
    v_mul_u32_u24 v7, 8192, v2
    v_add3_u32 v6, v6, v7, s52
    v_lshlrev_b32 v7, 2, v2
    v_xor_b32 v7, v7, v3
    v_lshl_add_u32 v6, v7, 4, v6
    v_and_b32 v7, 1, v2
    v_lshl_add_u32 v7, v7, 3, v4
    v_lshlrev_b32 v7, 8, v7
    v_lshrrev_b32 v8, 1, v2
    v_lshl_add_u32 v7, v8, 15, v7
    v_xor_b32 v8, s9, v4
    v_lshl_add_u32 v7, v8, 6, v7
    v_add_u32 v7, 0, v7
    v_lshl_add_u32 v8, v5, 3, v7
    v_lshl_add_u32 v10, v5, 4, v7
    v_add_u32 v9, 0x10000, v8
    v_add_u32 v11, 0x10000, v10
    s_add_u32 m0, s54, 0
    v_add_u32 v7, 0, v6
    global_load_lds_dwordx4 v7, s[68:69]
    s_add_u32 m0, s54, 1024
    v_add_u32 v7, 32768, v6
    global_load_lds_dwordx4 v7, s[68:69]
    s_add_u32 m0, s54, 2048
    v_add_u32 v7, 65536, v6
    global_load_lds_dwordx4 v7, s[68:69]
    s_add_u32 m0, s54, 3072
    v_add_u32 v7, 98304, v6
    global_load_lds_dwordx4 v7, s[68:69]
    s_add_u32 m0, s54, 4096
    v_add_u32 v7, 0, v6
    global_load_lds_dwordx4 v7, s[70:71]
    s_add_u32 m0, s54, 5120
    v_add_u32 v7, 32768, v6
    global_load_lds_dwordx4 v7, s[70:71]
    s_add_u32 m0, s54, 6144
    v_add_u32 v7, 65536, v6
    global_load_lds_dwordx4 v7, s[70:71]
    s_add_u32 m0, s54, 7168
    v_add_u32 v7, 98304, v6
    global_load_lds_dwordx4 v7, s[70:71]
    s_add_u32 m0, s54, 8192
    v_add_u32 v7, 524288, v6
    global_load_lds_dwordx4 v7, s[68:69]
    s_add_u32 m0, s54, 9216
    v_add_u32 v7, 557056, v6
    global_load_lds_dwordx4 v7, s[68:69]
    s_add_u32 m0, s54, 10240
    v_add_u32 v7, 589824, v6
    global_load_lds_dwordx4 v7, s[68:69]
    s_add_u32 m0, s54, 11264
    v_add_u32 v7, 622592, v6
    global_load_lds_dwordx4 v7, s[68:69]
    s_add_u32 m0, s54, 12288
    v_add_u32 v7, 524288, v6
    global_load_lds_dwordx4 v7, s[70:71]
    s_add_u32 m0, s54, 13312
    v_add_u32 v7, 557056, v6
    global_load_lds_dwordx4 v7, s[70:71]
    s_add_u32 m0, s54, 14336
    v_add_u32 v7, 589824, v6
    global_load_lds_dwordx4 v7, s[70:71]
    s_add_u32 m0, s54, 15360
    v_add_u32 v7, 622592, v6
    global_load_lds_dwordx4 v7, s[70:71]
    s_add_u32 m0, s54, 16384
    v_add_u32 v7, 1048576, v6
    global_load_lds_dwordx4 v7, s[68:69]
    s_add_u32 m0, s54, 17408
    v_add_u32 v7, 1081344, v6
    global_load_lds_dwordx4 v7, s[68:69]
    s_add_u32 m0, s54, 18432
    v_add_u32 v7, 1114112, v6
    global_load_lds_dwordx4 v7, s[68:69]
    s_add_u32 m0, s54, 19456
    v_add_u32 v7, 1146880, v6
    global_load_lds_dwordx4 v7, s[68:69]
    s_add_u32 m0, s54, 20480
    v_add_u32 v7, 1048576, v6
    global_load_lds_dwordx4 v7, s[70:71]
    s_add_u32 m0, s54, 21504
    v_add_u32 v7, 1081344, v6
    global_load_lds_dwordx4 v7, s[70:71]
    s_add_u32 m0, s54, 22528
    v_add_u32 v7, 1114112, v6
    global_load_lds_dwordx4 v7, s[70:71]
    s_add_u32 m0, s54, 23552
    v_add_u32 v7, 1146880, v6
    global_load_lds_dwordx4 v7, s[70:71]
    s_add_u32 m0, s54, 24576
    v_add_u32 v7, 1572864, v6
    global_load_lds_dwordx4 v7, s[68:69]
    s_add_u32 m0, s54, 25600
    v_add_u32 v7, 1605632, v6
    global_load_lds_dwordx4 v7, s[68:69]
    s_add_u32 m0, s54, 26624
    v_add_u32 v7, 1638400, v6
    global_load_lds_dwordx4 v7, s[68:69]
    s_add_u32 m0, s54, 27648
    v_add_u32 v7, 1671168, v6
    global_load_lds_dwordx4 v7, s[68:69]
    s_add_u32 m0, s54, 28672
    v_add_u32 v7, 1572864, v6
    global_load_lds_dwordx4 v7, s[70:71]
    s_add_u32 m0, s54, 29696
    v_add_u32 v7, 1605632, v6
    global_load_lds_dwordx4 v7, s[70:71]
    s_add_u32 m0, s54, 30720
    v_add_u32 v7, 1638400, v6
    global_load_lds_dwordx4 v7, s[70:71]
    s_add_u32 m0, s54, 31744
    v_add_u32 v7, 1671168, v6
    global_load_lds_dwordx4 v7, s[70:71]
    s_waitcnt vmcnt(28)
    s_barrier
    ds_read_b64_tr_b16 a[0:1], v8 offset:0
    ds_read_b64_tr_b16 a[2:3], v8 offset:1024
    ds_read_b64_tr_b16 a[4:5], v9 offset:0
    ds_read_b64_tr_b16 a[6:7], v9 offset:1024
    ds_read_b64_tr_b16 a[64:65], v8 offset:32
    ds_read_b64_tr_b16 a[66:67], v8 offset:1056
    ds_read_b64_tr_b16 a[68:69], v9 offset:32
    ds_read_b64_tr_b16 a[70:71], v9 offset:1056
    s_waitcnt lgkmcnt(0)
    s_waitcnt vmcnt(24)
    s_barrier
    ds_read_b64_tr_b16 a[128:129], v10 offset:4096
    ds_read_b64_tr_b16 a[130:131], v10 offset:5120
    ds_read_b64_tr_b16 a[132:133], v11 offset:4096
    ds_read_b64_tr_b16 a[134:135], v11 offset:5120
    ds_read_b64_tr_b16 a[192:193], v10 offset:4104
    ds_read_b64_tr_b16 a[194:195], v10 offset:5128
    ds_read_b64_tr_b16 a[196:197], v11 offset:4104
    ds_read_b64_tr_b16 a[198:199], v11 offset:5128
    s_add_u32 m0, s54, 0
    v_add_u32 v7, 2097152, v6
    global_load_lds_dwordx4 v7, s[68:69]
    s_add_u32 m0, s54, 1024
    v_add_u32 v7, 2129920, v6
    global_load_lds_dwordx4 v7, s[68:69]
    s_add_u32 m0, s54, 2048
    v_add_u32 v7, 2162688, v6
    global_load_lds_dwordx4 v7, s[68:69]
    s_add_u32 m0, s54, 3072
    v_add_u32 v7, 2195456, v6
    global_load_lds_dwordx4 v7, s[68:69]
    s_waitcnt lgkmcnt(0)
    s_waitcnt vmcnt(24)
    s_barrier
    ds_read_b64_tr_b16 a[8:9], v8 offset:8192
    ds_read_b64_tr_b16 a[10:11], v8 offset:9216
    ds_read_b64_tr_b16 a[12:13], v9 offset:8192
    ds_read_b64_tr_b16 a[14:15], v9 offset:9216
    ds_read_b64_tr_b16 a[72:73], v8 offset:8224
    ds_read_b64_tr_b16 a[74:75], v8 offset:9248
    ds_read_b64_tr_b16 a[76:77], v9 offset:8224
    ds_read_b64_tr_b16 a[78:79], v9 offset:9248
    s_add_u32 m0, s54, 4096
    v_add_u32 v7, 2097152, v6
    global_load_lds_dwordx4 v7, s[70:71]
    s_add_u32 m0, s54, 5120
    v_add_u32 v7, 2129920, v6
    global_load_lds_dwordx4 v7, s[70:71]
    s_add_u32 m0, s54, 6144
    v_add_u32 v7, 2162688, v6
    global_load_lds_dwordx4 v7, s[70:71]
    s_add_u32 m0, s54, 7168
    v_add_u32 v7, 2195456, v6
    global_load_lds_dwordx4 v7, s[70:71]
    s_waitcnt lgkmcnt(0)
    s_waitcnt vmcnt(24)
    s_barrier
    ds_read_b64_tr_b16 a[136:137], v10 offset:12288
    ds_read_b64_tr_b16 a[138:139], v10 offset:13312
    ds_read_b64_tr_b16 a[140:141], v11 offset:12288
    ds_read_b64_tr_b16 a[142:143], v11 offset:13312
    ds_read_b64_tr_b16 a[200:201], v10 offset:12296
    ds_read_b64_tr_b16 a[202:203], v10 offset:13320
    ds_read_b64_tr_b16 a[204:205], v11 offset:12296
    ds_read_b64_tr_b16 a[206:207], v11 offset:13320
    s_add_u32 m0, s54, 8192
    v_add_u32 v7, 2621440, v6
    global_load_lds_dwordx4 v7, s[68:69]
    s_add_u32 m0, s54, 9216
    v_add_u32 v7, 2654208, v6
    global_load_lds_dwordx4 v7, s[68:69]
    s_add_u32 m0, s54, 10240
    v_add_u32 v7, 2686976, v6
    global_load_lds_dwordx4 v7, s[68:69]
    s_add_u32 m0, s54, 11264
    v_add_u32 v7, 2719744, v6
    global_load_lds_dwordx4 v7, s[68:69]
    s_waitcnt lgkmcnt(0)
    s_waitcnt vmcnt(24)
    s_barrier
    ds_read_b64_tr_b16 a[16:17], v8 offset:16384
    ds_read_b64_tr_b16 a[18:19], v8 offset:17408
    ds_read_b64_tr_b16 a[20:21], v9 offset:16384
    ds_read_b64_tr_b16 a[22:23], v9 offset:17408
    ds_read_b64_tr_b16 a[80:81], v8 offset:16416
    ds_read_b64_tr_b16 a[82:83], v8 offset:17440
    ds_read_b64_tr_b16 a[84:85], v9 offset:16416
    ds_read_b64_tr_b16 a[86:87], v9 offset:17440
    s_add_u32 m0, s54, 12288
    v_add_u32 v7, 2621440, v6
    global_load_lds_dwordx4 v7, s[70:71]
    s_add_u32 m0, s54, 13312
    v_add_u32 v7, 2654208, v6
    global_load_lds_dwordx4 v7, s[70:71]
    s_add_u32 m0, s54, 14336
    v_add_u32 v7, 2686976, v6
    global_load_lds_dwordx4 v7, s[70:71]
    s_add_u32 m0, s54, 15360
    v_add_u32 v7, 2719744, v6
    global_load_lds_dwordx4 v7, s[70:71]
    s_waitcnt lgkmcnt(0)
    s_waitcnt vmcnt(24)
    s_barrier
    ds_read_b64_tr_b16 a[144:145], v10 offset:20480
    ds_read_b64_tr_b16 a[146:147], v10 offset:21504
    ds_read_b64_tr_b16 a[148:149], v11 offset:20480
    ds_read_b64_tr_b16 a[150:151], v11 offset:21504
    ds_read_b64_tr_b16 a[208:209], v10 offset:20488
    ds_read_b64_tr_b16 a[210:211], v10 offset:21512
    ds_read_b64_tr_b16 a[212:213], v11 offset:20488
    ds_read_b64_tr_b16 a[214:215], v11 offset:21512
    s_add_u32 m0, s54, 16384
    v_add_u32 v7, 3145728, v6
    global_load_lds_dwordx4 v7, s[68:69]
    s_add_u32 m0, s54, 17408
    v_add_u32 v7, 3178496, v6
    global_load_lds_dwordx4 v7, s[68:69]
    s_add_u32 m0, s54, 18432
    v_add_u32 v7, 3211264, v6
    global_load_lds_dwordx4 v7, s[68:69]
    s_add_u32 m0, s54, 19456
    v_add_u32 v7, 3244032, v6
    global_load_lds_dwordx4 v7, s[68:69]
    s_waitcnt lgkmcnt(0)
    s_waitcnt vmcnt(24)
    s_barrier
    ds_read_b64_tr_b16 a[24:25], v8 offset:24576
    ds_read_b64_tr_b16 a[26:27], v8 offset:25600
    ds_read_b64_tr_b16 a[28:29], v9 offset:24576
    ds_read_b64_tr_b16 a[30:31], v9 offset:25600
    ds_read_b64_tr_b16 a[88:89], v8 offset:24608
    ds_read_b64_tr_b16 a[90:91], v8 offset:25632
    ds_read_b64_tr_b16 a[92:93], v9 offset:24608
    ds_read_b64_tr_b16 a[94:95], v9 offset:25632
    s_add_u32 m0, s54, 20480
    v_add_u32 v7, 3145728, v6
    global_load_lds_dwordx4 v7, s[70:71]
    s_add_u32 m0, s54, 21504
    v_add_u32 v7, 3178496, v6
    global_load_lds_dwordx4 v7, s[70:71]
    s_add_u32 m0, s54, 22528
    v_add_u32 v7, 3211264, v6
    global_load_lds_dwordx4 v7, s[70:71]
    s_add_u32 m0, s54, 23552
    v_add_u32 v7, 3244032, v6
    global_load_lds_dwordx4 v7, s[70:71]
    s_waitcnt lgkmcnt(0)
    s_waitcnt vmcnt(24)
    s_barrier
    ds_read_b64_tr_b16 a[152:153], v10 offset:28672
    ds_read_b64_tr_b16 a[154:155], v10 offset:29696
    ds_read_b64_tr_b16 a[156:157], v11 offset:28672
    ds_read_b64_tr_b16 a[158:159], v11 offset:29696
    ds_read_b64_tr_b16 a[216:217], v10 offset:28680
    ds_read_b64_tr_b16 a[218:219], v10 offset:29704
    ds_read_b64_tr_b16 a[220:221], v11 offset:28680
    ds_read_b64_tr_b16 a[222:223], v11 offset:29704
    s_add_u32 m0, s54, 24576
    v_add_u32 v7, 3670016, v6
    global_load_lds_dwordx4 v7, s[68:69]
    s_add_u32 m0, s54, 25600
    v_add_u32 v7, 3702784, v6
    global_load_lds_dwordx4 v7, s[68:69]
    s_add_u32 m0, s54, 26624
    v_add_u32 v7, 3735552, v6
    global_load_lds_dwordx4 v7, s[68:69]
    s_add_u32 m0, s54, 27648
    v_add_u32 v7, 3768320, v6
    global_load_lds_dwordx4 v7, s[68:69]
    s_waitcnt lgkmcnt(0)
    s_waitcnt vmcnt(24)
    s_barrier
    ds_read_b64_tr_b16 a[32:33], v8 offset:0
    ds_read_b64_tr_b16 a[34:35], v8 offset:1024
    ds_read_b64_tr_b16 a[36:37], v9 offset:0
    ds_read_b64_tr_b16 a[38:39], v9 offset:1024
    ds_read_b64_tr_b16 a[96:97], v8 offset:32
    ds_read_b64_tr_b16 a[98:99], v8 offset:1056
    ds_read_b64_tr_b16 a[100:101], v9 offset:32
    ds_read_b64_tr_b16 a[102:103], v9 offset:1056
    s_add_u32 m0, s54, 28672
    v_add_u32 v7, 3670016, v6
    global_load_lds_dwordx4 v7, s[70:71]
    s_add_u32 m0, s54, 29696
    v_add_u32 v7, 3702784, v6
    global_load_lds_dwordx4 v7, s[70:71]
    s_add_u32 m0, s54, 30720
    v_add_u32 v7, 3735552, v6
    global_load_lds_dwordx4 v7, s[70:71]
    s_add_u32 m0, s54, 31744
    v_add_u32 v7, 3768320, v6
    global_load_lds_dwordx4 v7, s[70:71]
    s_waitcnt lgkmcnt(0)
    s_waitcnt vmcnt(24)
    s_barrier
    ds_read_b64_tr_b16 a[160:161], v10 offset:4096
    ds_read_b64_tr_b16 a[162:163], v10 offset:5120
    ds_read_b64_tr_b16 a[164:165], v11 offset:4096
    ds_read_b64_tr_b16 a[166:167], v11 offset:5120
    ds_read_b64_tr_b16 a[224:225], v10 offset:4104
    ds_read_b64_tr_b16 a[226:227], v10 offset:5128
    ds_read_b64_tr_b16 a[228:229], v11 offset:4104
    ds_read_b64_tr_b16 a[230:231], v11 offset:5128
    s_waitcnt lgkmcnt(0)
    s_waitcnt vmcnt(20)
    s_barrier
    ds_read_b64_tr_b16 a[40:41], v8 offset:8192
    ds_read_b64_tr_b16 a[42:43], v8 offset:9216
    ds_read_b64_tr_b16 a[44:45], v9 offset:8192
    ds_read_b64_tr_b16 a[46:47], v9 offset:9216
    ds_read_b64_tr_b16 a[104:105], v8 offset:8224
    ds_read_b64_tr_b16 a[106:107], v8 offset:9248
    ds_read_b64_tr_b16 a[108:109], v9 offset:8224
    ds_read_b64_tr_b16 a[110:111], v9 offset:9248
    s_waitcnt lgkmcnt(0)
    s_waitcnt vmcnt(16)
    s_barrier
    ds_read_b64_tr_b16 a[168:169], v10 offset:12288
    ds_read_b64_tr_b16 a[170:171], v10 offset:13312
    ds_read_b64_tr_b16 a[172:173], v11 offset:12288
    ds_read_b64_tr_b16 a[174:175], v11 offset:13312
    ds_read_b64_tr_b16 a[232:233], v10 offset:12296
    ds_read_b64_tr_b16 a[234:235], v10 offset:13320
    ds_read_b64_tr_b16 a[236:237], v11 offset:12296
    ds_read_b64_tr_b16 a[238:239], v11 offset:13320
    s_waitcnt lgkmcnt(0)
    s_waitcnt vmcnt(12)
    s_barrier
    ds_read_b64_tr_b16 a[48:49], v8 offset:16384
    ds_read_b64_tr_b16 a[50:51], v8 offset:17408
    ds_read_b64_tr_b16 a[52:53], v9 offset:16384
    ds_read_b64_tr_b16 a[54:55], v9 offset:17408
    ds_read_b64_tr_b16 a[112:113], v8 offset:16416
    ds_read_b64_tr_b16 a[114:115], v8 offset:17440
    ds_read_b64_tr_b16 a[116:117], v9 offset:16416
    ds_read_b64_tr_b16 a[118:119], v9 offset:17440
    s_waitcnt lgkmcnt(0)
    s_waitcnt vmcnt(8)
    s_barrier
    ds_read_b64_tr_b16 a[176:177], v10 offset:20480
    ds_read_b64_tr_b16 a[178:179], v10 offset:21504
    ds_read_b64_tr_b16 a[180:181], v11 offset:20480
    ds_read_b64_tr_b16 a[182:183], v11 offset:21504
    ds_read_b64_tr_b16 a[240:241], v10 offset:20488
    ds_read_b64_tr_b16 a[242:243], v10 offset:21512
    ds_read_b64_tr_b16 a[244:245], v11 offset:20488
    ds_read_b64_tr_b16 a[246:247], v11 offset:21512
    s_waitcnt lgkmcnt(0)
    s_waitcnt vmcnt(4)
    s_barrier
    ds_read_b64_tr_b16 a[56:57], v8 offset:24576
    ds_read_b64_tr_b16 a[58:59], v8 offset:25600
    ds_read_b64_tr_b16 a[60:61], v9 offset:24576
    ds_read_b64_tr_b16 a[62:63], v9 offset:25600
    ds_read_b64_tr_b16 a[120:121], v8 offset:24608
    ds_read_b64_tr_b16 a[122:123], v8 offset:25632
    ds_read_b64_tr_b16 a[124:125], v9 offset:24608
    ds_read_b64_tr_b16 a[126:127], v9 offset:25632
    s_waitcnt lgkmcnt(0)
    s_waitcnt vmcnt(0)
    s_barrier
    ds_read_b64_tr_b16 a[184:185], v10 offset:28672
    ds_read_b64_tr_b16 a[186:187], v10 offset:29696
    ds_read_b64_tr_b16 a[188:189], v11 offset:28672
    ds_read_b64_tr_b16 a[190:191], v11 offset:29696
    ds_read_b64_tr_b16 a[248:249], v10 offset:28680
    ds_read_b64_tr_b16 a[250:251], v10 offset:29704
    ds_read_b64_tr_b16 a[252:253], v11 offset:28680
    ds_read_b64_tr_b16 a[254:255], v11 offset:29704
    s_waitcnt lgkmcnt(0)
    v_lshrrev_b32 v27, 3, v3
    v_mul_u32_u24 v27, 3968, v27
    v_lshl_add_u32 v27, v1, 4, v27
    v_add_u32 v28, 8192, v27
    v_lshlrev_b32 v6, 4, v1
    v_add_u32 v6, 4096, v6
    v_add_u32 v7, 8192, v6
    v_add_u32 v14, 131072, v6
    s_lshl_b32 s52, s9, 19
    s_lshl_b32 s53, s8, 14
    s_add_u32 s52, s52, s53
    s_add_u32 s53, s52, 16777216
    s_add_u32 s40, s4, s53
    s_addc_u32 s41, s5, 0
    s_lshr_b32 s53, s52, 1
    s_add_u32 s53, s53, 67108864
    s_add_u32 s42, s4, s53
    s_addc_u32 s43, s5, 0
    s_lshl_b32 s53, s9, 13
    s_add_u32 s53, s53, 51380224
    s_add_u32 s44, s4, s53
    s_addc_u32 s45, s5, 0
    s_add_u32 s56, s44, 4224
    s_addc_u32 s57, s45, 0
    s_lshl_b32 s52, s9, 18
    s_lshl_b32 s53, s8, 12
    s_add_u32 s52, s52, s53
    s_add_u32 s52, s52, 83886080
    s_add_u32 s46, s4, s52
    s_addc_u32 s47, s5, 0
    s_movk_i32 s50, 8320
    s_lshl_b32 s52, s8, 7
    s_and_b32 s53, s9, 1
    s_lshl_b32 s53, s53, 4
    s_add_u32 s53, s53, s52
    s_add_u32 s53, s53, 786432
    v_lshlrev_b32 v8, 2, v5
    v_mov_b32 v9, 0
    v_add_u32 v8, s53, v8
    s_lshl_b32 s52, s9, 12
    s_lshl_b32 s53, s8, 7
    s_add_u32 s52, s52, s53
    s_add_u32 s52, s52, 811008
    v_mov_b32 v10, s52
    v_and_b32 v15, 1, v2
    v_xor_b32 v20, v1, v15
    s_and_b32 s52, s9, 1
    s_mul_i32 s52, s52, s50
    v_lshl_add_u32 v11, v20, 4, s52
    v_lshrrev_b32 v20, 3, v3
    v_xor_b32 v15, v15, v20
    v_lshlrev_b32 v15, 4, v15
    v_lshl_add_u32 v15, v20, 8, v15
    v_and_b32 v20, 1, v4
    v_lshl_add_u32 v15, v20, 6, v15
    v_and_b32 v20, 1, v1
    v_lshl_add_u32 v15, v20, 5, v15
    v_lshrrev_b32 v20, 1, v2
    v_lshl_add_u32 v15, v20, 11, v15
    v_lshrrev_b32 v20, 1, v5
    v_mad_u32_u24 v12, v20, s50, v15
    s_lshl_b32 s52, s9, 10
    v_lshl_add_u32 v26, v1, 4, s52
    v_lshrrev_b32 v29, 1, v26
    s_and_b32 s52, s9, 1
    s_lshl_b32 s53, s52, 5
    v_lshlrev_b32 v15, 4, v1
    v_xor_b32 v30, s53, v15
    s_lshl_b32 s53, s52, 11
    v_lshl_add_u32 v31, v1, 3, s53
    v_mov_b32 v13, 0xd028965f
    v_lshlrev_b32 v15, 2, v2
    s_lshr_b32 s49, s9, 1
    s_add_u32 s49, s49, 1
    s_mov_b32 s50, s9
    s_mov_b32 s48, 0
    v_add_u32 v20, 0, v15
    v_cmp_le_u32 s[60:61], v20, v3
    v_mov_b32 v16, 0x3f803f80
    v_add_u32 v20, 1, v15
    v_cmp_le_u32 s[62:63], v20, v3
    v_mov_b32 v17, 0x3f803f80
    v_add_u32 v20, 2, v15
    v_cmp_le_u32 s[64:65], v20, v3
    v_mov_b32 v18, 0x3f803f80
    v_add_u32 v20, 3, v15
    v_cmp_le_u32 s[66:67], v20, v3
    v_mov_b32 v19, 0x3f803f80
    s_barrier
    v_mov_b32 v21, 128
Lln_23:
    global_load_dword v20, v21, s[6:7] sc1
    s_sub_u32 s27, s27, 1
    s_cbranch_scc1 L_fin
    s_waitcnt vmcnt(0)
    v_cmp_gt_u32 vcc, 64, v20
    s_cbranch_vccnz Lln_23
    s_mov_b64 exec, 0xffff
Lpf_27:
    global_load_dword v20, v8, s[4:5] sc1
    s_sub_u32 s27, s27, 1
    s_cbranch_scc1 L_fin
    s_waitcnt vmcnt(0)
    v_cmp_gt_u32 vcc, s49, v20
    s_cbranch_vccnz Lpf_27
    s_mov_b64 exec, -1
    global_load_dwordx4 v[32:35], v6, s[42:43] offset:-4096 sc1
    global_load_dwordx4 v[36:39], v6, s[42:43] offset:-3072 sc1
    global_load_dwordx4 v[40:43], v6, s[42:43] offset:-2048 sc1
    global_load_dwordx4 v[44:47], v6, s[42:43] offset:-1024 sc1
    global_load_dwordx4 v[48:51], v6, s[42:43] offset:0 sc1
    global_load_dwordx4 v[52:55], v6, s[42:43] offset:1024 sc1
    global_load_dwordx4 v[56:59], v6, s[42:43] offset:2048 sc1
    global_load_dwordx4 v[60:63], v6, s[42:43] offset:3072 sc1
    global_load_dwordx4 v[64:67], v27, s[40:41] offset:0 sc1
    global_load_dwordx4 v[68:71], v27, s[40:41] offset:1024 sc1
    global_load_dwordx4 v[72:75], v27, s[40:41] offset:128 sc1
    global_load_dwordx4 v[76:79], v27, s[40:41] offset:1152 sc1
    global_load_dwordx4 v[80:83], v28, s[40:41] offset:0 sc1
    global_load_dwordx4 v[84:87], v28, s[40:41] offset:1024 sc1
    global_load_dwordx4 v[88:91], v28, s[40:41] offset:128 sc1
    global_load_dwordx4 v[92:95], v28, s[40:41] offset:1152 sc1
    global_load_dwordx4 v[96:99], v6, s[40:41] offset:-2048 sc1
    global_load_dwordx4 v[100:103], v6, s[40:41] offset:-1024 sc1
    global_load_dwordx4 v[104:107], v6, s[40:41] offset:2048 sc1
    global_load_dwordx4 v[108:111], v6, s[40:41] offset:3072 sc1
    global_load_dwordx4 v[112:115], v7, s[40:41] offset:-2048 sc1
    global_load_dwordx4 v[116:119], v7, s[40:41] offset:-1024 sc1
    global_load_dwordx4 v[120:123], v7, s[40:41] offset:2048 sc1
    global_load_dwordx4 v[124:127], v7, s[40:41] offset:3072 sc1
    s_cmp_gt_u32 s9, 1
    s_cbranch_scc1 Lax_25
Lat_24:
    s_waitcnt vmcnt(8)
    v_mfma_f32_16x16x32_bf16 v[144:147], v[64:67], v[32:35], 0
    v_mfma_f32_16x16x32_bf16 v[148:151], v[64:67], v[48:51], 0
    v_mfma_f32_16x16x32_bf16 v[152:155], v[80:83], v[48:51], 0
    v_mfma_f32_16x16x32_bf16 v[144:147], v[68:71], v[36:39], v[144:147]
    v_mfma_f32_16x16x32_bf16 v[148:151], v[68:71], v[52:55], v[148:151]
    v_mfma_f32_16x16x32_bf16 v[152:155], v[84:87], v[52:55], v[152:155]
    v_mfma_f32_16x16x32_bf16 v[144:147], v[72:75], v[40:43], v[144:147]
    v_mfma_f32_16x16x32_bf16 v[148:151], v[72:75], v[56:59], v[148:151]
    v_mfma_f32_16x16x32_bf16 v[152:155], v[88:91], v[56:59], v[152:155]
    v_mfma_f32_16x16x32_bf16 v[144:147], v[76:79], v[44:47], v[144:147]
    v_mfma_f32_16x16x32_bf16 v[148:151], v[76:79], v[60:63], v[148:151]
    v_mfma_f32_16x16x32_bf16 v[152:155], v[92:95], v[60:63], v[152:155]
    v_cndmask_b32 v144, v13, v144, s[60:61]
    v_cndmask_b32 v145, v13, v145, s[62:63]
    v_cndmask_b32 v146, v13, v146, s[64:65]
    v_cndmask_b32 v147, v13, v147, s[66:67]
    s_nop 3
    v_cndmask_b32 v152, v13, v152, s[60:61]
    v_cndmask_b32 v153, v13, v153, s[62:63]
    v_cndmask_b32 v154, v13, v154, s[64:65]
    v_cndmask_b32 v155, v13, v155, s[66:67]
    v_max3_f32 v20, v144, v145, v146
    v_max3_f32 v21, v148, v149, v150
    v_max_f32 v20, v20, v147
    v_max3_f32 v21, v21, v151, v152
    v_max3_f32 v21, v21, v153, v154
    v_max_f32 v21, v21, v155
Lap_28:
    global_load_dword v24, v9, s[56:57] sc1
    s_sub_u32 s27, s27, 1
    s_cbranch_scc1 L_fin
    s_waitcnt vmcnt(0)
    v_cmp_eq_u32 vcc, -1, v24
    s_cbranch_vccnz Lap_28
Lam_29:
    global_load_dwordx4 v[192:195], v6, s[44:45] offset:-4096 sc1
    global_load_dwordx4 v[196:199], v6, s[44:45] offset:-3072 sc1
    global_load_dwordx4 v[200:203], v6, s[44:45] offset:-2048 sc1
    global_load_dwordx4 v[204:207], v6, s[44:45] offset:-1024 sc1
    global_load_dwordx4 v[208:211], v6, s[44:45] offset:0 sc1
    global_load_dwordx4 v[212:215], v6, s[44:45] offset:1024 sc1
    global_load_dwordx4 v[216:219], v6, s[44:45] offset:2048 sc1
    global_load_dwordx4 v[220:223], v6, s[44:45] offset:3072 sc1
    s_sub_u32 s27, s27, 1
    s_cbranch_scc1 L_fin
    s_waitcnt vmcnt(7)
    ds_write_b128 v11, v[192:195] offset:0
    s_waitcnt vmcnt(6)
    ds_write_b128 v11, v[196:199] offset:1024
    s_waitcnt vmcnt(5)
    ds_write_b128 v11, v[200:203] offset:2048
    v_max3_u32 v24, v192, v196, v200
    s_waitcnt vmcnt(4)
    ds_write_b128 v11, v[204:207] offset:3072
    s_waitcnt vmcnt(3)
    ds_write_b128 v11, v[208:211] offset:4096
    v_max3_u32 v24, v24, v204, v208
    s_waitcnt vmcnt(2)
    ds_write_b128 v11, v[212:215] offset:5120
    s_waitcnt vmcnt(1)
    ds_write_b128 v11, v[216:219] offset:6144
    v_max3_u32 v24, v24, v212, v216
    s_waitcnt vmcnt(0)
    ds_write_b128 v11, v[220:223] offset:7168
    v_max_u32 v24, v24, v220
    v_cmp_eq_u32 vcc, -1, v24
    s_waitcnt lgkmcnt(0)
    s_cbranch_vccnz Lam_29
    s_barrier
    ds_read_b128 v[192:195], v12 offset:0
    ds_read_b128 v[196:199], v12 offset:512
    ds_read_b128 v[200:203], v12 offset:1024
    ds_read_b128 v[204:207], v12 offset:1536
    ds_read_b128 v[208:211], v12 offset:128
    ds_read_b128 v[212:215], v12 offset:640
    ds_read_b128 v[216:219], v12 offset:1152
    ds_read_b128 v[220:223], v12 offset:1664
    ds_read_b128 v[224:227], v12 offset:4096
    ds_read_b128 v[228:231], v12 offset:4608
    ds_read_b128 v[232:235], v12 offset:5120
    ds_read_b128 v[236:239], v12 offset:5632
    ds_read_b128 v[240:243], v12 offset:4224
    ds_read_b128 v[244:247], v12 offset:4736
    ds_read_b128 v[248:251], v12 offset:5248
    ds_read_b128 v[252:255], v12 offset:5760
    s_waitcnt lgkmcnt(15)
    v_mfma_f32_16x16x32_bf16 v[128:131], a[0:3], v[192:195], 0
    v_mfma_f32_16x16x32_bf16 v[132:135], a[64:67], v[192:195], 0
    v_mfma_f32_16x16x32_bf16 v[136:139], v[192:195], a[128:131], 0
    v_mfma_f32_16x16x32_bf16 v[140:143], v[192:195], a[192:195], 0
    s_waitcnt lgkmcnt(14)
    v_mfma_f32_16x16x32_bf16 v[128:131], a[4:7], v[196:199], v[128:131]
    v_mfma_f32_16x16x32_bf16 v[132:135], a[68:71], v[196:199], v[132:135]
    v_mfma_f32_16x16x32_bf16 v[136:139], v[196:199], a[132:135], v[136:139]
    v_mfma_f32_16x16x32_bf16 v[140:143], v[196:199], a[196:199], v[140:143]
    s_waitcnt lgkmcnt(13)
    v_mfma_f32_16x16x32_bf16 v[128:131], a[8:11], v[200:203], v[128:131]
    v_mfma_f32_16x16x32_bf16 v[132:135], a[72:75], v[200:203], v[132:135]
    v_mfma_f32_16x16x32_bf16 v[136:139], v[200:203], a[136:139], v[136:139]
    v_mfma_f32_16x16x32_bf16 v[140:143], v[200:203], a[200:203], v[140:143]
    s_waitcnt lgkmcnt(12)
    v_mfma_f32_16x16x32_bf16 v[128:131], a[12:15], v[204:207], v[128:131]
    v_mfma_f32_16x16x32_bf16 v[132:135], a[76:79], v[204:207], v[132:135]
    v_mfma_f32_16x16x32_bf16 v[136:139], v[204:207], a[140:143], v[136:139]
    v_mfma_f32_16x16x32_bf16 v[140:143], v[204:207], a[204:207], v[140:143]
    s_waitcnt lgkmcnt(11)
    v_mfma_f32_16x16x32_bf16 v[128:131], a[16:19], v[208:211], v[128:131]
    v_mfma_f32_16x16x32_bf16 v[132:135], a[80:83], v[208:211], v[132:135]
    v_mfma_f32_16x16x32_bf16 v[136:139], v[208:211], a[144:147], v[136:139]
    v_mfma_f32_16x16x32_bf16 v[140:143], v[208:211], a[208:211], v[140:143]
    s_waitcnt lgkmcnt(10)
    v_mfma_f32_16x16x32_bf16 v[128:131], a[20:23], v[212:215], v[128:131]
    v_mfma_f32_16x16x32_bf16 v[132:135], a[84:87], v[212:215], v[132:135]
    v_mfma_f32_16x16x32_bf16 v[136:139], v[212:215], a[148:151], v[136:139]
    v_mfma_f32_16x16x32_bf16 v[140:143], v[212:215], a[212:215], v[140:143]
    s_waitcnt lgkmcnt(9)
    v_mfma_f32_16x16x32_bf16 v[128:131], a[24:27], v[216:219], v[128:131]
    v_mfma_f32_16x16x32_bf16 v[132:135], a[88:91], v[216:219], v[132:135]
    v_mfma_f32_16x16x32_bf16 v[136:139], v[216:219], a[152:155], v[136:139]
    v_mfma_f32_16x16x32_bf16 v[140:143], v[216:219], a[216:219], v[140:143]
    s_waitcnt lgkmcnt(8)
    v_mfma_f32_16x16x32_bf16 v[128:131], a[28:31], v[220:223], v[128:131]
    v_mfma_f32_16x16x32_bf16 v[132:135], a[92:95], v[220:223], v[132:135]
    v_mfma_f32_16x16x32_bf16 v[136:139], v[220:223], a[156:159], v[136:139]
    v_mfma_f32_16x16x32_bf16 v[140:143], v[220:223], a[220:223], v[140:143]
    s_waitcnt lgkmcnt(7)
    v_mfma_f32_16x16x32_bf16 v[128:131], a[32:35], v[224:227], v[128:131]
    v_mfma_f32_16x16x32_bf16 v[132:135], a[96:99], v[224:227], v[132:135]
    v_mfma_f32_16x16x32_bf16 v[136:139], v[224:227], a[160:163], v[136:139]
    v_mfma_f32_16x16x32_bf16 v[140:143], v[224:227], a[224:227], v[140:143]
    s_waitcnt lgkmcnt(6)
    v_mfma_f32_16x16x32_bf16 v[128:131], a[36:39], v[228:231], v[128:131]
    v_mfma_f32_16x16x32_bf16 v[132:135], a[100:103], v[228:231], v[132:135]
    v_mfma_f32_16x16x32_bf16 v[136:139], v[228:231], a[164:167], v[136:139]
    v_mfma_f32_16x16x32_bf16 v[140:143], v[228:231], a[228:231], v[140:143]
    s_waitcnt lgkmcnt(5)
    v_mfma_f32_16x16x32_bf16 v[128:131], a[40:43], v[232:235], v[128:131]
    v_mfma_f32_16x16x32_bf16 v[132:135], a[104:107], v[232:235], v[132:135]
    v_mfma_f32_16x16x32_bf16 v[136:139], v[232:235], a[168:171], v[136:139]
    v_mfma_f32_16x16x32_bf16 v[140:143], v[232:235], a[232:235], v[140:143]
    s_waitcnt lgkmcnt(4)
    v_mfma_f32_16x16x32_bf16 v[128:131], a[44:47], v[236:239], v[128:131]
    v_mfma_f32_16x16x32_bf16 v[132:135], a[108:111], v[236:239], v[132:135]
    v_mfma_f32_16x16x32_bf16 v[136:139], v[236:239], a[172:175], v[136:139]
    v_mfma_f32_16x16x32_bf16 v[140:143], v[236:239], a[236:239], v[140:143]
    s_waitcnt lgkmcnt(3)
    v_mfma_f32_16x16x32_bf16 v[128:131], a[48:51], v[240:243], v[128:131]
    v_mfma_f32_16x16x32_bf16 v[132:135], a[112:115], v[240:243], v[132:135]
    v_mfma_f32_16x16x32_bf16 v[136:139], v[240:243], a[176:179], v[136:139]
    v_mfma_f32_16x16x32_bf16 v[140:143], v[240:243], a[240:243], v[140:143]
    s_waitcnt lgkmcnt(2)
    v_mfma_f32_16x16x32_bf16 v[128:131], a[52:55], v[244:247], v[128:131]
    v_mfma_f32_16x16x32_bf16 v[132:135], a[116:119], v[244:247], v[132:135]
    v_mfma_f32_16x16x32_bf16 v[136:139], v[244:247], a[180:183], v[136:139]
    v_mfma_f32_16x16x32_bf16 v[140:143], v[244:247], a[244:247], v[140:143]
    s_waitcnt lgkmcnt(1)
    v_mfma_f32_16x16x32_bf16 v[128:131], a[56:59], v[248:251], v[128:131]
    v_mfma_f32_16x16x32_bf16 v[132:135], a[120:123], v[248:251], v[132:135]
    v_mfma_f32_16x16x32_bf16 v[136:139], v[248:251], a[184:187], v[136:139]
    v_mfma_f32_16x16x32_bf16 v[140:143], v[248:251], a[248:251], v[140:143]
    s_waitcnt lgkmcnt(0)
    v_mfma_f32_16x16x32_bf16 v[128:131], a[60:63], v[252:255], v[128:131]
    v_mfma_f32_16x16x32_bf16 v[132:135], a[124:127], v[252:255], v[132:135]
    v_mfma_f32_16x16x32_bf16 v[136:139], v[252:255], a[188:191], v[136:139]
    v_mfma_f32_16x16x32_bf16 v[140:143], v[252:255], a[252:255], v[140:143]
    v_cvt_pk_bf16_f32 v192, v128, v129
    v_cvt_pk_bf16_f32 v193, v130, v131
    v_cvt_pk_bf16_f32 v194, v132, v133
    v_cvt_pk_bf16_f32 v195, v134, v135
    ds_write_b128 v26, v[192:195] offset:20480
    v_cvt_pk_bf16_f32 v196, v136, v137
    s_nop 1
    v_cvt_pk_bf16_f32 v197, v140, v141
    ds_write_b64 v29, v[196:197] offset:24576
    v_cvt_pk_bf16_f32 v198, v138, v139
    v_cvt_pk_bf16_f32 v199, v142, v143
    ds_write_b64 v29, v[198:199] offset:26624
    s_waitcnt lgkmcnt(0)
    s_barrier
    global_load_dword v15, v8, s[4:5] sc1
    ds_read_b128 v[176:179], v30 offset:20480
    ds_read_b128 v[180:183], v30 offset:21504
    ds_read_b128 v[184:187], v30 offset:22528
    ds_read_b128 v[188:191], v30 offset:23552
    ds_read_b64 v[130:131], v31 offset:24576
    ds_read_b64 v[134:135], v31 offset:25088
    ds_read_b64 v[138:139], v31 offset:25600
    ds_read_b64 v[142:143], v31 offset:26112
    s_waitcnt lgkmcnt(7)
    v_mfma_f32_16x16x32_bf16 v[156:159], v[176:179], v[32:35], 0
    v_mfma_f32_16x16x32_bf16 v[160:163], v[176:179], v[48:51], 0
    s_waitcnt lgkmcnt(6)
    v_mfma_f32_16x16x32_bf16 v[156:159], v[180:183], v[36:39], v[156:159]
    v_mfma_f32_16x16x32_bf16 v[160:163], v[180:183], v[52:55], v[160:163]
    s_waitcnt lgkmcnt(5)
    v_mfma_f32_16x16x32_bf16 v[156:159], v[184:187], v[40:43], v[156:159]
    v_mfma_f32_16x16x32_bf16 v[160:163], v[184:187], v[56:59], v[160:163]
    s_waitcnt lgkmcnt(4)
    v_mfma_f32_16x16x32_bf16 v[156:159], v[188:191], v[44:47], v[156:159]
    v_mfma_f32_16x16x32_bf16 v[160:163], v[188:191], v[60:63], v[160:163]
    s_nop 3
    v_max3_f32 v20, v20, v156, v157
    s_nop 2
    v_max3_f32 v21, v21, v160, v161
    v_mov_b32 v22, v20
    v_mov_b32 v23, v20
    s_nop 1
    v_permlane16_swap_b32 v22, v23
    v_max_f32 v22, v22, v23
    v_mov_b32 v23, v22
    s_nop 1
    v_permlane32_swap_b32 v22, v23
    v_max_f32 v20, v22, v23
    v_mov_b32 v24, v21
    v_mov_b32 v25, v21
    s_nop 1
    v_permlane16_swap_b32 v24, v25
    v_max_f32 v24, v24, v25
    v_mov_b32 v25, v24
    s_nop 1
    v_permlane32_swap_b32 v24, v25
    v_max_f32 v21, v24, v25
    v_mul_f32 v20, 0xbe0293ee, v20
    v_mul_f32 v21, 0xbe0293ee, v21
    v_fmamk_f32 v156, v156, 0x3e0293ee, v20
    v_fmamk_f32 v157, v157, 0x3e0293ee, v20
    v_fmamk_f32 v160, v160, 0x3e0293ee, v21
    v_fmamk_f32 v161, v161, 0x3e0293ee, v21
    v_fmamk_f32 v144, v144, 0x3e0293ee, v20
    v_fmamk_f32 v145, v145, 0x3e0293ee, v20
    v_fmamk_f32 v146, v146, 0x3e0293ee, v20
    v_fmamk_f32 v147, v147, 0x3e0293ee, v20
    v_fmamk_f32 v148, v148, 0x3e0293ee, v21
    v_fmamk_f32 v149, v149, 0x3e0293ee, v21
    v_fmamk_f32 v150, v150, 0x3e0293ee, v21
    v_fmamk_f32 v151, v151, 0x3e0293ee, v21
    v_fmamk_f32 v152, v152, 0x3e0293ee, v21
    v_fmamk_f32 v153, v153, 0x3e0293ee, v21
    v_fmamk_f32 v154, v154, 0x3e0293ee, v21
    v_fmamk_f32 v155, v155, 0x3e0293ee, v21
    v_exp_f32 v156, v156
    v_exp_f32 v157, v157
    v_exp_f32 v160, v160
    v_exp_f32 v161, v161
    v_exp_f32 v144, v144
    v_exp_f32 v145, v145
    v_exp_f32 v146, v146
    v_exp_f32 v147, v147
    v_exp_f32 v148, v148
    v_exp_f32 v149, v149
    v_exp_f32 v150, v150
    v_exp_f32 v151, v151
    v_exp_f32 v152, v152
    v_exp_f32 v153, v153
    v_exp_f32 v154, v154
    v_exp_f32 v155, v155
    v_cvt_pk_bf16_f32 v192, v156, v157
    v_mov_b32 v193, 0
    v_mov_b32 v194, 0
    v_cvt_pk_bf16_f32 v195, v156, v157
    v_cvt_pk_bf16_f32 v196, v160, v161
    v_mov_b32 v197, 0
    v_mov_b32 v198, 0
    v_cvt_pk_bf16_f32 v199, v160, v161
    v_cvt_pk_bf16_f32 v200, v144, v145
    v_cvt_pk_bf16_f32 v201, v146, v147
    v_mov_b32 v202, 0
    v_mov_b32 v203, 0
    v_cvt_pk_bf16_f32 v204, v148, v149
    v_cvt_pk_bf16_f32 v205, v150, v151
    v_cvt_pk_bf16_f32 v206, v152, v153
    v_cvt_pk_bf16_f32 v207, v154, v155
    s_waitcnt lgkmcnt(0)
    v_mfma_f32_16x16x16_bf16 v[208:211], v[16:17], v[192:193], 0
    v_mfma_f32_16x16x16_bf16 v[212:215], v[16:17], v[196:197], 0
    v_mfma_f32_16x16x16_bf16 v[32:35], v[130:131], v[192:193], 0
    v_mfma_f32_16x16x16_bf16 v[36:39], v[130:131], v[194:195], 0
    v_mfma_f32_16x16x16_bf16 v[40:43], v[134:135], v[192:193], 0
    v_mfma_f32_16x16x16_bf16 v[44:47], v[134:135], v[194:195], 0
    v_mfma_f32_16x16x16_bf16 v[48:51], v[138:139], v[192:193], 0
    v_mfma_f32_16x16x16_bf16 v[52:55], v[138:139], v[194:195], 0
    v_mfma_f32_16x16x16_bf16 v[56:59], v[142:143], v[192:193], 0
    v_mfma_f32_16x16x16_bf16 v[60:63], v[142:143], v[194:195], 0
    v_mfma_f32_16x16x16_bf16 v[64:67], v[130:131], v[196:197], 0
    v_mfma_f32_16x16x16_bf16 v[68:71], v[130:131], v[198:199], 0
    v_mfma_f32_16x16x16_bf16 v[72:75], v[134:135], v[196:197], 0
    v_mfma_f32_16x16x16_bf16 v[76:79], v[134:135], v[198:199], 0
    v_mfma_f32_16x16x16_bf16 v[80:83], v[138:139], v[196:197], 0
    v_mfma_f32_16x16x16_bf16 v[84:87], v[138:139], v[198:199], 0
    v_mfma_f32_16x16x16_bf16 v[88:91], v[142:143], v[196:197], 0
    v_mfma_f32_16x16x16_bf16 v[92:95], v[142:143], v[198:199], 0
    v_mfma_f32_16x16x32_bf16 v[208:211], v[16:19], v[200:203], v[208:211]
    v_mfma_f32_16x16x32_bf16 v[212:215], v[16:19], v[204:207], v[212:215]
    v_mfma_f32_16x16x32_bf16 v[32:35], v[96:99], v[200:203], v[32:35]
    v_mfma_f32_16x16x32_bf16 v[36:39], v[100:103], v[200:203], v[36:39]
    v_mfma_f32_16x16x32_bf16 v[40:43], v[104:107], v[200:203], v[40:43]
    v_mfma_f32_16x16x32_bf16 v[44:47], v[108:111], v[200:203], v[44:47]
    v_mfma_f32_16x16x32_bf16 v[48:51], v[112:115], v[200:203], v[48:51]
    v_mfma_f32_16x16x32_bf16 v[52:55], v[116:119], v[200:203], v[52:55]
    v_mfma_f32_16x16x32_bf16 v[56:59], v[120:123], v[200:203], v[56:59]
    v_mfma_f32_16x16x32_bf16 v[60:63], v[124:127], v[200:203], v[60:63]
    v_rcp_f32 v20, v208
    v_rcp_f32 v22, v212
    v_mfma_f32_16x16x32_bf16 v[64:67], v[96:99], v[204:207], v[64:67]
    v_mfma_f32_16x16x32_bf16 v[68:71], v[100:103], v[204:207], v[68:71]
    v_mfma_f32_16x16x32_bf16 v[72:75], v[104:107], v[204:207], v[72:75]
    v_mfma_f32_16x16x32_bf16 v[76:79], v[108:111], v[204:207], v[76:79]
    v_mfma_f32_16x16x32_bf16 v[80:83], v[112:115], v[204:207], v[80:83]
    v_mfma_f32_16x16x32_bf16 v[84:87], v[116:119], v[204:207], v[84:87]
    v_mfma_f32_16x16x32_bf16 v[88:91], v[120:123], v[204:207], v[88:91]
    v_mfma_f32_16x16x32_bf16 v[92:95], v[124:127], v[204:207], v[92:95]
    v_pk_mul_f32 v[32:33], v[32:33], v[20:21] op_sel_hi:[1,0]
    v_pk_mul_f32 v[34:35], v[34:35], v[20:21] op_sel_hi:[1,0]
    v_pk_mul_f32 v[36:37], v[36:37], v[20:21] op_sel_hi:[1,0]
    v_pk_mul_f32 v[38:39], v[38:39], v[20:21] op_sel_hi:[1,0]
    v_cvt_pk_bf16_f32 v32, v32, v33
    v_cvt_pk_bf16_f32 v33, v34, v35
    v_cvt_pk_bf16_f32 v34, v36, v37
    v_cvt_pk_bf16_f32 v35, v38, v39
    global_store_dwordx4 v6, v[32:35], s[46:47] offset:-4096 sc1
    v_pk_mul_f32 v[40:41], v[40:41], v[20:21] op_sel_hi:[1,0]
    v_pk_mul_f32 v[42:43], v[42:43], v[20:21] op_sel_hi:[1,0]
    v_pk_mul_f32 v[44:45], v[44:45], v[20:21] op_sel_hi:[1,0]
    v_pk_mul_f32 v[46:47], v[46:47], v[20:21] op_sel_hi:[1,0]
    v_cvt_pk_bf16_f32 v40, v40, v41
    v_cvt_pk_bf16_f32 v41, v42, v43
    v_cvt_pk_bf16_f32 v42, v44, v45
    v_cvt_pk_bf16_f32 v43, v46, v47
    global_store_dwordx4 v6, v[40:43], s[46:47] offset:-3072 sc1
    v_pk_mul_f32 v[48:49], v[48:49], v[20:21] op_sel_hi:[1,0]
    v_pk_mul_f32 v[50:51], v[50:51], v[20:21] op_sel_hi:[1,0]
    v_pk_mul_f32 v[52:53], v[52:53], v[20:21] op_sel_hi:[1,0]
    v_pk_mul_f32 v[54:55], v[54:55], v[20:21] op_sel_hi:[1,0]
    v_cvt_pk_bf16_f32 v48, v48, v49
    v_cvt_pk_bf16_f32 v49, v50, v51
    v_cvt_pk_bf16_f32 v50, v52, v53
    v_cvt_pk_bf16_f32 v51, v54, v55
    global_store_dwordx4 v6, v[48:51], s[46:47] offset:-2048 sc1
    v_pk_mul_f32 v[56:57], v[56:57], v[20:21] op_sel_hi:[1,0]
    v_pk_mul_f32 v[58:59], v[58:59], v[20:21] op_sel_hi:[1,0]
    v_pk_mul_f32 v[60:61], v[60:61], v[20:21] op_sel_hi:[1,0]
    v_pk_mul_f32 v[62:63], v[62:63], v[20:21] op_sel_hi:[1,0]
    v_cvt_pk_bf16_f32 v56, v56, v57
    v_cvt_pk_bf16_f32 v57, v58, v59
    v_cvt_pk_bf16_f32 v58, v60, v61
    v_cvt_pk_bf16_f32 v59, v62, v63
    global_store_dwordx4 v6, v[56:59], s[46:47] offset:-1024 sc1
    v_pk_mul_f32 v[64:65], v[64:65], v[22:23] op_sel_hi:[1,0]
    v_pk_mul_f32 v[66:67], v[66:67], v[22:23] op_sel_hi:[1,0]
    v_pk_mul_f32 v[68:69], v[68:69], v[22:23] op_sel_hi:[1,0]
    v_pk_mul_f32 v[70:71], v[70:71], v[22:23] op_sel_hi:[1,0]
    v_cvt_pk_bf16_f32 v64, v64, v65
    v_cvt_pk_bf16_f32 v65, v66, v67
    v_cvt_pk_bf16_f32 v66, v68, v69
    v_cvt_pk_bf16_f32 v67, v70, v71
    global_store_dwordx4 v14, v[64:67], s[46:47] offset:-4096 sc1
    v_pk_mul_f32 v[72:73], v[72:73], v[22:23] op_sel_hi:[1,0]
    v_pk_mul_f32 v[74:75], v[74:75], v[22:23] op_sel_hi:[1,0]
    v_pk_mul_f32 v[76:77], v[76:77], v[22:23] op_sel_hi:[1,0]
    v_pk_mul_f32 v[78:79], v[78:79], v[22:23] op_sel_hi:[1,0]
    v_cvt_pk_bf16_f32 v72, v72, v73
    v_cvt_pk_bf16_f32 v73, v74, v75
    v_cvt_pk_bf16_f32 v74, v76, v77
    v_cvt_pk_bf16_f32 v75, v78, v79
    global_store_dwordx4 v14, v[72:75], s[46:47] offset:-3072 sc1
    v_pk_mul_f32 v[80:81], v[80:81], v[22:23] op_sel_hi:[1,0]
    v_pk_mul_f32 v[82:83], v[82:83], v[22:23] op_sel_hi:[1,0]
    v_pk_mul_f32 v[84:85], v[84:85], v[22:23] op_sel_hi:[1,0]
    v_pk_mul_f32 v[86:87], v[86:87], v[22:23] op_sel_hi:[1,0]
    v_cvt_pk_bf16_f32 v80, v80, v81
    v_cvt_pk_bf16_f32 v81, v82, v83
    v_cvt_pk_bf16_f32 v82, v84, v85
    v_cvt_pk_bf16_f32 v83, v86, v87
    global_store_dwordx4 v14, v[80:83], s[46:47] offset:-2048 sc1
    v_pk_mul_f32 v[88:89], v[88:89], v[22:23] op_sel_hi:[1,0]
    v_pk_mul_f32 v[90:91], v[90:91], v[22:23] op_sel_hi:[1,0]
    v_pk_mul_f32 v[92:93], v[92:93], v[22:23] op_sel_hi:[1,0]
    v_pk_mul_f32 v[94:95], v[94:95], v[22:23] op_sel_hi:[1,0]
    v_cvt_pk_bf16_f32 v88, v88, v89
    v_cvt_pk_bf16_f32 v89, v90, v91
    v_cvt_pk_bf16_f32 v90, v92, v93
    v_cvt_pk_bf16_f32 v91, v94, v95
    global_store_dwordx4 v14, v[88:91], s[46:47] offset:-1024 sc1
    s_add_u32 s48, s48, 1
    v_mov_b32 v20, s48
    s_add_u32 s40, s40, 2097152
    s_addc_u32 s41, s41, 0
    s_add_u32 s42, s42, 1048576
    s_addc_u32 s43, s43, 0
    s_add_u32 s46, s46, 1048576
    s_addc_u32 s47, s47, 0
    s_add_u32 s44, s44, 32768
    s_addc_u32 s45, s45, 0
    s_add_u32 s50, s50, 4
    s_cmp_eq_u32 s50, 63
    s_cselect_b32 s52, 3, 4
    s_lshl_b32 s52, s52, 13
    s_add_u32 s56, s56, s52
    s_addc_u32 s57, s57, 0
    s_add_u32 s49, s49, 2
    s_cmp_eq_u32 s48, 16
    s_cbranch_scc1 Lal_26
    s_waitcnt vmcnt(8)
    v_cmp_gt_u32 vcc, s49, v15
    s_cbranch_vccnz Las_30
    global_load_dwordx4 v[32:35], v6, s[42:43] offset:-4096 sc1
    global_load_dwordx4 v[36:39], v6, s[42:43] offset:-3072 sc1
    global_load_dwordx4 v[40:43], v6, s[42:43] offset:-2048 sc1
    global_load_dwordx4 v[44:47], v6, s[42:43] offset:-1024 sc1
    global_load_dwordx4 v[48:51], v6, s[42:43] offset:0 sc1
    global_load_dwordx4 v[52:55], v6, s[42:43] offset:1024 sc1
    global_load_dwordx4 v[56:59], v6, s[42:43] offset:2048 sc1
    global_load_dwordx4 v[60:63], v6, s[42:43] offset:3072 sc1
    global_load_dwordx4 v[64:67], v27, s[40:41] offset:0 sc1
    global_load_dwordx4 v[68:71], v27, s[40:41] offset:1024 sc1
    global_load_dwordx4 v[72:75], v27, s[40:41] offset:128 sc1
    global_load_dwordx4 v[76:79], v27, s[40:41] offset:1152 sc1
    global_load_dwordx4 v[80:83], v28, s[40:41] offset:0 sc1
    global_load_dwordx4 v[84:87], v28, s[40:41] offset:1024 sc1
    global_load_dwordx4 v[88:91], v28, s[40:41] offset:128 sc1
    global_load_dwordx4 v[92:95], v28, s[40:41] offset:1152 sc1
    global_load_dwordx4 v[96:99], v6, s[40:41] offset:-2048 sc1
    global_load_dwordx4 v[100:103], v6, s[40:41] offset:-1024 sc1
    global_load_dwordx4 v[104:107], v6, s[40:41] offset:2048 sc1
    global_load_dwordx4 v[108:111], v6, s[40:41] offset:3072 sc1
    global_load_dwordx4 v[112:115], v7, s[40:41] offset:-2048 sc1
    global_load_dwordx4 v[116:119], v7, s[40:41] offset:-1024 sc1
    global_load_dwordx4 v[120:123], v7, s[40:41] offset:2048 sc1
    global_load_dwordx4 v[124:127], v7, s[40:41] offset:3072 sc1
    s_waitcnt vmcnt(24)
    s_mov_b64 exec, 1
    global_store_dword v10, v20, s[4:5] sc1
    s_mov_b64 exec, -1
Lax_25:
    s_barrier
    ds_read_b128 v[192:195], v12 offset:0
    ds_read_b128 v[196:199], v12 offset:512
    ds_read_b128 v[200:203], v12 offset:1024
    ds_read_b128 v[204:207], v12 offset:1536
    ds_read_b128 v[208:211], v12 offset:128
    ds_read_b128 v[212:215], v12 offset:640
    ds_read_b128 v[216:219], v12 offset:1152
    ds_read_b128 v[220:223], v12 offset:1664
    ds_read_b128 v[224:227], v12 offset:4096
    ds_read_b128 v[228:231], v12 offset:4608
    ds_read_b128 v[232:235], v12 offset:5120
    ds_read_b128 v[236:239], v12 offset:5632
    ds_read_b128 v[240:243], v12 offset:4224
    ds_read_b128 v[244:247], v12 offset:4736
    ds_read_b128 v[248:251], v12 offset:5248
    ds_read_b128 v[252:255], v12 offset:5760
    s_waitcnt lgkmcnt(15)
    v_mfma_f32_16x16x32_bf16 v[128:131], a[0:3], v[192:195], 0
    v_mfma_f32_16x16x32_bf16 v[132:135], a[64:67], v[192:195], 0
    v_mfma_f32_16x16x32_bf16 v[136:139], v[192:195], a[128:131], 0
    v_mfma_f32_16x16x32_bf16 v[140:143], v[192:195], a[192:195], 0
    s_waitcnt lgkmcnt(14)
    v_mfma_f32_16x16x32_bf16 v[128:131], a[4:7], v[196:199], v[128:131]
    v_mfma_f32_16x16x32_bf16 v[132:135], a[68:71], v[196:199], v[132:135]
    v_mfma_f32_16x16x32_bf16 v[136:139], v[196:199], a[132:135], v[136:139]
    v_mfma_f32_16x16x32_bf16 v[140:143], v[196:199], a[196:199], v[140:143]
    s_waitcnt lgkmcnt(13)
    v_mfma_f32_16x16x32_bf16 v[128:131], a[8:11], v[200:203], v[128:131]
    v_mfma_f32_16x16x32_bf16 v[132:135], a[72:75], v[200:203], v[132:135]
    v_mfma_f32_16x16x32_bf16 v[136:139], v[200:203], a[136:139], v[136:139]
    v_mfma_f32_16x16x32_bf16 v[140:143], v[200:203], a[200:203], v[140:143]
    s_waitcnt lgkmcnt(12)
    v_mfma_f32_16x16x32_bf16 v[128:131], a[12:15], v[204:207], v[128:131]
    v_mfma_f32_16x16x32_bf16 v[132:135], a[76:79], v[204:207], v[132:135]
    v_mfma_f32_16x16x32_bf16 v[136:139], v[204:207], a[140:143], v[136:139]
    v_mfma_f32_16x16x32_bf16 v[140:143], v[204:207], a[204:207], v[140:143]
    s_waitcnt lgkmcnt(11)
    v_mfma_f32_16x16x32_bf16 v[128:131], a[16:19], v[208:211], v[128:131]
    v_mfma_f32_16x16x32_bf16 v[132:135], a[80:83], v[208:211], v[132:135]
    v_mfma_f32_16x16x32_bf16 v[136:139], v[208:211], a[144:147], v[136:139]
    v_mfma_f32_16x16x32_bf16 v[140:143], v[208:211], a[208:211], v[140:143]
    s_waitcnt lgkmcnt(10)
    v_mfma_f32_16x16x32_bf16 v[128:131], a[20:23], v[212:215], v[128:131]
    v_mfma_f32_16x16x32_bf16 v[132:135], a[84:87], v[212:215], v[132:135]
    v_mfma_f32_16x16x32_bf16 v[136:139], v[212:215], a[148:151], v[136:139]
    v_mfma_f32_16x16x32_bf16 v[140:143], v[212:215], a[212:215], v[140:143]
    s_waitcnt lgkmcnt(9)
    v_mfma_f32_16x16x32_bf16 v[128:131], a[24:27], v[216:219], v[128:131]
    v_mfma_f32_16x16x32_bf16 v[132:135], a[88:91], v[216:219], v[132:135]
    v_mfma_f32_16x16x32_bf16 v[136:139], v[216:219], a[152:155], v[136:139]
    v_mfma_f32_16x16x32_bf16 v[140:143], v[216:219], a[216:219], v[140:143]
    s_waitcnt lgkmcnt(8)
    v_mfma_f32_16x16x32_bf16 v[128:131], a[28:31], v[220:223], v[128:131]
    v_mfma_f32_16x16x32_bf16 v[132:135], a[92:95], v[220:223], v[132:135]
    v_mfma_f32_16x16x32_bf16 v[136:139], v[220:223], a[156:159], v[136:139]
    v_mfma_f32_16x16x32_bf16 v[140:143], v[220:223], a[220:223], v[140:143]
    s_waitcnt lgkmcnt(7)
    v_mfma_f32_16x16x32_bf16 v[128:131], a[32:35], v[224:227], v[128:131]
    v_mfma_f32_16x16x32_bf16 v[132:135], a[96:99], v[224:227], v[132:135]
    v_mfma_f32_16x16x32_bf16 v[136:139], v[224:227], a[160:163], v[136:139]
    v_mfma_f32_16x16x32_bf16 v[140:143], v[224:227], a[224:227], v[140:143]
    s_waitcnt lgkmcnt(6)
    v_mfma_f32_16x16x32_bf16 v[128:131], a[36:39], v[228:231], v[128:131]
    v_mfma_f32_16x16x32_bf16 v[132:135], a[100:103], v[228:231], v[132:135]
    v_mfma_f32_16x16x32_bf16 v[136:139], v[228:231], a[164:167], v[136:139]
    v_mfma_f32_16x16x32_bf16 v[140:143], v[228:231], a[228:231], v[140:143]
    s_waitcnt lgkmcnt(5)
    v_mfma_f32_16x16x32_bf16 v[128:131], a[40:43], v[232:235], v[128:131]
    v_mfma_f32_16x16x32_bf16 v[132:135], a[104:107], v[232:235], v[132:135]
    v_mfma_f32_16x16x32_bf16 v[136:139], v[232:235], a[168:171], v[136:139]
    v_mfma_f32_16x16x32_bf16 v[140:143], v[232:235], a[232:235], v[140:143]
    s_waitcnt lgkmcnt(4)
    v_mfma_f32_16x16x32_bf16 v[128:131], a[44:47], v[236:239], v[128:131]
    v_mfma_f32_16x16x32_bf16 v[132:135], a[108:111], v[236:239], v[132:135]
    v_mfma_f32_16x16x32_bf16 v[136:139], v[236:239], a[172:175], v[136:139]
    v_mfma_f32_16x16x32_bf16 v[140:143], v[236:239], a[236:239], v[140:143]
    s_waitcnt lgkmcnt(3)
    v_mfma_f32_16x16x32_bf16 v[128:131], a[48:51], v[240:243], v[128:131]
    v_mfma_f32_16x16x32_bf16 v[132:135], a[112:115], v[240:243], v[132:135]
    v_mfma_f32_16x16x32_bf16 v[136:139], v[240:243], a[176:179], v[136:139]
    v_mfma_f32_16x16x32_bf16 v[140:143], v[240:243], a[240:243], v[140:143]
    s_waitcnt lgkmcnt(2)
    v_mfma_f32_16x16x32_bf16 v[128:131], a[52:55], v[244:247], v[128:131]
    v_mfma_f32_16x16x32_bf16 v[132:135], a[116:119], v[244:247], v[132:135]
    v_mfma_f32_16x16x32_bf16 v[136:139], v[244:247], a[180:183], v[136:139]
    v_mfma_f32_16x16x32_bf16 v[140:143], v[244:247], a[244:247], v[140:143]
    s_waitcnt lgkmcnt(1)
    v_mfma_f32_16x16x32_bf16 v[128:131], a[56:59], v[248:251], v[128:131]
    v_mfma_f32_16x16x32_bf16 v[132:135], a[120:123], v[248:251], v[132:135]
    v_mfma_f32_16x16x32_bf16 v[136:139], v[248:251], a[184:187], v[136:139]
    v_mfma_f32_16x16x32_bf16 v[140:143], v[248:251], a[248:251], v[140:143]
    s_waitcnt lgkmcnt(0)
    v_mfma_f32_16x16x32_bf16 v[128:131], a[60:63], v[252:255], v[128:131]
    v_mfma_f32_16x16x32_bf16 v[132:135], a[124:127], v[252:255], v[132:135]
    v_mfma_f32_16x16x32_bf16 v[136:139], v[252:255], a[188:191], v[136:139]
    v_mfma_f32_16x16x32_bf16 v[140:143], v[252:255], a[252:255], v[140:143]
    v_cvt_pk_bf16_f32 v192, v128, v129
    v_cvt_pk_bf16_f32 v193, v130, v131
    v_cvt_pk_bf16_f32 v194, v132, v133
    v_cvt_pk_bf16_f32 v195, v134, v135
    ds_write_b128 v26, v[192:195] offset:20480
    v_cvt_pk_bf16_f32 v196, v136, v137
    s_nop 1
    v_cvt_pk_bf16_f32 v197, v140, v141
    ds_write_b64 v29, v[196:197] offset:24576
    v_cvt_pk_bf16_f32 v198, v138, v139
    v_cvt_pk_bf16_f32 v199, v142, v143
    ds_write_b64 v29, v[198:199] offset:26624
    s_waitcnt lgkmcnt(0)
    s_barrier
    s_branch Lat_24
Las_30:
    s_waitcnt vmcnt(0)
    s_mov_b64 exec, 1
    global_store_dword v10, v20, s[4:5] sc1
    s_mov_b64 exec, -1
    s_mov_b64 exec, 0xffff
Lpf_31:
    global_load_dword v20, v8, s[4:5] sc1
    s_sub_u32 s27, s27, 1
    s_cbranch_scc1 L_fin
    s_waitcnt vmcnt(0)
    v_cmp_gt_u32 vcc, s49, v20
    s_cbranch_vccnz Lpf_31
    s_mov_b64 exec, -1
    global_load_dwordx4 v[32:35], v6, s[42:43] offset:-4096 sc1
    global_load_dwordx4 v[36:39], v6, s[42:43] offset:-3072 sc1
    global_load_dwordx4 v[40:43], v6, s[42:43] offset:-2048 sc1
    global_load_dwordx4 v[44:47], v6, s[42:43] offset:-1024 sc1
    global_load_dwordx4 v[48:51], v6, s[42:43] offset:0 sc1
    global_load_dwordx4 v[52:55], v6, s[42:43] offset:1024 sc1
    global_load_dwordx4 v[56:59], v6, s[42:43] offset:2048 sc1
    global_load_dwordx4 v[60:63], v6, s[42:43] offset:3072 sc1
    global_load_dwordx4 v[64:67], v27, s[40:41] offset:0 sc1
    global_load_dwordx4 v[68:71], v27, s[40:41] offset:1024 sc1
    global_load_dwordx4 v[72:75], v27, s[40:41] offset:128 sc1
    global_load_dwordx4 v[76:79], v27, s[40:41] offset:1152 sc1
    global_load_dwordx4 v[80:83], v28, s[40:41] offset:0 sc1
    global_load_dwordx4 v[84:87], v28, s[40:41] offset:1024 sc1
    global_load_dwordx4 v[88:91], v28, s[40:41] offset:128 sc1
    global_load_dwordx4 v[92:95], v28, s[40:41] offset:1152 sc1
    global_load_dwordx4 v[96:99], v6, s[40:41] offset:-2048 sc1
    global_load_dwordx4 v[100:103], v6, s[40:41] offset:-1024 sc1
    global_load_dwordx4 v[104:107], v6, s[40:41] offset:2048 sc1
    global_load_dwordx4 v[108:111], v6, s[40:41] offset:3072 sc1
    global_load_dwordx4 v[112:115], v7, s[40:41] offset:-2048 sc1
    global_load_dwordx4 v[116:119], v7, s[40:41] offset:-1024 sc1
    global_load_dwordx4 v[120:123], v7, s[40:41] offset:2048 sc1
    global_load_dwordx4 v[124:127], v7, s[40:41] offset:3072 sc1
    s_branch Lax_25
Lal_26:
    s_cmp_gt_u32 s9, 1
    s_cbranch_scc1 Las_30x
    s_barrier
    ds_read_b128 v[192:195], v12 offset:0
    ds_read_b128 v[196:199], v12 offset:512
    ds_read_b128 v[200:203], v12 offset:1024
    ds_read_b128 v[204:207], v12 offset:1536
    ds_read_b128 v[208:211], v12 offset:128
    ds_read_b128 v[212:215], v12 offset:640
    ds_read_b128 v[216:219], v12 offset:1152
    ds_read_b128 v[220:223], v12 offset:1664
    ds_read_b128 v[224:227], v12 offset:4096
    ds_read_b128 v[228:231], v12 offset:4608
    ds_read_b128 v[232:235], v12 offset:5120
    ds_read_b128 v[236:239], v12 offset:5632
    ds_read_b128 v[240:243], v12 offset:4224
    ds_read_b128 v[244:247], v12 offset:4736
    ds_read_b128 v[248:251], v12 offset:5248
    ds_read_b128 v[252:255], v12 offset:5760
    s_waitcnt lgkmcnt(15)
    v_mfma_f32_16x16x32_bf16 v[128:131], a[0:3], v[192:195], 0
    v_mfma_f32_16x16x32_bf16 v[132:135], a[64:67], v[192:195], 0
    v_mfma_f32_16x16x32_bf16 v[136:139], v[192:195], a[128:131], 0
    v_mfma_f32_16x16x32_bf16 v[140:143], v[192:195], a[192:195], 0
    s_waitcnt lgkmcnt(14)
    v_mfma_f32_16x16x32_bf16 v[128:131], a[4:7], v[196:199], v[128:131]
    v_mfma_f32_16x16x32_bf16 v[132:135], a[68:71], v[196:199], v[132:135]
    v_mfma_f32_16x16x32_bf16 v[136:139], v[196:199], a[132:135], v[136:139]
    v_mfma_f32_16x16x32_bf16 v[140:143], v[196:199], a[196:199], v[140:143]
    s_waitcnt lgkmcnt(13)
    v_mfma_f32_16x16x32_bf16 v[128:131], a[8:11], v[200:203], v[128:131]
    v_mfma_f32_16x16x32_bf16 v[132:135], a[72:75], v[200:203], v[132:135]
    v_mfma_f32_16x16x32_bf16 v[136:139], v[200:203], a[136:139], v[136:139]
    v_mfma_f32_16x16x32_bf16 v[140:143], v[200:203], a[200:203], v[140:143]
    s_waitcnt lgkmcnt(12)
    v_mfma_f32_16x16x32_bf16 v[128:131], a[12:15], v[204:207], v[128:131]
    v_mfma_f32_16x16x32_bf16 v[132:135], a[76:79], v[204:207], v[132:135]
    v_mfma_f32_16x16x32_bf16 v[136:139], v[204:207], a[140:143], v[136:139]
    v_mfma_f32_16x16x32_bf16 v[140:143], v[204:207], a[204:207], v[140:143]
    s_waitcnt lgkmcnt(11)
    v_mfma_f32_16x16x32_bf16 v[128:131], a[16:19], v[208:211], v[128:131]
    v_mfma_f32_16x16x32_bf16 v[132:135], a[80:83], v[208:211], v[132:135]
    v_mfma_f32_16x16x32_bf16 v[136:139], v[208:211], a[144:147], v[136:139]
    v_mfma_f32_16x16x32_bf16 v[140:143], v[208:211], a[208:211], v[140:143]
    s_waitcnt lgkmcnt(10)
    v_mfma_f32_16x16x32_bf16 v[128:131], a[20:23], v[212:215], v[128:131]
    v_mfma_f32_16x16x32_bf16 v[132:135], a[84:87], v[212:215], v[132:135]
    v_mfma_f32_16x16x32_bf16 v[136:139], v[212:215], a[148:151], v[136:139]
    v_mfma_f32_16x16x32_bf16 v[140:143], v[212:215], a[212:215], v[140:143]
    s_waitcnt lgkmcnt(9)
    v_mfma_f32_16x16x32_bf16 v[128:131], a[24:27], v[216:219], v[128:131]
    v_mfma_f32_16x16x32_bf16 v[132:135], a[88:91], v[216:219], v[132:135]
    v_mfma_f32_16x16x32_bf16 v[136:139], v[216:219], a[152:155], v[136:139]
    v_mfma_f32_16x16x32_bf16 v[140:143], v[216:219], a[216:219], v[140:143]
    s_waitcnt lgkmcnt(8)
    v_mfma_f32_16x16x32_bf16 v[128:131], a[28:31], v[220:223], v[128:131]
    v_mfma_f32_16x16x32_bf16 v[132:135], a[92:95], v[220:223], v[132:135]
    v_mfma_f32_16x16x32_bf16 v[136:139], v[220:223], a[156:159], v[136:139]
    v_mfma_f32_16x16x32_bf16 v[140:143], v[220:223], a[220:223], v[140:143]
    s_waitcnt lgkmcnt(7)
    v_mfma_f32_16x16x32_bf16 v[128:131], a[32:35], v[224:227], v[128:131]
    v_mfma_f32_16x16x32_bf16 v[132:135], a[96:99], v[224:227], v[132:135]
    v_mfma_f32_16x16x32_bf16 v[136:139], v[224:227], a[160:163], v[136:139]
    v_mfma_f32_16x16x32_bf16 v[140:143], v[224:227], a[224:227], v[140:143]
    s_waitcnt lgkmcnt(6)
    v_mfma_f32_16x16x32_bf16 v[128:131], a[36:39], v[228:231], v[128:131]
    v_mfma_f32_16x16x32_bf16 v[132:135], a[100:103], v[228:231], v[132:135]
    v_mfma_f32_16x16x32_bf16 v[136:139], v[228:231], a[164:167], v[136:139]
    v_mfma_f32_16x16x32_bf16 v[140:143], v[228:231], a[228:231], v[140:143]
    s_waitcnt lgkmcnt(5)
    v_mfma_f32_16x16x32_bf16 v[128:131], a[40:43], v[232:235], v[128:131]
    v_mfma_f32_16x16x32_bf16 v[132:135], a[104:107], v[232:235], v[132:135]
    v_mfma_f32_16x16x32_bf16 v[136:139], v[232:235], a[168:171], v[136:139]
    v_mfma_f32_16x16x32_bf16 v[140:143], v[232:235], a[232:235], v[140:143]
    s_waitcnt lgkmcnt(4)
    v_mfma_f32_16x16x32_bf16 v[128:131], a[44:47], v[236:239], v[128:131]
    v_mfma_f32_16x16x32_bf16 v[132:135], a[108:111], v[236:239], v[132:135]
    v_mfma_f32_16x16x32_bf16 v[136:139], v[236:239], a[172:175], v[136:139]
    v_mfma_f32_16x16x32_bf16 v[140:143], v[236:239], a[236:239], v[140:143]
    s_waitcnt lgkmcnt(3)
    v_mfma_f32_16x16x32_bf16 v[128:131], a[48:51], v[240:243], v[128:131]
    v_mfma_f32_16x16x32_bf16 v[132:135], a[112:115], v[240:243], v[132:135]
    v_mfma_f32_16x16x32_bf16 v[136:139], v[240:243], a[176:179], v[136:139]
    v_mfma_f32_16x16x32_bf16 v[140:143], v[240:243], a[240:243], v[140:143]
    s_waitcnt lgkmcnt(2)
    v_mfma_f32_16x16x32_bf16 v[128:131], a[52:55], v[244:247], v[128:131]
    v_mfma_f32_16x16x32_bf16 v[132:135], a[116:119], v[244:247], v[132:135]
    v_mfma_f32_16x16x32_bf16 v[136:139], v[244:247], a[180:183], v[136:139]
    v_mfma_f32_16x16x32_bf16 v[140:143], v[244:247], a[244:247], v[140:143]
    s_waitcnt lgkmcnt(1)
    v_mfma_f32_16x16x32_bf16 v[128:131], a[56:59], v[248:251], v[128:131]
    v_mfma_f32_16x16x32_bf16 v[132:135], a[120:123], v[248:251], v[132:135]
    v_mfma_f32_16x16x32_bf16 v[136:139], v[248:251], a[184:187], v[136:139]
    v_mfma_f32_16x16x32_bf16 v[140:143], v[248:251], a[248:251], v[140:143]
    s_waitcnt lgkmcnt(0)
    v_mfma_f32_16x16x32_bf16 v[128:131], a[60:63], v[252:255], v[128:131]
    v_mfma_f32_16x16x32_bf16 v[132:135], a[124:127], v[252:255], v[132:135]
    v_mfma_f32_16x16x32_bf16 v[136:139], v[252:255], a[188:191], v[136:139]
    v_mfma_f32_16x16x32_bf16 v[140:143], v[252:255], a[252:255], v[140:143]
    v_cvt_pk_bf16_f32 v192, v128, v129
    v_cvt_pk_bf16_f32 v193, v130, v131
    v_cvt_pk_bf16_f32 v194, v132, v133
    v_cvt_pk_bf16_f32 v195, v134, v135
    ds_write_b128 v26, v[192:195] offset:20480
    v_cvt_pk_bf16_f32 v196, v136, v137
    s_nop 1
    v_cvt_pk_bf16_f32 v197, v140, v141
    ds_write_b64 v29, v[196:197] offset:24576
    v_cvt_pk_bf16_f32 v198, v138, v139
    v_cvt_pk_bf16_f32 v199, v142, v143
    ds_write_b64 v29, v[198:199] offset:26624
    s_waitcnt lgkmcnt(0)
    s_barrier
Las_30x:
    s_waitcnt vmcnt(0)
    s_mov_b64 exec, 1
    global_store_dword v10, v20, s[4:5] sc1
    s_mov_b64 exec, -1
    s_branch L_fin
L_heads:
    v_and_b32 v1, 63, v0
    v_lshrrev_b32 v2, 4, v1
    v_and_b32 v3, 15, v1
    v_lshrrev_b32 v4, 2, v3
    v_and_b32 v5, 3, v1
    v_lshlrev_b32 v118, 4, v1
    v_lshlrev_b32 v8, 2, v2
    v_xor_b32 v8, v8, v3
    v_lshlrev_b32 v8, 4, v8
    v_lshrrev_b32 v9, 1, v2
    v_and_b32 v10, 1, v2
    v_lshl_add_u32 v6, v9, 3, v10
    v_lshl_add_u32 v6, v6, 13, v8
    s_lshl_b32 s52, s8, 8
    s_lshl_b32 s53, s9, 18
    s_add_u32 s52, s52, s53
    v_add_u32 v6, s52, v6
    v_lshl_add_u32 v7, v9, 2, v10
    v_lshl_add_u32 v7, v7, 10, v8
    s_lshl_b32 s52, s8, 17
    s_lshl_b32 s53, s9, 14
    s_add_u32 s52, s52, s53
    v_add_u32 v7, s52, v7
    s_lshl_b32 s54, s9, 15
    s_add_u32 s54, s54, 32768
    v_add_u32 v125, s54, v118
    s_waitcnt lgkmcnt(0)
    s_add_u32 m0, s54, 0
    v_add_u32 v13, 0, v6
    global_load_lds_dwordx4 v13, s[44:45]
    s_add_u32 m0, s54, 1024
    v_add_u32 v13, 16384, v6
    global_load_lds_dwordx4 v13, s[44:45]
    s_add_u32 m0, s54, 2048
    v_add_u32 v13, 32768, v6
    global_load_lds_dwordx4 v13, s[44:45]
    s_add_u32 m0, s54, 3072
    v_add_u32 v13, 49152, v6
    global_load_lds_dwordx4 v13, s[44:45]
    s_add_u32 m0, s54, 4096
    v_add_u32 v13, 131072, v6
    global_load_lds_dwordx4 v13, s[44:45]
    s_add_u32 m0, s54, 5120
    v_add_u32 v13, 147456, v6
    global_load_lds_dwordx4 v13, s[44:45]
    s_add_u32 m0, s54, 6144
    v_add_u32 v13, 163840, v6
    global_load_lds_dwordx4 v13, s[44:45]
    s_add_u32 m0, s54, 7168
    v_add_u32 v13, 180224, v6
    global_load_lds_dwordx4 v13, s[44:45]
    s_add_u32 m0, s54, 8192
    v_add_u32 v13, 1048576, v6
    global_load_lds_dwordx4 v13, s[44:45]
    s_add_u32 m0, s54, 9216
    v_add_u32 v13, 1064960, v6
    global_load_lds_dwordx4 v13, s[44:45]
    s_add_u32 m0, s54, 10240
    v_add_u32 v13, 1081344, v6
    global_load_lds_dwordx4 v13, s[44:45]
    s_add_u32 m0, s54, 11264
    v_add_u32 v13, 1097728, v6
    global_load_lds_dwordx4 v13, s[44:45]
    s_add_u32 m0, s54, 12288
    v_add_u32 v13, 1179648, v6
    global_load_lds_dwordx4 v13, s[44:45]
    s_add_u32 m0, s54, 13312
    v_add_u32 v13, 1196032, v6
    global_load_lds_dwordx4 v13, s[44:45]
    s_add_u32 m0, s54, 14336
    v_add_u32 v13, 1212416, v6
    global_load_lds_dwordx4 v13, s[44:45]
    s_add_u32 m0, s54, 15360
    v_add_u32 v13, 1228800, v6
    global_load_lds_dwordx4 v13, s[44:45]
    s_lshr_b32 s55, s8, 3
    s_lshr_b32 s56, s8, 1
    s_and_b32 s56, s56, 3
    s_and_b32 s57, s8, 1
    s_lshl_b32 s58, s55, 9
    s_lshl_b32 s59, s57, 11
    s_add_u32 s58, s58, s59
    s_lshr_b32 s59, s56, 1
    s_lshl_b32 s59, s59, 8
    s_add_u32 s58, s58, s59
    s_and_b32 s59, s56, 1
    s_lshl_b32 s59, s59, 6
    s_add_u32 s58, s58, s59
    v_and_b32 v12, 31, v1
    v_lshlrev_b32 v12, 1, v12
    v_add_u32 v120, s58, v12
    s_sub_u32 s58, 16384, s58
    s_and_b32 s59, s8, 3
    s_lshl_b32 s59, s59, 8
    s_add_u32 s58, s58, s59
    s_add_u32 s92, s4, s58
    s_addc_u32 s93, s5, 0
    s_lshl_b32 s58, s8, 1
    s_add_u32 s58, s58, 16384
    s_add_u32 s94, s4, s58
    s_addc_u32 s95, s5, 0
    v_mov_b32 v113, 0
    s_lshl_b32 s58, s56, 11
    s_lshl_b32 s59, s9, 8
    s_add_u32 s58, s58, s59
    s_lshl_b32 s59, s55, 6
    s_add_u32 s58, s58, s59
    s_lshl_b32 s59, s57, 5
    s_add_u32 s58, s58, s59
    v_and_b32 v12, 1, v2
    v_lshlrev_b32 v12, 10, v12
    v_lshl_add_u32 v12, v3, 1, v12
    v_add_u32 v9, s58, v12
    v_lshrrev_b32 v10, 3, v1
    v_and_b32 v11, 1, v4
    v_lshlrev_b32 v12, 6, v11
    v_lshl_add_u32 v12, v10, 8, v12
    v_and_b32 v11, 1, v1
    v_lshl_add_u32 v12, v11, 5, v12
    v_and_b32 v10, 2, v1
    v_lshl_add_u32 v127, v10, 3, v12
    v_lshl_add_u32 v12, v10, 2, v11
    v_lshl_add_u32 v12, v4, 1, v12
    v_lshl_add_u32 v12, v2, 4, v12
    v_lshlrev_b32 v111, 4, v12
    v_and_b32 v12, 31, v1
    v_lshlrev_b32 v110, 6, v12
    s_mul_i32 s58, s9, 66560
    s_lshl_b32 s59, s8, 6
    s_add_u32 s58, s58, s59
    v_mul_u32_u24 v12, 16640, v2
    v_lshl_add_u32 v12, v3, 2, v12
    v_add_u32 v119, s58, v12
    v_lshlrev_b32 v123, 2, v1
    s_lshr_b32 s58, s9, 1
    s_lshl_b32 s58, s58, 12
    s_and_b32 s59, s9, 1
    s_lshl_b32 s59, s59, 7
    s_add_u32 s58, s58, s59
    s_add_u32 s58, s58, 0
    s_add_u32 s10, s4, s58
    s_addc_u32 s11, s5, 0
    s_add_u32 s12, s10, 8192
    s_addc_u32 s13, s11, 0
    s_add_u32 s14, s4, 69632
    s_addc_u32 s15, s5, 0
    s_add_u32 s16, s4, 335872
    s_addc_u32 s17, s5, 0
    s_add_u32 s30, s14, 8320
    s_addc_u32 s31, s15, 0
    s_add_u32 s32, s16, 8320
    s_addc_u32 s33, s17, 0
    s_mul_i32 s58, s8, 8320
    s_lshl_b32 s59, s9, 11
    s_add_u32 s59, s59, s58
    s_add_u32 s59, s59, 65536
    s_add_u32 s18, s4, s59
    s_addc_u32 s19, s5, 0
    s_add_u32 s20, s18, 266240
    s_addc_u32 s21, s19, 0
    s_lshl_b32 s58, s8, 2
    s_add_u32 s58, s58, s9
    s_add_u32 s24, s10, 51380224
    s_addc_u32 s25, s11, 0
    s_lshl_b32 s59, s58, 12
    s_add_u32 s22, s4, 16777216
    s_addc_u32 s23, s5, 0
    s_add_u32 s22, s22, s59
    s_addc_u32 s23, s23, 0
    s_mov_b32 s28, 0x3e0293ee
    s_mov_b32 s29, 0x3e0293ee
    v_mov_b32 v108, -1
    s_waitcnt lgkmcnt(0)
    global_load_ushort v114, v9, s[40:41]
    ds_write_b32 v118, v108 offset:0
    ds_write_b32 v118, v108 offset:1024
    ds_write_b32 v118, v108 offset:2048
    ds_write_b32 v118, v108 offset:3072
    ds_write_b32 v118, v108 offset:4096
    ds_write_b32 v118, v108 offset:5120
    ds_write_b32 v118, v108 offset:6144
    ds_write_b32 v118, v108 offset:7168
    s_add_u32 m0, s54, 16384
    v_add_u32 v13, 2097152, v6
    global_load_lds_dwordx4 v13, s[44:45]
    s_add_u32 m0, s54, 17408
    v_add_u32 v13, 2113536, v6
    global_load_lds_dwordx4 v13, s[44:45]
    s_add_u32 m0, s54, 18432
    v_add_u32 v13, 2129920, v6
    global_load_lds_dwordx4 v13, s[44:45]
    s_add_u32 m0, s54, 19456
    v_add_u32 v13, 2146304, v6
    global_load_lds_dwordx4 v13, s[44:45]
    s_add_u32 m0, s54, 20480
    v_add_u32 v13, 2228224, v6
    global_load_lds_dwordx4 v13, s[44:45]
    s_add_u32 m0, s54, 21504
    v_add_u32 v13, 2244608, v6
    global_load_lds_dwordx4 v13, s[44:45]
    s_add_u32 m0, s54, 22528
    v_add_u32 v13, 2260992, v6
    global_load_lds_dwordx4 v13, s[44:45]
    s_add_u32 m0, s54, 23552
    v_add_u32 v13, 2277376, v6
    global_load_lds_dwordx4 v13, s[44:45]
    s_add_u32 m0, s54, 24576
    v_add_u32 v13, 3145728, v6
    global_load_lds_dwordx4 v13, s[44:45]
    s_add_u32 m0, s54, 25600
    v_add_u32 v13, 3162112, v6
    global_load_lds_dwordx4 v13, s[44:45]
    s_add_u32 m0, s54, 26624
    v_add_u32 v13, 3178496, v6
    global_load_lds_dwordx4 v13, s[44:45]
    s_add_u32 m0, s54, 27648
    v_add_u32 v13, 3194880, v6
    global_load_lds_dwordx4 v13, s[44:45]
    s_add_u32 m0, s54, 28672
    v_add_u32 v13, 3276800, v6
    global_load_lds_dwordx4 v13, s[44:45]
    s_add_u32 m0, s54, 29696
    v_add_u32 v13, 3293184, v6
    global_load_lds_dwordx4 v13, s[44:45]
    s_add_u32 m0, s54, 30720
    v_add_u32 v13, 3309568, v6
    global_load_lds_dwordx4 v13, s[44:45]
    s_add_u32 m0, s54, 31744
    v_add_u32 v13, 3325952, v6
    global_load_lds_dwordx4 v13, s[44:45]
    v_and_b32 v14, 2, v1
    v_cmp_eq_u32 vcc, 0, v14
    v_mov_b32 v15, 0xeeee
    v_mov_b32 v16, 0x4444
    v_cndmask_b32 v117, v15, v16, vcc
    v_mov_b32 v15, 0x3f80
    v_lshlrev_b32 v16, 4, v4
    v_lshlrev_b32 v15, v16, v15
    v_mov_b32 v16, 0x3f803f80
    v_cndmask_b32 v104, v16, v15, vcc
    v_cndmask_b32 v105, v16, v15, vcc
    v_cndmask_b32 v106, v16, v15, vcc
    v_cndmask_b32 v107, v16, v15, vcc
    v_mov_b32 v126, 0xbe0293ee
    v_xor_b32 v15, v2, v4
    v_lshlrev_b32 v15, 3, v15
    v_lshl_add_u32 v121, v3, 5, v15
    v_lshrrev_b32 v15, 1, v2
    v_lshl_add_u32 v15, v15, 4, v3
    v_lshlrev_b32 v15, 4, v15
    v_and_b32 v16, 1, v2
    v_lshl_add_u32 v109, v16, 3, v15
    v_xor_b32 v15, v5, v2
    v_lshlrev_b32 v15, 3, v15
    v_lshl_add_u32 v16, v2, 2, v4
    v_lshl_add_u32 v122, v16, 5, v15
    v_xor_b32 v15, 2, v14
    v_lshl_add_u32 v124, v15, 9, v118
    v_xor_b32 v15, s9, v4
    v_lshlrev_b32 v15, 6, v15
    v_lshl_add_u32 v15, v4, 8, v15
    v_add_u32 v15, 32768, v15
    v_lshrrev_b32 v10, 1, v2
    v_and_b32 v11, 1, v2
    v_lshl_add_u32 v16, v10, 15, v15
    v_lshl_add_u32 v16, v11, 11, v16
    v_lshl_add_u32 v17, v5, 3, v16
    v_lshl_add_u32 v18, v5, 4, v16
    v_add_u32 v8, 0x10000, v17
    v_add_u32 v9, 0x10000, v18
    v_lshl_add_u32 v16, v11, 16, v15
    v_lshl_add_u32 v16, v10, 11, v16
    v_lshl_add_u32 v19, v5, 3, v16
    s_lshl_b32 s59, s8, 7
    s_lshl_b32 s58, s9, 2
    s_add_u32 s59, s59, s58
    s_add_u32 s58, s59, 786432
    s_add_u32 s36, s4, s58
    s_addc_u32 s37, s5, 0
    s_and_b32 s59, s8, 3
    s_cmp_eq_u32 s59, 3
    s_cselect_b64 s[52:53], s[46:47], s[48:49]
    s_cselect_b32 s55, 21, 20
    s_lshr_b32 s58, s9, 1
    s_lshl_b32 s58, s58, s55
    s_and_b32 s55, s9, 1
    s_lshl_b32 s55, s55, 17
    s_add_u32 s58, s58, s55
    s_cmp_eq_u32 s59, 2
    s_cselect_b32 s55, 2097152, 0
    s_add_u32 s58, s58, s55
    s_lshr_b32 s55, s8, 2
    s_lshl_b32 s55, s55, 10
    s_add_u32 s58, s58, s55
    s_add_u32 s58, s58, 384
    v_lshrrev_b32 v11, 3, v1
    v_and_b32 v16, 7, v1
    v_lshlrev_b32 v16, 4, v16
    v_lshl_add_u32 v11, v11, 13, v16
    v_add_u32 v11, s58, v11
    s_cmp_eq_u32 s59, 1
    s_cselect_b32 s55, 0, 65536
    s_cselect_b32 s58, 0, 196608
    s_cselect_b32 s59, 0, -1
    v_and_b32 v11, s59, v11
    s_waitcnt vmcnt(29)
    s_barrier
    ds_read_b64_tr_b16 v[128:129], v17 offset:0
    ds_read_b64_tr_b16 v[130:131], v17 offset:1024
    ds_read_b64_tr_b16 v[132:133], v8 offset:0
    ds_read_b64_tr_b16 v[134:135], v8 offset:1024
    ds_read_b64_tr_b16 v[136:137], v17 offset:32
    ds_read_b64_tr_b16 v[138:139], v17 offset:1056
    ds_read_b64_tr_b16 v[140:141], v8 offset:32
    ds_read_b64_tr_b16 v[142:143], v8 offset:1056
    s_waitcnt lgkmcnt(0)
    s_waitcnt vmcnt(25)
    s_barrier
    ds_read_b64_tr_b16 v[144:145], v17 offset:4096
    ds_read_b64_tr_b16 v[146:147], v17 offset:5120
    ds_read_b64_tr_b16 v[148:149], v8 offset:4096
    ds_read_b64_tr_b16 v[150:151], v8 offset:5120
    ds_read_b64_tr_b16 v[152:153], v17 offset:4128
    ds_read_b64_tr_b16 v[154:155], v17 offset:5152
    ds_read_b64_tr_b16 v[156:157], v8 offset:4128
    ds_read_b64_tr_b16 v[158:159], v8 offset:5152
    s_add_u32 m0, s54, 0
    v_add_u32 v13, 1048576, v6
    global_load_lds_dwordx4 v13, s[46:47]
    s_add_u32 m0, s54, 1024
    v_add_u32 v13, 1064960, v6
    global_load_lds_dwordx4 v13, s[46:47]
    s_add_u32 m0, s54, 2048
    v_add_u32 v13, 1081344, v6
    global_load_lds_dwordx4 v13, s[46:47]
    s_add_u32 m0, s54, 3072
    v_add_u32 v13, 1097728, v6
    global_load_lds_dwordx4 v13, s[46:47]
    s_waitcnt lgkmcnt(0)
    s_waitcnt vmcnt(25)
    s_barrier
    global_load_dwordx4 v[24:27], v11, s[52:53]
    v_add_u32 v11, s55, v11
    global_load_dwordx4 v[24:27], v11, s[52:53]
    v_add_u32 v11, s58, v11
    ds_read_b64_tr_b16 v[160:161], v17 offset:8192
    ds_read_b64_tr_b16 v[162:163], v17 offset:9216
    ds_read_b64_tr_b16 v[164:165], v8 offset:8192
    ds_read_b64_tr_b16 v[166:167], v8 offset:9216
    ds_read_b64_tr_b16 v[168:169], v17 offset:8224
    ds_read_b64_tr_b16 v[170:171], v17 offset:9248
    ds_read_b64_tr_b16 v[172:173], v8 offset:8224
    ds_read_b64_tr_b16 v[174:175], v8 offset:9248
    s_add_u32 m0, s54, 4096
    v_add_u32 v13, 1179648, v6
    global_load_lds_dwordx4 v13, s[46:47]
    s_add_u32 m0, s54, 5120
    v_add_u32 v13, 1196032, v6
    global_load_lds_dwordx4 v13, s[46:47]
    s_add_u32 m0, s54, 6144
    v_add_u32 v13, 1212416, v6
    global_load_lds_dwordx4 v13, s[46:47]
    s_add_u32 m0, s54, 7168
    v_add_u32 v13, 1228800, v6
    global_load_lds_dwordx4 v13, s[46:47]
    s_waitcnt lgkmcnt(0)
    s_waitcnt vmcnt(27)
    s_barrier
    global_load_dwordx4 v[24:27], v11, s[52:53]
    v_add_u32 v11, s55, v11
    global_load_dwordx4 v[24:27], v11, s[52:53]
    v_add_u32 v11, s58, v11
    ds_read_b64_tr_b16 v[176:177], v17 offset:12288
    ds_read_b64_tr_b16 v[178:179], v17 offset:13312
    ds_read_b64_tr_b16 v[180:181], v8 offset:12288
    ds_read_b64_tr_b16 v[182:183], v8 offset:13312
    ds_read_b64_tr_b16 v[184:185], v17 offset:12320
    ds_read_b64_tr_b16 v[186:187], v17 offset:13344
    ds_read_b64_tr_b16 v[188:189], v8 offset:12320
    ds_read_b64_tr_b16 v[190:191], v8 offset:13344
    s_add_u32 m0, s54, 8192
    v_add_u32 v13, 3145728, v6
    global_load_lds_dwordx4 v13, s[46:47]
    s_add_u32 m0, s54, 9216
    v_add_u32 v13, 3162112, v6
    global_load_lds_dwordx4 v13, s[46:47]
    s_add_u32 m0, s54, 10240
    v_add_u32 v13, 3178496, v6
    global_load_lds_dwordx4 v13, s[46:47]
    s_add_u32 m0, s54, 11264
    v_add_u32 v13, 3194880, v6
    global_load_lds_dwordx4 v13, s[46:47]
    s_waitcnt lgkmcnt(0)
    s_waitcnt vmcnt(28)
    s_barrier
    global_load_dwordx4 v[24:27], v11, s[52:53]
    v_add_u32 v11, s55, v11
    global_load_dwordx4 v[24:27], v11, s[52:53]
    v_add_u32 v11, s58, v11
    global_store_short v120, v114, s[10:11] sc1
    ds_read_b64_tr_b16 v[192:193], v17 offset:16384
    ds_read_b64_tr_b16 v[194:195], v17 offset:17408
    ds_read_b64_tr_b16 v[196:197], v8 offset:16384
    ds_read_b64_tr_b16 v[198:199], v8 offset:17408
    ds_read_b64_tr_b16 v[200:201], v17 offset:16416
    ds_read_b64_tr_b16 v[202:203], v17 offset:17440
    ds_read_b64_tr_b16 v[204:205], v8 offset:16416
    ds_read_b64_tr_b16 v[206:207], v8 offset:17440
    s_add_u32 m0, s54, 12288
    v_add_u32 v13, 3276800, v6
    global_load_lds_dwordx4 v13, s[46:47]
    s_add_u32 m0, s54, 13312
    v_add_u32 v13, 3293184, v6
    global_load_lds_dwordx4 v13, s[46:47]
    s_add_u32 m0, s54, 14336
    v_add_u32 v13, 3309568, v6
    global_load_lds_dwordx4 v13, s[46:47]
    s_add_u32 m0, s54, 15360
    v_add_u32 v13, 3325952, v6
    global_load_lds_dwordx4 v13, s[46:47]
    s_waitcnt lgkmcnt(0)
    s_waitcnt vmcnt(31)
    s_barrier
    global_load_dwordx4 v[24:27], v11, s[52:53]
    v_add_u32 v11, s55, v11
    global_load_dwordx4 v[24:27], v11, s[52:53]
    ds_read_b64_tr_b16 v[208:209], v17 offset:20480
    ds_read_b64_tr_b16 v[210:211], v17 offset:21504
    ds_read_b64_tr_b16 v[212:213], v8 offset:20480
    ds_read_b64_tr_b16 v[214:215], v8 offset:21504
    ds_read_b64_tr_b16 v[216:217], v17 offset:20512
    ds_read_b64_tr_b16 v[218:219], v17 offset:21536
    ds_read_b64_tr_b16 v[220:221], v8 offset:20512
    ds_read_b64_tr_b16 v[222:223], v8 offset:21536
    s_add_u32 m0, s54, 16384
    v_add_u32 v13, 0, v6
    global_load_lds_dwordx4 v13, s[48:49]
    s_add_u32 m0, s54, 17408
    v_add_u32 v13, 16384, v6
    global_load_lds_dwordx4 v13, s[48:49]
    s_add_u32 m0, s54, 18432
    v_add_u32 v13, 32768, v6
    global_load_lds_dwordx4 v13, s[48:49]
    s_add_u32 m0, s54, 19456
    v_add_u32 v13, 49152, v6
    global_load_lds_dwordx4 v13, s[48:49]
    s_waitcnt lgkmcnt(0)
    s_waitcnt vmcnt(33)
    s_barrier
    ds_read_b64_tr_b16 v[224:225], v17 offset:24576
    ds_read_b64_tr_b16 v[226:227], v17 offset:25600
    ds_read_b64_tr_b16 v[228:229], v8 offset:24576
    ds_read_b64_tr_b16 v[230:231], v8 offset:25600
    ds_read_b64_tr_b16 v[232:233], v17 offset:24608
    ds_read_b64_tr_b16 v[234:235], v17 offset:25632
    ds_read_b64_tr_b16 v[236:237], v8 offset:24608
    ds_read_b64_tr_b16 v[238:239], v8 offset:25632
    s_add_u32 m0, s54, 20480
    v_add_u32 v13, 131072, v6
    global_load_lds_dwordx4 v13, s[48:49]
    s_add_u32 m0, s54, 21504
    v_add_u32 v13, 147456, v6
    global_load_lds_dwordx4 v13, s[48:49]
    s_add_u32 m0, s54, 22528
    v_add_u32 v13, 163840, v6
    global_load_lds_dwordx4 v13, s[48:49]
    s_add_u32 m0, s54, 23552
    v_add_u32 v13, 180224, v6
    global_load_lds_dwordx4 v13, s[48:49]
    s_waitcnt lgkmcnt(0)
    s_waitcnt vmcnt(33)
    s_barrier
    ds_read_b64_tr_b16 v[240:241], v17 offset:28672
    ds_read_b64_tr_b16 v[242:243], v17 offset:29696
    ds_read_b64_tr_b16 v[244:245], v8 offset:28672
    ds_read_b64_tr_b16 v[246:247], v8 offset:29696
    ds_read_b64_tr_b16 v[248:249], v17 offset:28704
    ds_read_b64_tr_b16 v[250:251], v17 offset:29728
    ds_read_b64_tr_b16 v[252:253], v8 offset:28704
    ds_read_b64_tr_b16 v[254:255], v8 offset:29728
    s_add_u32 m0, s54, 24576
    v_add_u32 v13, 1048576, v6
    global_load_lds_dwordx4 v13, s[48:49]
    s_add_u32 m0, s54, 25600
    v_add_u32 v13, 1064960, v6
    global_load_lds_dwordx4 v13, s[48:49]
    s_add_u32 m0, s54, 26624
    v_add_u32 v13, 1081344, v6
    global_load_lds_dwordx4 v13, s[48:49]
    s_add_u32 m0, s54, 27648
    v_add_u32 v13, 1097728, v6
    global_load_lds_dwordx4 v13, s[48:49]
    s_waitcnt lgkmcnt(0)
    s_waitcnt vmcnt(33)
    s_barrier
    ds_read_b64_tr_b16 a[0:1], v17 offset:0
    ds_read_b64_tr_b16 a[2:3], v17 offset:1024
    ds_read_b64_tr_b16 a[4:5], v8 offset:0
    ds_read_b64_tr_b16 a[6:7], v8 offset:1024
    ds_read_b64_tr_b16 a[8:9], v17 offset:32
    ds_read_b64_tr_b16 a[10:11], v17 offset:1056
    ds_read_b64_tr_b16 a[12:13], v8 offset:32
    ds_read_b64_tr_b16 a[14:15], v8 offset:1056
    s_add_u32 m0, s54, 28672
    v_add_u32 v13, 1179648, v6
    global_load_lds_dwordx4 v13, s[48:49]
    s_add_u32 m0, s54, 29696
    v_add_u32 v13, 1196032, v6
    global_load_lds_dwordx4 v13, s[48:49]
    s_add_u32 m0, s54, 30720
    v_add_u32 v13, 1212416, v6
    global_load_lds_dwordx4 v13, s[48:49]
    s_add_u32 m0, s54, 31744
    v_add_u32 v13, 1228800, v6
    global_load_lds_dwordx4 v13, s[48:49]
    s_waitcnt lgkmcnt(0)
    s_waitcnt vmcnt(31)
    s_barrier
    ds_read_b64_tr_b16 a[16:17], v17 offset:4096
    ds_read_b64_tr_b16 a[18:19], v17 offset:5120
    ds_read_b64_tr_b16 a[20:21], v8 offset:4096
    ds_read_b64_tr_b16 a[22:23], v8 offset:5120
    ds_read_b64_tr_b16 a[24:25], v17 offset:4128
    ds_read_b64_tr_b16 a[26:27], v17 offset:5152
    ds_read_b64_tr_b16 a[28:29], v8 offset:4128
    ds_read_b64_tr_b16 a[30:31], v8 offset:5152
    s_add_u32 m0, s54, 0
    v_add_u32 v13, 2097152, v6
    global_load_lds_dwordx4 v13, s[48:49]
    s_add_u32 m0, s54, 1024
    v_add_u32 v13, 2113536, v6
    global_load_lds_dwordx4 v13, s[48:49]
    s_add_u32 m0, s54, 2048
    v_add_u32 v13, 2129920, v6
    global_load_lds_dwordx4 v13, s[48:49]
    s_add_u32 m0, s54, 3072
    v_add_u32 v13, 2146304, v6
    global_load_lds_dwordx4 v13, s[48:49]
    s_waitcnt lgkmcnt(0)
    s_waitcnt vmcnt(29)
    s_barrier
    ds_read_b64_tr_b16 a[32:33], v17 offset:8192
    ds_read_b64_tr_b16 a[34:35], v17 offset:9216
    ds_read_b64_tr_b16 a[36:37], v8 offset:8192
    ds_read_b64_tr_b16 a[38:39], v8 offset:9216
    ds_read_b64_tr_b16 a[40:41], v17 offset:8224
    ds_read_b64_tr_b16 a[42:43], v17 offset:9248
    ds_read_b64_tr_b16 a[44:45], v8 offset:8224
    ds_read_b64_tr_b16 a[46:47], v8 offset:9248
    s_add_u32 m0, s54, 4096
    v_add_u32 v13, 2228224, v6
    global_load_lds_dwordx4 v13, s[48:49]
    s_add_u32 m0, s54, 5120
    v_add_u32 v13, 2244608, v6
    global_load_lds_dwordx4 v13, s[48:49]
    s_add_u32 m0, s54, 6144
    v_add_u32 v13, 2260992, v6
    global_load_lds_dwordx4 v13, s[48:49]
    s_add_u32 m0, s54, 7168
    v_add_u32 v13, 2277376, v6
    global_load_lds_dwordx4 v13, s[48:49]
    s_waitcnt lgkmcnt(0)
    s_waitcnt vmcnt(26)
    s_barrier
    s_lshl_b32 s59, s35, 3
    s_lshl_b64 s[56:57], 1, s59
    v_mov_b32 v20, s56
    v_mov_b32 v21, s57
    v_mov_b32 v22, 0
    s_mov_b64 exec, 1
    global_atomic_add_x2 v22, v[20:21], s[6:7] sc1
    s_mov_b64 exec, -1
    ds_read_b64_tr_b16 a[48:49], v17 offset:12288
    ds_read_b64_tr_b16 a[50:51], v17 offset:13312
    ds_read_b64_tr_b16 a[52:53], v8 offset:12288
    ds_read_b64_tr_b16 a[54:55], v8 offset:13312
    ds_read_b64_tr_b16 a[56:57], v17 offset:12320
    ds_read_b64_tr_b16 a[58:59], v17 offset:13344
    ds_read_b64_tr_b16 a[60:61], v8 offset:12320
    ds_read_b64_tr_b16 a[62:63], v8 offset:13344
    s_add_u32 m0, s54, 8192
    v_add_u32 v13, 3145728, v6
    global_load_lds_dwordx4 v13, s[48:49]
    s_add_u32 m0, s54, 9216
    v_add_u32 v13, 3162112, v6
    global_load_lds_dwordx4 v13, s[48:49]
    s_add_u32 m0, s54, 10240
    v_add_u32 v13, 3178496, v6
    global_load_lds_dwordx4 v13, s[48:49]
    s_add_u32 m0, s54, 11264
    v_add_u32 v13, 3194880, v6
    global_load_lds_dwordx4 v13, s[48:49]
    s_waitcnt lgkmcnt(0)
    s_waitcnt vmcnt(25)
    s_barrier
    ds_read_b64_tr_b16 a[64:65], v18 offset:16384
    ds_read_b64_tr_b16 a[66:67], v18 offset:17408
    ds_read_b64_tr_b16 a[68:69], v9 offset:16384
    ds_read_b64_tr_b16 a[70:71], v9 offset:17408
    ds_read_b64_tr_b16 a[72:73], v18 offset:16392
    ds_read_b64_tr_b16 a[74:75], v18 offset:17416
    ds_read_b64_tr_b16 a[76:77], v9 offset:16392
    ds_read_b64_tr_b16 a[78:79], v9 offset:17416
    s_add_u32 m0, s54, 12288
    v_add_u32 v13, 0, v7
    global_load_lds_dwordx4 v13, s[50:51]
    s_add_u32 m0, s54, 13312
    v_add_u32 v13, 2048, v7
    global_load_lds_dwordx4 v13, s[50:51]
    s_add_u32 m0, s54, 14336
    v_add_u32 v13, 8192, v7
    global_load_lds_dwordx4 v13, s[50:51]
    s_add_u32 m0, s54, 15360
    v_add_u32 v13, 10240, v7
    global_load_lds_dwordx4 v13, s[50:51]
    s_waitcnt lgkmcnt(0)
    s_waitcnt vmcnt(25)
    s_barrier
    ds_read_b64_tr_b16 a[80:81], v18 offset:20480
    ds_read_b64_tr_b16 a[82:83], v18 offset:21504
    ds_read_b64_tr_b16 a[84:85], v9 offset:20480
    ds_read_b64_tr_b16 a[86:87], v9 offset:21504
    ds_read_b64_tr_b16 a[88:89], v18 offset:20488
    ds_read_b64_tr_b16 a[90:91], v18 offset:21512
    ds_read_b64_tr_b16 a[92:93], v9 offset:20488
    ds_read_b64_tr_b16 a[94:95], v9 offset:21512
    s_add_u32 m0, s54, 16384
    v_add_u32 v13, 65536, v7
    global_load_lds_dwordx4 v13, s[50:51]
    s_add_u32 m0, s54, 17408
    v_add_u32 v13, 67584, v7
    global_load_lds_dwordx4 v13, s[50:51]
    s_add_u32 m0, s54, 18432
    v_add_u32 v13, 73728, v7
    global_load_lds_dwordx4 v13, s[50:51]
    s_add_u32 m0, s54, 19456
    v_add_u32 v13, 75776, v7
    global_load_lds_dwordx4 v13, s[50:51]
    s_waitcnt lgkmcnt(0)
    s_waitcnt vmcnt(25)
    s_barrier
    ds_read_b64_tr_b16 a[96:97], v18 offset:24576
    ds_read_b64_tr_b16 a[98:99], v18 offset:25600
    ds_read_b64_tr_b16 a[100:101], v9 offset:24576
    ds_read_b64_tr_b16 a[102:103], v9 offset:25600
    ds_read_b64_tr_b16 a[104:105], v18 offset:24584
    ds_read_b64_tr_b16 a[106:107], v18 offset:25608
    ds_read_b64_tr_b16 a[108:109], v9 offset:24584
    ds_read_b64_tr_b16 a[110:111], v9 offset:25608
    s_add_u32 m0, s54, 20480
    v_add_u32 v13, 256, v7
    global_load_lds_dwordx4 v13, s[50:51]
    s_add_u32 m0, s54, 21504
    v_add_u32 v13, 2304, v7
    global_load_lds_dwordx4 v13, s[50:51]
    s_add_u32 m0, s54, 22528
    v_add_u32 v13, 8448, v7
    global_load_lds_dwordx4 v13, s[50:51]
    s_add_u32 m0, s54, 23552
    v_add_u32 v13, 10496, v7
    global_load_lds_dwordx4 v13, s[50:51]
    s_waitcnt lgkmcnt(0)
    s_waitcnt vmcnt(25)
    s_barrier
    ds_read_b64_tr_b16 a[112:113], v18 offset:28672
    ds_read_b64_tr_b16 a[114:115], v18 offset:29696
    ds_read_b64_tr_b16 a[116:117], v9 offset:28672
    ds_read_b64_tr_b16 a[118:119], v9 offset:29696
    ds_read_b64_tr_b16 a[120:121], v18 offset:28680
    ds_read_b64_tr_b16 a[122:123], v18 offset:29704
    ds_read_b64_tr_b16 a[124:125], v9 offset:28680
    ds_read_b64_tr_b16 a[126:127], v9 offset:29704
    s_add_u32 m0, s54, 24576
    v_add_u32 v13, 65792, v7
    global_load_lds_dwordx4 v13, s[50:51]
    s_add_u32 m0, s54, 25600
    v_add_u32 v13, 67840, v7
    global_load_lds_dwordx4 v13, s[50:51]
    s_add_u32 m0, s54, 26624
    v_add_u32 v13, 73984, v7
    global_load_lds_dwordx4 v13, s[50:51]
    s_add_u32 m0, s54, 27648
    v_add_u32 v13, 76032, v7
    global_load_lds_dwordx4 v13, s[50:51]
    s_waitcnt lgkmcnt(0)
    s_waitcnt vmcnt(25)
    s_barrier
    ds_read_b64_tr_b16 a[128:129], v18 offset:0
    ds_read_b64_tr_b16 a[130:131], v18 offset:1024
    ds_read_b64_tr_b16 a[132:133], v9 offset:0
    ds_read_b64_tr_b16 a[134:135], v9 offset:1024
    ds_read_b64_tr_b16 a[136:137], v18 offset:8
    ds_read_b64_tr_b16 a[138:139], v18 offset:1032
    ds_read_b64_tr_b16 a[140:141], v9 offset:8
    ds_read_b64_tr_b16 a[142:143], v9 offset:1032
    s_add_u32 m0, s54, 28672
    v_add_u32 v13, 512, v7
    global_load_lds_dwordx4 v13, s[50:51]
    s_add_u32 m0, s54, 29696
    v_add_u32 v13, 2560, v7
    global_load_lds_dwordx4 v13, s[50:51]
    s_add_u32 m0, s54, 30720
    v_add_u32 v13, 8704, v7
    global_load_lds_dwordx4 v13, s[50:51]
    s_add_u32 m0, s54, 31744
    v_add_u32 v13, 10752, v7
    global_load_lds_dwordx4 v13, s[50:51]
    s_waitcnt lgkmcnt(0)
    s_waitcnt vmcnt(25)
    s_barrier
    ds_read_b64_tr_b16 a[144:145], v18 offset:4096
    ds_read_b64_tr_b16 a[146:147], v18 offset:5120
    ds_read_b64_tr_b16 a[148:149], v9 offset:4096
    ds_read_b64_tr_b16 a[150:151], v9 offset:5120
    ds_read_b64_tr_b16 a[152:153], v18 offset:4104
    ds_read_b64_tr_b16 a[154:155], v18 offset:5128
    ds_read_b64_tr_b16 a[156:157], v9 offset:4104
    ds_read_b64_tr_b16 a[158:159], v9 offset:5128
    s_add_u32 m0, s54, 0
    v_add_u32 v13, 0, v6
    global_load_lds_dwordx4 v13, s[46:47]
    s_add_u32 m0, s54, 1024
    v_add_u32 v13, 16384, v6
    global_load_lds_dwordx4 v13, s[46:47]
    s_add_u32 m0, s54, 2048
    v_add_u32 v13, 32768, v6
    global_load_lds_dwordx4 v13, s[46:47]
    s_add_u32 m0, s54, 3072
    v_add_u32 v13, 49152, v6
    global_load_lds_dwordx4 v13, s[46:47]
    s_waitcnt lgkmcnt(0)
    s_waitcnt vmcnt(24)
    s_barrier
    ds_read_b64_tr_b16 a[160:161], v18 offset:8192
    ds_read_b64_tr_b16 a[162:163], v18 offset:9216
    ds_read_b64_tr_b16 a[164:165], v9 offset:8192
    ds_read_b64_tr_b16 a[166:167], v9 offset:9216
    ds_read_b64_tr_b16 a[168:169], v18 offset:8200
    ds_read_b64_tr_b16 a[170:171], v18 offset:9224
    ds_read_b64_tr_b16 a[172:173], v9 offset:8200
    ds_read_b64_tr_b16 a[174:175], v9 offset:9224
    s_add_u32 m0, s54, 4096
    v_add_u32 v13, 66048, v7
    global_load_lds_dwordx4 v13, s[50:51]
    s_add_u32 m0, s54, 5120
    v_add_u32 v13, 68096, v7
    global_load_lds_dwordx4 v13, s[50:51]
    s_add_u32 m0, s54, 6144
    v_add_u32 v13, 74240, v7
    global_load_lds_dwordx4 v13, s[50:51]
    s_add_u32 m0, s54, 7168
    v_add_u32 v13, 76288, v7
    global_load_lds_dwordx4 v13, s[50:51]
    s_waitcnt lgkmcnt(0)
    s_waitcnt vmcnt(24)
    s_barrier
    ds_read_b64_tr_b16 a[176:177], v19 offset:12288
    ds_read_b64_tr_b16 a[178:179], v19 offset:13312
    ds_read_b64_tr_b16 a[180:181], v19 offset:45056
    ds_read_b64_tr_b16 a[182:183], v19 offset:46080
    ds_read_b64_tr_b16 a[184:185], v19 offset:12320
    ds_read_b64_tr_b16 a[186:187], v19 offset:13344
    ds_read_b64_tr_b16 a[188:189], v19 offset:45088
    ds_read_b64_tr_b16 a[190:191], v19 offset:46112
    s_add_u32 m0, s54, 8192
    v_add_u32 v13, 131072, v6
    global_load_lds_dwordx4 v13, s[46:47]
    s_add_u32 m0, s54, 9216
    v_add_u32 v13, 147456, v6
    global_load_lds_dwordx4 v13, s[46:47]
    s_add_u32 m0, s54, 10240
    v_add_u32 v13, 163840, v6
    global_load_lds_dwordx4 v13, s[46:47]
    s_add_u32 m0, s54, 11264
    v_add_u32 v13, 180224, v6
    global_load_lds_dwordx4 v13, s[46:47]
    s_waitcnt lgkmcnt(0)
    s_waitcnt vmcnt(24)
    s_barrier
    global_load_dword v10, v113, s[6:7] offset:128 sc1
    global_load_dwordx2 v[14:15], v113, s[6:7] offset:0 sc1
    ds_read_b64_tr_b16 a[192:193], v19 offset:16384
    ds_read_b64_tr_b16 a[194:195], v19 offset:17408
    ds_read_b64_tr_b16 a[196:197], v19 offset:49152
    ds_read_b64_tr_b16 a[198:199], v19 offset:50176
    ds_read_b64_tr_b16 a[200:201], v19 offset:16416
    ds_read_b64_tr_b16 a[202:203], v19 offset:17440
    ds_read_b64_tr_b16 a[204:205], v19 offset:49184
    ds_read_b64_tr_b16 a[206:207], v19 offset:50208
    s_add_u32 m0, s54, 12288
    v_add_u32 v13, 2097152, v6
    global_load_lds_dwordx4 v13, s[46:47]
    s_add_u32 m0, s54, 13312
    v_add_u32 v13, 2113536, v6
    global_load_lds_dwordx4 v13, s[46:47]
    s_add_u32 m0, s54, 14336
    v_add_u32 v13, 2129920, v6
    global_load_lds_dwordx4 v13, s[46:47]
    s_add_u32 m0, s54, 15360
    v_add_u32 v13, 2146304, v6
    global_load_lds_dwordx4 v13, s[46:47]
    s_waitcnt lgkmcnt(0)
    s_waitcnt vmcnt(26)
    s_barrier
    ds_read_b64_tr_b16 a[208:209], v19 offset:20480
    ds_read_b64_tr_b16 a[210:211], v19 offset:21504
    ds_read_b64_tr_b16 a[212:213], v19 offset:53248
    ds_read_b64_tr_b16 a[214:215], v19 offset:54272
    ds_read_b64_tr_b16 a[216:217], v19 offset:20512
    ds_read_b64_tr_b16 a[218:219], v19 offset:21536
    ds_read_b64_tr_b16 a[220:221], v19 offset:53280
    ds_read_b64_tr_b16 a[222:223], v19 offset:54304
    s_add_u32 m0, s54, 16384
    v_add_u32 v13, 768, v7
    global_load_lds_dwordx4 v13, s[50:51]
    s_add_u32 m0, s54, 17408
    v_add_u32 v13, 2816, v7
    global_load_lds_dwordx4 v13, s[50:51]
    s_add_u32 m0, s54, 18432
    v_add_u32 v13, 8960, v7
    global_load_lds_dwordx4 v13, s[50:51]
    s_add_u32 m0, s54, 19456
    v_add_u32 v13, 11008, v7
    global_load_lds_dwordx4 v13, s[50:51]
    s_waitcnt lgkmcnt(0)
    s_waitcnt vmcnt(26)
    s_barrier
    ds_read_b64_tr_b16 a[224:225], v19 offset:24576
    ds_read_b64_tr_b16 a[226:227], v19 offset:25600
    ds_read_b64_tr_b16 a[228:229], v19 offset:57344
    ds_read_b64_tr_b16 a[230:231], v19 offset:58368
    ds_read_b64_tr_b16 a[232:233], v19 offset:24608
    ds_read_b64_tr_b16 a[234:235], v19 offset:25632
    ds_read_b64_tr_b16 a[236:237], v19 offset:57376
    ds_read_b64_tr_b16 a[238:239], v19 offset:58400
    s_add_u32 m0, s54, 20480
    v_add_u32 v13, 2228224, v6
    global_load_lds_dwordx4 v13, s[46:47]
    s_add_u32 m0, s54, 21504
    v_add_u32 v13, 2244608, v6
    global_load_lds_dwordx4 v13, s[46:47]
    s_add_u32 m0, s54, 22528
    v_add_u32 v13, 2260992, v6
    global_load_lds_dwordx4 v13, s[46:47]
    s_add_u32 m0, s54, 23552
    v_add_u32 v13, 2277376, v6
    global_load_lds_dwordx4 v13, s[46:47]
    s_waitcnt lgkmcnt(0)
    s_waitcnt vmcnt(26)
    s_barrier
    ds_read_b64_tr_b16 a[240:241], v19 offset:28672
    ds_read_b64_tr_b16 a[242:243], v19 offset:29696
    ds_read_b64_tr_b16 a[244:245], v19 offset:61440
    ds_read_b64_tr_b16 a[246:247], v19 offset:62464
    ds_read_b64_tr_b16 a[248:249], v19 offset:28704
    ds_read_b64_tr_b16 a[250:251], v19 offset:29728
    ds_read_b64_tr_b16 a[252:253], v19 offset:61472
    ds_read_b64_tr_b16 a[254:255], v19 offset:62496
    s_add_u32 m0, s54, 24576
    v_add_u32 v13, 3276800, v6
    global_load_lds_dwordx4 v13, s[48:49]
    s_add_u32 m0, s54, 25600
    v_add_u32 v13, 3293184, v6
    global_load_lds_dwordx4 v13, s[48:49]
    s_add_u32 m0, s54, 26624
    v_add_u32 v13, 3309568, v6
    global_load_lds_dwordx4 v13, s[48:49]
    s_add_u32 m0, s54, 27648
    v_add_u32 v13, 3325952, v6
    global_load_lds_dwordx4 v13, s[48:49]
    s_waitcnt lgkmcnt(0)
    s_waitcnt vmcnt(26)
    s_barrier
    s_or_b32 s59, s8, s9
    s_cbranch_scc1 Lgo_32
    v_mov_b32 v20, 1
    v_mov_b32 v22, 160
    s_mov_b64 exec, 1
    global_store_dword v22, v20, s[6:7] sc1
    s_mov_b64 exec, -1
Lgo_32:
    ds_read_b64_tr_b16 v[24:25], v17 offset:0
    ds_read_b64_tr_b16 v[26:27], v17 offset:1024
    ds_read_b64_tr_b16 v[28:29], v8 offset:0
    ds_read_b64_tr_b16 v[30:31], v8 offset:1024
    ds_read_b64_tr_b16 v[32:33], v17 offset:32
    ds_read_b64_tr_b16 v[34:35], v17 offset:1056
    ds_read_b64_tr_b16 v[36:37], v8 offset:32
    ds_read_b64_tr_b16 v[38:39], v8 offset:1056
    s_add_u32 m0, s54, 28672
    v_add_u32 v13, 66304, v7
    global_load_lds_dwordx4 v13, s[50:51]
    s_add_u32 m0, s54, 29696
    v_add_u32 v13, 68352, v7
    global_load_lds_dwordx4 v13, s[50:51]
    s_add_u32 m0, s54, 30720
    v_add_u32 v13, 74496, v7
    global_load_lds_dwordx4 v13, s[50:51]
    s_add_u32 m0, s54, 31744
    v_add_u32 v13, 76544, v7
    global_load_lds_dwordx4 v13, s[50:51]
    s_waitcnt lgkmcnt(0)
    s_waitcnt vmcnt(26)
    s_barrier
    ds_read_b64_tr_b16 v[40:41], v19 offset:4096
    ds_read_b64_tr_b16 v[42:43], v19 offset:5120
    ds_read_b64_tr_b16 v[44:45], v19 offset:36864
    ds_read_b64_tr_b16 v[46:47], v19 offset:37888
    ds_read_b64_tr_b16 v[48:49], v19 offset:4128
    ds_read_b64_tr_b16 v[50:51], v19 offset:5152
    ds_read_b64_tr_b16 v[52:53], v19 offset:36896
    ds_read_b64_tr_b16 v[54:55], v19 offset:37920
    ds_write_b128 v125, v[24:27] offset:0
    ds_write_b128 v125, v[28:31] offset:1024
    ds_write_b128 v125, v[32:35] offset:2048
    ds_write_b128 v125, v[36:39] offset:3072
    s_waitcnt lgkmcnt(0)
    s_waitcnt vmcnt(22)
    s_barrier
    ds_read_b64_tr_b16 v[24:25], v17 offset:8192
    ds_read_b64_tr_b16 v[26:27], v17 offset:9216
    ds_read_b64_tr_b16 v[28:29], v8 offset:8192
    ds_read_b64_tr_b16 v[30:31], v8 offset:9216
    ds_read_b64_tr_b16 v[32:33], v17 offset:8224
    ds_read_b64_tr_b16 v[34:35], v17 offset:9248
    ds_read_b64_tr_b16 v[36:37], v8 offset:8224
    ds_read_b64_tr_b16 v[38:39], v8 offset:9248
    ds_write_b128 v125, v[40:43] offset:4096
    ds_write_b128 v125, v[44:47] offset:5120
    ds_write_b128 v125, v[48:51] offset:6144
    ds_write_b128 v125, v[52:55] offset:7168
    s_waitcnt lgkmcnt(0)
    s_waitcnt vmcnt(16)
    s_barrier
    ds_read_b64_tr_b16 v[40:41], v17 offset:12288
    ds_read_b64_tr_b16 v[42:43], v17 offset:13312
    ds_read_b64_tr_b16 v[44:45], v8 offset:12288
    ds_read_b64_tr_b16 v[46:47], v8 offset:13312
    ds_read_b64_tr_b16 v[48:49], v17 offset:12320
    ds_read_b64_tr_b16 v[50:51], v17 offset:13344
    ds_read_b64_tr_b16 v[52:53], v8 offset:12320
    ds_read_b64_tr_b16 v[54:55], v8 offset:13344
    ds_write_b128 v125, v[24:27] offset:8192
    ds_write_b128 v125, v[28:31] offset:9216
    ds_write_b128 v125, v[32:35] offset:10240
    ds_write_b128 v125, v[36:39] offset:11264
    s_waitcnt lgkmcnt(0)
    s_waitcnt vmcnt(12)
    s_barrier
    global_load_dword v12, v113, s[36:37] sc1
    ds_read_b64_tr_b16 v[24:25], v19 offset:16384
    ds_read_b64_tr_b16 v[26:27], v19 offset:17408
    ds_read_b64_tr_b16 v[28:29], v19 offset:49152
    ds_read_b64_tr_b16 v[30:31], v19 offset:50176
    ds_read_b64_tr_b16 v[32:33], v19 offset:16416
    ds_read_b64_tr_b16 v[34:35], v19 offset:17440
    ds_read_b64_tr_b16 v[36:37], v19 offset:49184
    ds_read_b64_tr_b16 v[38:39], v19 offset:50208
    ds_write_b128 v125, v[40:43] offset:12288
    ds_write_b128 v125, v[44:47] offset:13312
    ds_write_b128 v125, v[48:51] offset:14336
    ds_write_b128 v125, v[52:55] offset:15360
    s_waitcnt lgkmcnt(0)
    s_waitcnt vmcnt(9)
    s_barrier
    ds_read_b64_tr_b16 v[40:41], v17 offset:20480
    ds_read_b64_tr_b16 v[42:43], v17 offset:21504
    ds_read_b64_tr_b16 v[44:45], v8 offset:20480
    ds_read_b64_tr_b16 v[46:47], v8 offset:21504
    ds_read_b64_tr_b16 v[48:49], v17 offset:20512
    ds_read_b64_tr_b16 v[50:51], v17 offset:21536
    ds_read_b64_tr_b16 v[52:53], v8 offset:20512
    ds_read_b64_tr_b16 v[54:55], v8 offset:21536
    ds_write_b128 v125, v[24:27] offset:16384
    ds_write_b128 v125, v[28:31] offset:17408
    ds_write_b128 v125, v[32:35] offset:18432
    ds_write_b128 v125, v[36:39] offset:19456
    s_waitcnt lgkmcnt(0)
    s_waitcnt vmcnt(5)
    s_barrier
    ds_read_b64_tr_b16 v[24:25], v18 offset:24576
    ds_read_b64_tr_b16 v[26:27], v18 offset:25600
    ds_read_b64_tr_b16 v[28:29], v9 offset:24576
    ds_read_b64_tr_b16 v[30:31], v9 offset:25600
    ds_read_b64_tr_b16 v[32:33], v18 offset:24584
    ds_read_b64_tr_b16 v[34:35], v18 offset:25608
    ds_read_b64_tr_b16 v[36:37], v9 offset:24584
    ds_read_b64_tr_b16 v[38:39], v9 offset:25608
    ds_write_b128 v125, v[40:43] offset:20480
    ds_write_b128 v125, v[44:47] offset:21504
    ds_write_b128 v125, v[48:51] offset:22528
    ds_write_b128 v125, v[52:55] offset:23552
    s_waitcnt lgkmcnt(0)
    s_waitcnt vmcnt(0)
    v_sad_u8 v23, v14, 0, 0
    v_sad_u8 v23, v15, 0, v23
    v_lshrrev_b32 v10, 6, v10
    v_lshrrev_b32 v23, 7, v23
    v_min3_u32 v10, v10, v23, v12
    v_cmp_eq_u32 vcc, 0, v10
    s_cbranch_vccnz Lnk_33
    s_lshl_b32 s59, s9, 12
    s_add_u32 m0, s59, 16384
    v_subrev_u32 v20, s9, v5
    v_lshl_add_u32 v20, v20, 2, 16
    global_load_dword v116, v20, s[36:37] sc1
    global_load_lds_dwordx4 v118, s[22:23] offset:0 sc1
    global_load_lds_dwordx4 v118, s[22:23] offset:1024 sc1
    global_load_lds_dwordx4 v118, s[22:23] offset:2048 sc1
    global_load_lds_dwordx4 v118, s[22:23] offset:3072 sc1
Lnk_33:
    s_barrier
    ds_read_b64_tr_b16 v[40:41], v19 offset:28672
    ds_read_b64_tr_b16 v[42:43], v19 offset:29696
    ds_read_b64_tr_b16 v[44:45], v19 offset:61440
    ds_read_b64_tr_b16 v[46:47], v19 offset:62464
    ds_read_b64_tr_b16 v[48:49], v19 offset:28704
    ds_read_b64_tr_b16 v[50:51], v19 offset:29728
    ds_read_b64_tr_b16 v[52:53], v19 offset:61472
    ds_read_b64_tr_b16 v[54:55], v19 offset:62496
    ds_write_b128 v125, v[24:27] offset:24576
    ds_write_b128 v125, v[28:31] offset:25600
    ds_write_b128 v125, v[32:35] offset:26624
    ds_write_b128 v125, v[36:39] offset:27648
    s_waitcnt lgkmcnt(0)
    s_barrier
    ds_write_b128 v125, v[40:43] offset:28672
    ds_write_b128 v125, v[44:47] offset:29696
    ds_write_b128 v125, v[48:51] offset:30720
    ds_write_b128 v125, v[52:55] offset:31744
    v_cmp_eq_u32 vcc, 0, v10
    v_mov_b32 v20, v14
    v_mov_b32 v21, v15
    s_cbranch_vccz Lqk_34
    v_mov_b32 v21, 128
Lln_35:
    global_load_dword v20, v21, s[6:7] sc1
    s_sub_u32 s27, s27, 1
    s_cbranch_scc1 L_fin
    s_waitcnt vmcnt(0)
    v_cmp_gt_u32 vcc, 64, v20
    s_cbranch_vccnz Lln_35
Lkv_36:
    global_load_dword v116, v113, s[36:37] sc1
    s_sub_u32 s27, s27, 1
    s_cbranch_scc1 L_fin
    s_waitcnt vmcnt(0)
    v_cmp_eq_u32 vcc, 0, v116
    s_cbranch_vccnz Lkv_36
    s_lshl_b32 s59, s9, 12
    s_add_u32 m0, s59, 16384
    v_subrev_u32 v20, s9, v5
    v_lshl_add_u32 v20, v20, 2, 16
    global_load_dword v116, v20, s[36:37] sc1
    global_load_lds_dwordx4 v118, s[22:23] offset:0 sc1
    global_load_lds_dwordx4 v118, s[22:23] offset:1024 sc1
    global_load_lds_dwordx4 v118, s[22:23] offset:2048 sc1
    global_load_lds_dwordx4 v118, s[22:23] offset:3072 sc1
    v_mov_b32 v22, 0
Lhb_37:
    global_load_dwordx2 v[20:21], v22, s[6:7] sc1
    s_sub_u32 s27, s27, 1
    s_cbranch_scc1 L_fin
    s_waitcnt vmcnt(0)
    v_sad_u8 v23, v20, 0, 0
    v_sad_u8 v23, v21, 0, v23
    v_cmp_gt_u32 vcc, 128, v23
    s_cbranch_vccnz Lhb_37
Lqk_34:
    v_readfirstlane_b32 s40, v20
    v_readfirstlane_b32 s41, v21
    s_mov_b32 s26, 0
    s_or_b32 s40, s40, s41
    s_and_b32 s40, s40, 0x80808080
    s_waitcnt vmcnt(0)
    s_add_u32 s22, s22, 524288
    s_addc_u32 s23, s23, 0
    s_cmp_eq_u32 s40, 0
    s_cbranch_scc1 L_slow
    s_mov_b32 s64, 0xcccccccc
    s_mov_b32 s65, 0xcccccccc
    s_mov_b32 s74, 0x10001
    s_mov_b32 s75, 0x10001
    s_cmp_eq_u32 s9, 1
    s_cbranch_scc1 Lwv_39
    s_cmp_eq_u32 s9, 2
    s_cbranch_scc1 Lwv_40
    s_cmp_eq_u32 s9, 3
    s_cbranch_scc1 Lwv_41
Lwv_38:
    s_mov_b32 m0, 0
    ds_read_b128 v[32:35], v125 offset:0
    ds_read_b128 v[36:39], v125 offset:1024
    ds_read_b128 v[40:43], v125 offset:8192
    ds_read_b128 v[44:47], v125 offset:9216
    ds_read_b128 v[48:51], v125 offset:2048
    ds_read_b128 v[52:55], v125 offset:3072
    ds_read_b128 v[96:99], v125 offset:10240
    ds_read_b128 v[100:103], v125 offset:11264
    v_mov_b32 v115, s26
    v_and_b32 v116, 768, v118
Lhl0_42:
    s_mov_b64 exec, s[74:75]
    global_store_short v116, v115, s[94:95]
    s_mov_b64 exec, -1
    v_xor_b32 v112, 8, v109
    ds_read_b64 v[90:91], v109 offset:19456
    ds_read_b64 v[88:89], v112 offset:18432
    ds_read_b64 v[94:95], v109 offset:19968
    ds_read_b64 v[92:93], v112 offset:18944
    ds_read_b128 v[56:59], v111 offset:16384
    ds_read_b128 v[60:63], v111 offset:17408
    s_waitcnt vmcnt(0)
    global_load_ushort v17, v120, s[92:93] sc1
    global_load_lds_dwordx4 v127, s[10:11] sc1
    global_load_lds_dwordx4 v127, s[10:11] offset:2048 sc1
    v_mov_b64 v[64:65], 0
    v_mov_b64 v[66:67], 0
    v_mov_b64 v[68:69], 0
    v_mov_b64 v[70:71], 0
    v_mov_b64 v[72:73], 0
    v_mov_b64 v[74:75], 0
    v_mov_b64 v[76:77], 0
    v_mov_b64 v[78:79], 0
    v_mov_b64 v[80:81], 0
    v_mov_b64 v[82:83], 0
    v_mov_b64 v[84:85], 0
    v_mov_b64 v[86:87], 0
    s_waitcnt lgkmcnt(2)
    v_swap_b32 v89, v90
    v_swap_b32 v93, v94
    global_load_ushort v18, v120, s[92:93] sc1
    global_load_lds_dwordx4 v127, s[10:11] sc1
    global_load_lds_dwordx4 v127, s[10:11] offset:2048 sc1
    s_waitcnt vmcnt(5)
    v_cmp_ne_u32 vcc, s26, v17
    s_waitcnt vmcnt(3)
    s_cbranch_vccnz Lvf_44
Lvb_45:
    s_barrier
    ds_read_b128 v[0:3], v118 offset:0
    ds_read_b128 v[4:7], v118 offset:2048
    s_waitcnt lgkmcnt(1)
    v_smfmac_f32_16x16x64_bf16 v[64:67], v[0:3], v[128:135], v117
    ds_read_b128 v[24:27], v118 offset:0
    ds_read_b128 v[8:11], v118 offset:1024
    s_waitcnt lgkmcnt(2)
    v_smfmac_f32_16x16x64_bf16 v[64:67], v[4:7], v[144:151], v117
    ds_read_b128 v[28:31], v118 offset:2048
    ds_read_b128 v[12:15], v118 offset:3072
    v_cmp_u_f32 vcc, v0, v4
    v_smfmac_f32_16x16x64_bf16 v[68:71], v[0:3], v[136:143], v117
    v_smfmac_f32_16x16x64_bf16 v[68:71], v[4:7], v[152:159], v117
    s_cbranch_vccnz Lfa_46
    global_store_short v120, v108, s[12:13]
    s_mov_b32 m0, 16384
    v_smfmac_f32_16x16x64_bf16 v[72:75], v[0:3], v[32:39], v117
    s_waitcnt vmcnt(3)
    global_load_lds_dwordx4 v118, s[22:23] offset:0 sc1
    v_smfmac_f32_16x16x64_bf16 v[72:75], v[4:7], v[40:47], v117
    ds_read_b128 v[16:19], v118 offset:4096
    s_waitcnt lgkmcnt(1)
    v_cmp_u_f32 vcc, v8, v12
    v_smfmac_f32_16x16x64_bf16 v[76:79], v[0:3], v[48:55], v117
    global_store_short v120, v114, s[24:25] sc1
    ds_read_b128 v[20:23], v118 offset:6144
    v_smfmac_f32_16x16x64_bf16 v[76:79], v[4:7], v[96:103], v117
    s_cbranch_vccnz Lfs_51
Lbk_52:
Lqj_50:
    v_smfmac_f32_16x16x64_bf16 v[64:67], v[8:11], v[160:167], v117
    ds_read_b128 v[96:99], v125 offset:12288
    ds_read_b128 v[44:47], v125 offset:15360
    v_smfmac_f32_16x16x64_bf16 v[64:67], v[12:15], v[176:183], v117
    global_load_lds_dwordx4 v118, s[22:23] offset:1024 sc1
    ds_read_b128 v[100:103], v125 offset:13312
    v_smfmac_f32_16x16x64_bf16 v[68:71], v[8:11], v[168:175], v117
    ds_read_b128 v[24:27], v118 offset:5120
    s_waitcnt lgkmcnt(4)
    v_cmp_u_f32 vcc, v16, v20
    v_smfmac_f32_16x16x64_bf16 v[68:71], v[12:15], v[184:191], v117
    ds_read_b128 v[28:31], v118 offset:7168
    ds_read_b128 v[40:43], v125 offset:14336
    v_smfmac_f32_16x16x64_bf16 v[72:75], v[8:11], a[0:7], v117
    s_cbranch_vccnz Lfs_61
Lbk_62:
    ds_read_b128 v[32:35], v125 offset:20480
    v_smfmac_f32_16x16x64_bf16 v[64:67], v[16:19], v[192:199], v117
    s_add_u32 s24, s24, 8192
    s_addc_u32 s25, s25, 0
    ds_read_b128 v[36:39], v125 offset:21504
    v_smfmac_f32_16x16x64_bf16 v[64:67], v[20:23], v[208:215], v117
    global_load_lds_dwordx4 v118, s[22:23] offset:2048 sc1
    ds_read_b128 v[48:51], v125 offset:22528
    v_smfmac_f32_16x16x64_bf16 v[68:71], v[16:19], v[200:207], v117
    s_add_u32 s26, s26, 1
    s_waitcnt lgkmcnt(4)
    v_cmp_u_f32 vcc, v24, v28
    v_smfmac_f32_16x16x64_bf16 v[68:71], v[20:23], v[216:223], v117
    ds_read_b128 v[52:55], v125 offset:23552
    v_smfmac_f32_16x16x64_bf16 v[72:75], v[16:19], v[96:103], v117
    s_cbranch_vccnz Lfs_64
Lbk_65:
    v_smfmac_f32_16x16x64_bf16 v[64:67], v[24:27], v[224:231], v117
    s_mov_b64 vcc, s[64:65]
    v_smfmac_f32_16x16x64_bf16 v[64:67], v[28:31], v[240:247], v117
    global_load_lds_dwordx4 v118, s[22:23] offset:3072 sc1
    v_smfmac_f32_16x16x64_bf16 v[68:71], v[24:27], v[232:239], v117
    s_add_u32 s22, s22, 524288
    s_addc_u32 s23, s23, 0
    v_smfmac_f32_16x16x64_bf16 v[68:71], v[28:31], v[248:255], v117
    s_waitcnt lgkmcnt(2)
    v_add_f32 v64, v64, v66
    v_smfmac_f32_16x16x64_bf16 v[72:75], v[20:23], v[32:39], v117
    ds_read_b128 v[32:35], v125 offset:24576
    v_add_f32 v65, v65, v67
    v_smfmac_f32_16x16x64_bf16 v[72:75], v[12:15], a[16:23], v117
    ds_read_b128 v[36:39], v125 offset:25600
    v_cvt_pk_bf16_f32 v102, v64, v65
    v_add_f32 v68, v68, v70
    v_smfmac_f32_16x16x64_bf16 v[72:75], v[24:27], a[32:39], v117
    ds_write_b32 v121, v102 offset:8192
    v_add_f32 v69, v69, v71
    v_cvt_pk_bf16_f32 v103, v68, v69
    v_smfmac_f32_16x16x64_bf16 v[72:75], v[28:31], a[48:55], v117
    ds_write_b32 v121, v103 offset:8704
    v_smfmac_f32_16x16x64_bf16 v[76:79], v[16:19], v[40:47], v117
    ds_read_b128 v[40:43], v125 offset:26624
    s_waitcnt lgkmcnt(5)
    v_smfmac_f32_16x16x64_bf16 v[76:79], v[20:23], v[48:55], v117
    ds_read_b128 v[44:47], v125 offset:27648
    v_add_f32 v72, v72, v74
    v_smfmac_f32_16x16x64_bf16 v[76:79], v[8:11], a[8:15], v117
    ds_read_b128 v[48:51], v125 offset:4096
    v_smfmac_f32_16x16x64_bf16 v[76:79], v[12:15], a[24:31], v117
    s_waitcnt lgkmcnt(3)
    s_barrier
    v_smfmac_f32_16x16x64_bf16 v[76:79], v[24:27], a[40:47], v117
    ds_read_b64_tr_b16 v[64:65], v122 offset:8192
    ds_read_b64_tr_b16 v[66:67], v122 offset:8704
    v_smfmac_f32_16x16x64_bf16 v[76:79], v[28:31], a[56:63], v117
    ds_read_b64_tr_b16 v[68:69], v122 offset:9216
    ds_read_b64_tr_b16 v[70:71], v122 offset:9728
    v_add_f32 v73, v73, v75
    v_cvt_pk_bf16_f32 v100, v72, v73
    v_smfmac_f32_16x16x64_bf16 v[80:83], v[0:3], a[64:71], v117
    ds_write_b32 v121, v100 offset:10240
    v_smfmac_f32_16x16x64_bf16 v[84:87], v[0:3], a[72:79], v117
    s_waitcnt lgkmcnt(3)
    ds_read_b128 v[52:55], v125 offset:5120
    v_add_f32 v76, v76, v78
    v_mfma_f32_16x16x32_bf16 v[96:99], v[56:59], v[64:67], 0
    s_waitcnt lgkmcnt(2)
    v_add_f32 v77, v77, v79
    v_cvt_pk_bf16_f32 v101, v76, v77
    v_mfma_f32_16x16x32_bf16 v[96:99], v[60:63], v[68:71], v[96:99]
    ds_write_b32 v121, v101 offset:10752
    v_smfmac_f32_16x16x64_bf16 v[80:83], v[4:7], a[80:87], v117
    s_mov_b32 exec_hi, 0
    global_store_dword v110, v108, s[20:21]
    s_mov_b32 exec_hi, -1
    v_smfmac_f32_16x16x64_bf16 v[84:87], v[4:7], a[88:95], v117
    v_add_f32_dpp v98, v96, v98 quad_perm:[0,1,0,1] row_mask:0xf bank_mask:0xf
    v_add_f32_dpp v99, v97, v99 quad_perm:[0,1,0,1] row_mask:0xf bank_mask:0xf
    v_smfmac_f32_16x16x64_bf16 v[80:83], v[8:11], a[96:103], v117
    ds_write_b64 v109, v[98:99] offset:12288
    v_smfmac_f32_16x16x64_bf16 v[84:87], v[8:11], a[104:111], v117
    s_waitcnt lgkmcnt(1)
    s_barrier
    v_smfmac_f32_16x16x64_bf16 v[80:83], v[12:15], a[112:119], v117
    ds_read_b64_tr_b16 v[72:73], v122 offset:10240
    ds_read_b64_tr_b16 v[74:75], v122 offset:10752
    v_smfmac_f32_16x16x64_bf16 v[84:87], v[12:15], a[120:127], v117
    ds_read_b64_tr_b16 v[76:77], v122 offset:11264
    ds_read_b64_tr_b16 v[78:79], v122 offset:11776
    v_smfmac_f32_16x16x64_bf16 v[80:83], v[16:19], a[128:135], v117
    ds_read_b128 v[8:11], v125 offset:18432
    v_smfmac_f32_16x16x64_bf16 v[84:87], v[16:19], a[136:143], v117
    s_waitcnt lgkmcnt(5)
    s_barrier
    s_waitcnt lgkmcnt(3)
    v_mfma_f32_16x16x32_bf16 v[0:3], v[72:75], v[64:67], 0
    ds_read_b128 v[56:59], v124 offset:12288
    s_waitcnt lgkmcnt(2)
    v_mfma_f32_16x16x32_bf16 v[0:3], v[76:79], v[68:71], v[0:3]
    ds_read_b128 v[12:15], v125 offset:19456
    v_smfmac_f32_16x16x64_bf16 v[80:83], v[20:23], a[144:151], v117
    v_smfmac_f32_16x16x64_bf16 v[84:87], v[20:23], a[152:159], v117
    v_add_f32_dpp v2, v0, v2 quad_perm:[0,1,0,1] row_mask:0xf bank_mask:0xf
    v_smfmac_f32_16x16x64_bf16 v[80:83], v[24:27], a[160:167], v117
    s_waitcnt lgkmcnt(1)
    v_max3_f32 v60, v56, v57, v58
    v_add_f32_dpp v3, v1, v3 quad_perm:[0,1,0,1] row_mask:0xf bank_mask:0xf
    v_smfmac_f32_16x16x64_bf16 v[84:87], v[24:27], a[168:175], v117
    v_max_f32 v60, v60, v59
    v_smfmac_f32_16x16x64_bf16 v[80:83], v[28:31], v[32:39], v117
    s_nop 0
    v_max_f32_dpp v60, v60, v60 quad_perm:[2,3,0,1] row_mask:0xf bank_mask:0xf
    v_smfmac_f32_16x16x64_bf16 v[84:87], v[28:31], v[40:47], v117
    v_max3_f32 v61, v60, v2, v3
    v_max3_f32 v62, v60, v2, v3
    v_mov_b64 v[64:65], 0
    v_mov_b64 v[66:67], 0
    v_permlane16_swap_b32 v61, v62
    v_max_f32 v60, v61, v62
    v_max_f32 v63, v61, v62
    v_pk_add_f32 v[80:81], v[80:81], v[82:83]
    v_pk_add_f32 v[84:85], v[84:85], v[86:87]
    v_permlane32_swap_b32 v60, v63
    v_max_f32 v61, v60, v63
    v_cvt_pk_bf16_f32 v114, v80, v81
    v_cvt_pk_bf16_f32 v115, v84, v85
    v_mul_f32_dpp v62, v61, v126 quad_perm:[2,3,2,3] row_mask:0xf bank_mask:0xf
    v_pk_fma_f32 v[2:3], v[2:3], s[28:29], v[62:63] op_sel_hi:[1,1,0]
    v_pk_fma_f32 v[56:57], v[56:57], s[28:29], v[62:63] op_sel_hi:[1,1,0]
    v_exp_f32 v2, v2
    v_exp_f32 v3, v3
    v_pk_fma_f32 v[58:59], v[58:59], s[28:29], v[62:63] op_sel_hi:[1,1,0]
    v_cvt_pk_bf16_f32 v80, v2, v3
    v_exp_f32 v56, v56
    v_cndmask_b32 v5, v113, v80, vcc
    v_cndmask_b32_dpp v4, v80, v113, vcc quad_perm:[2,3,2,3] row_mask:0xf bank_mask:0xf
    v_exp_f32 v57, v57
    v_exp_f32 v58, v58
    v_mfma_f32_16x16x16_bf16 v[76:79], v[4:5], v[104:105], 0
    v_cvt_pk_bf16_f32 v84, v56, v57
    v_exp_f32 v59, v59
    v_mfma_f32_16x16x16_bf16 v[72:75], v[4:5], v[114:115], 0
    v_cvt_pk_bf16_f32 v85, v58, v59
    v_mov_b32_dpp v86, v84 quad_perm:[2,3,0,1] row_mask:0xf bank_mask:0xf
    v_mov_b64 v[68:69], 0
    v_mov_b32_dpp v87, v85 quad_perm:[2,3,0,1] row_mask:0xf bank_mask:0xf
    v_mov_b64 v[70:71], 0
    v_mov_b64 v[80:81], 0
    v_mfma_f32_16x16x32_bf16 v[76:79], v[84:87], v[104:107], v[76:79]
    ds_read_b128 v[32:35], v125 offset:6144
    v_smfmac_f32_16x16x64_bf16 v[72:75], v[84:87], v[88:95], v117
    ds_read_b128 v[36:39], v125 offset:7168
    s_nop 2
    v_rcp_f32_dpp v60, v76 quad_perm:[2,3,2,3] row_mask:0xf bank_mask:0xf
    v_rcp_f32_dpp v61, v77 quad_perm:[2,3,2,3] row_mask:0xf bank_mask:0xf
    s_nop 1
    v_pk_mul_f32 v[72:73], v[72:73], v[60:61]
    v_pk_mul_f32 v[74:75], v[74:75], v[60:61]
    v_cvt_pk_bf16_f32 v56, v72, v73
    v_cvt_pk_bf16_f32 v57, v74, v75
    ds_write_b64 v121, v[56:57] offset:14336
    v_mov_b64 v[82:83], 0
    v_mov_b64 v[84:85], 0
    v_mov_b64 v[86:87], 0
    v_mov_b64 v[72:73], 0
    v_mov_b64 v[74:75], 0
    v_mov_b64 v[76:77], 0
    v_mov_b64 v[78:79], 0
    v_mov_b64 v[88:89], 0
    v_mov_b64 v[90:91], 0
    v_mov_b64 v[92:93], 0
    v_mov_b64 v[94:95], 0
    s_waitcnt vmcnt(6)
    s_waitcnt lgkmcnt(0)
    s_barrier
    ds_read_b64_tr_b16 v[96:97], v122 offset:14336
    ds_read_b64_tr_b16 v[98:99], v122 offset:14848
    ds_read_b64_tr_b16 v[100:101], v122 offset:15360
    ds_read_b64_tr_b16 v[102:103], v122 offset:15872
    ds_read_b128 v[40:43], v125 offset:16384
    ds_read_b128 v[44:47], v125 offset:17408
    s_waitcnt lgkmcnt(4)
    v_smfmac_f32_16x16x64_bf16 v[72:75], v[96:99], a[176:183], v117
    ds_read_b128 v[24:27], v125 offset:28672
    s_waitcnt lgkmcnt(3)
    v_smfmac_f32_16x16x64_bf16 v[72:75], v[100:103], a[192:199], v117
    ds_read_b128 v[28:31], v125 offset:29696
    v_smfmac_f32_16x16x64_bf16 v[76:79], v[96:99], a[184:191], v117
    global_load_ushort v16, v120, s[92:93] offset:1024 sc1
    ds_read_b128 v[56:59], v125 offset:30720
    v_smfmac_f32_16x16x64_bf16 v[76:79], v[100:103], a[200:207], v117
    global_load_ushort v16, v120, s[92:93] offset:1024 sc1
    ds_read_b128 v[60:63], v125 offset:31744
    v_add_f32 v72, v72, v74
    v_add_f32 v73, v73, v75
    v_cvt_pk_bf16_f32 v72, v72, v73
    v_smfmac_f32_16x16x64_bf16 v[80:83], v[96:99], a[208:215], v117
    global_store_dword v119, v72, s[14:15] offset:-4096
    global_load_ushort v16, v120, s[92:93] offset:1024 sc1
    v_add_f32 v76, v76, v78
    v_add_f32 v77, v77, v79
    v_cvt_pk_bf16_f32 v76, v76, v77
    v_smfmac_f32_16x16x64_bf16 v[80:83], v[100:103], a[224:231], v117
    global_store_dword v119, v76, s[30:31] offset:-4096
    v_smfmac_f32_16x16x64_bf16 v[84:87], v[96:99], a[216:223], v117
    global_load_ushort v16, v120, s[92:93] offset:1024 sc1
    v_smfmac_f32_16x16x64_bf16 v[84:87], v[100:103], a[232:239], v117
    global_load_ushort v16, v120, s[92:93] offset:1024 sc1
    v_add_f32 v80, v80, v82
    v_smfmac_f32_16x16x64_bf16 v[64:67], v[96:99], a[240:247], v117
    global_load_ushort v16, v120, s[92:93] offset:1024 sc1
    v_add_f32 v81, v81, v83
    v_cvt_pk_bf16_f32 v80, v80, v81
    v_smfmac_f32_16x16x64_bf16 v[64:67], v[100:103], v[48:55], v117
    global_store_dword v119, v80, s[14:15] offset:-2048
    v_add_f32 v84, v84, v86
    v_smfmac_f32_16x16x64_bf16 v[68:71], v[96:99], a[248:255], v117
    global_load_ushort v16, v120, s[92:93] offset:1024 sc1
    v_add_f32 v85, v85, v87
    v_cvt_pk_bf16_f32 v84, v84, v85
    v_smfmac_f32_16x16x64_bf16 v[68:71], v[100:103], v[32:39], v117
    s_waitcnt lgkmcnt(4)
    global_store_dword v119, v84, s[30:31] offset:-2048
    v_add_f32 v64, v64, v66
    v_smfmac_f32_16x16x64_bf16 v[88:91], v[96:99], v[40:47], v117
    s_waitcnt lgkmcnt(2)
    global_load_ushort v16, v120, s[92:93] offset:1024 sc1
    v_add_f32 v65, v65, v67
    v_cvt_pk_bf16_f32 v64, v64, v65
    v_smfmac_f32_16x16x64_bf16 v[88:91], v[100:103], v[24:31], v117
    global_store_dword v119, v64, s[14:15] offset:0
    v_add_f32 v68, v68, v70
    v_smfmac_f32_16x16x64_bf16 v[92:95], v[96:99], v[8:15], v117
    s_waitcnt lgkmcnt(0)
    global_load_ushort v16, v120, s[92:93] offset:1024 sc1
    v_add_f32 v69, v69, v71
    v_cvt_pk_bf16_f32 v68, v68, v69
    v_smfmac_f32_16x16x64_bf16 v[92:95], v[100:103], v[56:63], v117
    global_store_dword v119, v68, s[30:31] offset:0
    v_add_f32 v88, v88, v90
    v_add_f32 v89, v89, v91
    v_cvt_pk_bf16_f32 v88, v88, v89
    global_store_dword v119, v88, s[14:15] offset:2048
    s_mov_b32 m0, 0
    ds_read_b128 v[32:35], v125 offset:0
    ds_read_b128 v[36:39], v125 offset:1024
    global_load_ushort v16, v120, s[92:93] offset:1024 sc1
    v_add_f32 v92, v92, v94
    v_add_f32 v93, v93, v95
    v_cvt_pk_bf16_f32 v92, v92, v93
    global_store_dword v119, v92, s[30:31] offset:2048
Lgf_67:
    v_cmp_ne_u32 vcc, s26, v16
    global_load_ushort v16, v120, s[92:93] offset:1024 sc1
    s_cbranch_vccz Lgb_68
    v_cmp_ne_u32 vcc, s26, v16
    global_load_ushort v16, v120, s[92:93] offset:1024 sc1
    s_cbranch_vccz Lgb_68
    v_cmp_ne_u32 vcc, s26, v16
    global_load_ushort v16, v120, s[92:93] offset:1024 sc1
    s_cbranch_vccz Lgb_68
    v_cmp_ne_u32 vcc, s26, v16
    global_load_ushort v16, v120, s[92:93] offset:1024 sc1
    s_sub_u32 s27, s27, 1
    s_cbranch_vccz Lgb_68
    s_cbranch_scc0 Lgf_67
    s_branch L_fin
Lgb_68:
    s_barrier
    global_load_dword v0, v123, s[18:19] offset:0 sc1
    global_load_dword v1, v123, s[18:19] offset:256 sc1
    global_load_dword v2, v123, s[18:19] offset:512 sc1
    global_load_dword v3, v123, s[18:19] offset:768 sc1
    global_load_dword v4, v123, s[18:19] offset:1024 sc1
    global_load_dword v5, v123, s[18:19] offset:1280 sc1
    global_load_dword v6, v123, s[18:19] offset:1536 sc1
    global_load_dword v7, v123, s[18:19] offset:1792 sc1
    ds_read_b128 v[40:43], v125 offset:8192
    ds_read_b128 v[44:47], v125 offset:9216
    ds_read_b128 v[48:51], v125 offset:2048
    ds_read_b128 v[52:55], v125 offset:3072
    ds_read_b128 v[96:99], v125 offset:10240
    ds_read_b128 v[100:103], v125 offset:11264
    v_mov_b32 v115, s26
    s_waitcnt vmcnt(4)
    v_mfma_f32_16x16x32_bf16 v[24:27], v[104:107], v[0:3], 0
    v_max3_u32 v28, v0, v1, v2
    s_waitcnt vmcnt(0)
    v_mfma_f32_16x16x32_bf16 v[24:27], v[104:107], v[4:7], v[24:27]
    v_max3_u32 v29, v4, v5, v6
    v_max3_u32 v28, v28, v3, v7
    v_cmp_u_f32 vcc, v28, v29
    s_nop 4
    v_cvt_pk_bf16_f32 v114, v24, v24
    s_cbranch_vccnz Lpf_69
Lpj_70:
    global_store_short v120, v114, s[12:13]
    s_cmp_eq_u32 s26, 63
    s_cbranch_scc1 Llast_43
    s_mov_b64 exec, s[74:75]
    global_store_short v116, v115, s[94:95]
    s_mov_b64 exec, -1
    v_xor_b32 v112, 8, v109
    ds_read_b64 v[90:91], v109 offset:19456
    ds_read_b64 v[88:89], v112 offset:18432
    ds_read_b64 v[94:95], v109 offset:19968
    ds_read_b64 v[92:93], v112 offset:18944
    ds_read_b128 v[56:59], v111 offset:16384
    ds_read_b128 v[60:63], v111 offset:17408
    s_waitcnt vmcnt(0)
    global_load_ushort v17, v120, s[92:93] sc1
    global_load_lds_dwordx4 v127, s[12:13] sc1
    global_load_lds_dwordx4 v127, s[12:13] offset:2048 sc1
    v_mov_b64 v[64:65], 0
    v_mov_b64 v[66:67], 0
    v_mov_b64 v[68:69], 0
    v_mov_b64 v[70:71], 0
    v_mov_b64 v[72:73], 0
    v_mov_b64 v[74:75], 0
    v_mov_b64 v[76:77], 0
    v_mov_b64 v[78:79], 0
    v_mov_b64 v[80:81], 0
    v_mov_b64 v[82:83], 0
    v_mov_b64 v[84:85], 0
    v_mov_b64 v[86:87], 0
    s_waitcnt lgkmcnt(2)
    v_swap_b32 v89, v90
    v_swap_b32 v93, v94
    global_load_ushort v18, v120, s[92:93] sc1
    global_load_lds_dwordx4 v127, s[12:13] sc1
    global_load_lds_dwordx4 v127, s[12:13] offset:2048 sc1
    s_waitcnt vmcnt(5)
    v_cmp_ne_u32 vcc, s26, v17
    s_waitcnt vmcnt(3)
    s_cbranch_vccnz Lvf_72
Lvb_73:
    s_barrier
    ds_read_b128 v[0:3], v118 offset:0
    ds_read_b128 v[4:7], v118 offset:2048
    s_waitcnt lgkmcnt(1)
    v_smfmac_f32_16x16x64_bf16 v[64:67], v[0:3], v[128:135], v117
    ds_read_b128 v[24:27], v118 offset:0
    ds_read_b128 v[8:11], v118 offset:1024
    s_waitcnt lgkmcnt(2)
    v_smfmac_f32_16x16x64_bf16 v[64:67], v[4:7], v[144:151], v117
    ds_read_b128 v[28:31], v118 offset:2048
    ds_read_b128 v[12:15], v118 offset:3072
    v_cmp_u_f32 vcc, v0, v4
    v_smfmac_f32_16x16x64_bf16 v[68:71], v[0:3], v[136:143], v117
    v_smfmac_f32_16x16x64_bf16 v[68:71], v[4:7], v[152:159], v117
    s_cbranch_vccnz Lfa_74
    global_store_short v120, v108, s[10:11]
    s_mov_b32 m0, 16384
    v_smfmac_f32_16x16x64_bf16 v[72:75], v[0:3], v[32:39], v117
    s_waitcnt vmcnt(3)
    global_load_lds_dwordx4 v118, s[22:23] offset:0 sc1
    v_smfmac_f32_16x16x64_bf16 v[72:75], v[4:7], v[40:47], v117
    ds_read_b128 v[16:19], v118 offset:4096
    s_waitcnt lgkmcnt(1)
    v_cmp_u_f32 vcc, v8, v12
    v_smfmac_f32_16x16x64_bf16 v[76:79], v[0:3], v[48:55], v117
    global_store_short v120, v114, s[24:25] sc1
    ds_read_b128 v[20:23], v118 offset:6144
    v_smfmac_f32_16x16x64_bf16 v[76:79], v[4:7], v[96:103], v117
    s_cbranch_vccnz Lfs_79
Lbk_80:
Lqj_78:
    v_smfmac_f32_16x16x64_bf16 v[64:67], v[8:11], v[160:167], v117
    ds_read_b128 v[96:99], v125 offset:12288
    ds_read_b128 v[44:47], v125 offset:15360
    v_smfmac_f32_16x16x64_bf16 v[64:67], v[12:15], v[176:183], v117
    global_load_lds_dwordx4 v118, s[22:23] offset:1024 sc1
    ds_read_b128 v[100:103], v125 offset:13312
    v_smfmac_f32_16x16x64_bf16 v[68:71], v[8:11], v[168:175], v117
    ds_read_b128 v[24:27], v118 offset:5120
    s_waitcnt lgkmcnt(4)
    v_cmp_u_f32 vcc, v16, v20
    v_smfmac_f32_16x16x64_bf16 v[68:71], v[12:15], v[184:191], v117
    ds_read_b128 v[28:31], v118 offset:7168
    ds_read_b128 v[40:43], v125 offset:14336
    v_smfmac_f32_16x16x64_bf16 v[72:75], v[8:11], a[0:7], v117
    s_cbranch_vccnz Lfs_89
Lbk_90:
    ds_read_b128 v[32:35], v125 offset:20480
    v_smfmac_f32_16x16x64_bf16 v[64:67], v[16:19], v[192:199], v117
    s_add_u32 s24, s24, 8192
    s_addc_u32 s25, s25, 0
    ds_read_b128 v[36:39], v125 offset:21504
    v_smfmac_f32_16x16x64_bf16 v[64:67], v[20:23], v[208:215], v117
    global_load_lds_dwordx4 v118, s[22:23] offset:2048 sc1
    ds_read_b128 v[48:51], v125 offset:22528
    v_smfmac_f32_16x16x64_bf16 v[68:71], v[16:19], v[200:207], v117
    s_add_u32 s26, s26, 1
    s_waitcnt lgkmcnt(4)
    v_cmp_u_f32 vcc, v24, v28
    v_smfmac_f32_16x16x64_bf16 v[68:71], v[20:23], v[216:223], v117
    ds_read_b128 v[52:55], v125 offset:23552
    v_smfmac_f32_16x16x64_bf16 v[72:75], v[16:19], v[96:103], v117
    s_cbranch_vccnz Lfs_92
Lbk_93:
    v_smfmac_f32_16x16x64_bf16 v[64:67], v[24:27], v[224:231], v117
    s_mov_b64 vcc, s[64:65]
    v_smfmac_f32_16x16x64_bf16 v[64:67], v[28:31], v[240:247], v117
    global_load_lds_dwordx4 v118, s[22:23] offset:3072 sc1
    v_smfmac_f32_16x16x64_bf16 v[68:71], v[24:27], v[232:239], v117
    s_add_u32 s22, s22, 524288
    s_addc_u32 s23, s23, 0
    v_smfmac_f32_16x16x64_bf16 v[68:71], v[28:31], v[248:255], v117
    s_waitcnt lgkmcnt(2)
    v_add_f32 v64, v64, v66
    v_smfmac_f32_16x16x64_bf16 v[72:75], v[20:23], v[32:39], v117
    ds_read_b128 v[32:35], v125 offset:24576
    v_add_f32 v65, v65, v67
    v_smfmac_f32_16x16x64_bf16 v[72:75], v[12:15], a[16:23], v117
    ds_read_b128 v[36:39], v125 offset:25600
    v_cvt_pk_bf16_f32 v102, v64, v65
    v_add_f32 v68, v68, v70
    v_smfmac_f32_16x16x64_bf16 v[72:75], v[24:27], a[32:39], v117
    ds_write_b32 v121, v102 offset:8192
    v_add_f32 v69, v69, v71
    v_cvt_pk_bf16_f32 v103, v68, v69
    v_smfmac_f32_16x16x64_bf16 v[72:75], v[28:31], a[48:55], v117
    ds_write_b32 v121, v103 offset:8704
    v_smfmac_f32_16x16x64_bf16 v[76:79], v[16:19], v[40:47], v117
    ds_read_b128 v[40:43], v125 offset:26624
    s_waitcnt lgkmcnt(5)
    v_smfmac_f32_16x16x64_bf16 v[76:79], v[20:23], v[48:55], v117
    ds_read_b128 v[44:47], v125 offset:27648
    v_add_f32 v72, v72, v74
    v_smfmac_f32_16x16x64_bf16 v[76:79], v[8:11], a[8:15], v117
    ds_read_b128 v[48:51], v125 offset:4096
    v_smfmac_f32_16x16x64_bf16 v[76:79], v[12:15], a[24:31], v117
    s_waitcnt lgkmcnt(3)
    s_barrier
    v_smfmac_f32_16x16x64_bf16 v[76:79], v[24:27], a[40:47], v117
    ds_read_b64_tr_b16 v[64:65], v122 offset:8192
    ds_read_b64_tr_b16 v[66:67], v122 offset:8704
    v_smfmac_f32_16x16x64_bf16 v[76:79], v[28:31], a[56:63], v117
    ds_read_b64_tr_b16 v[68:69], v122 offset:9216
    ds_read_b64_tr_b16 v[70:71], v122 offset:9728
    v_add_f32 v73, v73, v75
    v_cvt_pk_bf16_f32 v100, v72, v73
    v_smfmac_f32_16x16x64_bf16 v[80:83], v[0:3], a[64:71], v117
    ds_write_b32 v121, v100 offset:10240
    v_smfmac_f32_16x16x64_bf16 v[84:87], v[0:3], a[72:79], v117
    s_waitcnt lgkmcnt(3)
    ds_read_b128 v[52:55], v125 offset:5120
    v_add_f32 v76, v76, v78
    v_mfma_f32_16x16x32_bf16 v[96:99], v[56:59], v[64:67], 0
    s_waitcnt lgkmcnt(2)
    v_add_f32 v77, v77, v79
    v_cvt_pk_bf16_f32 v101, v76, v77
    v_mfma_f32_16x16x32_bf16 v[96:99], v[60:63], v[68:71], v[96:99]
    ds_write_b32 v121, v101 offset:10752
    v_smfmac_f32_16x16x64_bf16 v[80:83], v[4:7], a[80:87], v117
    s_mov_b32 exec_hi, 0
    global_store_dword v110, v108, s[18:19]
    s_mov_b32 exec_hi, -1
    v_smfmac_f32_16x16x64_bf16 v[84:87], v[4:7], a[88:95], v117
    v_add_f32_dpp v98, v96, v98 quad_perm:[0,1,0,1] row_mask:0xf bank_mask:0xf
    v_add_f32_dpp v99, v97, v99 quad_perm:[0,1,0,1] row_mask:0xf bank_mask:0xf
    v_smfmac_f32_16x16x64_bf16 v[80:83], v[8:11], a[96:103], v117
    ds_write_b64 v109, v[98:99] offset:12288
    v_smfmac_f32_16x16x64_bf16 v[84:87], v[8:11], a[104:111], v117
    s_waitcnt lgkmcnt(1)
    s_barrier
    v_smfmac_f32_16x16x64_bf16 v[80:83], v[12:15], a[112:119], v117
    ds_read_b64_tr_b16 v[72:73], v122 offset:10240
    ds_read_b64_tr_b16 v[74:75], v122 offset:10752
    v_smfmac_f32_16x16x64_bf16 v[84:87], v[12:15], a[120:127], v117
    ds_read_b64_tr_b16 v[76:77], v122 offset:11264
    ds_read_b64_tr_b16 v[78:79], v122 offset:11776
    v_smfmac_f32_16x16x64_bf16 v[80:83], v[16:19], a[128:135], v117
    ds_read_b128 v[8:11], v125 offset:18432
    v_smfmac_f32_16x16x64_bf16 v[84:87], v[16:19], a[136:143], v117
    s_waitcnt lgkmcnt(5)
    s_barrier
    s_waitcnt lgkmcnt(3)
    v_mfma_f32_16x16x32_bf16 v[0:3], v[72:75], v[64:67], 0
    ds_read_b128 v[56:59], v124 offset:12288
    s_waitcnt lgkmcnt(2)
    v_mfma_f32_16x16x32_bf16 v[0:3], v[76:79], v[68:71], v[0:3]
    ds_read_b128 v[12:15], v125 offset:19456
    v_smfmac_f32_16x16x64_bf16 v[80:83], v[20:23], a[144:151], v117
    v_smfmac_f32_16x16x64_bf16 v[84:87], v[20:23], a[152:159], v117
    v_add_f32_dpp v2, v0, v2 quad_perm:[0,1,0,1] row_mask:0xf bank_mask:0xf
    v_smfmac_f32_16x16x64_bf16 v[80:83], v[24:27], a[160:167], v117
    s_waitcnt lgkmcnt(1)
    v_max3_f32 v60, v56, v57, v58
    v_add_f32_dpp v3, v1, v3 quad_perm:[0,1,0,1] row_mask:0xf bank_mask:0xf
    v_smfmac_f32_16x16x64_bf16 v[84:87], v[24:27], a[168:175], v117
    v_max_f32 v60, v60, v59
    v_smfmac_f32_16x16x64_bf16 v[80:83], v[28:31], v[32:39], v117
    s_nop 0
    v_max_f32_dpp v60, v60, v60 quad_perm:[2,3,0,1] row_mask:0xf bank_mask:0xf
    v_smfmac_f32_16x16x64_bf16 v[84:87], v[28:31], v[40:47], v117
    v_max3_f32 v61, v60, v2, v3
    v_max3_f32 v62, v60, v2, v3
    v_mov_b64 v[64:65], 0
    v_mov_b64 v[66:67], 0
    v_permlane16_swap_b32 v61, v62
    v_max_f32 v60, v61, v62
    v_max_f32 v63, v61, v62
    v_pk_add_f32 v[80:81], v[80:81], v[82:83]
    v_pk_add_f32 v[84:85], v[84:85], v[86:87]
    v_permlane32_swap_b32 v60, v63
    v_max_f32 v61, v60, v63
    v_cvt_pk_bf16_f32 v114, v80, v81
    v_cvt_pk_bf16_f32 v115, v84, v85
    v_mul_f32_dpp v62, v61, v126 quad_perm:[2,3,2,3] row_mask:0xf bank_mask:0xf
    v_pk_fma_f32 v[2:3], v[2:3], s[28:29], v[62:63] op_sel_hi:[1,1,0]
    v_pk_fma_f32 v[56:57], v[56:57], s[28:29], v[62:63] op_sel_hi:[1,1,0]
    v_exp_f32 v2, v2
    v_exp_f32 v3, v3
    v_pk_fma_f32 v[58:59], v[58:59], s[28:29], v[62:63] op_sel_hi:[1,1,0]
    v_cvt_pk_bf16_f32 v80, v2, v3
    v_exp_f32 v56, v56
    v_cndmask_b32 v5, v113, v80, vcc
    v_cndmask_b32_dpp v4, v80, v113, vcc quad_perm:[2,3,2,3] row_mask:0xf bank_mask:0xf
    v_exp_f32 v57, v57
    v_exp_f32 v58, v58
    v_mfma_f32_16x16x16_bf16 v[76:79], v[4:5], v[104:105], 0
    v_cvt_pk_bf16_f32 v84, v56, v57
    v_exp_f32 v59, v59
    v_mfma_f32_16x16x16_bf16 v[72:75], v[4:5], v[114:115], 0
    v_cvt_pk_bf16_f32 v85, v58, v59
    v_mov_b32_dpp v86, v84 quad_perm:[2,3,0,1] row_mask:0xf bank_mask:0xf
    v_mov_b64 v[68:69], 0
    v_mov_b32_dpp v87, v85 quad_perm:[2,3,0,1] row_mask:0xf bank_mask:0xf
    v_mov_b64 v[70:71], 0
    v_mov_b64 v[80:81], 0
    v_mfma_f32_16x16x32_bf16 v[76:79], v[84:87], v[104:107], v[76:79]
    ds_read_b128 v[32:35], v125 offset:6144
    v_smfmac_f32_16x16x64_bf16 v[72:75], v[84:87], v[88:95], v117
    ds_read_b128 v[36:39], v125 offset:7168
    s_nop 2
    v_rcp_f32_dpp v60, v76 quad_perm:[2,3,2,3] row_mask:0xf bank_mask:0xf
    v_rcp_f32_dpp v61, v77 quad_perm:[2,3,2,3] row_mask:0xf bank_mask:0xf
    s_nop 1
    v_pk_mul_f32 v[72:73], v[72:73], v[60:61]
    v_pk_mul_f32 v[74:75], v[74:75], v[60:61]
    v_cvt_pk_bf16_f32 v56, v72, v73
    v_cvt_pk_bf16_f32 v57, v74, v75
    ds_write_b64 v121, v[56:57] offset:14336
    v_mov_b64 v[82:83], 0
    v_mov_b64 v[84:85], 0
    v_mov_b64 v[86:87], 0
    v_mov_b64 v[72:73], 0
    v_mov_b64 v[74:75], 0
    v_mov_b64 v[76:77], 0
    v_mov_b64 v[78:79], 0
    v_mov_b64 v[88:89], 0
    v_mov_b64 v[90:91], 0
    v_mov_b64 v[92:93], 0
    v_mov_b64 v[94:95], 0
    s_waitcnt vmcnt(6)
    s_waitcnt lgkmcnt(0)
    s_barrier
    ds_read_b64_tr_b16 v[96:97], v122 offset:14336
    ds_read_b64_tr_b16 v[98:99], v122 offset:14848
    ds_read_b64_tr_b16 v[100:101], v122 offset:15360
    ds_read_b64_tr_b16 v[102:103], v122 offset:15872
    ds_read_b128 v[40:43], v125 offset:16384
    ds_read_b128 v[44:47], v125 offset:17408
    s_waitcnt lgkmcnt(4)
    v_smfmac_f32_16x16x64_bf16 v[72:75], v[96:99], a[176:183], v117
    ds_read_b128 v[24:27], v125 offset:28672
    s_waitcnt lgkmcnt(3)
    v_smfmac_f32_16x16x64_bf16 v[72:75], v[100:103], a[192:199], v117
    ds_read_b128 v[28:31], v125 offset:29696
    v_smfmac_f32_16x16x64_bf16 v[76:79], v[96:99], a[184:191], v117
    global_load_ushort v16, v120, s[92:93] offset:1024 sc1
    ds_read_b128 v[56:59], v125 offset:30720
    v_smfmac_f32_16x16x64_bf16 v[76:79], v[100:103], a[200:207], v117
    global_load_ushort v16, v120, s[92:93] offset:1024 sc1
    ds_read_b128 v[60:63], v125 offset:31744
    v_add_f32 v72, v72, v74
    v_add_f32 v73, v73, v75
    v_cvt_pk_bf16_f32 v72, v72, v73
    v_smfmac_f32_16x16x64_bf16 v[80:83], v[96:99], a[208:215], v117
    global_store_dword v119, v72, s[16:17] offset:-4096
    global_load_ushort v16, v120, s[92:93] offset:1024 sc1
    v_add_f32 v76, v76, v78
    v_add_f32 v77, v77, v79
    v_cvt_pk_bf16_f32 v76, v76, v77
    v_smfmac_f32_16x16x64_bf16 v[80:83], v[100:103], a[224:231], v117
    global_store_dword v119, v76, s[32:33] offset:-4096
    v_smfmac_f32_16x16x64_bf16 v[84:87], v[96:99], a[216:223], v117
    global_load_ushort v16, v120, s[92:93] offset:1024 sc1
    v_smfmac_f32_16x16x64_bf16 v[84:87], v[100:103], a[232:239], v117
    global_load_ushort v16, v120, s[92:93] offset:1024 sc1
    v_add_f32 v80, v80, v82
    v_smfmac_f32_16x16x64_bf16 v[64:67], v[96:99], a[240:247], v117
    global_load_ushort v16, v120, s[92:93] offset:1024 sc1
    v_add_f32 v81, v81, v83
    v_cvt_pk_bf16_f32 v80, v80, v81
    v_smfmac_f32_16x16x64_bf16 v[64:67], v[100:103], v[48:55], v117
    global_store_dword v119, v80, s[16:17] offset:-2048
    v_add_f32 v84, v84, v86
    v_smfmac_f32_16x16x64_bf16 v[68:71], v[96:99], a[248:255], v117
    global_load_ushort v16, v120, s[92:93] offset:1024 sc1
    v_add_f32 v85, v85, v87
    v_cvt_pk_bf16_f32 v84, v84, v85
    v_smfmac_f32_16x16x64_bf16 v[68:71], v[100:103], v[32:39], v117
    s_waitcnt lgkmcnt(4)
    global_store_dword v119, v84, s[32:33] offset:-2048
    v_add_f32 v64, v64, v66
    v_smfmac_f32_16x16x64_bf16 v[88:91], v[96:99], v[40:47], v117
    s_waitcnt lgkmcnt(2)
    global_load_ushort v16, v120, s[92:93] offset:1024 sc1
    v_add_f32 v65, v65, v67
    v_cvt_pk_bf16_f32 v64, v64, v65
    v_smfmac_f32_16x16x64_bf16 v[88:91], v[100:103], v[24:31], v117
    global_store_dword v119, v64, s[16:17] offset:0
    v_add_f32 v68, v68, v70
    v_smfmac_f32_16x16x64_bf16 v[92:95], v[96:99], v[8:15], v117
    s_waitcnt lgkmcnt(0)
    global_load_ushort v16, v120, s[92:93] offset:1024 sc1
    v_add_f32 v69, v69, v71
    v_cvt_pk_bf16_f32 v68, v68, v69
    v_smfmac_f32_16x16x64_bf16 v[92:95], v[100:103], v[56:63], v117
    global_store_dword v119, v68, s[32:33] offset:0
    v_add_f32 v88, v88, v90
    v_add_f32 v89, v89, v91
    v_cvt_pk_bf16_f32 v88, v88, v89
    global_store_dword v119, v88, s[16:17] offset:2048
    s_mov_b32 m0, 0
    ds_read_b128 v[32:35], v125 offset:0
    ds_read_b128 v[36:39], v125 offset:1024
    global_load_ushort v16, v120, s[92:93] offset:1024 sc1
    v_add_f32 v92, v92, v94
    v_add_f32 v93, v93, v95
    v_cvt_pk_bf16_f32 v92, v92, v93
    global_store_dword v119, v92, s[32:33] offset:2048
Lgf_95:
    v_cmp_ne_u32 vcc, s26, v16
    global_load_ushort v16, v120, s[92:93] offset:1024 sc1
    s_cbranch_vccz Lgb_96
    v_cmp_ne_u32 vcc, s26, v16
    global_load_ushort v16, v120, s[92:93] offset:1024 sc1
    s_cbranch_vccz Lgb_96
    v_cmp_ne_u32 vcc, s26, v16
    global_load_ushort v16, v120, s[92:93] offset:1024 sc1
    s_cbranch_vccz Lgb_96
    v_cmp_ne_u32 vcc, s26, v16
    global_load_ushort v16, v120, s[92:93] offset:1024 sc1
    s_sub_u32 s27, s27, 1
    s_cbranch_vccz Lgb_96
    s_cbranch_scc0 Lgf_95
    s_branch L_fin
Lgb_96:
    s_barrier
    global_load_dword v0, v123, s[20:21] offset:0 sc1
    global_load_dword v1, v123, s[20:21] offset:256 sc1
    global_load_dword v2, v123, s[20:21] offset:512 sc1
    global_load_dword v3, v123, s[20:21] offset:768 sc1
    global_load_dword v4, v123, s[20:21] offset:1024 sc1
    global_load_dword v5, v123, s[20:21] offset:1280 sc1
    global_load_dword v6, v123, s[20:21] offset:1536 sc1
    global_load_dword v7, v123, s[20:21] offset:1792 sc1
    ds_read_b128 v[40:43], v125 offset:8192
    ds_read_b128 v[44:47], v125 offset:9216
    ds_read_b128 v[48:51], v125 offset:2048
    ds_read_b128 v[52:55], v125 offset:3072
    ds_read_b128 v[96:99], v125 offset:10240
    ds_read_b128 v[100:103], v125 offset:11264
    v_mov_b32 v115, s26
    s_waitcnt vmcnt(4)
    v_mfma_f32_16x16x32_bf16 v[24:27], v[104:107], v[0:3], 0
    v_max3_u32 v28, v0, v1, v2
    s_waitcnt vmcnt(0)
    v_mfma_f32_16x16x32_bf16 v[24:27], v[104:107], v[4:7], v[24:27]
    v_max3_u32 v29, v4, v5, v6
    v_max3_u32 v28, v28, v3, v7
    v_cmp_u_f32 vcc, v28, v29
    s_nop 4
    v_cvt_pk_bf16_f32 v114, v24, v24
    s_cbranch_vccnz Lpf_97
Lpj_98:
    global_store_short v120, v114, s[10:11]
    s_branch Lhl0_42
Llast_43:
    global_store_short v120, v114, s[24:25] sc1
    s_branch L_fin
.p2align 6
Lvf_44:
    global_load_ushort v17, v120, s[92:93] sc1
    global_load_lds_dwordx4 v127, s[10:11] sc1
    global_load_lds_dwordx4 v127, s[10:11] offset:2048 sc1
    s_waitcnt vmcnt(5)
    v_cmp_ne_u32 vcc, s26, v18
    s_waitcnt vmcnt(3)
    s_cbranch_vccz Lvb_45
    global_load_ushort v18, v120, s[92:93] sc1
    global_load_lds_dwordx4 v127, s[10:11] sc1
    global_load_lds_dwordx4 v127, s[10:11] offset:2048 sc1
    s_waitcnt vmcnt(5)
    v_cmp_ne_u32 vcc, s26, v17
    s_sub_u32 s27, s27, 1
    s_waitcnt vmcnt(3)
    s_cbranch_vccz Lvb_45
    s_cbranch_scc0 Lvf_44
    s_branch L_fin
Lfa_46:
    s_waitcnt lgkmcnt(1)
    ds_read_b128 v[0:3], v118 offset:0
    ds_read_b128 v[4:7], v118 offset:2048
    global_load_lds_dwordx4 v127, s[10:11] sc1
    global_load_lds_dwordx4 v127, s[10:11] offset:2048 sc1
Lqb_48:
    ds_read_b128 v[8:11], v118 offset:1024
    ds_read_b128 v[12:15], v118 offset:3072
    v_smfmac_f32_16x16x64_bf16 v[72:75], v[24:27], v[32:39], v117
    v_max_u32 v112, v24, v28
    v_cmp_eq_u32 vcc, -1, v112
    v_smfmac_f32_16x16x64_bf16 v[72:75], v[28:31], v[40:47], v117
    v_smfmac_f32_16x16x64_bf16 v[76:79], v[24:27], v[48:55], v117
    s_cbranch_vccnz Lfb_47
    v_mov_b64 v[64:65], 0
    v_mov_b64 v[66:67], 0
    v_smfmac_f32_16x16x64_bf16 v[76:79], v[28:31], v[96:103], v117
    global_store_short v120, v108, s[12:13]
    s_mov_b32 m0, 16384
    v_mov_b64 v[68:69], 0
    v_mov_b64 v[70:71], 0
    v_smfmac_f32_16x16x64_bf16 v[64:67], v[24:27], v[128:135], v117
    s_waitcnt vmcnt(3)
    global_load_lds_dwordx4 v118, s[22:23] offset:0 sc1
    v_smfmac_f32_16x16x64_bf16 v[64:67], v[28:31], v[144:151], v117
    ds_read_b128 v[16:19], v118 offset:4096
    s_waitcnt lgkmcnt(1)
    v_cmp_u_f32 vcc, v8, v12
    v_smfmac_f32_16x16x64_bf16 v[68:71], v[24:27], v[136:143], v117
    global_store_short v120, v114, s[24:25] sc1
    ds_read_b128 v[20:23], v118 offset:6144
    v_smfmac_f32_16x16x64_bf16 v[68:71], v[28:31], v[152:159], v117
    s_cbranch_vccnz Lfs_54
Lbk_55:
    s_branch Lqj_50
Lfb_47:
    v_mov_b64 v[64:65], 0
    v_mov_b64 v[66:67], 0
    v_mov_b64 v[68:69], 0
    v_mov_b64 v[70:71], 0
    v_mov_b64 v[72:73], 0
    v_mov_b64 v[74:75], 0
    s_nop 0
    v_mov_b64 v[76:77], 0
    v_mov_b64 v[78:79], 0
Lr0_57:
    ds_read_b128 v[24:27], v118 offset:0
    ds_read_b128 v[28:31], v118 offset:2048
    global_load_lds_dwordx4 v127, s[10:11] sc1
    global_load_lds_dwordx4 v127, s[10:11] offset:2048 sc1
    s_waitcnt lgkmcnt(2)
    v_max_u32 v112, v0, v4
    v_cmp_eq_u32 vcc, -1, v112
    s_cbranch_vccz Lqa_49
    ds_read_b128 v[0:3], v118 offset:0
    ds_read_b128 v[4:7], v118 offset:2048
    global_load_lds_dwordx4 v127, s[10:11] sc1
    global_load_lds_dwordx4 v127, s[10:11] offset:2048 sc1
    s_waitcnt lgkmcnt(2)
    v_max_u32 v112, v24, v28
    v_cmp_eq_u32 vcc, -1, v112
    s_cbranch_vccz Lqb_48
    s_sub_u32 s27, s27, 1
    s_cbranch_scc0 Lr0_57
    s_branch L_fin
Lqa_49:
    ds_read_b128 v[8:11], v118 offset:1024
    ds_read_b128 v[12:15], v118 offset:3072
    v_smfmac_f32_16x16x64_bf16 v[64:67], v[0:3], v[128:135], v117
    v_smfmac_f32_16x16x64_bf16 v[64:67], v[4:7], v[144:151], v117
    v_smfmac_f32_16x16x64_bf16 v[68:71], v[0:3], v[136:143], v117
    v_smfmac_f32_16x16x64_bf16 v[68:71], v[4:7], v[152:159], v117
    global_store_short v120, v108, s[12:13]
    s_mov_b32 m0, 16384
    v_smfmac_f32_16x16x64_bf16 v[72:75], v[0:3], v[32:39], v117
    s_waitcnt vmcnt(3)
    global_load_lds_dwordx4 v118, s[22:23] offset:0 sc1
    v_smfmac_f32_16x16x64_bf16 v[72:75], v[4:7], v[40:47], v117
    ds_read_b128 v[16:19], v118 offset:4096
    s_waitcnt lgkmcnt(1)
    v_cmp_u_f32 vcc, v8, v12
    v_smfmac_f32_16x16x64_bf16 v[76:79], v[0:3], v[48:55], v117
    global_store_short v120, v114, s[24:25] sc1
    ds_read_b128 v[20:23], v118 offset:6144
    v_smfmac_f32_16x16x64_bf16 v[76:79], v[4:7], v[96:103], v117
    s_cbranch_vccnz Lfs_58
Lbk_59:
    s_branch Lqj_50
Lpf_69:
    global_load_dword v16, v123, s[18:19] offset:0 sc1
    global_load_dword v17, v123, s[18:19] offset:256 sc1
    global_load_dword v18, v123, s[18:19] offset:512 sc1
    global_load_dword v19, v123, s[18:19] offset:768 sc1
    global_load_dword v20, v123, s[18:19] offset:1024 sc1
    global_load_dword v21, v123, s[18:19] offset:1280 sc1
    global_load_dword v22, v123, s[18:19] offset:1536 sc1
    global_load_dword v23, v123, s[18:19] offset:1792 sc1
    global_load_dword v8, v123, s[18:19] offset:0 sc1
    global_load_dword v9, v123, s[18:19] offset:256 sc1
    global_load_dword v10, v123, s[18:19] offset:512 sc1
    global_load_dword v11, v123, s[18:19] offset:768 sc1
    global_load_dword v12, v123, s[18:19] offset:1024 sc1
    global_load_dword v13, v123, s[18:19] offset:1280 sc1
    global_load_dword v14, v123, s[18:19] offset:1536 sc1
    global_load_dword v15, v123, s[18:19] offset:1792 sc1
    s_waitcnt vmcnt(12)
    v_mfma_f32_16x16x32_bf16 v[24:27], v[104:107], v[16:19], 0
    v_max3_u32 v28, v16, v17, v18
    s_waitcnt vmcnt(8)
    v_mfma_f32_16x16x32_bf16 v[24:27], v[104:107], v[20:23], v[24:27]
    v_max3_u32 v29, v20, v21, v22
    v_max3_u32 v28, v28, v19, v23
    v_max_u32 v28, v28, v29
    v_cmp_eq_u32 vcc, -1, v28
    s_nop 3
    v_cvt_pk_bf16_f32 v114, v24, v24
    s_cbranch_vccz Lpj_70
Lpl_71:
    global_load_dword v16, v123, s[18:19] offset:0 sc1
    global_load_dword v17, v123, s[18:19] offset:256 sc1
    global_load_dword v18, v123, s[18:19] offset:512 sc1
    global_load_dword v19, v123, s[18:19] offset:768 sc1
    global_load_dword v20, v123, s[18:19] offset:1024 sc1
    global_load_dword v21, v123, s[18:19] offset:1280 sc1
    global_load_dword v22, v123, s[18:19] offset:1536 sc1
    global_load_dword v23, v123, s[18:19] offset:1792 sc1
    s_waitcnt vmcnt(12)
    v_mfma_f32_16x16x32_bf16 v[24:27], v[104:107], v[8:11], 0
    v_max3_u32 v28, v8, v9, v10
    s_waitcnt vmcnt(8)
    v_mfma_f32_16x16x32_bf16 v[24:27], v[104:107], v[12:15], v[24:27]
    v_max3_u32 v29, v12, v13, v14
    v_max3_u32 v28, v28, v11, v15
    v_max_u32 v28, v28, v29
    v_cmp_eq_u32 vcc, -1, v28
    s_nop 3
    v_cvt_pk_bf16_f32 v114, v24, v24
    s_cbranch_vccz Lpj_70
    global_load_dword v8, v123, s[18:19] offset:0 sc1
    global_load_dword v9, v123, s[18:19] offset:256 sc1
    global_load_dword v10, v123, s[18:19] offset:512 sc1
    global_load_dword v11, v123, s[18:19] offset:768 sc1
    global_load_dword v12, v123, s[18:19] offset:1024 sc1
    global_load_dword v13, v123, s[18:19] offset:1280 sc1
    global_load_dword v14, v123, s[18:19] offset:1536 sc1
    global_load_dword v15, v123, s[18:19] offset:1792 sc1
    s_waitcnt vmcnt(12)
    v_mfma_f32_16x16x32_bf16 v[24:27], v[104:107], v[16:19], 0
    v_max3_u32 v28, v16, v17, v18
    s_waitcnt vmcnt(8)
    v_mfma_f32_16x16x32_bf16 v[24:27], v[104:107], v[20:23], v[24:27]
    v_max3_u32 v29, v20, v21, v22
    v_max3_u32 v28, v28, v19, v23
    v_max_u32 v28, v28, v29
    v_cmp_eq_u32 vcc, -1, v28
    s_nop 3
    v_cvt_pk_bf16_f32 v114, v24, v24
    s_cbranch_vccz Lpj_70
    s_sub_u32 s27, s27, 1
    s_cbranch_scc0 Lpl_71
    s_branch L_fin
.p2align 6
Lvf_72:
    global_load_ushort v17, v120, s[92:93] sc1
    global_load_lds_dwordx4 v127, s[12:13] sc1
    global_load_lds_dwordx4 v127, s[12:13] offset:2048 sc1
    s_waitcnt vmcnt(5)
    v_cmp_ne_u32 vcc, s26, v18
    s_waitcnt vmcnt(3)
    s_cbranch_vccz Lvb_73
    global_load_ushort v18, v120, s[92:93] sc1
    global_load_lds_dwordx4 v127, s[12:13] sc1
    global_load_lds_dwordx4 v127, s[12:13] offset:2048 sc1
    s_waitcnt vmcnt(5)
    v_cmp_ne_u32 vcc, s26, v17
    s_sub_u32 s27, s27, 1
    s_waitcnt vmcnt(3)
    s_cbranch_vccz Lvb_73
    s_cbranch_scc0 Lvf_72
    s_branch L_fin
Lfa_74:
    s_waitcnt lgkmcnt(1)
    ds_read_b128 v[0:3], v118 offset:0
    ds_read_b128 v[4:7], v118 offset:2048
    global_load_lds_dwordx4 v127, s[12:13] sc1
    global_load_lds_dwordx4 v127, s[12:13] offset:2048 sc1
Lqb_76:
    ds_read_b128 v[8:11], v118 offset:1024
    ds_read_b128 v[12:15], v118 offset:3072
    v_smfmac_f32_16x16x64_bf16 v[72:75], v[24:27], v[32:39], v117
    v_max_u32 v112, v24, v28
    v_cmp_eq_u32 vcc, -1, v112
    v_smfmac_f32_16x16x64_bf16 v[72:75], v[28:31], v[40:47], v117
    v_smfmac_f32_16x16x64_bf16 v[76:79], v[24:27], v[48:55], v117
    s_cbranch_vccnz Lfb_75
    v_mov_b64 v[64:65], 0
    v_mov_b64 v[66:67], 0
    v_smfmac_f32_16x16x64_bf16 v[76:79], v[28:31], v[96:103], v117
    global_store_short v120, v108, s[10:11]
    s_mov_b32 m0, 16384
    v_mov_b64 v[68:69], 0
    v_mov_b64 v[70:71], 0
    v_smfmac_f32_16x16x64_bf16 v[64:67], v[24:27], v[128:135], v117
    s_waitcnt vmcnt(3)
    global_load_lds_dwordx4 v118, s[22:23] offset:0 sc1
    v_smfmac_f32_16x16x64_bf16 v[64:67], v[28:31], v[144:151], v117
    ds_read_b128 v[16:19], v118 offset:4096
    s_waitcnt lgkmcnt(1)
    v_cmp_u_f32 vcc, v8, v12
    v_smfmac_f32_16x16x64_bf16 v[68:71], v[24:27], v[136:143], v117
    global_store_short v120, v114, s[24:25] sc1
    ds_read_b128 v[20:23], v118 offset:6144
    v_smfmac_f32_16x16x64_bf16 v[68:71], v[28:31], v[152:159], v117
    s_cbranch_vccnz Lfs_82
Lbk_83:
    s_branch Lqj_78
Lfb_75:
    v_mov_b64 v[64:65], 0
    v_mov_b64 v[66:67], 0
    v_mov_b64 v[68:69], 0
    v_mov_b64 v[70:71], 0
    v_mov_b64 v[72:73], 0
    v_mov_b64 v[74:75], 0
    s_nop 0
    v_mov_b64 v[76:77], 0
    v_mov_b64 v[78:79], 0
Lr0_85:
    ds_read_b128 v[24:27], v118 offset:0
    ds_read_b128 v[28:31], v118 offset:2048
    global_load_lds_dwordx4 v127, s[12:13] sc1
    global_load_lds_dwordx4 v127, s[12:13] offset:2048 sc1
    s_waitcnt lgkmcnt(2)
    v_max_u32 v112, v0, v4
    v_cmp_eq_u32 vcc, -1, v112
    s_cbranch_vccz Lqa_77
    ds_read_b128 v[0:3], v118 offset:0
    ds_read_b128 v[4:7], v118 offset:2048
    global_load_lds_dwordx4 v127, s[12:13] sc1
    global_load_lds_dwordx4 v127, s[12:13] offset:2048 sc1
    s_waitcnt lgkmcnt(2)
    v_max_u32 v112, v24, v28
    v_cmp_eq_u32 vcc, -1, v112
    s_cbranch_vccz Lqb_76
    s_sub_u32 s27, s27, 1
    s_cbranch_scc0 Lr0_85
    s_branch L_fin
Lqa_77:
    ds_read_b128 v[8:11], v118 offset:1024
    ds_read_b128 v[12:15], v118 offset:3072
    v_smfmac_f32_16x16x64_bf16 v[64:67], v[0:3], v[128:135], v117
    v_smfmac_f32_16x16x64_bf16 v[64:67], v[4:7], v[144:151], v117
    v_smfmac_f32_16x16x64_bf16 v[68:71], v[0:3], v[136:143], v117
    v_smfmac_f32_16x16x64_bf16 v[68:71], v[4:7], v[152:159], v117
    global_store_short v120, v108, s[10:11]
    s_mov_b32 m0, 16384
    v_smfmac_f32_16x16x64_bf16 v[72:75], v[0:3], v[32:39], v117
    s_waitcnt vmcnt(3)
    global_load_lds_dwordx4 v118, s[22:23] offset:0 sc1
    v_smfmac_f32_16x16x64_bf16 v[72:75], v[4:7], v[40:47], v117
    ds_read_b128 v[16:19], v118 offset:4096
    s_waitcnt lgkmcnt(1)
    v_cmp_u_f32 vcc, v8, v12
    v_smfmac_f32_16x16x64_bf16 v[76:79], v[0:3], v[48:55], v117
    global_store_short v120, v114, s[24:25] sc1
    ds_read_b128 v[20:23], v118 offset:6144
    v_smfmac_f32_16x16x64_bf16 v[76:79], v[4:7], v[96:103], v117
    s_cbranch_vccnz Lfs_86
Lbk_87:
    s_branch Lqj_78
Lpf_97:
    global_load_dword v16, v123, s[20:21] offset:0 sc1
    global_load_dword v17, v123, s[20:21] offset:256 sc1
    global_load_dword v18, v123, s[20:21] offset:512 sc1
    global_load_dword v19, v123, s[20:21] offset:768 sc1
    global_load_dword v20, v123, s[20:21] offset:1024 sc1
    global_load_dword v21, v123, s[20:21] offset:1280 sc1
    global_load_dword v22, v123, s[20:21] offset:1536 sc1
    global_load_dword v23, v123, s[20:21] offset:1792 sc1
    global_load_dword v8, v123, s[20:21] offset:0 sc1
    global_load_dword v9, v123, s[20:21] offset:256 sc1
    global_load_dword v10, v123, s[20:21] offset:512 sc1
    global_load_dword v11, v123, s[20:21] offset:768 sc1
    global_load_dword v12, v123, s[20:21] offset:1024 sc1
    global_load_dword v13, v123, s[20:21] offset:1280 sc1
    global_load_dword v14, v123, s[20:21] offset:1536 sc1
    global_load_dword v15, v123, s[20:21] offset:1792 sc1
    s_waitcnt vmcnt(12)
    v_mfma_f32_16x16x32_bf16 v[24:27], v[104:107], v[16:19], 0
    v_max3_u32 v28, v16, v17, v18
    s_waitcnt vmcnt(8)
    v_mfma_f32_16x16x32_bf16 v[24:27], v[104:107], v[20:23], v[24:27]
    v_max3_u32 v29, v20, v21, v22
    v_max3_u32 v28, v28, v19, v23
    v_max_u32 v28, v28, v29
    v_cmp_eq_u32 vcc, -1, v28
    s_nop 3
    v_cvt_pk_bf16_f32 v114, v24, v24
    s_cbranch_vccz Lpj_98
Lpl_99:
    global_load_dword v16, v123, s[20:21] offset:0 sc1
    global_load_dword v17, v123, s[20:21] offset:256 sc1
    global_load_dword v18, v123, s[20:21] offset:512 sc1
    global_load_dword v19, v123, s[20:21] offset:768 sc1
    global_load_dword v20, v123, s[20:21] offset:1024 sc1
    global_load_dword v21, v123, s[20:21] offset:1280 sc1
    global_load_dword v22, v123, s[20:21] offset:1536 sc1
    global_load_dword v23, v123, s[20:21] offset:1792 sc1
    s_waitcnt vmcnt(12)
    v_mfma_f32_16x16x32_bf16 v[24:27], v[104:107], v[8:11], 0
    v_max3_u32 v28, v8, v9, v10
    s_waitcnt vmcnt(8)
    v_mfma_f32_16x16x32_bf16 v[24:27], v[104:107], v[12:15], v[24:27]
    v_max3_u32 v29, v12, v13, v14
    v_max3_u32 v28, v28, v11, v15
    v_max_u32 v28, v28, v29
    v_cmp_eq_u32 vcc, -1, v28
    s_nop 3
    v_cvt_pk_bf16_f32 v114, v24, v24
    s_cbranch_vccz Lpj_98
    global_load_dword v8, v123, s[20:21] offset:0 sc1
    global_load_dword v9, v123, s[20:21] offset:256 sc1
    global_load_dword v10, v123, s[20:21] offset:512 sc1
    global_load_dword v11, v123, s[20:21] offset:768 sc1
    global_load_dword v12, v123, s[20:21] offset:1024 sc1
    global_load_dword v13, v123, s[20:21] offset:1280 sc1
    global_load_dword v14, v123, s[20:21] offset:1536 sc1
    global_load_dword v15, v123, s[20:21] offset:1792 sc1
    s_waitcnt vmcnt(12)
    v_mfma_f32_16x16x32_bf16 v[24:27], v[104:107], v[16:19], 0
    v_max3_u32 v28, v16, v17, v18
    s_waitcnt vmcnt(8)
    v_mfma_f32_16x16x32_bf16 v[24:27], v[104:107], v[20:23], v[24:27]
    v_max3_u32 v29, v20, v21, v22
    v_max3_u32 v28, v28, v19, v23
    v_max_u32 v28, v28, v29
    v_cmp_eq_u32 vcc, -1, v28
    s_nop 3
    v_cvt_pk_bf16_f32 v114, v24, v24
    s_cbranch_vccz Lpj_98
    s_sub_u32 s27, s27, 1
    s_cbranch_scc0 Lpl_99
    s_branch L_fin
Lfs_51:
Lfl_53:
    ds_read_b128 v[8:11], v118 offset:1024
    ds_read_b128 v[12:15], v118 offset:3072
    s_sub_u32 s27, s27, 1
    s_waitcnt lgkmcnt(0)
    v_max_u32 v112, v8, v12
    v_cmp_eq_u32 vcc, -1, v112
    s_cbranch_vccz Lbk_52
    s_cbranch_scc0 Lfl_53
    s_branch L_fin
Lfs_54:
Lfl_56:
    ds_read_b128 v[8:11], v118 offset:1024
    ds_read_b128 v[12:15], v118 offset:3072
    s_sub_u32 s27, s27, 1
    s_waitcnt lgkmcnt(0)
    v_max_u32 v112, v8, v12
    v_cmp_eq_u32 vcc, -1, v112
    s_cbranch_vccz Lbk_55
    s_cbranch_scc0 Lfl_56
    s_branch L_fin
Lfs_58:
Lfl_60:
    ds_read_b128 v[8:11], v118 offset:1024
    ds_read_b128 v[12:15], v118 offset:3072
    s_sub_u32 s27, s27, 1
    s_waitcnt lgkmcnt(0)
    v_max_u32 v112, v8, v12
    v_cmp_eq_u32 vcc, -1, v112
    s_cbranch_vccz Lbk_59
    s_cbranch_scc0 Lfl_60
    s_branch L_fin
Lfs_61:
Lfl_63:
    ds_read_b128 v[16:19], v118 offset:4096
    ds_read_b128 v[20:23], v118 offset:6144
    s_sub_u32 s27, s27, 1
    s_waitcnt lgkmcnt(0)
    v_max_u32 v112, v16, v20
    v_cmp_eq_u32 vcc, -1, v112
    s_cbranch_vccz Lbk_62
    s_cbranch_scc0 Lfl_63
    s_branch L_fin
Lfs_64:
Lfl_66:
    ds_read_b128 v[24:27], v118 offset:5120
    ds_read_b128 v[28:31], v118 offset:7168
    s_sub_u32 s27, s27, 1
    s_waitcnt lgkmcnt(0)
    v_max_u32 v112, v24, v28
    v_cmp_eq_u32 vcc, -1, v112
    s_cbranch_vccz Lbk_65
    s_cbranch_scc0 Lfl_66
    s_branch L_fin
Lfs_79:
Lfl_81:
    ds_read_b128 v[8:11], v118 offset:1024
    ds_read_b128 v[12:15], v118 offset:3072
    s_sub_u32 s27, s27, 1
    s_waitcnt lgkmcnt(0)
    v_max_u32 v112, v8, v12
    v_cmp_eq_u32 vcc, -1, v112
    s_cbranch_vccz Lbk_80
    s_cbranch_scc0 Lfl_81
    s_branch L_fin
Lfs_82:
Lfl_84:
    ds_read_b128 v[8:11], v118 offset:1024
    ds_read_b128 v[12:15], v118 offset:3072
    s_sub_u32 s27, s27, 1
    s_waitcnt lgkmcnt(0)
    v_max_u32 v112, v8, v12
    v_cmp_eq_u32 vcc, -1, v112
    s_cbranch_vccz Lbk_83
    s_cbranch_scc0 Lfl_84
    s_branch L_fin
Lfs_86:
Lfl_88:
    ds_read_b128 v[8:11], v118 offset:1024
    ds_read_b128 v[12:15], v118 offset:3072
    s_sub_u32 s27, s27, 1
    s_waitcnt lgkmcnt(0)
    v_max_u32 v112, v8, v12
    v_cmp_eq_u32 vcc, -1, v112
    s_cbranch_vccz Lbk_87
    s_cbranch_scc0 Lfl_88
    s_branch L_fin
Lfs_89:
Lfl_91:
    ds_read_b128 v[16:19], v118 offset:4096
    ds_read_b128 v[20:23], v118 offset:6144
    s_sub_u32 s27, s27, 1
    s_waitcnt lgkmcnt(0)
    v_max_u32 v112, v16, v20
    v_cmp_eq_u32 vcc, -1, v112
    s_cbranch_vccz Lbk_90
    s_cbranch_scc0 Lfl_91
    s_branch L_fin
Lfs_92:
Lfl_94:
    ds_read_b128 v[24:27], v118 offset:5120
    ds_read_b128 v[28:31], v118 offset:7168
    s_sub_u32 s27, s27, 1
    s_waitcnt lgkmcnt(0)
    v_max_u32 v112, v24, v28
    v_cmp_eq_u32 vcc, -1, v112
    s_cbranch_vccz Lbk_93
    s_cbranch_scc0 Lfl_94
    s_branch L_fin
Lwv_39:
    s_mov_b32 m0, 1024
    ds_read_b128 v[32:35], v125 offset:0
    ds_read_b128 v[36:39], v125 offset:1024
    ds_read_b128 v[40:43], v125 offset:8192
    ds_read_b128 v[44:47], v125 offset:9216
    ds_read_b128 v[48:51], v125 offset:2048
    ds_read_b128 v[52:55], v125 offset:3072
    ds_read_b128 v[96:99], v125 offset:10240
    ds_read_b128 v[100:103], v125 offset:11264
    v_mov_b64 v[64:65], 0
    v_mov_b64 v[66:67], 0
    v_mov_b64 v[68:69], 0
    v_mov_b64 v[70:71], 0
Lhl1_100:
    s_add_u32 s40, s26, 1
    s_lshr_b32 s40, s40, 1
    s_min_u32 s40, s40, 31
    v_cmp_ge_u32 vcc, s40, v116
    v_xor_b32 v112, 8, v109
    ds_read_b64 v[90:91], v109 offset:23552
    ds_read_b64 v[88:89], v112 offset:22528
    ds_read_b64 v[94:95], v109 offset:24064
    ds_read_b64 v[92:93], v112 offset:23040
    ds_read_b128 v[56:59], v111 offset:20480
    ds_read_b128 v[60:63], v111 offset:21504
    s_cbranch_vccnz Lkf_102
Lkr_103:
    v_mov_b64 v[72:73], 0
    v_mov_b64 v[74:75], 0
    v_mov_b64 v[76:77], 0
    v_mov_b64 v[78:79], 0
    v_mov_b64 v[80:81], 0
    v_mov_b64 v[82:83], 0
    v_mov_b64 v[84:85], 0
    v_mov_b64 v[86:87], 0
    s_waitcnt lgkmcnt(2)
    v_swap_b32 v89, v90
    v_swap_b32 v93, v94
    s_waitcnt vmcnt(0)
    global_load_lds_dwordx4 v127, s[10:11] sc1
    global_load_lds_dwordx4 v127, s[10:11] offset:2048 sc1
    s_barrier
    ds_read_b128 v[0:3], v118 offset:0
    ds_read_b128 v[4:7], v118 offset:2048
    global_load_lds_dwordx4 v127, s[10:11] sc1
    global_load_lds_dwordx4 v127, s[10:11] offset:2048 sc1
    s_waitcnt lgkmcnt(1)
    v_smfmac_f32_16x16x64_bf16 v[64:67], v[0:3], v[128:135], v117
    ds_read_b128 v[24:27], v118 offset:0
    ds_read_b128 v[8:11], v118 offset:1024
    s_waitcnt lgkmcnt(2)
    v_smfmac_f32_16x16x64_bf16 v[64:67], v[4:7], v[144:151], v117
    ds_read_b128 v[28:31], v118 offset:2048
    ds_read_b128 v[12:15], v118 offset:3072
    v_cmp_u_f32 vcc, v0, v4
    v_smfmac_f32_16x16x64_bf16 v[68:71], v[0:3], v[136:143], v117
    v_smfmac_f32_16x16x64_bf16 v[68:71], v[4:7], v[152:159], v117
    s_cbranch_vccnz Lfa_104
    global_store_short v120, v108, s[12:13]
    s_mov_b32 m0, 20480
    v_smfmac_f32_16x16x64_bf16 v[72:75], v[0:3], v[32:39], v117
    global_load_lds_dwordx4 v118, s[22:23] offset:0 sc1
    v_smfmac_f32_16x16x64_bf16 v[72:75], v[4:7], v[40:47], v117
    ds_read_b128 v[16:19], v118 offset:4096
    s_waitcnt lgkmcnt(1)
    v_cmp_u_f32 vcc, v8, v12
    v_smfmac_f32_16x16x64_bf16 v[76:79], v[0:3], v[48:55], v117
    global_store_short v120, v114, s[24:25] sc1
    ds_read_b128 v[20:23], v118 offset:6144
    v_smfmac_f32_16x16x64_bf16 v[76:79], v[4:7], v[96:103], v117
    s_cbranch_vccnz Lfs_109
Lbk_110:
Lqj_108:
    v_smfmac_f32_16x16x64_bf16 v[64:67], v[8:11], v[160:167], v117
    ds_read_b128 v[96:99], v125 offset:12288
    ds_read_b128 v[44:47], v125 offset:15360
    v_and_b32 v116, 12, v123
    v_smfmac_f32_16x16x64_bf16 v[64:67], v[12:15], v[176:183], v117
    global_load_lds_dwordx4 v118, s[22:23] offset:1024 sc1
    ds_read_b128 v[100:103], v125 offset:13312
    v_smfmac_f32_16x16x64_bf16 v[68:71], v[8:11], v[168:175], v117
    ds_read_b128 v[24:27], v118 offset:5120
    s_waitcnt lgkmcnt(4)
    v_cmp_u_f32 vcc, v16, v20
    v_smfmac_f32_16x16x64_bf16 v[68:71], v[12:15], v[184:191], v117
    ds_read_b128 v[28:31], v118 offset:7168
    ds_read_b128 v[40:43], v125 offset:14336
    v_smfmac_f32_16x16x64_bf16 v[72:75], v[8:11], a[0:7], v117
    s_cbranch_vccnz Lfs_122
Lbk_123:
    ds_read_b128 v[32:35], v125 offset:20480
    v_smfmac_f32_16x16x64_bf16 v[64:67], v[16:19], v[192:199], v117
    s_add_u32 s24, s24, 8192
    s_addc_u32 s25, s25, 0
    ds_read_b128 v[36:39], v125 offset:21504
    v_smfmac_f32_16x16x64_bf16 v[64:67], v[20:23], v[208:215], v117
    global_load_lds_dwordx4 v118, s[22:23] offset:2048 sc1
    ds_read_b128 v[48:51], v125 offset:22528
    v_smfmac_f32_16x16x64_bf16 v[68:71], v[16:19], v[200:207], v117
    s_add_u32 s26, s26, 1
    s_waitcnt lgkmcnt(4)
    v_cmp_u_f32 vcc, v24, v28
    v_smfmac_f32_16x16x64_bf16 v[68:71], v[20:23], v[216:223], v117
    global_load_dword v116, v116, s[36:37] offset:-4 sc1
    ds_read_b128 v[52:55], v125 offset:23552
    v_smfmac_f32_16x16x64_bf16 v[72:75], v[16:19], v[96:103], v117
    s_cbranch_vccnz Lfs_125
Lbk_126:
    v_smfmac_f32_16x16x64_bf16 v[64:67], v[24:27], v[224:231], v117
    s_mov_b64 vcc, s[64:65]
    v_smfmac_f32_16x16x64_bf16 v[64:67], v[28:31], v[240:247], v117
    global_load_lds_dwordx4 v118, s[22:23] offset:3072 sc1
    v_smfmac_f32_16x16x64_bf16 v[68:71], v[24:27], v[232:239], v117
    s_add_u32 s22, s22, 524288
    s_addc_u32 s23, s23, 0
    v_smfmac_f32_16x16x64_bf16 v[68:71], v[28:31], v[248:255], v117
    s_waitcnt lgkmcnt(2)
    v_add_f32 v64, v64, v66
    v_smfmac_f32_16x16x64_bf16 v[72:75], v[20:23], v[32:39], v117
    ds_read_b128 v[32:35], v125 offset:24576
    v_add_f32 v65, v65, v67
    v_smfmac_f32_16x16x64_bf16 v[72:75], v[12:15], a[16:23], v117
    ds_read_b128 v[36:39], v125 offset:25600
    v_cvt_pk_bf16_f32 v102, v64, v65
    v_add_f32 v68, v68, v70
    v_smfmac_f32_16x16x64_bf16 v[72:75], v[24:27], a[32:39], v117
    ds_write_b32 v121, v102 offset:9216
    v_add_f32 v69, v69, v71
    v_cvt_pk_bf16_f32 v103, v68, v69
    v_smfmac_f32_16x16x64_bf16 v[72:75], v[28:31], a[48:55], v117
    ds_write_b32 v121, v103 offset:9728
    v_smfmac_f32_16x16x64_bf16 v[76:79], v[16:19], v[40:47], v117
    ds_read_b128 v[40:43], v125 offset:26624
    s_waitcnt lgkmcnt(5)
    v_smfmac_f32_16x16x64_bf16 v[76:79], v[20:23], v[48:55], v117
    ds_read_b128 v[44:47], v125 offset:27648
    v_add_f32 v72, v72, v74
    v_smfmac_f32_16x16x64_bf16 v[76:79], v[8:11], a[8:15], v117
    ds_read_b128 v[48:51], v125 offset:4096
    v_smfmac_f32_16x16x64_bf16 v[76:79], v[12:15], a[24:31], v117
    s_waitcnt lgkmcnt(3)
    s_barrier
    v_smfmac_f32_16x16x64_bf16 v[76:79], v[24:27], a[40:47], v117
    ds_read_b64_tr_b16 v[64:65], v122 offset:8192
    ds_read_b64_tr_b16 v[66:67], v122 offset:8704
    v_smfmac_f32_16x16x64_bf16 v[76:79], v[28:31], a[56:63], v117
    ds_read_b64_tr_b16 v[68:69], v122 offset:9216
    ds_read_b64_tr_b16 v[70:71], v122 offset:9728
    v_add_f32 v73, v73, v75
    v_cvt_pk_bf16_f32 v100, v72, v73
    v_smfmac_f32_16x16x64_bf16 v[80:83], v[0:3], a[64:71], v117
    ds_write_b32 v121, v100 offset:11264
    v_smfmac_f32_16x16x64_bf16 v[84:87], v[0:3], a[72:79], v117
    s_waitcnt lgkmcnt(3)
    ds_read_b128 v[52:55], v125 offset:5120
    v_add_f32 v76, v76, v78
    v_mfma_f32_16x16x32_bf16 v[96:99], v[56:59], v[64:67], 0
    s_waitcnt lgkmcnt(2)
    v_add_f32 v77, v77, v79
    v_cvt_pk_bf16_f32 v101, v76, v77
    v_mfma_f32_16x16x32_bf16 v[96:99], v[60:63], v[68:71], v[96:99]
    ds_write_b32 v121, v101 offset:11776
    v_smfmac_f32_16x16x64_bf16 v[80:83], v[4:7], a[80:87], v117
    s_mov_b32 exec_hi, 0
    global_store_dword v110, v108, s[20:21]
    s_mov_b32 exec_hi, -1
    v_smfmac_f32_16x16x64_bf16 v[84:87], v[4:7], a[88:95], v117
    v_add_f32_dpp v98, v96, v98 quad_perm:[0,1,0,1] row_mask:0xf bank_mask:0xf
    v_add_f32_dpp v99, v97, v99 quad_perm:[0,1,0,1] row_mask:0xf bank_mask:0xf
    v_smfmac_f32_16x16x64_bf16 v[80:83], v[8:11], a[96:103], v117
    ds_write_b64 v109, v[98:99] offset:12800
    v_smfmac_f32_16x16x64_bf16 v[84:87], v[8:11], a[104:111], v117
    s_waitcnt lgkmcnt(1)
    s_barrier
    v_smfmac_f32_16x16x64_bf16 v[80:83], v[12:15], a[112:119], v117
    s_waitcnt vmcnt(8)
    ds_read_b64_tr_b16 v[72:73], v122 offset:10240
    ds_read_b64_tr_b16 v[74:75], v122 offset:10752
    v_smfmac_f32_16x16x64_bf16 v[84:87], v[12:15], a[120:127], v117
    ds_read_b64_tr_b16 v[76:77], v122 offset:11264
    ds_read_b64_tr_b16 v[78:79], v122 offset:11776
    v_smfmac_f32_16x16x64_bf16 v[80:83], v[16:19], a[128:135], v117
    ds_read_b128 v[8:11], v125 offset:18432
    v_smfmac_f32_16x16x64_bf16 v[84:87], v[16:19], a[136:143], v117
    s_waitcnt lgkmcnt(5)
    s_barrier
    s_waitcnt lgkmcnt(3)
    v_mfma_f32_16x16x32_bf16 v[0:3], v[72:75], v[64:67], 0
    ds_read_b128 v[56:59], v124 offset:12288
    s_waitcnt lgkmcnt(2)
    v_mfma_f32_16x16x32_bf16 v[0:3], v[76:79], v[68:71], v[0:3]
    ds_read_b128 v[12:15], v125 offset:19456
    v_smfmac_f32_16x16x64_bf16 v[80:83], v[20:23], a[144:151], v117
    ds_write_b32 v118, v108 offset:1024
    v_smfmac_f32_16x16x64_bf16 v[84:87], v[20:23], a[152:159], v117
    ds_write_b32 v118, v108 offset:3072
    v_add_f32_dpp v2, v0, v2 quad_perm:[0,1,0,1] row_mask:0xf bank_mask:0xf
    v_smfmac_f32_16x16x64_bf16 v[80:83], v[24:27], a[160:167], v117
    s_waitcnt lgkmcnt(3)
    v_max3_f32 v60, v56, v57, v58
    v_add_f32_dpp v3, v1, v3 quad_perm:[0,1,0,1] row_mask:0xf bank_mask:0xf
    v_smfmac_f32_16x16x64_bf16 v[84:87], v[24:27], a[168:175], v117
    v_max_f32 v60, v60, v59
    v_smfmac_f32_16x16x64_bf16 v[80:83], v[28:31], v[32:39], v117
    s_nop 0
    v_max_f32_dpp v60, v60, v60 quad_perm:[2,3,0,1] row_mask:0xf bank_mask:0xf
    v_smfmac_f32_16x16x64_bf16 v[84:87], v[28:31], v[40:47], v117
    v_max3_f32 v61, v60, v2, v3
    v_max3_f32 v62, v60, v2, v3
    v_mov_b64 v[64:65], 0
    v_mov_b64 v[66:67], 0
    v_permlane16_swap_b32 v61, v62
    v_max_f32 v60, v61, v62
    v_max_f32 v63, v61, v62
    v_pk_add_f32 v[80:81], v[80:81], v[82:83]
    v_pk_add_f32 v[84:85], v[84:85], v[86:87]
    v_permlane32_swap_b32 v60, v63
    v_max_f32 v61, v60, v63
    v_cvt_pk_bf16_f32 v114, v80, v81
    v_cvt_pk_bf16_f32 v115, v84, v85
    v_mul_f32_dpp v62, v61, v126 quad_perm:[2,3,2,3] row_mask:0xf bank_mask:0xf
    v_pk_fma_f32 v[2:3], v[2:3], s[28:29], v[62:63] op_sel_hi:[1,1,0]
    v_pk_fma_f32 v[56:57], v[56:57], s[28:29], v[62:63] op_sel_hi:[1,1,0]
    v_exp_f32 v2, v2
    v_exp_f32 v3, v3
    v_pk_fma_f32 v[58:59], v[58:59], s[28:29], v[62:63] op_sel_hi:[1,1,0]
    v_cvt_pk_bf16_f32 v80, v2, v3
    v_exp_f32 v56, v56
    v_cndmask_b32 v5, v113, v80, vcc
    v_cndmask_b32_dpp v4, v80, v113, vcc quad_perm:[2,3,2,3] row_mask:0xf bank_mask:0xf
    v_exp_f32 v57, v57
    v_exp_f32 v58, v58
    v_mfma_f32_16x16x16_bf16 v[76:79], v[4:5], v[104:105], 0
    v_cvt_pk_bf16_f32 v84, v56, v57
    v_exp_f32 v59, v59
    v_mfma_f32_16x16x16_bf16 v[72:75], v[4:5], v[114:115], 0
    v_cvt_pk_bf16_f32 v85, v58, v59
    v_mov_b32_dpp v86, v84 quad_perm:[2,3,0,1] row_mask:0xf bank_mask:0xf
    v_mov_b64 v[68:69], 0
    v_mov_b32_dpp v87, v85 quad_perm:[2,3,0,1] row_mask:0xf bank_mask:0xf
    v_mov_b64 v[70:71], 0
    v_mov_b64 v[80:81], 0
    v_mfma_f32_16x16x32_bf16 v[76:79], v[84:87], v[104:107], v[76:79]
    ds_read_b128 v[32:35], v125 offset:6144
    v_smfmac_f32_16x16x64_bf16 v[72:75], v[84:87], v[88:95], v117
    ds_read_b128 v[36:39], v125 offset:7168
    s_nop 2
    v_rcp_f32_dpp v60, v76 quad_perm:[2,3,2,3] row_mask:0xf bank_mask:0xf
    v_rcp_f32_dpp v61, v77 quad_perm:[2,3,2,3] row_mask:0xf bank_mask:0xf
    s_nop 1
    v_pk_mul_f32 v[72:73], v[72:73], v[60:61]
    v_pk_mul_f32 v[74:75], v[74:75], v[60:61]
    v_cvt_pk_bf16_f32 v56, v72, v73
    v_cvt_pk_bf16_f32 v57, v74, v75
    ds_write_b64 v121, v[56:57] offset:14848
    v_mov_b64 v[82:83], 0
    v_mov_b64 v[84:85], 0
    v_mov_b64 v[86:87], 0
    v_mov_b64 v[72:73], 0
    v_mov_b64 v[74:75], 0
    v_mov_b64 v[76:77], 0
    v_mov_b64 v[78:79], 0
    v_mov_b64 v[88:89], 0
    v_mov_b64 v[90:91], 0
    v_mov_b64 v[92:93], 0
    v_mov_b64 v[94:95], 0
    s_waitcnt vmcnt(7)
    s_waitcnt lgkmcnt(0)
    s_barrier
    ds_read_b64_tr_b16 v[96:97], v122 offset:14336
    ds_read_b64_tr_b16 v[98:99], v122 offset:14848
    ds_read_b64_tr_b16 v[100:101], v122 offset:15360
    ds_read_b64_tr_b16 v[102:103], v122 offset:15872
    ds_read_b128 v[40:43], v125 offset:16384
    ds_read_b128 v[44:47], v125 offset:17408
    s_waitcnt lgkmcnt(4)
    v_smfmac_f32_16x16x64_bf16 v[72:75], v[96:99], a[176:183], v117
    ds_read_b128 v[24:27], v125 offset:28672
    s_waitcnt lgkmcnt(3)
    v_smfmac_f32_16x16x64_bf16 v[72:75], v[100:103], a[192:199], v117
    ds_read_b128 v[28:31], v125 offset:29696
    v_smfmac_f32_16x16x64_bf16 v[76:79], v[96:99], a[184:191], v117
    ds_read_b128 v[56:59], v125 offset:30720
    v_smfmac_f32_16x16x64_bf16 v[76:79], v[100:103], a[200:207], v117
    ds_read_b128 v[60:63], v125 offset:31744
    v_add_f32 v72, v72, v74
    v_add_f32 v73, v73, v75
    v_cvt_pk_bf16_f32 v72, v72, v73
    v_smfmac_f32_16x16x64_bf16 v[80:83], v[96:99], a[208:215], v117
    global_store_dword v119, v72, s[14:15] offset:-4096
    s_nop 1
    v_add_f32 v76, v76, v78
    v_add_f32 v77, v77, v79
    v_cvt_pk_bf16_f32 v76, v76, v77
    v_smfmac_f32_16x16x64_bf16 v[80:83], v[100:103], a[224:231], v117
    global_store_dword v119, v76, s[30:31] offset:-4096
    v_smfmac_f32_16x16x64_bf16 v[84:87], v[96:99], a[216:223], v117
    v_smfmac_f32_16x16x64_bf16 v[84:87], v[100:103], a[232:239], v117
    v_add_f32 v80, v80, v82
    v_smfmac_f32_16x16x64_bf16 v[64:67], v[96:99], a[240:247], v117
    v_add_f32 v81, v81, v83
    v_cvt_pk_bf16_f32 v80, v80, v81
    v_smfmac_f32_16x16x64_bf16 v[64:67], v[100:103], v[48:55], v117
    global_store_dword v119, v80, s[14:15] offset:-2048
    v_add_f32 v84, v84, v86
    v_smfmac_f32_16x16x64_bf16 v[68:71], v[96:99], a[248:255], v117
    v_add_f32 v85, v85, v87
    v_cvt_pk_bf16_f32 v84, v84, v85
    v_smfmac_f32_16x16x64_bf16 v[68:71], v[100:103], v[32:39], v117
    s_waitcnt lgkmcnt(4)
    global_store_dword v119, v84, s[30:31] offset:-2048
    v_add_f32 v64, v64, v66
    v_smfmac_f32_16x16x64_bf16 v[88:91], v[96:99], v[40:47], v117
    s_waitcnt lgkmcnt(2)
    v_add_f32 v65, v65, v67
    v_cvt_pk_bf16_f32 v64, v64, v65
    v_smfmac_f32_16x16x64_bf16 v[88:91], v[100:103], v[24:31], v117
    global_store_dword v119, v64, s[14:15] offset:0
    v_add_f32 v68, v68, v70
    v_smfmac_f32_16x16x64_bf16 v[92:95], v[96:99], v[8:15], v117
    s_waitcnt lgkmcnt(0)
    v_add_f32 v69, v69, v71
    v_cvt_pk_bf16_f32 v68, v68, v69
    v_smfmac_f32_16x16x64_bf16 v[92:95], v[100:103], v[56:63], v117
    global_store_dword v119, v68, s[30:31] offset:0
    v_add_f32 v88, v88, v90
    v_add_f32 v89, v89, v91
    v_cvt_pk_bf16_f32 v88, v88, v89
    global_store_dword v119, v88, s[14:15] offset:2048
    s_mov_b32 m0, 1024
    ds_read_b128 v[32:35], v125 offset:0
    ds_read_b128 v[36:39], v125 offset:1024
    v_add_f32 v92, v92, v94
    v_add_f32 v93, v93, v95
    v_cvt_pk_bf16_f32 v92, v92, v93
    global_store_dword v119, v92, s[30:31] offset:2048
    s_barrier
    ds_read_b128 v[40:43], v125 offset:8192
    ds_read_b128 v[44:47], v125 offset:9216
    ds_read_b128 v[48:51], v125 offset:2048
    ds_read_b128 v[52:55], v125 offset:3072
    ds_read_b128 v[96:99], v125 offset:10240
    ds_read_b128 v[100:103], v125 offset:11264
    global_load_dword v0, v123, s[18:19] offset:0 sc1
    global_load_dword v1, v123, s[18:19] offset:256 sc1
    global_load_dword v2, v123, s[18:19] offset:512 sc1
    global_load_dword v3, v123, s[18:19] offset:768 sc1
    global_load_dword v4, v123, s[18:19] offset:1024 sc1
    global_load_dword v5, v123, s[18:19] offset:1280 sc1
    global_load_dword v6, v123, s[18:19] offset:1536 sc1
    global_load_dword v7, v123, s[18:19] offset:1792 sc1
    v_mov_b64 v[64:65], 0
    v_mov_b64 v[66:67], 0
    v_mov_b64 v[68:69], 0
    v_mov_b64 v[70:71], 0
    s_waitcnt vmcnt(4)
    v_mfma_f32_16x16x32_bf16 v[24:27], v[104:107], v[0:3], 0
    v_max3_u32 v28, v0, v1, v2
    s_waitcnt vmcnt(0)
    v_mfma_f32_16x16x32_bf16 v[24:27], v[104:107], v[4:7], v[24:27]
    v_max3_u32 v29, v4, v5, v6
    v_max3_u32 v28, v28, v3, v7
    v_cmp_u_f32 vcc, v28, v29
    s_nop 4
    v_cvt_pk_bf16_f32 v114, v24, v24
    s_cbranch_vccnz Lpf_128
Lpj_129:
    global_store_short v120, v114, s[12:13]
    s_cmp_eq_u32 s26, 63
    s_cbranch_scc1 Llast_101
    s_add_u32 s40, s26, 1
    s_lshr_b32 s40, s40, 1
    s_min_u32 s40, s40, 31
    v_cmp_ge_u32 vcc, s40, v116
    v_xor_b32 v112, 8, v109
    ds_read_b64 v[90:91], v109 offset:23552
    ds_read_b64 v[88:89], v112 offset:22528
    ds_read_b64 v[94:95], v109 offset:24064
    ds_read_b64 v[92:93], v112 offset:23040
    ds_read_b128 v[56:59], v111 offset:20480
    ds_read_b128 v[60:63], v111 offset:21504
    s_cbranch_vccnz Lkf_131
Lkr_132:
    v_mov_b64 v[72:73], 0
    v_mov_b64 v[74:75], 0
    v_mov_b64 v[76:77], 0
    v_mov_b64 v[78:79], 0
    v_mov_b64 v[80:81], 0
    v_mov_b64 v[82:83], 0
    v_mov_b64 v[84:85], 0
    v_mov_b64 v[86:87], 0
    s_waitcnt lgkmcnt(2)
    v_swap_b32 v89, v90
    v_swap_b32 v93, v94
    s_waitcnt vmcnt(0)
    global_load_lds_dwordx4 v127, s[12:13] sc1
    global_load_lds_dwordx4 v127, s[12:13] offset:2048 sc1
    s_barrier
    ds_read_b128 v[0:3], v118 offset:0
    ds_read_b128 v[4:7], v118 offset:2048
    global_load_lds_dwordx4 v127, s[12:13] sc1
    global_load_lds_dwordx4 v127, s[12:13] offset:2048 sc1
    s_waitcnt lgkmcnt(1)
    v_smfmac_f32_16x16x64_bf16 v[64:67], v[0:3], v[128:135], v117
    ds_read_b128 v[24:27], v118 offset:0
    ds_read_b128 v[8:11], v118 offset:1024
    s_waitcnt lgkmcnt(2)
    v_smfmac_f32_16x16x64_bf16 v[64:67], v[4:7], v[144:151], v117
    ds_read_b128 v[28:31], v118 offset:2048
    ds_read_b128 v[12:15], v118 offset:3072
    v_cmp_u_f32 vcc, v0, v4
    v_smfmac_f32_16x16x64_bf16 v[68:71], v[0:3], v[136:143], v117
    v_smfmac_f32_16x16x64_bf16 v[68:71], v[4:7], v[152:159], v117
    s_cbranch_vccnz Lfa_133
    global_store_short v120, v108, s[10:11]
    s_mov_b32 m0, 20480
    v_smfmac_f32_16x16x64_bf16 v[72:75], v[0:3], v[32:39], v117
    global_load_lds_dwordx4 v118, s[22:23] offset:0 sc1
    v_smfmac_f32_16x16x64_bf16 v[72:75], v[4:7], v[40:47], v117
    ds_read_b128 v[16:19], v118 offset:4096
    s_waitcnt lgkmcnt(1)
    v_cmp_u_f32 vcc, v8, v12
    v_smfmac_f32_16x16x64_bf16 v[76:79], v[0:3], v[48:55], v117
    global_store_short v120, v114, s[24:25] sc1
    ds_read_b128 v[20:23], v118 offset:6144
    v_smfmac_f32_16x16x64_bf16 v[76:79], v[4:7], v[96:103], v117
    s_cbranch_vccnz Lfs_138
Lbk_139:
Lqj_137:
    v_smfmac_f32_16x16x64_bf16 v[64:67], v[8:11], v[160:167], v117
    ds_read_b128 v[96:99], v125 offset:12288
    ds_read_b128 v[44:47], v125 offset:15360
    v_and_b32 v116, 12, v123
    v_smfmac_f32_16x16x64_bf16 v[64:67], v[12:15], v[176:183], v117
    global_load_lds_dwordx4 v118, s[22:23] offset:1024 sc1
    ds_read_b128 v[100:103], v125 offset:13312
    v_smfmac_f32_16x16x64_bf16 v[68:71], v[8:11], v[168:175], v117
    ds_read_b128 v[24:27], v118 offset:5120
    s_waitcnt lgkmcnt(4)
    v_cmp_u_f32 vcc, v16, v20
    v_smfmac_f32_16x16x64_bf16 v[68:71], v[12:15], v[184:191], v117
    ds_read_b128 v[28:31], v118 offset:7168
    ds_read_b128 v[40:43], v125 offset:14336
    v_smfmac_f32_16x16x64_bf16 v[72:75], v[8:11], a[0:7], v117
    s_cbranch_vccnz Lfs_151
Lbk_152:
    ds_read_b128 v[32:35], v125 offset:20480
    v_smfmac_f32_16x16x64_bf16 v[64:67], v[16:19], v[192:199], v117
    s_add_u32 s24, s24, 8192
    s_addc_u32 s25, s25, 0
    ds_read_b128 v[36:39], v125 offset:21504
    v_smfmac_f32_16x16x64_bf16 v[64:67], v[20:23], v[208:215], v117
    global_load_lds_dwordx4 v118, s[22:23] offset:2048 sc1
    ds_read_b128 v[48:51], v125 offset:22528
    v_smfmac_f32_16x16x64_bf16 v[68:71], v[16:19], v[200:207], v117
    s_add_u32 s26, s26, 1
    s_waitcnt lgkmcnt(4)
    v_cmp_u_f32 vcc, v24, v28
    v_smfmac_f32_16x16x64_bf16 v[68:71], v[20:23], v[216:223], v117
    global_load_dword v116, v116, s[36:37] offset:12 sc1
    ds_read_b128 v[52:55], v125 offset:23552
    v_smfmac_f32_16x16x64_bf16 v[72:75], v[16:19], v[96:103], v117
    s_cbranch_vccnz Lfs_154
Lbk_155:
    v_smfmac_f32_16x16x64_bf16 v[64:67], v[24:27], v[224:231], v117
    s_mov_b64 vcc, s[64:65]
    v_smfmac_f32_16x16x64_bf16 v[64:67], v[28:31], v[240:247], v117
    global_load_lds_dwordx4 v118, s[22:23] offset:3072 sc1
    v_smfmac_f32_16x16x64_bf16 v[68:71], v[24:27], v[232:239], v117
    s_add_u32 s22, s22, 524288
    s_addc_u32 s23, s23, 0
    v_smfmac_f32_16x16x64_bf16 v[68:71], v[28:31], v[248:255], v117
    s_waitcnt lgkmcnt(2)
    v_add_f32 v64, v64, v66
    v_smfmac_f32_16x16x64_bf16 v[72:75], v[20:23], v[32:39], v117
    ds_read_b128 v[32:35], v125 offset:24576
    v_add_f32 v65, v65, v67
    v_smfmac_f32_16x16x64_bf16 v[72:75], v[12:15], a[16:23], v117
    ds_read_b128 v[36:39], v125 offset:25600
    v_cvt_pk_bf16_f32 v102, v64, v65
    v_add_f32 v68, v68, v70
    v_smfmac_f32_16x16x64_bf16 v[72:75], v[24:27], a[32:39], v117
    ds_write_b32 v121, v102 offset:9216
    v_add_f32 v69, v69, v71
    v_cvt_pk_bf16_f32 v103, v68, v69
    v_smfmac_f32_16x16x64_bf16 v[72:75], v[28:31], a[48:55], v117
    ds_write_b32 v121, v103 offset:9728
    v_smfmac_f32_16x16x64_bf16 v[76:79], v[16:19], v[40:47], v117
    ds_read_b128 v[40:43], v125 offset:26624
    s_waitcnt lgkmcnt(5)
    v_smfmac_f32_16x16x64_bf16 v[76:79], v[20:23], v[48:55], v117
    ds_read_b128 v[44:47], v125 offset:27648
    v_add_f32 v72, v72, v74
    v_smfmac_f32_16x16x64_bf16 v[76:79], v[8:11], a[8:15], v117
    ds_read_b128 v[48:51], v125 offset:4096
    v_smfmac_f32_16x16x64_bf16 v[76:79], v[12:15], a[24:31], v117
    s_waitcnt lgkmcnt(3)
    s_barrier
    v_smfmac_f32_16x16x64_bf16 v[76:79], v[24:27], a[40:47], v117
    ds_read_b64_tr_b16 v[64:65], v122 offset:8192
    ds_read_b64_tr_b16 v[66:67], v122 offset:8704
    v_smfmac_f32_16x16x64_bf16 v[76:79], v[28:31], a[56:63], v117
    ds_read_b64_tr_b16 v[68:69], v122 offset:9216
    ds_read_b64_tr_b16 v[70:71], v122 offset:9728
    v_add_f32 v73, v73, v75
    v_cvt_pk_bf16_f32 v100, v72, v73
    v_smfmac_f32_16x16x64_bf16 v[80:83], v[0:3], a[64:71], v117
    ds_write_b32 v121, v100 offset:11264
    v_smfmac_f32_16x16x64_bf16 v[84:87], v[0:3], a[72:79], v117
    s_waitcnt lgkmcnt(3)
    ds_read_b128 v[52:55], v125 offset:5120
    v_add_f32 v76, v76, v78
    v_mfma_f32_16x16x32_bf16 v[96:99], v[56:59], v[64:67], 0
    s_waitcnt lgkmcnt(2)
    v_add_f32 v77, v77, v79
    v_cvt_pk_bf16_f32 v101, v76, v77
    v_mfma_f32_16x16x32_bf16 v[96:99], v[60:63], v[68:71], v[96:99]
    ds_write_b32 v121, v101 offset:11776
    v_smfmac_f32_16x16x64_bf16 v[80:83], v[4:7], a[80:87], v117
    s_mov_b32 exec_hi, 0
    global_store_dword v110, v108, s[18:19]
    s_mov_b32 exec_hi, -1
    v_smfmac_f32_16x16x64_bf16 v[84:87], v[4:7], a[88:95], v117
    v_add_f32_dpp v98, v96, v98 quad_perm:[0,1,0,1] row_mask:0xf bank_mask:0xf
    v_add_f32_dpp v99, v97, v99 quad_perm:[0,1,0,1] row_mask:0xf bank_mask:0xf
    v_smfmac_f32_16x16x64_bf16 v[80:83], v[8:11], a[96:103], v117
    ds_write_b64 v109, v[98:99] offset:12800
    v_smfmac_f32_16x16x64_bf16 v[84:87], v[8:11], a[104:111], v117
    s_waitcnt lgkmcnt(1)
    s_barrier
    v_smfmac_f32_16x16x64_bf16 v[80:83], v[12:15], a[112:119], v117
    s_waitcnt vmcnt(8)
    ds_read_b64_tr_b16 v[72:73], v122 offset:10240
    ds_read_b64_tr_b16 v[74:75], v122 offset:10752
    v_smfmac_f32_16x16x64_bf16 v[84:87], v[12:15], a[120:127], v117
    ds_read_b64_tr_b16 v[76:77], v122 offset:11264
    ds_read_b64_tr_b16 v[78:79], v122 offset:11776
    v_smfmac_f32_16x16x64_bf16 v[80:83], v[16:19], a[128:135], v117
    ds_read_b128 v[8:11], v125 offset:18432
    v_smfmac_f32_16x16x64_bf16 v[84:87], v[16:19], a[136:143], v117
    s_waitcnt lgkmcnt(5)
    s_barrier
    s_waitcnt lgkmcnt(3)
    v_mfma_f32_16x16x32_bf16 v[0:3], v[72:75], v[64:67], 0
    ds_read_b128 v[56:59], v124 offset:12288
    s_waitcnt lgkmcnt(2)
    v_mfma_f32_16x16x32_bf16 v[0:3], v[76:79], v[68:71], v[0:3]
    ds_read_b128 v[12:15], v125 offset:19456
    v_smfmac_f32_16x16x64_bf16 v[80:83], v[20:23], a[144:151], v117
    ds_write_b32 v118, v108 offset:1024
    v_smfmac_f32_16x16x64_bf16 v[84:87], v[20:23], a[152:159], v117
    ds_write_b32 v118, v108 offset:3072
    v_add_f32_dpp v2, v0, v2 quad_perm:[0,1,0,1] row_mask:0xf bank_mask:0xf
    v_smfmac_f32_16x16x64_bf16 v[80:83], v[24:27], a[160:167], v117
    s_waitcnt lgkmcnt(3)
    v_max3_f32 v60, v56, v57, v58
    v_add_f32_dpp v3, v1, v3 quad_perm:[0,1,0,1] row_mask:0xf bank_mask:0xf
    v_smfmac_f32_16x16x64_bf16 v[84:87], v[24:27], a[168:175], v117
    v_max_f32 v60, v60, v59
    v_smfmac_f32_16x16x64_bf16 v[80:83], v[28:31], v[32:39], v117
    s_nop 0
    v_max_f32_dpp v60, v60, v60 quad_perm:[2,3,0,1] row_mask:0xf bank_mask:0xf
    v_smfmac_f32_16x16x64_bf16 v[84:87], v[28:31], v[40:47], v117
    v_max3_f32 v61, v60, v2, v3
    v_max3_f32 v62, v60, v2, v3
    v_mov_b64 v[64:65], 0
    v_mov_b64 v[66:67], 0
    v_permlane16_swap_b32 v61, v62
    v_max_f32 v60, v61, v62
    v_max_f32 v63, v61, v62
    v_pk_add_f32 v[80:81], v[80:81], v[82:83]
    v_pk_add_f32 v[84:85], v[84:85], v[86:87]
    v_permlane32_swap_b32 v60, v63
    v_max_f32 v61, v60, v63
    v_cvt_pk_bf16_f32 v114, v80, v81
    v_cvt_pk_bf16_f32 v115, v84, v85
    v_mul_f32_dpp v62, v61, v126 quad_perm:[2,3,2,3] row_mask:0xf bank_mask:0xf
    v_pk_fma_f32 v[2:3], v[2:3], s[28:29], v[62:63] op_sel_hi:[1,1,0]
    v_pk_fma_f32 v[56:57], v[56:57], s[28:29], v[62:63] op_sel_hi:[1,1,0]
    v_exp_f32 v2, v2
    v_exp_f32 v3, v3
    v_pk_fma_f32 v[58:59], v[58:59], s[28:29], v[62:63] op_sel_hi:[1,1,0]
    v_cvt_pk_bf16_f32 v80, v2, v3
    v_exp_f32 v56, v56
    v_cndmask_b32 v5, v113, v80, vcc
    v_cndmask_b32_dpp v4, v80, v113, vcc quad_perm:[2,3,2,3] row_mask:0xf bank_mask:0xf
    v_exp_f32 v57, v57
    v_exp_f32 v58, v58
    v_mfma_f32_16x16x16_bf16 v[76:79], v[4:5], v[104:105], 0
    v_cvt_pk_bf16_f32 v84, v56, v57
    v_exp_f32 v59, v59
    v_mfma_f32_16x16x16_bf16 v[72:75], v[4:5], v[114:115], 0
    v_cvt_pk_bf16_f32 v85, v58, v59
    v_mov_b32_dpp v86, v84 quad_perm:[2,3,0,1] row_mask:0xf bank_mask:0xf
    v_mov_b64 v[68:69], 0
    v_mov_b32_dpp v87, v85 quad_perm:[2,3,0,1] row_mask:0xf bank_mask:0xf
    v_mov_b64 v[70:71], 0
    v_mov_b64 v[80:81], 0
    v_mfma_f32_16x16x32_bf16 v[76:79], v[84:87], v[104:107], v[76:79]
    ds_read_b128 v[32:35], v125 offset:6144
    v_smfmac_f32_16x16x64_bf16 v[72:75], v[84:87], v[88:95], v117
    ds_read_b128 v[36:39], v125 offset:7168
    s_nop 2
    v_rcp_f32_dpp v60, v76 quad_perm:[2,3,2,3] row_mask:0xf bank_mask:0xf
    v_rcp_f32_dpp v61, v77 quad_perm:[2,3,2,3] row_mask:0xf bank_mask:0xf
    s_nop 1
    v_pk_mul_f32 v[72:73], v[72:73], v[60:61]
    v_pk_mul_f32 v[74:75], v[74:75], v[60:61]
    v_cvt_pk_bf16_f32 v56, v72, v73
    v_cvt_pk_bf16_f32 v57, v74, v75
    ds_write_b64 v121, v[56:57] offset:14848
    v_mov_b64 v[82:83], 0
    v_mov_b64 v[84:85], 0
    v_mov_b64 v[86:87], 0
    v_mov_b64 v[72:73], 0
    v_mov_b64 v[74:75], 0
    v_mov_b64 v[76:77], 0
    v_mov_b64 v[78:79], 0
    v_mov_b64 v[88:89], 0
    v_mov_b64 v[90:91], 0
    v_mov_b64 v[92:93], 0
    v_mov_b64 v[94:95], 0
    s_waitcnt vmcnt(7)
    s_waitcnt lgkmcnt(0)
    s_barrier
    ds_read_b64_tr_b16 v[96:97], v122 offset:14336
    ds_read_b64_tr_b16 v[98:99], v122 offset:14848
    ds_read_b64_tr_b16 v[100:101], v122 offset:15360
    ds_read_b64_tr_b16 v[102:103], v122 offset:15872
    ds_read_b128 v[40:43], v125 offset:16384
    ds_read_b128 v[44:47], v125 offset:17408
    s_waitcnt lgkmcnt(4)
    v_smfmac_f32_16x16x64_bf16 v[72:75], v[96:99], a[176:183], v117
    ds_read_b128 v[24:27], v125 offset:28672
    s_waitcnt lgkmcnt(3)
    v_smfmac_f32_16x16x64_bf16 v[72:75], v[100:103], a[192:199], v117
    ds_read_b128 v[28:31], v125 offset:29696
    v_smfmac_f32_16x16x64_bf16 v[76:79], v[96:99], a[184:191], v117
    ds_read_b128 v[56:59], v125 offset:30720
    v_smfmac_f32_16x16x64_bf16 v[76:79], v[100:103], a[200:207], v117
    ds_read_b128 v[60:63], v125 offset:31744
    v_add_f32 v72, v72, v74
    v_add_f32 v73, v73, v75
    v_cvt_pk_bf16_f32 v72, v72, v73
    v_smfmac_f32_16x16x64_bf16 v[80:83], v[96:99], a[208:215], v117
    global_store_dword v119, v72, s[16:17] offset:-4096
    s_nop 1
    v_add_f32 v76, v76, v78
    v_add_f32 v77, v77, v79
    v_cvt_pk_bf16_f32 v76, v76, v77
    v_smfmac_f32_16x16x64_bf16 v[80:83], v[100:103], a[224:231], v117
    global_store_dword v119, v76, s[32:33] offset:-4096
    v_smfmac_f32_16x16x64_bf16 v[84:87], v[96:99], a[216:223], v117
    v_smfmac_f32_16x16x64_bf16 v[84:87], v[100:103], a[232:239], v117
    v_add_f32 v80, v80, v82
    v_smfmac_f32_16x16x64_bf16 v[64:67], v[96:99], a[240:247], v117
    v_add_f32 v81, v81, v83
    v_cvt_pk_bf16_f32 v80, v80, v81
    v_smfmac_f32_16x16x64_bf16 v[64:67], v[100:103], v[48:55], v117
    global_store_dword v119, v80, s[16:17] offset:-2048
    v_add_f32 v84, v84, v86
    v_smfmac_f32_16x16x64_bf16 v[68:71], v[96:99], a[248:255], v117
    v_add_f32 v85, v85, v87
    v_cvt_pk_bf16_f32 v84, v84, v85
    v_smfmac_f32_16x16x64_bf16 v[68:71], v[100:103], v[32:39], v117
    s_waitcnt lgkmcnt(4)
    global_store_dword v119, v84, s[32:33] offset:-2048
    v_add_f32 v64, v64, v66
    v_smfmac_f32_16x16x64_bf16 v[88:91], v[96:99], v[40:47], v117
    s_waitcnt lgkmcnt(2)
    v_add_f32 v65, v65, v67
    v_cvt_pk_bf16_f32 v64, v64, v65
    v_smfmac_f32_16x16x64_bf16 v[88:91], v[100:103], v[24:31], v117
    global_store_dword v119, v64, s[16:17] offset:0
    v_add_f32 v68, v68, v70
    v_smfmac_f32_16x16x64_bf16 v[92:95], v[96:99], v[8:15], v117
    s_waitcnt lgkmcnt(0)
    v_add_f32 v69, v69, v71
    v_cvt_pk_bf16_f32 v68, v68, v69
    v_smfmac_f32_16x16x64_bf16 v[92:95], v[100:103], v[56:63], v117
    global_store_dword v119, v68, s[32:33] offset:0
    v_add_f32 v88, v88, v90
    v_add_f32 v89, v89, v91
    v_cvt_pk_bf16_f32 v88, v88, v89
    global_store_dword v119, v88, s[16:17] offset:2048
    s_mov_b32 m0, 1024
    ds_read_b128 v[32:35], v125 offset:0
    ds_read_b128 v[36:39], v125 offset:1024
    v_add_f32 v92, v92, v94
    v_add_f32 v93, v93, v95
    v_cvt_pk_bf16_f32 v92, v92, v93
    global_store_dword v119, v92, s[32:33] offset:2048
    s_barrier
    ds_read_b128 v[40:43], v125 offset:8192
    ds_read_b128 v[44:47], v125 offset:9216
    ds_read_b128 v[48:51], v125 offset:2048
    ds_read_b128 v[52:55], v125 offset:3072
    ds_read_b128 v[96:99], v125 offset:10240
    ds_read_b128 v[100:103], v125 offset:11264
    global_load_dword v0, v123, s[20:21] offset:0 sc1
    global_load_dword v1, v123, s[20:21] offset:256 sc1
    global_load_dword v2, v123, s[20:21] offset:512 sc1
    global_load_dword v3, v123, s[20:21] offset:768 sc1
    global_load_dword v4, v123, s[20:21] offset:1024 sc1
    global_load_dword v5, v123, s[20:21] offset:1280 sc1
    global_load_dword v6, v123, s[20:21] offset:1536 sc1
    global_load_dword v7, v123, s[20:21] offset:1792 sc1
    v_mov_b64 v[64:65], 0
    v_mov_b64 v[66:67], 0
    v_mov_b64 v[68:69], 0
    v_mov_b64 v[70:71], 0
    s_waitcnt vmcnt(4)
    v_mfma_f32_16x16x32_bf16 v[24:27], v[104:107], v[0:3], 0
    v_max3_u32 v28, v0, v1, v2
    s_waitcnt vmcnt(0)
    v_mfma_f32_16x16x32_bf16 v[24:27], v[104:107], v[4:7], v[24:27]
    v_max3_u32 v29, v4, v5, v6
    v_max3_u32 v28, v28, v3, v7
    v_cmp_u_f32 vcc, v28, v29
    s_nop 4
    v_cvt_pk_bf16_f32 v114, v24, v24
    s_cbranch_vccnz Lpf_157
Lpj_158:
    global_store_short v120, v114, s[10:11]
    s_branch Lhl1_100
Llast_101:
    global_store_short v120, v114, s[24:25] sc1
    s_branch L_fin
Lfa_104:
    s_waitcnt lgkmcnt(1)
    ds_read_b128 v[0:3], v118 offset:0
    ds_read_b128 v[4:7], v118 offset:2048
    global_load_lds_dwordx4 v127, s[10:11] sc1
    global_load_lds_dwordx4 v127, s[10:11] offset:2048 sc1
Lqb_106:
    ds_read_b128 v[8:11], v118 offset:1024
    ds_read_b128 v[12:15], v118 offset:3072
    v_smfmac_f32_16x16x64_bf16 v[72:75], v[24:27], v[32:39], v117
    v_max_u32 v112, v24, v28
    v_cmp_eq_u32 vcc, -1, v112
    v_smfmac_f32_16x16x64_bf16 v[72:75], v[28:31], v[40:47], v117
    v_smfmac_f32_16x16x64_bf16 v[76:79], v[24:27], v[48:55], v117
    s_cbranch_vccnz Lfb_105
    v_mov_b64 v[64:65], 0
    v_mov_b64 v[66:67], 0
    v_smfmac_f32_16x16x64_bf16 v[76:79], v[28:31], v[96:103], v117
    global_store_short v120, v108, s[12:13]
    s_mov_b32 m0, 20480
    v_mov_b64 v[68:69], 0
    v_mov_b64 v[70:71], 0
    v_smfmac_f32_16x16x64_bf16 v[64:67], v[24:27], v[128:135], v117
    global_load_lds_dwordx4 v118, s[22:23] offset:0 sc1
    v_smfmac_f32_16x16x64_bf16 v[64:67], v[28:31], v[144:151], v117
    ds_read_b128 v[16:19], v118 offset:4096
    s_waitcnt lgkmcnt(1)
    v_cmp_u_f32 vcc, v8, v12
    v_smfmac_f32_16x16x64_bf16 v[68:71], v[24:27], v[136:143], v117
    global_store_short v120, v114, s[24:25] sc1
    ds_read_b128 v[20:23], v118 offset:6144
    v_smfmac_f32_16x16x64_bf16 v[68:71], v[28:31], v[152:159], v117
    s_cbranch_vccnz Lfs_113
Lbk_114:
    s_branch Lqj_108
Lfb_105:
    v_mov_b64 v[64:65], 0
    v_mov_b64 v[66:67], 0
    v_mov_b64 v[68:69], 0
    v_mov_b64 v[70:71], 0
    v_mov_b64 v[72:73], 0
    v_mov_b64 v[74:75], 0
    s_nop 0
    v_mov_b64 v[76:77], 0
    v_mov_b64 v[78:79], 0
Lr0_117:
    ds_read_b128 v[24:27], v118 offset:0
    ds_read_b128 v[28:31], v118 offset:2048
    global_load_lds_dwordx4 v127, s[10:11] sc1
    global_load_lds_dwordx4 v127, s[10:11] offset:2048 sc1
    s_waitcnt lgkmcnt(2)
    v_max_u32 v112, v0, v4
    v_cmp_eq_u32 vcc, -1, v112
    s_cbranch_vccz Lqa_107
    ds_read_b128 v[0:3], v118 offset:0
    ds_read_b128 v[4:7], v118 offset:2048
    global_load_lds_dwordx4 v127, s[10:11] sc1
    global_load_lds_dwordx4 v127, s[10:11] offset:2048 sc1
    s_waitcnt lgkmcnt(2)
    v_max_u32 v112, v24, v28
    v_cmp_eq_u32 vcc, -1, v112
    s_cbranch_vccz Lqb_106
    s_sub_u32 s27, s27, 1
    s_cbranch_scc0 Lr0_117
    s_branch L_fin
Lqa_107:
    ds_read_b128 v[8:11], v118 offset:1024
    ds_read_b128 v[12:15], v118 offset:3072
    v_smfmac_f32_16x16x64_bf16 v[64:67], v[0:3], v[128:135], v117
    v_smfmac_f32_16x16x64_bf16 v[64:67], v[4:7], v[144:151], v117
    v_smfmac_f32_16x16x64_bf16 v[68:71], v[0:3], v[136:143], v117
    v_smfmac_f32_16x16x64_bf16 v[68:71], v[4:7], v[152:159], v117
    global_store_short v120, v108, s[12:13]
    s_mov_b32 m0, 20480
    v_smfmac_f32_16x16x64_bf16 v[72:75], v[0:3], v[32:39], v117
    global_load_lds_dwordx4 v118, s[22:23] offset:0 sc1
    v_smfmac_f32_16x16x64_bf16 v[72:75], v[4:7], v[40:47], v117
    ds_read_b128 v[16:19], v118 offset:4096
    s_waitcnt lgkmcnt(1)
    v_cmp_u_f32 vcc, v8, v12
    v_smfmac_f32_16x16x64_bf16 v[76:79], v[0:3], v[48:55], v117
    global_store_short v120, v114, s[24:25] sc1
    ds_read_b128 v[20:23], v118 offset:6144
    v_smfmac_f32_16x16x64_bf16 v[76:79], v[4:7], v[96:103], v117
    s_cbranch_vccnz Lfs_118
Lbk_119:
    s_branch Lqj_108
Lpf_128:
    global_load_dword v16, v123, s[18:19] offset:0 sc1
    global_load_dword v17, v123, s[18:19] offset:256 sc1
    global_load_dword v18, v123, s[18:19] offset:512 sc1
    global_load_dword v19, v123, s[18:19] offset:768 sc1
    global_load_dword v20, v123, s[18:19] offset:1024 sc1
    global_load_dword v21, v123, s[18:19] offset:1280 sc1
    global_load_dword v22, v123, s[18:19] offset:1536 sc1
    global_load_dword v23, v123, s[18:19] offset:1792 sc1
    global_load_dword v8, v123, s[18:19] offset:0 sc1
    global_load_dword v9, v123, s[18:19] offset:256 sc1
    global_load_dword v10, v123, s[18:19] offset:512 sc1
    global_load_dword v11, v123, s[18:19] offset:768 sc1
    global_load_dword v12, v123, s[18:19] offset:1024 sc1
    global_load_dword v13, v123, s[18:19] offset:1280 sc1
    global_load_dword v14, v123, s[18:19] offset:1536 sc1
    global_load_dword v15, v123, s[18:19] offset:1792 sc1
    s_waitcnt vmcnt(12)
    v_mfma_f32_16x16x32_bf16 v[24:27], v[104:107], v[16:19], 0
    v_max3_u32 v28, v16, v17, v18
    s_waitcnt vmcnt(8)
    v_mfma_f32_16x16x32_bf16 v[24:27], v[104:107], v[20:23], v[24:27]
    v_max3_u32 v29, v20, v21, v22
    v_max3_u32 v28, v28, v19, v23
    v_max_u32 v28, v28, v29
    v_cmp_eq_u32 vcc, -1, v28
    s_nop 3
    v_cvt_pk_bf16_f32 v114, v24, v24
    s_cbranch_vccz Lpj_129
Lpl_130:
    global_load_dword v16, v123, s[18:19] offset:0 sc1
    global_load_dword v17, v123, s[18:19] offset:256 sc1
    global_load_dword v18, v123, s[18:19] offset:512 sc1
    global_load_dword v19, v123, s[18:19] offset:768 sc1
    global_load_dword v20, v123, s[18:19] offset:1024 sc1
    global_load_dword v21, v123, s[18:19] offset:1280 sc1
    global_load_dword v22, v123, s[18:19] offset:1536 sc1
    global_load_dword v23, v123, s[18:19] offset:1792 sc1
    s_waitcnt vmcnt(12)
    v_mfma_f32_16x16x32_bf16 v[24:27], v[104:107], v[8:11], 0
    v_max3_u32 v28, v8, v9, v10
    s_waitcnt vmcnt(8)
    v_mfma_f32_16x16x32_bf16 v[24:27], v[104:107], v[12:15], v[24:27]
    v_max3_u32 v29, v12, v13, v14
    v_max3_u32 v28, v28, v11, v15
    v_max_u32 v28, v28, v29
    v_cmp_eq_u32 vcc, -1, v28
    s_nop 3
    v_cvt_pk_bf16_f32 v114, v24, v24
    s_cbranch_vccz Lpj_129
    global_load_dword v8, v123, s[18:19] offset:0 sc1
    global_load_dword v9, v123, s[18:19] offset:256 sc1
    global_load_dword v10, v123, s[18:19] offset:512 sc1
    global_load_dword v11, v123, s[18:19] offset:768 sc1
    global_load_dword v12, v123, s[18:19] offset:1024 sc1
    global_load_dword v13, v123, s[18:19] offset:1280 sc1
    global_load_dword v14, v123, s[18:19] offset:1536 sc1
    global_load_dword v15, v123, s[18:19] offset:1792 sc1
    s_waitcnt vmcnt(12)
    v_mfma_f32_16x16x32_bf16 v[24:27], v[104:107], v[16:19], 0
    v_max3_u32 v28, v16, v17, v18
    s_waitcnt vmcnt(8)
    v_mfma_f32_16x16x32_bf16 v[24:27], v[104:107], v[20:23], v[24:27]
    v_max3_u32 v29, v20, v21, v22
    v_max3_u32 v28, v28, v19, v23
    v_max_u32 v28, v28, v29
    v_cmp_eq_u32 vcc, -1, v28
    s_nop 3
    v_cvt_pk_bf16_f32 v114, v24, v24
    s_cbranch_vccz Lpj_129
    s_sub_u32 s27, s27, 1
    s_cbranch_scc0 Lpl_130
    s_branch L_fin
Lfa_133:
    s_waitcnt lgkmcnt(1)
    ds_read_b128 v[0:3], v118 offset:0
    ds_read_b128 v[4:7], v118 offset:2048
    global_load_lds_dwordx4 v127, s[12:13] sc1
    global_load_lds_dwordx4 v127, s[12:13] offset:2048 sc1
Lqb_135:
    ds_read_b128 v[8:11], v118 offset:1024
    ds_read_b128 v[12:15], v118 offset:3072
    v_smfmac_f32_16x16x64_bf16 v[72:75], v[24:27], v[32:39], v117
    v_max_u32 v112, v24, v28
    v_cmp_eq_u32 vcc, -1, v112
    v_smfmac_f32_16x16x64_bf16 v[72:75], v[28:31], v[40:47], v117
    v_smfmac_f32_16x16x64_bf16 v[76:79], v[24:27], v[48:55], v117
    s_cbranch_vccnz Lfb_134
    v_mov_b64 v[64:65], 0
    v_mov_b64 v[66:67], 0
    v_smfmac_f32_16x16x64_bf16 v[76:79], v[28:31], v[96:103], v117
    global_store_short v120, v108, s[10:11]
    s_mov_b32 m0, 20480
    v_mov_b64 v[68:69], 0
    v_mov_b64 v[70:71], 0
    v_smfmac_f32_16x16x64_bf16 v[64:67], v[24:27], v[128:135], v117
    global_load_lds_dwordx4 v118, s[22:23] offset:0 sc1
    v_smfmac_f32_16x16x64_bf16 v[64:67], v[28:31], v[144:151], v117
    ds_read_b128 v[16:19], v118 offset:4096
    s_waitcnt lgkmcnt(1)
    v_cmp_u_f32 vcc, v8, v12
    v_smfmac_f32_16x16x64_bf16 v[68:71], v[24:27], v[136:143], v117
    global_store_short v120, v114, s[24:25] sc1
    ds_read_b128 v[20:23], v118 offset:6144
    v_smfmac_f32_16x16x64_bf16 v[68:71], v[28:31], v[152:159], v117
    s_cbranch_vccnz Lfs_142
Lbk_143:
    s_branch Lqj_137
Lfb_134:
    v_mov_b64 v[64:65], 0
    v_mov_b64 v[66:67], 0
    v_mov_b64 v[68:69], 0
    v_mov_b64 v[70:71], 0
    v_mov_b64 v[72:73], 0
    v_mov_b64 v[74:75], 0
    s_nop 0
    v_mov_b64 v[76:77], 0
    v_mov_b64 v[78:79], 0
Lr0_146:
    ds_read_b128 v[24:27], v118 offset:0
    ds_read_b128 v[28:31], v118 offset:2048
    global_load_lds_dwordx4 v127, s[12:13] sc1
    global_load_lds_dwordx4 v127, s[12:13] offset:2048 sc1
    s_waitcnt lgkmcnt(2)
    v_max_u32 v112, v0, v4
    v_cmp_eq_u32 vcc, -1, v112
    s_cbranch_vccz Lqa_136
    ds_read_b128 v[0:3], v118 offset:0
    ds_read_b128 v[4:7], v118 offset:2048
    global_load_lds_dwordx4 v127, s[12:13] sc1
    global_load_lds_dwordx4 v127, s[12:13] offset:2048 sc1
    s_waitcnt lgkmcnt(2)
    v_max_u32 v112, v24, v28
    v_cmp_eq_u32 vcc, -1, v112
    s_cbranch_vccz Lqb_135
    s_sub_u32 s27, s27, 1
    s_cbranch_scc0 Lr0_146
    s_branch L_fin
Lqa_136:
    ds_read_b128 v[8:11], v118 offset:1024
    ds_read_b128 v[12:15], v118 offset:3072
    v_smfmac_f32_16x16x64_bf16 v[64:67], v[0:3], v[128:135], v117
    v_smfmac_f32_16x16x64_bf16 v[64:67], v[4:7], v[144:151], v117
    v_smfmac_f32_16x16x64_bf16 v[68:71], v[0:3], v[136:143], v117
    v_smfmac_f32_16x16x64_bf16 v[68:71], v[4:7], v[152:159], v117
    global_store_short v120, v108, s[10:11]
    s_mov_b32 m0, 20480
    v_smfmac_f32_16x16x64_bf16 v[72:75], v[0:3], v[32:39], v117
    global_load_lds_dwordx4 v118, s[22:23] offset:0 sc1
    v_smfmac_f32_16x16x64_bf16 v[72:75], v[4:7], v[40:47], v117
    ds_read_b128 v[16:19], v118 offset:4096
    s_waitcnt lgkmcnt(1)
    v_cmp_u_f32 vcc, v8, v12
    v_smfmac_f32_16x16x64_bf16 v[76:79], v[0:3], v[48:55], v117
    global_store_short v120, v114, s[24:25] sc1
    ds_read_b128 v[20:23], v118 offset:6144
    v_smfmac_f32_16x16x64_bf16 v[76:79], v[4:7], v[96:103], v117
    s_cbranch_vccnz Lfs_147
Lbk_148:
    s_branch Lqj_137
Lpf_157:
    global_load_dword v16, v123, s[20:21] offset:0 sc1
    global_load_dword v17, v123, s[20:21] offset:256 sc1
    global_load_dword v18, v123, s[20:21] offset:512 sc1
    global_load_dword v19, v123, s[20:21] offset:768 sc1
    global_load_dword v20, v123, s[20:21] offset:1024 sc1
    global_load_dword v21, v123, s[20:21] offset:1280 sc1
    global_load_dword v22, v123, s[20:21] offset:1536 sc1
    global_load_dword v23, v123, s[20:21] offset:1792 sc1
    global_load_dword v8, v123, s[20:21] offset:0 sc1
    global_load_dword v9, v123, s[20:21] offset:256 sc1
    global_load_dword v10, v123, s[20:21] offset:512 sc1
    global_load_dword v11, v123, s[20:21] offset:768 sc1
    global_load_dword v12, v123, s[20:21] offset:1024 sc1
    global_load_dword v13, v123, s[20:21] offset:1280 sc1
    global_load_dword v14, v123, s[20:21] offset:1536 sc1
    global_load_dword v15, v123, s[20:21] offset:1792 sc1
    s_waitcnt vmcnt(12)
    v_mfma_f32_16x16x32_bf16 v[24:27], v[104:107], v[16:19], 0
    v_max3_u32 v28, v16, v17, v18
    s_waitcnt vmcnt(8)
    v_mfma_f32_16x16x32_bf16 v[24:27], v[104:107], v[20:23], v[24:27]
    v_max3_u32 v29, v20, v21, v22
    v_max3_u32 v28, v28, v19, v23
    v_max_u32 v28, v28, v29
    v_cmp_eq_u32 vcc, -1, v28
    s_nop 3
    v_cvt_pk_bf16_f32 v114, v24, v24
    s_cbranch_vccz Lpj_158
Lpl_159:
    global_load_dword v16, v123, s[20:21] offset:0 sc1
    global_load_dword v17, v123, s[20:21] offset:256 sc1
    global_load_dword v18, v123, s[20:21] offset:512 sc1
    global_load_dword v19, v123, s[20:21] offset:768 sc1
    global_load_dword v20, v123, s[20:21] offset:1024 sc1
    global_load_dword v21, v123, s[20:21] offset:1280 sc1
    global_load_dword v22, v123, s[20:21] offset:1536 sc1
    global_load_dword v23, v123, s[20:21] offset:1792 sc1
    s_waitcnt vmcnt(12)
    v_mfma_f32_16x16x32_bf16 v[24:27], v[104:107], v[8:11], 0
    v_max3_u32 v28, v8, v9, v10
    s_waitcnt vmcnt(8)
    v_mfma_f32_16x16x32_bf16 v[24:27], v[104:107], v[12:15], v[24:27]
    v_max3_u32 v29, v12, v13, v14
    v_max3_u32 v28, v28, v11, v15
    v_max_u32 v28, v28, v29
    v_cmp_eq_u32 vcc, -1, v28
    s_nop 3
    v_cvt_pk_bf16_f32 v114, v24, v24
    s_cbranch_vccz Lpj_158
    global_load_dword v8, v123, s[20:21] offset:0 sc1
    global_load_dword v9, v123, s[20:21] offset:256 sc1
    global_load_dword v10, v123, s[20:21] offset:512 sc1
    global_load_dword v11, v123, s[20:21] offset:768 sc1
    global_load_dword v12, v123, s[20:21] offset:1024 sc1
    global_load_dword v13, v123, s[20:21] offset:1280 sc1
    global_load_dword v14, v123, s[20:21] offset:1536 sc1
    global_load_dword v15, v123, s[20:21] offset:1792 sc1
    s_waitcnt vmcnt(12)
    v_mfma_f32_16x16x32_bf16 v[24:27], v[104:107], v[16:19], 0
    v_max3_u32 v28, v16, v17, v18
    s_waitcnt vmcnt(8)
    v_mfma_f32_16x16x32_bf16 v[24:27], v[104:107], v[20:23], v[24:27]
    v_max3_u32 v29, v20, v21, v22
    v_max3_u32 v28, v28, v19, v23
    v_max_u32 v28, v28, v29
    v_cmp_eq_u32 vcc, -1, v28
    s_nop 3
    v_cvt_pk_bf16_f32 v114, v24, v24
    s_cbranch_vccz Lpj_158
    s_sub_u32 s27, s27, 1
    s_cbranch_scc0 Lpl_159
    s_branch L_fin
Lkf_102:
    v_and_b32 v116, 12, v123
    global_load_dword v116, v116, s[36:37] offset:12 sc1
    s_sub_u32 s27, s27, 1
    s_cbranch_scc1 L_fin
    s_waitcnt vmcnt(0)
    v_cmp_ge_u32 vcc, s40, v116
    s_cbranch_vccnz Lkf_102
    s_branch Lkr_103
Lfs_109:
Lfl_111:
    ds_read_b128 v[8:11], v118 offset:1024
    ds_read_b128 v[12:15], v118 offset:3072
    s_sub_u32 s27, s27, 1
    s_waitcnt lgkmcnt(0)
    v_max_u32 v112, v8, v12
    v_cmp_eq_u32 vcc, -1, v112
    s_cbranch_vccz Lbk_110
    s_waitcnt vmcnt(3)
    ds_read_b128 v[8:11], v118 offset:1024
    ds_read_b128 v[12:15], v118 offset:3072
    s_sub_u32 s27, s27, 1
    s_waitcnt lgkmcnt(0)
    v_max_u32 v112, v8, v12
    v_cmp_eq_u32 vcc, -1, v112
    s_cbranch_vccz Lbk_110
Lfl_112:
    s_mov_b32 s40, m0
    s_mov_b32 m0, 1024
    s_nop 0
    global_load_lds_dwordx4 v127, s[10:11] sc1
    global_load_lds_dwordx4 v127, s[10:11] offset:2048 sc1
    s_waitcnt vmcnt(0)
    s_mov_b32 m0, s40
    ds_read_b128 v[8:11], v118 offset:1024
    ds_read_b128 v[12:15], v118 offset:3072
    s_sub_u32 s27, s27, 1
    s_waitcnt lgkmcnt(0)
    v_max_u32 v112, v8, v12
    v_cmp_eq_u32 vcc, -1, v112
    s_cbranch_vccz Lbk_110
    s_cbranch_scc0 Lfl_112
    s_branch L_fin
Lfs_113:
Lfl_115:
    ds_read_b128 v[8:11], v118 offset:1024
    ds_read_b128 v[12:15], v118 offset:3072
    s_sub_u32 s27, s27, 1
    s_waitcnt lgkmcnt(0)
    v_max_u32 v112, v8, v12
    v_cmp_eq_u32 vcc, -1, v112
    s_cbranch_vccz Lbk_114
    s_waitcnt vmcnt(3)
    ds_read_b128 v[8:11], v118 offset:1024
    ds_read_b128 v[12:15], v118 offset:3072
    s_sub_u32 s27, s27, 1
    s_waitcnt lgkmcnt(0)
    v_max_u32 v112, v8, v12
    v_cmp_eq_u32 vcc, -1, v112
    s_cbranch_vccz Lbk_114
Lfl_116:
    s_mov_b32 s40, m0
    s_mov_b32 m0, 1024
    s_nop 0
    global_load_lds_dwordx4 v127, s[10:11] sc1
    global_load_lds_dwordx4 v127, s[10:11] offset:2048 sc1
    s_waitcnt vmcnt(0)
    s_mov_b32 m0, s40
    ds_read_b128 v[8:11], v118 offset:1024
    ds_read_b128 v[12:15], v118 offset:3072
    s_sub_u32 s27, s27, 1
    s_waitcnt lgkmcnt(0)
    v_max_u32 v112, v8, v12
    v_cmp_eq_u32 vcc, -1, v112
    s_cbranch_vccz Lbk_114
    s_cbranch_scc0 Lfl_116
    s_branch L_fin
Lfs_118:
Lfl_120:
    ds_read_b128 v[8:11], v118 offset:1024
    ds_read_b128 v[12:15], v118 offset:3072
    s_sub_u32 s27, s27, 1
    s_waitcnt lgkmcnt(0)
    v_max_u32 v112, v8, v12
    v_cmp_eq_u32 vcc, -1, v112
    s_cbranch_vccz Lbk_119
    s_waitcnt vmcnt(3)
    ds_read_b128 v[8:11], v118 offset:1024
    ds_read_b128 v[12:15], v118 offset:3072
    s_sub_u32 s27, s27, 1
    s_waitcnt lgkmcnt(0)
    v_max_u32 v112, v8, v12
    v_cmp_eq_u32 vcc, -1, v112
    s_cbranch_vccz Lbk_119
Lfl_121:
    s_mov_b32 s40, m0
    s_mov_b32 m0, 1024
    s_nop 0
    global_load_lds_dwordx4 v127, s[10:11] sc1
    global_load_lds_dwordx4 v127, s[10:11] offset:2048 sc1
    s_waitcnt vmcnt(0)
    s_mov_b32 m0, s40
    ds_read_b128 v[8:11], v118 offset:1024
    ds_read_b128 v[12:15], v118 offset:3072
    s_sub_u32 s27, s27, 1
    s_waitcnt lgkmcnt(0)
    v_max_u32 v112, v8, v12
    v_cmp_eq_u32 vcc, -1, v112
    s_cbranch_vccz Lbk_119
    s_cbranch_scc0 Lfl_121
    s_branch L_fin
Lfs_122:
Lfl_124:
    ds_read_b128 v[16:19], v118 offset:4096
    ds_read_b128 v[20:23], v118 offset:6144
    s_sub_u32 s27, s27, 1
    s_waitcnt lgkmcnt(0)
    v_max_u32 v112, v16, v20
    v_cmp_eq_u32 vcc, -1, v112
    s_cbranch_vccz Lbk_123
    s_cbranch_scc0 Lfl_124
    s_branch L_fin
Lfs_125:
Lfl_127:
    ds_read_b128 v[24:27], v118 offset:5120
    ds_read_b128 v[28:31], v118 offset:7168
    s_sub_u32 s27, s27, 1
    s_waitcnt lgkmcnt(0)
    v_max_u32 v112, v24, v28
    v_cmp_eq_u32 vcc, -1, v112
    s_cbranch_vccz Lbk_126
    s_cbranch_scc0 Lfl_127
    s_branch L_fin
Lkf_131:
    v_and_b32 v116, 12, v123
    global_load_dword v116, v116, s[36:37] offset:-4 sc1
    s_sub_u32 s27, s27, 1
    s_cbranch_scc1 L_fin
    s_waitcnt vmcnt(0)
    v_cmp_ge_u32 vcc, s40, v116
    s_cbranch_vccnz Lkf_131
    s_branch Lkr_132
Lfs_138:
Lfl_140:
    ds_read_b128 v[8:11], v118 offset:1024
    ds_read_b128 v[12:15], v118 offset:3072
    s_sub_u32 s27, s27, 1
    s_waitcnt lgkmcnt(0)
    v_max_u32 v112, v8, v12
    v_cmp_eq_u32 vcc, -1, v112
    s_cbranch_vccz Lbk_139
    s_waitcnt vmcnt(3)
    ds_read_b128 v[8:11], v118 offset:1024
    ds_read_b128 v[12:15], v118 offset:3072
    s_sub_u32 s27, s27, 1
    s_waitcnt lgkmcnt(0)
    v_max_u32 v112, v8, v12
    v_cmp_eq_u32 vcc, -1, v112
    s_cbranch_vccz Lbk_139
Lfl_141:
    s_mov_b32 s40, m0
    s_mov_b32 m0, 1024
    s_nop 0
    global_load_lds_dwordx4 v127, s[12:13] sc1
    global_load_lds_dwordx4 v127, s[12:13] offset:2048 sc1
    s_waitcnt vmcnt(0)
    s_mov_b32 m0, s40
    ds_read_b128 v[8:11], v118 offset:1024
    ds_read_b128 v[12:15], v118 offset:3072
    s_sub_u32 s27, s27, 1
    s_waitcnt lgkmcnt(0)
    v_max_u32 v112, v8, v12
    v_cmp_eq_u32 vcc, -1, v112
    s_cbranch_vccz Lbk_139
    s_cbranch_scc0 Lfl_141
    s_branch L_fin
Lfs_142:
Lfl_144:
    ds_read_b128 v[8:11], v118 offset:1024
    ds_read_b128 v[12:15], v118 offset:3072
    s_sub_u32 s27, s27, 1
    s_waitcnt lgkmcnt(0)
    v_max_u32 v112, v8, v12
    v_cmp_eq_u32 vcc, -1, v112
    s_cbranch_vccz Lbk_143
    s_waitcnt vmcnt(3)
    ds_read_b128 v[8:11], v118 offset:1024
    ds_read_b128 v[12:15], v118 offset:3072
    s_sub_u32 s27, s27, 1
    s_waitcnt lgkmcnt(0)
    v_max_u32 v112, v8, v12
    v_cmp_eq_u32 vcc, -1, v112
    s_cbranch_vccz Lbk_143
Lfl_145:
    s_mov_b32 s40, m0
    s_mov_b32 m0, 1024
    s_nop 0
    global_load_lds_dwordx4 v127, s[12:13] sc1
    global_load_lds_dwordx4 v127, s[12:13] offset:2048 sc1
    s_waitcnt vmcnt(0)
    s_mov_b32 m0, s40
    ds_read_b128 v[8:11], v118 offset:1024
    ds_read_b128 v[12:15], v118 offset:3072
    s_sub_u32 s27, s27, 1
    s_waitcnt lgkmcnt(0)
    v_max_u32 v112, v8, v12
    v_cmp_eq_u32 vcc, -1, v112
    s_cbranch_vccz Lbk_143
    s_cbranch_scc0 Lfl_145
    s_branch L_fin
Lfs_147:
Lfl_149:
    ds_read_b128 v[8:11], v118 offset:1024
    ds_read_b128 v[12:15], v118 offset:3072
    s_sub_u32 s27, s27, 1
    s_waitcnt lgkmcnt(0)
    v_max_u32 v112, v8, v12
    v_cmp_eq_u32 vcc, -1, v112
    s_cbranch_vccz Lbk_148
    s_waitcnt vmcnt(3)
    ds_read_b128 v[8:11], v118 offset:1024
    ds_read_b128 v[12:15], v118 offset:3072
    s_sub_u32 s27, s27, 1
    s_waitcnt lgkmcnt(0)
    v_max_u32 v112, v8, v12
    v_cmp_eq_u32 vcc, -1, v112
    s_cbranch_vccz Lbk_148
Lfl_150:
    s_mov_b32 s40, m0
    s_mov_b32 m0, 1024
    s_nop 0
    global_load_lds_dwordx4 v127, s[12:13] sc1
    global_load_lds_dwordx4 v127, s[12:13] offset:2048 sc1
    s_waitcnt vmcnt(0)
    s_mov_b32 m0, s40
    ds_read_b128 v[8:11], v118 offset:1024
    ds_read_b128 v[12:15], v118 offset:3072
    s_sub_u32 s27, s27, 1
    s_waitcnt lgkmcnt(0)
    v_max_u32 v112, v8, v12
    v_cmp_eq_u32 vcc, -1, v112
    s_cbranch_vccz Lbk_148
    s_cbranch_scc0 Lfl_150
    s_branch L_fin
Lfs_151:
Lfl_153:
    ds_read_b128 v[16:19], v118 offset:4096
    ds_read_b128 v[20:23], v118 offset:6144
    s_sub_u32 s27, s27, 1
    s_waitcnt lgkmcnt(0)
    v_max_u32 v112, v16, v20
    v_cmp_eq_u32 vcc, -1, v112
    s_cbranch_vccz Lbk_152
    s_cbranch_scc0 Lfl_153
    s_branch L_fin
Lfs_154:
Lfl_156:
    ds_read_b128 v[24:27], v118 offset:5120
    ds_read_b128 v[28:31], v118 offset:7168
    s_sub_u32 s27, s27, 1
    s_waitcnt lgkmcnt(0)
    v_max_u32 v112, v24, v28
    v_cmp_eq_u32 vcc, -1, v112
    s_cbranch_vccz Lbk_155
    s_cbranch_scc0 Lfl_156
    s_branch L_fin
Lwv_40:
    s_mov_b32 m0, 4096
    ds_read_b128 v[32:35], v125 offset:0
    ds_read_b128 v[36:39], v125 offset:1024
    ds_read_b128 v[40:43], v125 offset:8192
    ds_read_b128 v[44:47], v125 offset:9216
    ds_read_b128 v[48:51], v125 offset:2048
    ds_read_b128 v[52:55], v125 offset:3072
    ds_read_b128 v[96:99], v125 offset:10240
    ds_read_b128 v[100:103], v125 offset:11264
    v_mov_b64 v[64:65], 0
    v_mov_b64 v[66:67], 0
    v_mov_b64 v[68:69], 0
    v_mov_b64 v[70:71], 0
    v_mov_b64 v[72:73], 0
    v_mov_b64 v[74:75], 0
    v_mov_b64 v[76:77], 0
    v_mov_b64 v[78:79], 0
    v_mov_b64 v[80:81], 0
    v_mov_b64 v[82:83], 0
    v_mov_b64 v[84:85], 0
    v_mov_b64 v[86:87], 0
    v_xor_b32 v112, 8, v109
    ds_read_b64 v[90:91], v109 offset:27648
    ds_read_b64 v[88:89], v112 offset:26624
    ds_read_b64 v[94:95], v109 offset:28160
    ds_read_b64 v[92:93], v112 offset:27136
    ds_read_b128 v[56:59], v111 offset:24576
    ds_read_b128 v[60:63], v111 offset:25600
    s_waitcnt lgkmcnt(2)
    v_swap_b32 v89, v90
    v_swap_b32 v93, v94
Lhl2_160:
    s_waitcnt vmcnt(0)
    global_load_lds_dwordx4 v127, s[10:11] sc1
    global_load_lds_dwordx4 v127, s[10:11] offset:2048 sc1
    s_barrier
    ds_read_b128 v[0:3], v118 offset:0
    ds_read_b128 v[4:7], v118 offset:2048
    global_load_lds_dwordx4 v127, s[10:11] sc1
    global_load_lds_dwordx4 v127, s[10:11] offset:2048 sc1
    s_waitcnt lgkmcnt(1)
    v_smfmac_f32_16x16x64_bf16 v[64:67], v[0:3], v[128:135], v117
    ds_read_b128 v[24:27], v118 offset:0
    ds_read_b128 v[8:11], v118 offset:1024
    s_waitcnt lgkmcnt(2)
    v_smfmac_f32_16x16x64_bf16 v[64:67], v[4:7], v[144:151], v117
    ds_read_b128 v[28:31], v118 offset:2048
    ds_read_b128 v[12:15], v118 offset:3072
    v_cmp_u_f32 vcc, v0, v4
    v_smfmac_f32_16x16x64_bf16 v[68:71], v[0:3], v[136:143], v117
    v_smfmac_f32_16x16x64_bf16 v[68:71], v[4:7], v[152:159], v117
    s_cbranch_vccnz Lfa_162
    global_store_short v120, v108, s[12:13]
    s_mov_b32 m0, 24576
    v_smfmac_f32_16x16x64_bf16 v[72:75], v[0:3], v[32:39], v117
    global_load_lds_dwordx4 v118, s[22:23] offset:0 sc1
    v_smfmac_f32_16x16x64_bf16 v[72:75], v[4:7], v[40:47], v117
    ds_read_b128 v[16:19], v118 offset:4096
    s_waitcnt lgkmcnt(1)
    v_cmp_u_f32 vcc, v8, v12
    v_smfmac_f32_16x16x64_bf16 v[76:79], v[0:3], v[48:55], v117
    global_store_short v120, v114, s[24:25] sc1
    ds_read_b128 v[20:23], v118 offset:6144
    v_smfmac_f32_16x16x64_bf16 v[76:79], v[4:7], v[96:103], v117
    s_cbranch_vccnz Lfs_167
Lbk_168:
Lqj_166:
    v_smfmac_f32_16x16x64_bf16 v[64:67], v[8:11], v[160:167], v117
    ds_read_b128 v[96:99], v125 offset:12288
    ds_read_b128 v[44:47], v125 offset:15360
    v_smfmac_f32_16x16x64_bf16 v[64:67], v[12:15], v[176:183], v117
    global_load_lds_dwordx4 v118, s[22:23] offset:1024 sc1
    ds_read_b128 v[100:103], v125 offset:13312
    v_smfmac_f32_16x16x64_bf16 v[68:71], v[8:11], v[168:175], v117
    ds_read_b128 v[24:27], v118 offset:5120
    s_waitcnt lgkmcnt(4)
    v_cmp_u_f32 vcc, v16, v20
    v_smfmac_f32_16x16x64_bf16 v[68:71], v[12:15], v[184:191], v117
    ds_read_b128 v[28:31], v118 offset:7168
    ds_read_b128 v[40:43], v125 offset:14336
    v_smfmac_f32_16x16x64_bf16 v[72:75], v[8:11], a[0:7], v117
    s_cbranch_vccnz Lfs_177
Lbk_178:
    ds_read_b128 v[32:35], v125 offset:20480
    v_smfmac_f32_16x16x64_bf16 v[64:67], v[16:19], v[192:199], v117
    s_add_u32 s24, s24, 8192
    s_addc_u32 s25, s25, 0
    ds_read_b128 v[36:39], v125 offset:21504
    v_smfmac_f32_16x16x64_bf16 v[64:67], v[20:23], v[208:215], v117
    global_load_lds_dwordx4 v118, s[22:23] offset:2048 sc1
    ds_read_b128 v[48:51], v125 offset:22528
    v_smfmac_f32_16x16x64_bf16 v[68:71], v[16:19], v[200:207], v117
    s_add_u32 s26, s26, 1
    s_waitcnt lgkmcnt(4)
    v_cmp_u_f32 vcc, v24, v28
    v_smfmac_f32_16x16x64_bf16 v[68:71], v[20:23], v[216:223], v117
    ds_read_b128 v[52:55], v125 offset:23552
    v_smfmac_f32_16x16x64_bf16 v[72:75], v[16:19], v[96:103], v117
    s_cbranch_vccnz Lfs_181
Lbk_182:
    v_smfmac_f32_16x16x64_bf16 v[64:67], v[24:27], v[224:231], v117
    s_mov_b64 vcc, s[64:65]
    v_smfmac_f32_16x16x64_bf16 v[64:67], v[28:31], v[240:247], v117
    global_load_lds_dwordx4 v118, s[22:23] offset:3072 sc1
    v_smfmac_f32_16x16x64_bf16 v[68:71], v[24:27], v[232:239], v117
    s_add_u32 s22, s22, 524288
    s_addc_u32 s23, s23, 0
    v_smfmac_f32_16x16x64_bf16 v[68:71], v[28:31], v[248:255], v117
    s_waitcnt lgkmcnt(2)
    v_add_f32 v64, v64, v66
    v_smfmac_f32_16x16x64_bf16 v[72:75], v[20:23], v[32:39], v117
    ds_read_b128 v[32:35], v125 offset:24576
    v_add_f32 v65, v65, v67
    v_smfmac_f32_16x16x64_bf16 v[72:75], v[12:15], a[16:23], v117
    ds_read_b128 v[36:39], v125 offset:25600
    v_cvt_pk_bf16_f32 v102, v64, v65
    v_add_f32 v68, v68, v70
    v_smfmac_f32_16x16x64_bf16 v[72:75], v[24:27], a[32:39], v117
    ds_write_b32 v121, v102 offset:8196
    v_add_f32 v69, v69, v71
    v_cvt_pk_bf16_f32 v103, v68, v69
    v_smfmac_f32_16x16x64_bf16 v[72:75], v[28:31], a[48:55], v117
    ds_write_b32 v121, v103 offset:8708
    v_smfmac_f32_16x16x64_bf16 v[76:79], v[16:19], v[40:47], v117
    ds_read_b128 v[40:43], v125 offset:26624
    s_waitcnt lgkmcnt(5)
    v_smfmac_f32_16x16x64_bf16 v[76:79], v[20:23], v[48:55], v117
    ds_read_b128 v[44:47], v125 offset:27648
    v_add_f32 v72, v72, v74
    v_smfmac_f32_16x16x64_bf16 v[76:79], v[8:11], a[8:15], v117
    ds_read_b128 v[48:51], v125 offset:4096
    v_smfmac_f32_16x16x64_bf16 v[76:79], v[12:15], a[24:31], v117
    s_waitcnt lgkmcnt(3)
    s_barrier
    v_smfmac_f32_16x16x64_bf16 v[76:79], v[24:27], a[40:47], v117
    ds_read_b64_tr_b16 v[64:65], v122 offset:8192
    ds_read_b64_tr_b16 v[66:67], v122 offset:8704
    v_smfmac_f32_16x16x64_bf16 v[76:79], v[28:31], a[56:63], v117
    ds_read_b64_tr_b16 v[68:69], v122 offset:9216
    ds_read_b64_tr_b16 v[70:71], v122 offset:9728
    v_add_f32 v73, v73, v75
    v_cvt_pk_bf16_f32 v100, v72, v73
    v_smfmac_f32_16x16x64_bf16 v[80:83], v[0:3], a[64:71], v117
    ds_write_b32 v121, v100 offset:10244
    v_smfmac_f32_16x16x64_bf16 v[84:87], v[0:3], a[72:79], v117
    s_waitcnt lgkmcnt(3)
    ds_read_b128 v[52:55], v125 offset:5120
    v_add_f32 v76, v76, v78
    v_mfma_f32_16x16x32_bf16 v[96:99], v[56:59], v[64:67], 0
    s_waitcnt lgkmcnt(2)
    v_add_f32 v77, v77, v79
    v_cvt_pk_bf16_f32 v101, v76, v77
    v_mfma_f32_16x16x32_bf16 v[96:99], v[60:63], v[68:71], v[96:99]
    ds_write_b32 v121, v101 offset:10756
    v_smfmac_f32_16x16x64_bf16 v[80:83], v[4:7], a[80:87], v117
    s_mov_b32 exec_hi, 0
    global_store_dword v110, v108, s[20:21]
    s_mov_b32 exec_hi, -1
    v_smfmac_f32_16x16x64_bf16 v[84:87], v[4:7], a[88:95], v117
    v_add_f32_dpp v96, v98, v96 quad_perm:[2,3,2,3] row_mask:0xf bank_mask:0xf
    v_add_f32_dpp v97, v99, v97 quad_perm:[2,3,2,3] row_mask:0xf bank_mask:0xf
    v_smfmac_f32_16x16x64_bf16 v[80:83], v[8:11], a[96:103], v117
    ds_write_b64 v109, v[96:97] offset:13312
    v_smfmac_f32_16x16x64_bf16 v[84:87], v[8:11], a[104:111], v117
    s_waitcnt lgkmcnt(1)
    s_barrier
    v_smfmac_f32_16x16x64_bf16 v[80:83], v[12:15], a[112:119], v117
    s_waitcnt vmcnt(7)
    ds_read_b64_tr_b16 v[72:73], v122 offset:10240
    ds_read_b64_tr_b16 v[74:75], v122 offset:10752
    v_smfmac_f32_16x16x64_bf16 v[84:87], v[12:15], a[120:127], v117
    ds_read_b64_tr_b16 v[76:77], v122 offset:11264
    ds_read_b64_tr_b16 v[78:79], v122 offset:11776
    v_smfmac_f32_16x16x64_bf16 v[80:83], v[16:19], a[128:135], v117
    ds_read_b128 v[8:11], v125 offset:18432
    v_smfmac_f32_16x16x64_bf16 v[84:87], v[16:19], a[136:143], v117
    s_waitcnt lgkmcnt(5)
    s_barrier
    s_waitcnt lgkmcnt(3)
    v_mfma_f32_16x16x32_bf16 v[0:3], v[72:75], v[64:67], 0
    ds_read_b128 v[56:59], v124 offset:12288
    s_waitcnt lgkmcnt(2)
    v_mfma_f32_16x16x32_bf16 v[0:3], v[76:79], v[68:71], v[0:3]
    ds_read_b128 v[12:15], v125 offset:19456
    v_smfmac_f32_16x16x64_bf16 v[80:83], v[20:23], a[144:151], v117
    ds_write_b32 v118, v108 offset:4096
    v_smfmac_f32_16x16x64_bf16 v[84:87], v[20:23], a[152:159], v117
    ds_write_b32 v118, v108 offset:6144
    v_add_f32_dpp v2, v0, v2 quad_perm:[0,1,0,1] row_mask:0xf bank_mask:0xf
    v_smfmac_f32_16x16x64_bf16 v[80:83], v[24:27], a[160:167], v117
    s_waitcnt lgkmcnt(3)
    v_max3_f32 v60, v56, v57, v58
    v_add_f32_dpp v3, v1, v3 quad_perm:[0,1,0,1] row_mask:0xf bank_mask:0xf
    v_smfmac_f32_16x16x64_bf16 v[84:87], v[24:27], a[168:175], v117
    v_max_f32 v60, v60, v59
    v_smfmac_f32_16x16x64_bf16 v[80:83], v[28:31], v[32:39], v117
    s_nop 0
    v_max_f32_dpp v60, v60, v60 quad_perm:[2,3,0,1] row_mask:0xf bank_mask:0xf
    v_smfmac_f32_16x16x64_bf16 v[84:87], v[28:31], v[40:47], v117
    v_max3_f32 v61, v60, v2, v3
    v_max3_f32 v62, v60, v2, v3
    v_mov_b64 v[64:65], 0
    v_mov_b64 v[66:67], 0
    v_permlane16_swap_b32 v61, v62
    v_max_f32 v60, v61, v62
    v_max_f32 v63, v61, v62
    v_pk_add_f32 v[80:81], v[80:81], v[82:83]
    v_pk_add_f32 v[84:85], v[84:85], v[86:87]
    v_permlane32_swap_b32 v60, v63
    v_max_f32 v61, v60, v63
    v_cvt_pk_bf16_f32 v114, v80, v81
    v_cvt_pk_bf16_f32 v115, v84, v85
    v_mul_f32_dpp v62, v61, v126 quad_perm:[2,3,2,3] row_mask:0xf bank_mask:0xf
    v_pk_fma_f32 v[2:3], v[2:3], s[28:29], v[62:63] op_sel_hi:[1,1,0]
    v_pk_fma_f32 v[56:57], v[56:57], s[28:29], v[62:63] op_sel_hi:[1,1,0]
    v_exp_f32 v2, v2
    v_exp_f32 v3, v3
    v_pk_fma_f32 v[58:59], v[58:59], s[28:29], v[62:63] op_sel_hi:[1,1,0]
    v_cvt_pk_bf16_f32 v80, v2, v3
    v_exp_f32 v56, v56
    v_cndmask_b32 v5, v113, v80, vcc
    v_cndmask_b32_dpp v4, v80, v113, vcc quad_perm:[2,3,2,3] row_mask:0xf bank_mask:0xf
    v_exp_f32 v57, v57
    v_exp_f32 v58, v58
    v_mfma_f32_16x16x16_bf16 v[76:79], v[4:5], v[104:105], 0
    v_cvt_pk_bf16_f32 v84, v56, v57
    v_exp_f32 v59, v59
    v_mfma_f32_16x16x16_bf16 v[72:75], v[4:5], v[114:115], 0
    v_cvt_pk_bf16_f32 v85, v58, v59
    v_mov_b32_dpp v86, v84 quad_perm:[2,3,0,1] row_mask:0xf bank_mask:0xf
    v_mov_b64 v[68:69], 0
    v_mov_b32_dpp v87, v85 quad_perm:[2,3,0,1] row_mask:0xf bank_mask:0xf
    v_mov_b64 v[70:71], 0
    v_mov_b64 v[80:81], 0
    v_mfma_f32_16x16x32_bf16 v[76:79], v[84:87], v[104:107], v[76:79]
    ds_read_b128 v[32:35], v125 offset:6144
    v_smfmac_f32_16x16x64_bf16 v[72:75], v[84:87], v[88:95], v117
    ds_read_b128 v[36:39], v125 offset:7168
    s_nop 2
    v_rcp_f32_dpp v60, v76 quad_perm:[2,3,2,3] row_mask:0xf bank_mask:0xf
    v_rcp_f32_dpp v61, v77 quad_perm:[2,3,2,3] row_mask:0xf bank_mask:0xf
    s_nop 1
    v_pk_mul_f32 v[72:73], v[72:73], v[60:61]
    v_pk_mul_f32 v[74:75], v[74:75], v[60:61]
    v_cvt_pk_bf16_f32 v56, v72, v73
    v_cvt_pk_bf16_f32 v57, v74, v75
    ds_write_b64 v121, v[56:57] offset:15360
    v_mov_b64 v[82:83], 0
    v_mov_b64 v[84:85], 0
    v_mov_b64 v[86:87], 0
    v_mov_b64 v[72:73], 0
    v_mov_b64 v[74:75], 0
    v_mov_b64 v[76:77], 0
    v_mov_b64 v[78:79], 0
    v_mov_b64 v[88:89], 0
    v_mov_b64 v[90:91], 0
    v_mov_b64 v[92:93], 0
    v_mov_b64 v[94:95], 0
    s_waitcnt vmcnt(6)
    s_waitcnt lgkmcnt(0)
    s_barrier
    ds_read_b64_tr_b16 v[96:97], v122 offset:14336
    ds_read_b64_tr_b16 v[98:99], v122 offset:14848
    ds_read_b64_tr_b16 v[100:101], v122 offset:15360
    ds_read_b64_tr_b16 v[102:103], v122 offset:15872
    ds_read_b128 v[40:43], v125 offset:16384
    ds_read_b128 v[44:47], v125 offset:17408
    s_waitcnt lgkmcnt(4)
    v_smfmac_f32_16x16x64_bf16 v[72:75], v[96:99], a[176:183], v117
    ds_read_b128 v[24:27], v125 offset:28672
    s_waitcnt lgkmcnt(3)
    v_smfmac_f32_16x16x64_bf16 v[72:75], v[100:103], a[192:199], v117
    ds_read_b128 v[28:31], v125 offset:29696
    v_smfmac_f32_16x16x64_bf16 v[76:79], v[96:99], a[184:191], v117
    ds_read_b128 v[56:59], v125 offset:30720
    v_smfmac_f32_16x16x64_bf16 v[76:79], v[100:103], a[200:207], v117
    ds_read_b128 v[60:63], v125 offset:31744
    v_add_f32 v72, v72, v74
    v_add_f32 v73, v73, v75
    v_cvt_pk_bf16_f32 v72, v72, v73
    v_smfmac_f32_16x16x64_bf16 v[80:83], v[96:99], a[208:215], v117
    global_store_dword v119, v72, s[14:15] offset:-4096
    s_nop 1
    v_add_f32 v76, v76, v78
    v_add_f32 v77, v77, v79
    v_cvt_pk_bf16_f32 v76, v76, v77
    v_smfmac_f32_16x16x64_bf16 v[80:83], v[100:103], a[224:231], v117
    global_store_dword v119, v76, s[30:31] offset:-4096
    v_smfmac_f32_16x16x64_bf16 v[84:87], v[96:99], a[216:223], v117
    v_smfmac_f32_16x16x64_bf16 v[84:87], v[100:103], a[232:239], v117
    v_add_f32 v80, v80, v82
    v_smfmac_f32_16x16x64_bf16 v[64:67], v[96:99], a[240:247], v117
    v_add_f32 v81, v81, v83
    v_cvt_pk_bf16_f32 v80, v80, v81
    v_smfmac_f32_16x16x64_bf16 v[64:67], v[100:103], v[48:55], v117
    global_store_dword v119, v80, s[14:15] offset:-2048
    v_add_f32 v84, v84, v86
    v_smfmac_f32_16x16x64_bf16 v[68:71], v[96:99], a[248:255], v117
    v_add_f32 v85, v85, v87
    v_cvt_pk_bf16_f32 v84, v84, v85
    v_smfmac_f32_16x16x64_bf16 v[68:71], v[100:103], v[32:39], v117
    s_waitcnt lgkmcnt(4)
    global_store_dword v119, v84, s[30:31] offset:-2048
    v_add_f32 v64, v64, v66
    v_smfmac_f32_16x16x64_bf16 v[88:91], v[96:99], v[40:47], v117
    s_waitcnt lgkmcnt(2)
    v_add_f32 v65, v65, v67
    v_cvt_pk_bf16_f32 v64, v64, v65
    v_smfmac_f32_16x16x64_bf16 v[88:91], v[100:103], v[24:31], v117
    global_store_dword v119, v64, s[14:15] offset:0
    v_add_f32 v68, v68, v70
    v_smfmac_f32_16x16x64_bf16 v[92:95], v[96:99], v[8:15], v117
    s_waitcnt lgkmcnt(0)
    v_add_f32 v69, v69, v71
    v_cvt_pk_bf16_f32 v68, v68, v69
    v_smfmac_f32_16x16x64_bf16 v[92:95], v[100:103], v[56:63], v117
    global_store_dword v119, v68, s[30:31] offset:0
    v_add_f32 v88, v88, v90
    v_add_f32 v89, v89, v91
    v_cvt_pk_bf16_f32 v88, v88, v89
    global_store_dword v119, v88, s[14:15] offset:2048
    s_mov_b32 m0, 4096
    ds_read_b128 v[32:35], v125 offset:0
    ds_read_b128 v[36:39], v125 offset:1024
    v_add_f32 v92, v92, v94
    v_add_f32 v93, v93, v95
    v_cvt_pk_bf16_f32 v92, v92, v93
    global_store_dword v119, v92, s[30:31] offset:2048
    s_barrier
    ds_read_b128 v[40:43], v125 offset:8192
    ds_read_b128 v[44:47], v125 offset:9216
    ds_read_b128 v[48:51], v125 offset:2048
    ds_read_b128 v[52:55], v125 offset:3072
    ds_read_b128 v[96:99], v125 offset:10240
    ds_read_b128 v[100:103], v125 offset:11264
    v_mov_b64 v[64:65], 0
    v_mov_b64 v[66:67], 0
    v_mov_b64 v[68:69], 0
    v_mov_b64 v[70:71], 0
    v_mov_b64 v[72:73], 0
    v_mov_b64 v[74:75], 0
    v_mov_b64 v[76:77], 0
    v_mov_b64 v[78:79], 0
    v_mov_b64 v[80:81], 0
    v_mov_b64 v[82:83], 0
    v_mov_b64 v[84:85], 0
    v_mov_b64 v[86:87], 0
    s_waitcnt vmcnt(8)
    v_xor_b32 v112, 8, v109
    global_load_dword v0, v123, s[18:19] offset:0 sc1
    global_load_dword v1, v123, s[18:19] offset:256 sc1
    global_load_dword v2, v123, s[18:19] offset:512 sc1
    global_load_dword v3, v123, s[18:19] offset:768 sc1
    global_load_dword v4, v123, s[18:19] offset:1024 sc1
    global_load_dword v5, v123, s[18:19] offset:1280 sc1
    global_load_dword v6, v123, s[18:19] offset:1536 sc1
    global_load_dword v7, v123, s[18:19] offset:1792 sc1
    ds_read_b64 v[90:91], v109 offset:27648
    ds_read_b64 v[88:89], v112 offset:26624
    ds_read_b64 v[94:95], v109 offset:28160
    ds_read_b64 v[92:93], v112 offset:27136
    ds_read_b128 v[56:59], v111 offset:24576
    ds_read_b128 v[60:63], v111 offset:25600
    s_waitcnt lgkmcnt(2)
    v_swap_b32 v89, v90
    v_swap_b32 v93, v94
    s_waitcnt vmcnt(4)
    v_mfma_f32_16x16x32_bf16 v[24:27], v[104:107], v[0:3], 0
    v_max3_u32 v28, v0, v1, v2
    s_waitcnt vmcnt(0)
    v_mfma_f32_16x16x32_bf16 v[24:27], v[104:107], v[4:7], v[24:27]
    v_max3_u32 v29, v4, v5, v6
    v_max3_u32 v28, v28, v3, v7
    v_cmp_u_f32 vcc, v28, v29
    s_nop 4
    v_cvt_pk_bf16_f32 v114, v24, v24
    s_cbranch_vccnz Lpf_184
Lpj_185:
    global_store_short v120, v114, s[12:13]
    s_cmp_eq_u32 s26, 63
    s_cbranch_scc1 Llast_161
    s_waitcnt vmcnt(0)
    global_load_lds_dwordx4 v127, s[12:13] sc1
    global_load_lds_dwordx4 v127, s[12:13] offset:2048 sc1
    s_barrier
    ds_read_b128 v[0:3], v118 offset:0
    ds_read_b128 v[4:7], v118 offset:2048
    global_load_lds_dwordx4 v127, s[12:13] sc1
    global_load_lds_dwordx4 v127, s[12:13] offset:2048 sc1
    s_waitcnt lgkmcnt(1)
    v_smfmac_f32_16x16x64_bf16 v[64:67], v[0:3], v[128:135], v117
    ds_read_b128 v[24:27], v118 offset:0
    ds_read_b128 v[8:11], v118 offset:1024
    s_waitcnt lgkmcnt(2)
    v_smfmac_f32_16x16x64_bf16 v[64:67], v[4:7], v[144:151], v117
    ds_read_b128 v[28:31], v118 offset:2048
    ds_read_b128 v[12:15], v118 offset:3072
    v_cmp_u_f32 vcc, v0, v4
    v_smfmac_f32_16x16x64_bf16 v[68:71], v[0:3], v[136:143], v117
    v_smfmac_f32_16x16x64_bf16 v[68:71], v[4:7], v[152:159], v117
    s_cbranch_vccnz Lfa_187
    global_store_short v120, v108, s[10:11]
    s_mov_b32 m0, 24576
    v_smfmac_f32_16x16x64_bf16 v[72:75], v[0:3], v[32:39], v117
    global_load_lds_dwordx4 v118, s[22:23] offset:0 sc1
    v_smfmac_f32_16x16x64_bf16 v[72:75], v[4:7], v[40:47], v117
    ds_read_b128 v[16:19], v118 offset:4096
    s_waitcnt lgkmcnt(1)
    v_cmp_u_f32 vcc, v8, v12
    v_smfmac_f32_16x16x64_bf16 v[76:79], v[0:3], v[48:55], v117
    global_store_short v120, v114, s[24:25] sc1
    ds_read_b128 v[20:23], v118 offset:6144
    v_smfmac_f32_16x16x64_bf16 v[76:79], v[4:7], v[96:103], v117
    s_cbranch_vccnz Lfs_192
Lbk_193:
Lqj_191:
    v_smfmac_f32_16x16x64_bf16 v[64:67], v[8:11], v[160:167], v117
    ds_read_b128 v[96:99], v125 offset:12288
    ds_read_b128 v[44:47], v125 offset:15360
    v_smfmac_f32_16x16x64_bf16 v[64:67], v[12:15], v[176:183], v117
    global_load_lds_dwordx4 v118, s[22:23] offset:1024 sc1
    ds_read_b128 v[100:103], v125 offset:13312
    v_smfmac_f32_16x16x64_bf16 v[68:71], v[8:11], v[168:175], v117
    ds_read_b128 v[24:27], v118 offset:5120
    s_waitcnt lgkmcnt(4)
    v_cmp_u_f32 vcc, v16, v20
    v_smfmac_f32_16x16x64_bf16 v[68:71], v[12:15], v[184:191], v117
    ds_read_b128 v[28:31], v118 offset:7168
    ds_read_b128 v[40:43], v125 offset:14336
    v_smfmac_f32_16x16x64_bf16 v[72:75], v[8:11], a[0:7], v117
    s_cbranch_vccnz Lfs_202
Lbk_203:
    ds_read_b128 v[32:35], v125 offset:20480
    v_smfmac_f32_16x16x64_bf16 v[64:67], v[16:19], v[192:199], v117
    s_add_u32 s24, s24, 8192
    s_addc_u32 s25, s25, 0
    ds_read_b128 v[36:39], v125 offset:21504
    v_smfmac_f32_16x16x64_bf16 v[64:67], v[20:23], v[208:215], v117
    global_load_lds_dwordx4 v118, s[22:23] offset:2048 sc1
    ds_read_b128 v[48:51], v125 offset:22528
    v_smfmac_f32_16x16x64_bf16 v[68:71], v[16:19], v[200:207], v117
    s_add_u32 s26, s26, 1
    s_waitcnt lgkmcnt(4)
    v_cmp_u_f32 vcc, v24, v28
    v_smfmac_f32_16x16x64_bf16 v[68:71], v[20:23], v[216:223], v117
    ds_read_b128 v[52:55], v125 offset:23552
    v_smfmac_f32_16x16x64_bf16 v[72:75], v[16:19], v[96:103], v117
    s_cbranch_vccnz Lfs_206
Lbk_207:
    v_smfmac_f32_16x16x64_bf16 v[64:67], v[24:27], v[224:231], v117
    s_mov_b64 vcc, s[64:65]
    v_smfmac_f32_16x16x64_bf16 v[64:67], v[28:31], v[240:247], v117
    global_load_lds_dwordx4 v118, s[22:23] offset:3072 sc1
    v_smfmac_f32_16x16x64_bf16 v[68:71], v[24:27], v[232:239], v117
    s_add_u32 s22, s22, 524288
    s_addc_u32 s23, s23, 0
    v_smfmac_f32_16x16x64_bf16 v[68:71], v[28:31], v[248:255], v117
    s_waitcnt lgkmcnt(2)
    v_add_f32 v64, v64, v66
    v_smfmac_f32_16x16x64_bf16 v[72:75], v[20:23], v[32:39], v117
    ds_read_b128 v[32:35], v125 offset:24576
    v_add_f32 v65, v65, v67
    v_smfmac_f32_16x16x64_bf16 v[72:75], v[12:15], a[16:23], v117
    ds_read_b128 v[36:39], v125 offset:25600
    v_cvt_pk_bf16_f32 v102, v64, v65
    v_add_f32 v68, v68, v70
    v_smfmac_f32_16x16x64_bf16 v[72:75], v[24:27], a[32:39], v117
    ds_write_b32 v121, v102 offset:8196
    v_add_f32 v69, v69, v71
    v_cvt_pk_bf16_f32 v103, v68, v69
    v_smfmac_f32_16x16x64_bf16 v[72:75], v[28:31], a[48:55], v117
    ds_write_b32 v121, v103 offset:8708
    v_smfmac_f32_16x16x64_bf16 v[76:79], v[16:19], v[40:47], v117
    ds_read_b128 v[40:43], v125 offset:26624
    s_waitcnt lgkmcnt(5)
    v_smfmac_f32_16x16x64_bf16 v[76:79], v[20:23], v[48:55], v117
    ds_read_b128 v[44:47], v125 offset:27648
    v_add_f32 v72, v72, v74
    v_smfmac_f32_16x16x64_bf16 v[76:79], v[8:11], a[8:15], v117
    ds_read_b128 v[48:51], v125 offset:4096
    v_smfmac_f32_16x16x64_bf16 v[76:79], v[12:15], a[24:31], v117
    s_waitcnt lgkmcnt(3)
    s_barrier
    v_smfmac_f32_16x16x64_bf16 v[76:79], v[24:27], a[40:47], v117
    ds_read_b64_tr_b16 v[64:65], v122 offset:8192
    ds_read_b64_tr_b16 v[66:67], v122 offset:8704
    v_smfmac_f32_16x16x64_bf16 v[76:79], v[28:31], a[56:63], v117
    ds_read_b64_tr_b16 v[68:69], v122 offset:9216
    ds_read_b64_tr_b16 v[70:71], v122 offset:9728
    v_add_f32 v73, v73, v75
    v_cvt_pk_bf16_f32 v100, v72, v73
    v_smfmac_f32_16x16x64_bf16 v[80:83], v[0:3], a[64:71], v117
    ds_write_b32 v121, v100 offset:10244
    v_smfmac_f32_16x16x64_bf16 v[84:87], v[0:3], a[72:79], v117
    s_waitcnt lgkmcnt(3)
    ds_read_b128 v[52:55], v125 offset:5120
    v_add_f32 v76, v76, v78
    v_mfma_f32_16x16x32_bf16 v[96:99], v[56:59], v[64:67], 0
    s_waitcnt lgkmcnt(2)
    v_add_f32 v77, v77, v79
    v_cvt_pk_bf16_f32 v101, v76, v77
    v_mfma_f32_16x16x32_bf16 v[96:99], v[60:63], v[68:71], v[96:99]
    ds_write_b32 v121, v101 offset:10756
    v_smfmac_f32_16x16x64_bf16 v[80:83], v[4:7], a[80:87], v117
    s_mov_b32 exec_hi, 0
    global_store_dword v110, v108, s[18:19]
    s_mov_b32 exec_hi, -1
    v_smfmac_f32_16x16x64_bf16 v[84:87], v[4:7], a[88:95], v117
    v_add_f32_dpp v96, v98, v96 quad_perm:[2,3,2,3] row_mask:0xf bank_mask:0xf
    v_add_f32_dpp v97, v99, v97 quad_perm:[2,3,2,3] row_mask:0xf bank_mask:0xf
    v_smfmac_f32_16x16x64_bf16 v[80:83], v[8:11], a[96:103], v117
    ds_write_b64 v109, v[96:97] offset:13312
    v_smfmac_f32_16x16x64_bf16 v[84:87], v[8:11], a[104:111], v117
    s_waitcnt lgkmcnt(1)
    s_barrier
    v_smfmac_f32_16x16x64_bf16 v[80:83], v[12:15], a[112:119], v117
    s_waitcnt vmcnt(7)
    ds_read_b64_tr_b16 v[72:73], v122 offset:10240
    ds_read_b64_tr_b16 v[74:75], v122 offset:10752
    v_smfmac_f32_16x16x64_bf16 v[84:87], v[12:15], a[120:127], v117
    ds_read_b64_tr_b16 v[76:77], v122 offset:11264
    ds_read_b64_tr_b16 v[78:79], v122 offset:11776
    v_smfmac_f32_16x16x64_bf16 v[80:83], v[16:19], a[128:135], v117
    ds_read_b128 v[8:11], v125 offset:18432
    v_smfmac_f32_16x16x64_bf16 v[84:87], v[16:19], a[136:143], v117
    s_waitcnt lgkmcnt(5)
    s_barrier
    s_waitcnt lgkmcnt(3)
    v_mfma_f32_16x16x32_bf16 v[0:3], v[72:75], v[64:67], 0
    ds_read_b128 v[56:59], v124 offset:12288
    s_waitcnt lgkmcnt(2)
    v_mfma_f32_16x16x32_bf16 v[0:3], v[76:79], v[68:71], v[0:3]
    ds_read_b128 v[12:15], v125 offset:19456
    v_smfmac_f32_16x16x64_bf16 v[80:83], v[20:23], a[144:151], v117
    ds_write_b32 v118, v108 offset:4096
    v_smfmac_f32_16x16x64_bf16 v[84:87], v[20:23], a[152:159], v117
    ds_write_b32 v118, v108 offset:6144
    v_add_f32_dpp v2, v0, v2 quad_perm:[0,1,0,1] row_mask:0xf bank_mask:0xf
    v_smfmac_f32_16x16x64_bf16 v[80:83], v[24:27], a[160:167], v117
    s_waitcnt lgkmcnt(3)
    v_max3_f32 v60, v56, v57, v58
    v_add_f32_dpp v3, v1, v3 quad_perm:[0,1,0,1] row_mask:0xf bank_mask:0xf
    v_smfmac_f32_16x16x64_bf16 v[84:87], v[24:27], a[168:175], v117
    v_max_f32 v60, v60, v59
    v_smfmac_f32_16x16x64_bf16 v[80:83], v[28:31], v[32:39], v117
    s_nop 0
    v_max_f32_dpp v60, v60, v60 quad_perm:[2,3,0,1] row_mask:0xf bank_mask:0xf
    v_smfmac_f32_16x16x64_bf16 v[84:87], v[28:31], v[40:47], v117
    v_max3_f32 v61, v60, v2, v3
    v_max3_f32 v62, v60, v2, v3
    v_mov_b64 v[64:65], 0
    v_mov_b64 v[66:67], 0
    v_permlane16_swap_b32 v61, v62
    v_max_f32 v60, v61, v62
    v_max_f32 v63, v61, v62
    v_pk_add_f32 v[80:81], v[80:81], v[82:83]
    v_pk_add_f32 v[84:85], v[84:85], v[86:87]
    v_permlane32_swap_b32 v60, v63
    v_max_f32 v61, v60, v63
    v_cvt_pk_bf16_f32 v114, v80, v81
    v_cvt_pk_bf16_f32 v115, v84, v85
    v_mul_f32_dpp v62, v61, v126 quad_perm:[2,3,2,3] row_mask:0xf bank_mask:0xf
    v_pk_fma_f32 v[2:3], v[2:3], s[28:29], v[62:63] op_sel_hi:[1,1,0]
    v_pk_fma_f32 v[56:57], v[56:57], s[28:29], v[62:63] op_sel_hi:[1,1,0]
    v_exp_f32 v2, v2
    v_exp_f32 v3, v3
    v_pk_fma_f32 v[58:59], v[58:59], s[28:29], v[62:63] op_sel_hi:[1,1,0]
    v_cvt_pk_bf16_f32 v80, v2, v3
    v_exp_f32 v56, v56
    v_cndmask_b32 v5, v113, v80, vcc
    v_cndmask_b32_dpp v4, v80, v113, vcc quad_perm:[2,3,2,3] row_mask:0xf bank_mask:0xf
    v_exp_f32 v57, v57
    v_exp_f32 v58, v58
    v_mfma_f32_16x16x16_bf16 v[76:79], v[4:5], v[104:105], 0
    v_cvt_pk_bf16_f32 v84, v56, v57
    v_exp_f32 v59, v59
    v_mfma_f32_16x16x16_bf16 v[72:75], v[4:5], v[114:115], 0
    v_cvt_pk_bf16_f32 v85, v58, v59
    v_mov_b32_dpp v86, v84 quad_perm:[2,3,0,1] row_mask:0xf bank_mask:0xf
    v_mov_b64 v[68:69], 0
    v_mov_b32_dpp v87, v85 quad_perm:[2,3,0,1] row_mask:0xf bank_mask:0xf
    v_mov_b64 v[70:71], 0
    v_mov_b64 v[80:81], 0
    v_mfma_f32_16x16x32_bf16 v[76:79], v[84:87], v[104:107], v[76:79]
    ds_read_b128 v[32:35], v125 offset:6144
    v_smfmac_f32_16x16x64_bf16 v[72:75], v[84:87], v[88:95], v117
    ds_read_b128 v[36:39], v125 offset:7168
    s_nop 2
    v_rcp_f32_dpp v60, v76 quad_perm:[2,3,2,3] row_mask:0xf bank_mask:0xf
    v_rcp_f32_dpp v61, v77 quad_perm:[2,3,2,3] row_mask:0xf bank_mask:0xf
    s_nop 1
    v_pk_mul_f32 v[72:73], v[72:73], v[60:61]
    v_pk_mul_f32 v[74:75], v[74:75], v[60:61]
    v_cvt_pk_bf16_f32 v56, v72, v73
    v_cvt_pk_bf16_f32 v57, v74, v75
    ds_write_b64 v121, v[56:57] offset:15360
    v_mov_b64 v[82:83], 0
    v_mov_b64 v[84:85], 0
    v_mov_b64 v[86:87], 0
    v_mov_b64 v[72:73], 0
    v_mov_b64 v[74:75], 0
    v_mov_b64 v[76:77], 0
    v_mov_b64 v[78:79], 0
    v_mov_b64 v[88:89], 0
    v_mov_b64 v[90:91], 0
    v_mov_b64 v[92:93], 0
    v_mov_b64 v[94:95], 0
    s_waitcnt vmcnt(6)
    s_waitcnt lgkmcnt(0)
    s_barrier
    ds_read_b64_tr_b16 v[96:97], v122 offset:14336
    ds_read_b64_tr_b16 v[98:99], v122 offset:14848
    ds_read_b64_tr_b16 v[100:101], v122 offset:15360
    ds_read_b64_tr_b16 v[102:103], v122 offset:15872
    ds_read_b128 v[40:43], v125 offset:16384
    ds_read_b128 v[44:47], v125 offset:17408
    s_waitcnt lgkmcnt(4)
    v_smfmac_f32_16x16x64_bf16 v[72:75], v[96:99], a[176:183], v117
    ds_read_b128 v[24:27], v125 offset:28672
    s_waitcnt lgkmcnt(3)
    v_smfmac_f32_16x16x64_bf16 v[72:75], v[100:103], a[192:199], v117
    ds_read_b128 v[28:31], v125 offset:29696
    v_smfmac_f32_16x16x64_bf16 v[76:79], v[96:99], a[184:191], v117
    ds_read_b128 v[56:59], v125 offset:30720
    v_smfmac_f32_16x16x64_bf16 v[76:79], v[100:103], a[200:207], v117
    ds_read_b128 v[60:63], v125 offset:31744
    v_add_f32 v72, v72, v74
    v_add_f32 v73, v73, v75
    v_cvt_pk_bf16_f32 v72, v72, v73
    v_smfmac_f32_16x16x64_bf16 v[80:83], v[96:99], a[208:215], v117
    global_store_dword v119, v72, s[16:17] offset:-4096
    s_nop 1
    v_add_f32 v76, v76, v78
    v_add_f32 v77, v77, v79
    v_cvt_pk_bf16_f32 v76, v76, v77
    v_smfmac_f32_16x16x64_bf16 v[80:83], v[100:103], a[224:231], v117
    global_store_dword v119, v76, s[32:33] offset:-4096
    v_smfmac_f32_16x16x64_bf16 v[84:87], v[96:99], a[216:223], v117
    v_smfmac_f32_16x16x64_bf16 v[84:87], v[100:103], a[232:239], v117
    v_add_f32 v80, v80, v82
    v_smfmac_f32_16x16x64_bf16 v[64:67], v[96:99], a[240:247], v117
    v_add_f32 v81, v81, v83
    v_cvt_pk_bf16_f32 v80, v80, v81
    v_smfmac_f32_16x16x64_bf16 v[64:67], v[100:103], v[48:55], v117
    global_store_dword v119, v80, s[16:17] offset:-2048
    v_add_f32 v84, v84, v86
    v_smfmac_f32_16x16x64_bf16 v[68:71], v[96:99], a[248:255], v117
    v_add_f32 v85, v85, v87
    v_cvt_pk_bf16_f32 v84, v84, v85
    v_smfmac_f32_16x16x64_bf16 v[68:71], v[100:103], v[32:39], v117
    s_waitcnt lgkmcnt(4)
    global_store_dword v119, v84, s[32:33] offset:-2048
    v_add_f32 v64, v64, v66
    v_smfmac_f32_16x16x64_bf16 v[88:91], v[96:99], v[40:47], v117
    s_waitcnt lgkmcnt(2)
    v_add_f32 v65, v65, v67
    v_cvt_pk_bf16_f32 v64, v64, v65
    v_smfmac_f32_16x16x64_bf16 v[88:91], v[100:103], v[24:31], v117
    global_store_dword v119, v64, s[16:17] offset:0
    v_add_f32 v68, v68, v70
    v_smfmac_f32_16x16x64_bf16 v[92:95], v[96:99], v[8:15], v117
    s_waitcnt lgkmcnt(0)
    v_add_f32 v69, v69, v71
    v_cvt_pk_bf16_f32 v68, v68, v69
    v_smfmac_f32_16x16x64_bf16 v[92:95], v[100:103], v[56:63], v117
    global_store_dword v119, v68, s[32:33] offset:0
    v_add_f32 v88, v88, v90
    v_add_f32 v89, v89, v91
    v_cvt_pk_bf16_f32 v88, v88, v89
    global_store_dword v119, v88, s[16:17] offset:2048
    s_mov_b32 m0, 4096
    ds_read_b128 v[32:35], v125 offset:0
    ds_read_b128 v[36:39], v125 offset:1024
    v_add_f32 v92, v92, v94
    v_add_f32 v93, v93, v95
    v_cvt_pk_bf16_f32 v92, v92, v93
    global_store_dword v119, v92, s[32:33] offset:2048
    s_barrier
    ds_read_b128 v[40:43], v125 offset:8192
    ds_read_b128 v[44:47], v125 offset:9216
    ds_read_b128 v[48:51], v125 offset:2048
    ds_read_b128 v[52:55], v125 offset:3072
    ds_read_b128 v[96:99], v125 offset:10240
    ds_read_b128 v[100:103], v125 offset:11264
    v_mov_b64 v[64:65], 0
    v_mov_b64 v[66:67], 0
    v_mov_b64 v[68:69], 0
    v_mov_b64 v[70:71], 0
    v_mov_b64 v[72:73], 0
    v_mov_b64 v[74:75], 0
    v_mov_b64 v[76:77], 0
    v_mov_b64 v[78:79], 0
    v_mov_b64 v[80:81], 0
    v_mov_b64 v[82:83], 0
    v_mov_b64 v[84:85], 0
    v_mov_b64 v[86:87], 0
    s_waitcnt vmcnt(8)
    v_xor_b32 v112, 8, v109
    global_load_dword v0, v123, s[20:21] offset:0 sc1
    global_load_dword v1, v123, s[20:21] offset:256 sc1
    global_load_dword v2, v123, s[20:21] offset:512 sc1
    global_load_dword v3, v123, s[20:21] offset:768 sc1
    global_load_dword v4, v123, s[20:21] offset:1024 sc1
    global_load_dword v5, v123, s[20:21] offset:1280 sc1
    global_load_dword v6, v123, s[20:21] offset:1536 sc1
    global_load_dword v7, v123, s[20:21] offset:1792 sc1
    ds_read_b64 v[90:91], v109 offset:27648
    ds_read_b64 v[88:89], v112 offset:26624
    ds_read_b64 v[94:95], v109 offset:28160
    ds_read_b64 v[92:93], v112 offset:27136
    ds_read_b128 v[56:59], v111 offset:24576
    ds_read_b128 v[60:63], v111 offset:25600
    s_waitcnt lgkmcnt(2)
    v_swap_b32 v89, v90
    v_swap_b32 v93, v94
    s_waitcnt vmcnt(4)
    v_mfma_f32_16x16x32_bf16 v[24:27], v[104:107], v[0:3], 0
    v_max3_u32 v28, v0, v1, v2
    s_waitcnt vmcnt(0)
    v_mfma_f32_16x16x32_bf16 v[24:27], v[104:107], v[4:7], v[24:27]
    v_max3_u32 v29, v4, v5, v6
    v_max3_u32 v28, v28, v3, v7
    v_cmp_u_f32 vcc, v28, v29
    s_nop 4
    v_cvt_pk_bf16_f32 v114, v24, v24
    s_cbranch_vccnz Lpf_209
Lpj_210:
    global_store_short v120, v114, s[10:11]
    s_branch Lhl2_160
Llast_161:
    global_store_short v120, v114, s[24:25] sc1
    s_branch L_fin
Lfa_162:
    s_waitcnt lgkmcnt(1)
    ds_read_b128 v[0:3], v118 offset:0
    ds_read_b128 v[4:7], v118 offset:2048
    global_load_lds_dwordx4 v127, s[10:11] sc1
    global_load_lds_dwordx4 v127, s[10:11] offset:2048 sc1
Lqb_164:
    ds_read_b128 v[8:11], v118 offset:1024
    ds_read_b128 v[12:15], v118 offset:3072
    v_smfmac_f32_16x16x64_bf16 v[72:75], v[24:27], v[32:39], v117
    v_max_u32 v112, v24, v28
    v_cmp_eq_u32 vcc, -1, v112
    v_smfmac_f32_16x16x64_bf16 v[72:75], v[28:31], v[40:47], v117
    v_smfmac_f32_16x16x64_bf16 v[76:79], v[24:27], v[48:55], v117
    s_cbranch_vccnz Lfb_163
    v_mov_b64 v[64:65], 0
    v_mov_b64 v[66:67], 0
    v_smfmac_f32_16x16x64_bf16 v[76:79], v[28:31], v[96:103], v117
    global_store_short v120, v108, s[12:13]
    s_mov_b32 m0, 24576
    v_mov_b64 v[68:69], 0
    v_mov_b64 v[70:71], 0
    v_smfmac_f32_16x16x64_bf16 v[64:67], v[24:27], v[128:135], v117
    global_load_lds_dwordx4 v118, s[22:23] offset:0 sc1
    v_smfmac_f32_16x16x64_bf16 v[64:67], v[28:31], v[144:151], v117
    ds_read_b128 v[16:19], v118 offset:4096
    s_waitcnt lgkmcnt(1)
    v_cmp_u_f32 vcc, v8, v12
    v_smfmac_f32_16x16x64_bf16 v[68:71], v[24:27], v[136:143], v117
    global_store_short v120, v114, s[24:25] sc1
    ds_read_b128 v[20:23], v118 offset:6144
    v_smfmac_f32_16x16x64_bf16 v[68:71], v[28:31], v[152:159], v117
    s_cbranch_vccnz Lfs_170
Lbk_171:
    s_branch Lqj_166
Lfb_163:
    v_mov_b64 v[64:65], 0
    v_mov_b64 v[66:67], 0
    v_mov_b64 v[68:69], 0
    v_mov_b64 v[70:71], 0
    v_mov_b64 v[72:73], 0
    v_mov_b64 v[74:75], 0
    s_nop 0
    v_mov_b64 v[76:77], 0
    v_mov_b64 v[78:79], 0
Lr0_173:
    ds_read_b128 v[24:27], v118 offset:0
    ds_read_b128 v[28:31], v118 offset:2048
    global_load_lds_dwordx4 v127, s[10:11] sc1
    global_load_lds_dwordx4 v127, s[10:11] offset:2048 sc1
    s_waitcnt lgkmcnt(2)
    v_max_u32 v112, v0, v4
    v_cmp_eq_u32 vcc, -1, v112
    s_cbranch_vccz Lqa_165
    ds_read_b128 v[0:3], v118 offset:0
    ds_read_b128 v[4:7], v118 offset:2048
    global_load_lds_dwordx4 v127, s[10:11] sc1
    global_load_lds_dwordx4 v127, s[10:11] offset:2048 sc1
    s_waitcnt lgkmcnt(2)
    v_max_u32 v112, v24, v28
    v_cmp_eq_u32 vcc, -1, v112
    s_cbranch_vccz Lqb_164
    s_sub_u32 s27, s27, 1
    s_cbranch_scc0 Lr0_173
    s_branch L_fin
Lqa_165:
    ds_read_b128 v[8:11], v118 offset:1024
    ds_read_b128 v[12:15], v118 offset:3072
    v_smfmac_f32_16x16x64_bf16 v[64:67], v[0:3], v[128:135], v117
    v_smfmac_f32_16x16x64_bf16 v[64:67], v[4:7], v[144:151], v117
    v_smfmac_f32_16x16x64_bf16 v[68:71], v[0:3], v[136:143], v117
    v_smfmac_f32_16x16x64_bf16 v[68:71], v[4:7], v[152:159], v117
    global_store_short v120, v108, s[12:13]
    s_mov_b32 m0, 24576
    v_smfmac_f32_16x16x64_bf16 v[72:75], v[0:3], v[32:39], v117
    global_load_lds_dwordx4 v118, s[22:23] offset:0 sc1
    v_smfmac_f32_16x16x64_bf16 v[72:75], v[4:7], v[40:47], v117
    ds_read_b128 v[16:19], v118 offset:4096
    s_waitcnt lgkmcnt(1)
    v_cmp_u_f32 vcc, v8, v12
    v_smfmac_f32_16x16x64_bf16 v[76:79], v[0:3], v[48:55], v117
    global_store_short v120, v114, s[24:25] sc1
    ds_read_b128 v[20:23], v118 offset:6144
    v_smfmac_f32_16x16x64_bf16 v[76:79], v[4:7], v[96:103], v117
    s_cbranch_vccnz Lfs_174
Lbk_175:
    s_branch Lqj_166
Lpf_184:
    global_load_dword v16, v123, s[18:19] offset:0 sc1
    global_load_dword v17, v123, s[18:19] offset:256 sc1
    global_load_dword v18, v123, s[18:19] offset:512 sc1
    global_load_dword v19, v123, s[18:19] offset:768 sc1
    global_load_dword v20, v123, s[18:19] offset:1024 sc1
    global_load_dword v21, v123, s[18:19] offset:1280 sc1
    global_load_dword v22, v123, s[18:19] offset:1536 sc1
    global_load_dword v23, v123, s[18:19] offset:1792 sc1
    global_load_dword v8, v123, s[18:19] offset:0 sc1
    global_load_dword v9, v123, s[18:19] offset:256 sc1
    global_load_dword v10, v123, s[18:19] offset:512 sc1
    global_load_dword v11, v123, s[18:19] offset:768 sc1
    global_load_dword v12, v123, s[18:19] offset:1024 sc1
    global_load_dword v13, v123, s[18:19] offset:1280 sc1
    global_load_dword v14, v123, s[18:19] offset:1536 sc1
    global_load_dword v15, v123, s[18:19] offset:1792 sc1
    s_waitcnt vmcnt(12)
    v_mfma_f32_16x16x32_bf16 v[24:27], v[104:107], v[16:19], 0
    v_max3_u32 v28, v16, v17, v18
    s_waitcnt vmcnt(8)
    v_mfma_f32_16x16x32_bf16 v[24:27], v[104:107], v[20:23], v[24:27]
    v_max3_u32 v29, v20, v21, v22
    v_max3_u32 v28, v28, v19, v23
    v_max_u32 v28, v28, v29
    v_cmp_eq_u32 vcc, -1, v28
    s_nop 3
    v_cvt_pk_bf16_f32 v114, v24, v24
    s_cbranch_vccz Lpj_185
Lpl_186:
    global_load_dword v16, v123, s[18:19] offset:0 sc1
    global_load_dword v17, v123, s[18:19] offset:256 sc1
    global_load_dword v18, v123, s[18:19] offset:512 sc1
    global_load_dword v19, v123, s[18:19] offset:768 sc1
    global_load_dword v20, v123, s[18:19] offset:1024 sc1
    global_load_dword v21, v123, s[18:19] offset:1280 sc1
    global_load_dword v22, v123, s[18:19] offset:1536 sc1
    global_load_dword v23, v123, s[18:19] offset:1792 sc1
    s_waitcnt vmcnt(12)
    v_mfma_f32_16x16x32_bf16 v[24:27], v[104:107], v[8:11], 0
    v_max3_u32 v28, v8, v9, v10
    s_waitcnt vmcnt(8)
    v_mfma_f32_16x16x32_bf16 v[24:27], v[104:107], v[12:15], v[24:27]
    v_max3_u32 v29, v12, v13, v14
    v_max3_u32 v28, v28, v11, v15
    v_max_u32 v28, v28, v29
    v_cmp_eq_u32 vcc, -1, v28
    s_nop 3
    v_cvt_pk_bf16_f32 v114, v24, v24
    s_cbranch_vccz Lpj_185
    global_load_dword v8, v123, s[18:19] offset:0 sc1
    global_load_dword v9, v123, s[18:19] offset:256 sc1
    global_load_dword v10, v123, s[18:19] offset:512 sc1
    global_load_dword v11, v123, s[18:19] offset:768 sc1
    global_load_dword v12, v123, s[18:19] offset:1024 sc1
    global_load_dword v13, v123, s[18:19] offset:1280 sc1
    global_load_dword v14, v123, s[18:19] offset:1536 sc1
    global_load_dword v15, v123, s[18:19] offset:1792 sc1
    s_waitcnt vmcnt(12)
    v_mfma_f32_16x16x32_bf16 v[24:27], v[104:107], v[16:19], 0
    v_max3_u32 v28, v16, v17, v18
    s_waitcnt vmcnt(8)
    v_mfma_f32_16x16x32_bf16 v[24:27], v[104:107], v[20:23], v[24:27]
    v_max3_u32 v29, v20, v21, v22
    v_max3_u32 v28, v28, v19, v23
    v_max_u32 v28, v28, v29
    v_cmp_eq_u32 vcc, -1, v28
    s_nop 3
    v_cvt_pk_bf16_f32 v114, v24, v24
    s_cbranch_vccz Lpj_185
    s_sub_u32 s27, s27, 1
    s_cbranch_scc0 Lpl_186
    s_branch L_fin
Lfa_187:
    s_waitcnt lgkmcnt(1)
    ds_read_b128 v[0:3], v118 offset:0
    ds_read_b128 v[4:7], v118 offset:2048
    global_load_lds_dwordx4 v127, s[12:13] sc1
    global_load_lds_dwordx4 v127, s[12:13] offset:2048 sc1
Lqb_189:
    ds_read_b128 v[8:11], v118 offset:1024
    ds_read_b128 v[12:15], v118 offset:3072
    v_smfmac_f32_16x16x64_bf16 v[72:75], v[24:27], v[32:39], v117
    v_max_u32 v112, v24, v28
    v_cmp_eq_u32 vcc, -1, v112
    v_smfmac_f32_16x16x64_bf16 v[72:75], v[28:31], v[40:47], v117
    v_smfmac_f32_16x16x64_bf16 v[76:79], v[24:27], v[48:55], v117
    s_cbranch_vccnz Lfb_188
    v_mov_b64 v[64:65], 0
    v_mov_b64 v[66:67], 0
    v_smfmac_f32_16x16x64_bf16 v[76:79], v[28:31], v[96:103], v117
    global_store_short v120, v108, s[10:11]
    s_mov_b32 m0, 24576
    v_mov_b64 v[68:69], 0
    v_mov_b64 v[70:71], 0
    v_smfmac_f32_16x16x64_bf16 v[64:67], v[24:27], v[128:135], v117
    global_load_lds_dwordx4 v118, s[22:23] offset:0 sc1
    v_smfmac_f32_16x16x64_bf16 v[64:67], v[28:31], v[144:151], v117
    ds_read_b128 v[16:19], v118 offset:4096
    s_waitcnt lgkmcnt(1)
    v_cmp_u_f32 vcc, v8, v12
    v_smfmac_f32_16x16x64_bf16 v[68:71], v[24:27], v[136:143], v117
    global_store_short v120, v114, s[24:25] sc1
    ds_read_b128 v[20:23], v118 offset:6144
    v_smfmac_f32_16x16x64_bf16 v[68:71], v[28:31], v[152:159], v117
    s_cbranch_vccnz Lfs_195
Lbk_196:
    s_branch Lqj_191
Lfb_188:
    v_mov_b64 v[64:65], 0
    v_mov_b64 v[66:67], 0
    v_mov_b64 v[68:69], 0
    v_mov_b64 v[70:71], 0
    v_mov_b64 v[72:73], 0
    v_mov_b64 v[74:75], 0
    s_nop 0
    v_mov_b64 v[76:77], 0
    v_mov_b64 v[78:79], 0
Lr0_198:
    ds_read_b128 v[24:27], v118 offset:0
    ds_read_b128 v[28:31], v118 offset:2048
    global_load_lds_dwordx4 v127, s[12:13] sc1
    global_load_lds_dwordx4 v127, s[12:13] offset:2048 sc1
    s_waitcnt lgkmcnt(2)
    v_max_u32 v112, v0, v4
    v_cmp_eq_u32 vcc, -1, v112
    s_cbranch_vccz Lqa_190
    ds_read_b128 v[0:3], v118 offset:0
    ds_read_b128 v[4:7], v118 offset:2048
    global_load_lds_dwordx4 v127, s[12:13] sc1
    global_load_lds_dwordx4 v127, s[12:13] offset:2048 sc1
    s_waitcnt lgkmcnt(2)
    v_max_u32 v112, v24, v28
    v_cmp_eq_u32 vcc, -1, v112
    s_cbranch_vccz Lqb_189
    s_sub_u32 s27, s27, 1
    s_cbranch_scc0 Lr0_198
    s_branch L_fin
Lqa_190:
    ds_read_b128 v[8:11], v118 offset:1024
    ds_read_b128 v[12:15], v118 offset:3072
    v_smfmac_f32_16x16x64_bf16 v[64:67], v[0:3], v[128:135], v117
    v_smfmac_f32_16x16x64_bf16 v[64:67], v[4:7], v[144:151], v117
    v_smfmac_f32_16x16x64_bf16 v[68:71], v[0:3], v[136:143], v117
    v_smfmac_f32_16x16x64_bf16 v[68:71], v[4:7], v[152:159], v117
    global_store_short v120, v108, s[10:11]
    s_mov_b32 m0, 24576
    v_smfmac_f32_16x16x64_bf16 v[72:75], v[0:3], v[32:39], v117
    global_load_lds_dwordx4 v118, s[22:23] offset:0 sc1
    v_smfmac_f32_16x16x64_bf16 v[72:75], v[4:7], v[40:47], v117
    ds_read_b128 v[16:19], v118 offset:4096
    s_waitcnt lgkmcnt(1)
    v_cmp_u_f32 vcc, v8, v12
    v_smfmac_f32_16x16x64_bf16 v[76:79], v[0:3], v[48:55], v117
    global_store_short v120, v114, s[24:25] sc1
    ds_read_b128 v[20:23], v118 offset:6144
    v_smfmac_f32_16x16x64_bf16 v[76:79], v[4:7], v[96:103], v117
    s_cbranch_vccnz Lfs_199
Lbk_200:
    s_branch Lqj_191
Lpf_209:
    global_load_dword v16, v123, s[20:21] offset:0 sc1
    global_load_dword v17, v123, s[20:21] offset:256 sc1
    global_load_dword v18, v123, s[20:21] offset:512 sc1
    global_load_dword v19, v123, s[20:21] offset:768 sc1
    global_load_dword v20, v123, s[20:21] offset:1024 sc1
    global_load_dword v21, v123, s[20:21] offset:1280 sc1
    global_load_dword v22, v123, s[20:21] offset:1536 sc1
    global_load_dword v23, v123, s[20:21] offset:1792 sc1
    global_load_dword v8, v123, s[20:21] offset:0 sc1
    global_load_dword v9, v123, s[20:21] offset:256 sc1
    global_load_dword v10, v123, s[20:21] offset:512 sc1
    global_load_dword v11, v123, s[20:21] offset:768 sc1
    global_load_dword v12, v123, s[20:21] offset:1024 sc1
    global_load_dword v13, v123, s[20:21] offset:1280 sc1
    global_load_dword v14, v123, s[20:21] offset:1536 sc1
    global_load_dword v15, v123, s[20:21] offset:1792 sc1
    s_waitcnt vmcnt(12)
    v_mfma_f32_16x16x32_bf16 v[24:27], v[104:107], v[16:19], 0
    v_max3_u32 v28, v16, v17, v18
    s_waitcnt vmcnt(8)
    v_mfma_f32_16x16x32_bf16 v[24:27], v[104:107], v[20:23], v[24:27]
    v_max3_u32 v29, v20, v21, v22
    v_max3_u32 v28, v28, v19, v23
    v_max_u32 v28, v28, v29
    v_cmp_eq_u32 vcc, -1, v28
    s_nop 3
    v_cvt_pk_bf16_f32 v114, v24, v24
    s_cbranch_vccz Lpj_210
Lpl_211:
    global_load_dword v16, v123, s[20:21] offset:0 sc1
    global_load_dword v17, v123, s[20:21] offset:256 sc1
    global_load_dword v18, v123, s[20:21] offset:512 sc1
    global_load_dword v19, v123, s[20:21] offset:768 sc1
    global_load_dword v20, v123, s[20:21] offset:1024 sc1
    global_load_dword v21, v123, s[20:21] offset:1280 sc1
    global_load_dword v22, v123, s[20:21] offset:1536 sc1
    global_load_dword v23, v123, s[20:21] offset:1792 sc1
    s_waitcnt vmcnt(12)
    v_mfma_f32_16x16x32_bf16 v[24:27], v[104:107], v[8:11], 0
    v_max3_u32 v28, v8, v9, v10
    s_waitcnt vmcnt(8)
    v_mfma_f32_16x16x32_bf16 v[24:27], v[104:107], v[12:15], v[24:27]
    v_max3_u32 v29, v12, v13, v14
    v_max3_u32 v28, v28, v11, v15
    v_max_u32 v28, v28, v29
    v_cmp_eq_u32 vcc, -1, v28
    s_nop 3
    v_cvt_pk_bf16_f32 v114, v24, v24
    s_cbranch_vccz Lpj_210
    global_load_dword v8, v123, s[20:21] offset:0 sc1
    global_load_dword v9, v123, s[20:21] offset:256 sc1
    global_load_dword v10, v123, s[20:21] offset:512 sc1
    global_load_dword v11, v123, s[20:21] offset:768 sc1
    global_load_dword v12, v123, s[20:21] offset:1024 sc1
    global_load_dword v13, v123, s[20:21] offset:1280 sc1
    global_load_dword v14, v123, s[20:21] offset:1536 sc1
    global_load_dword v15, v123, s[20:21] offset:1792 sc1
    s_waitcnt vmcnt(12)
    v_mfma_f32_16x16x32_bf16 v[24:27], v[104:107], v[16:19], 0
    v_max3_u32 v28, v16, v17, v18
    s_waitcnt vmcnt(8)
    v_mfma_f32_16x16x32_bf16 v[24:27], v[104:107], v[20:23], v[24:27]
    v_max3_u32 v29, v20, v21, v22
    v_max3_u32 v28, v28, v19, v23
    v_max_u32 v28, v28, v29
    v_cmp_eq_u32 vcc, -1, v28
    s_nop 3
    v_cvt_pk_bf16_f32 v114, v24, v24
    s_cbranch_vccz Lpj_210
    s_sub_u32 s27, s27, 1
    s_cbranch_scc0 Lpl_211
    s_branch L_fin
Lfs_167:
Lfl_169:
    ds_read_b128 v[8:11], v118 offset:1024
    ds_read_b128 v[12:15], v118 offset:3072
    s_sub_u32 s27, s27, 1
    s_waitcnt lgkmcnt(0)
    v_max_u32 v112, v8, v12
    v_cmp_eq_u32 vcc, -1, v112
    s_cbranch_vccz Lbk_168
    s_cbranch_scc0 Lfl_169
    s_branch L_fin
Lfs_170:
Lfl_172:
    ds_read_b128 v[8:11], v118 offset:1024
    ds_read_b128 v[12:15], v118 offset:3072
    s_sub_u32 s27, s27, 1
    s_waitcnt lgkmcnt(0)
    v_max_u32 v112, v8, v12
    v_cmp_eq_u32 vcc, -1, v112
    s_cbranch_vccz Lbk_171
    s_cbranch_scc0 Lfl_172
    s_branch L_fin
Lfs_174:
Lfl_176:
    ds_read_b128 v[8:11], v118 offset:1024
    ds_read_b128 v[12:15], v118 offset:3072
    s_sub_u32 s27, s27, 1
    s_waitcnt lgkmcnt(0)
    v_max_u32 v112, v8, v12
    v_cmp_eq_u32 vcc, -1, v112
    s_cbranch_vccz Lbk_175
    s_cbranch_scc0 Lfl_176
    s_branch L_fin
Lfs_177:
Lfl_179:
    ds_read_b128 v[16:19], v118 offset:4096
    ds_read_b128 v[20:23], v118 offset:6144
    s_sub_u32 s27, s27, 1
    s_waitcnt lgkmcnt(0)
    v_max_u32 v112, v16, v20
    v_cmp_eq_u32 vcc, -1, v112
    s_cbranch_vccz Lbk_178
    s_waitcnt vmcnt(4)
    ds_read_b128 v[16:19], v118 offset:4096
    ds_read_b128 v[20:23], v118 offset:6144
    s_sub_u32 s27, s27, 1
    s_waitcnt lgkmcnt(0)
    v_max_u32 v112, v16, v20
    v_cmp_eq_u32 vcc, -1, v112
    s_cbranch_vccz Lbk_178
Lfl_180:
    s_mov_b32 s40, m0
    s_mov_b32 m0, 4096
    s_nop 0
    global_load_lds_dwordx4 v127, s[10:11] sc1
    global_load_lds_dwordx4 v127, s[10:11] offset:2048 sc1
    s_waitcnt vmcnt(0)
    s_mov_b32 m0, s40
    ds_read_b128 v[16:19], v118 offset:4096
    ds_read_b128 v[20:23], v118 offset:6144
    s_sub_u32 s27, s27, 1
    s_waitcnt lgkmcnt(0)
    v_max_u32 v112, v16, v20
    v_cmp_eq_u32 vcc, -1, v112
    s_cbranch_vccz Lbk_178
    s_cbranch_scc0 Lfl_180
    s_branch L_fin
Lfs_181:
Lfl_183:
    ds_read_b128 v[24:27], v118 offset:5120
    ds_read_b128 v[28:31], v118 offset:7168
    s_sub_u32 s27, s27, 1
    s_waitcnt lgkmcnt(0)
    v_max_u32 v112, v24, v28
    v_cmp_eq_u32 vcc, -1, v112
    s_cbranch_vccz Lbk_182
    s_cbranch_scc0 Lfl_183
    s_branch L_fin
Lfs_192:
Lfl_194:
    ds_read_b128 v[8:11], v118 offset:1024
    ds_read_b128 v[12:15], v118 offset:3072
    s_sub_u32 s27, s27, 1
    s_waitcnt lgkmcnt(0)
    v_max_u32 v112, v8, v12
    v_cmp_eq_u32 vcc, -1, v112
    s_cbranch_vccz Lbk_193
    s_cbranch_scc0 Lfl_194
    s_branch L_fin
Lfs_195:
Lfl_197:
    ds_read_b128 v[8:11], v118 offset:1024
    ds_read_b128 v[12:15], v118 offset:3072
    s_sub_u32 s27, s27, 1
    s_waitcnt lgkmcnt(0)
    v_max_u32 v112, v8, v12
    v_cmp_eq_u32 vcc, -1, v112
    s_cbranch_vccz Lbk_196
    s_cbranch_scc0 Lfl_197
    s_branch L_fin
Lfs_199:
Lfl_201:
    ds_read_b128 v[8:11], v118 offset:1024
    ds_read_b128 v[12:15], v118 offset:3072
    s_sub_u32 s27, s27, 1
    s_waitcnt lgkmcnt(0)
    v_max_u32 v112, v8, v12
    v_cmp_eq_u32 vcc, -1, v112
    s_cbranch_vccz Lbk_200
    s_cbranch_scc0 Lfl_201
    s_branch L_fin
Lfs_202:
Lfl_204:
    ds_read_b128 v[16:19], v118 offset:4096
    ds_read_b128 v[20:23], v118 offset:6144
    s_sub_u32 s27, s27, 1
    s_waitcnt lgkmcnt(0)
    v_max_u32 v112, v16, v20
    v_cmp_eq_u32 vcc, -1, v112
    s_cbranch_vccz Lbk_203
    s_waitcnt vmcnt(4)
    ds_read_b128 v[16:19], v118 offset:4096
    ds_read_b128 v[20:23], v118 offset:6144
    s_sub_u32 s27, s27, 1
    s_waitcnt lgkmcnt(0)
    v_max_u32 v112, v16, v20
    v_cmp_eq_u32 vcc, -1, v112
    s_cbranch_vccz Lbk_203
Lfl_205:
    s_mov_b32 s40, m0
    s_mov_b32 m0, 4096
    s_nop 0
    global_load_lds_dwordx4 v127, s[12:13] sc1
    global_load_lds_dwordx4 v127, s[12:13] offset:2048 sc1
    s_waitcnt vmcnt(0)
    s_mov_b32 m0, s40
    ds_read_b128 v[16:19], v118 offset:4096
    ds_read_b128 v[20:23], v118 offset:6144
    s_sub_u32 s27, s27, 1
    s_waitcnt lgkmcnt(0)
    v_max_u32 v112, v16, v20
    v_cmp_eq_u32 vcc, -1, v112
    s_cbranch_vccz Lbk_203
    s_cbranch_scc0 Lfl_205
    s_branch L_fin
Lfs_206:
Lfl_208:
    ds_read_b128 v[24:27], v118 offset:5120
    ds_read_b128 v[28:31], v118 offset:7168
    s_sub_u32 s27, s27, 1
    s_waitcnt lgkmcnt(0)
    v_max_u32 v112, v24, v28
    v_cmp_eq_u32 vcc, -1, v112
    s_cbranch_vccz Lbk_207
    s_cbranch_scc0 Lfl_208
    s_branch L_fin
Lwv_41:
    s_mov_b32 m0, 5120
    ds_read_b128 v[32:35], v125 offset:0
    ds_read_b128 v[36:39], v125 offset:1024
    ds_read_b128 v[40:43], v125 offset:8192
    ds_read_b128 v[44:47], v125 offset:9216
    ds_read_b128 v[48:51], v125 offset:2048
    ds_read_b128 v[52:55], v125 offset:3072
    ds_read_b128 v[96:99], v125 offset:10240
    ds_read_b128 v[100:103], v125 offset:11264
    v_mov_b64 v[64:65], 0
    v_mov_b64 v[66:67], 0
    v_mov_b64 v[68:69], 0
    v_mov_b64 v[70:71], 0
    v_mov_b64 v[72:73], 0
    v_mov_b64 v[74:75], 0
    v_mov_b64 v[76:77], 0
    v_mov_b64 v[78:79], 0
    v_mov_b64 v[80:81], 0
    v_mov_b64 v[82:83], 0
    v_mov_b64 v[84:85], 0
    v_mov_b64 v[86:87], 0
    v_xor_b32 v112, 8, v109
    ds_read_b64 v[90:91], v109 offset:31744
    ds_read_b64 v[88:89], v112 offset:30720
    ds_read_b64 v[94:95], v109 offset:32256
    ds_read_b64 v[92:93], v112 offset:31232
    ds_read_b128 v[56:59], v111 offset:28672
    ds_read_b128 v[60:63], v111 offset:29696
    s_waitcnt lgkmcnt(2)
    v_swap_b32 v89, v90
    v_swap_b32 v93, v94
    v_and_b32 v116, 768, v118
Lhl3_212:
    s_waitcnt vmcnt(0)
    global_load_lds_dwordx4 v127, s[10:11] sc1
    global_load_lds_dwordx4 v127, s[10:11] offset:2048 sc1
    s_barrier
    ds_read_b128 v[0:3], v118 offset:0
    ds_read_b128 v[4:7], v118 offset:2048
    global_load_lds_dwordx4 v127, s[10:11] sc1
    global_load_lds_dwordx4 v127, s[10:11] offset:2048 sc1
    s_waitcnt lgkmcnt(1)
    v_smfmac_f32_16x16x64_bf16 v[64:67], v[0:3], v[128:135], v117
    ds_read_b128 v[24:27], v118 offset:0
    ds_read_b128 v[8:11], v118 offset:1024
    s_waitcnt lgkmcnt(2)
    v_smfmac_f32_16x16x64_bf16 v[64:67], v[4:7], v[144:151], v117
    ds_read_b128 v[28:31], v118 offset:2048
    ds_read_b128 v[12:15], v118 offset:3072
    v_cmp_u_f32 vcc, v0, v4
    v_smfmac_f32_16x16x64_bf16 v[68:71], v[0:3], v[136:143], v117
    v_smfmac_f32_16x16x64_bf16 v[68:71], v[4:7], v[152:159], v117
    s_cbranch_vccnz Lfa_214
    global_store_short v120, v108, s[12:13]
    s_mov_b32 m0, 28672
    v_smfmac_f32_16x16x64_bf16 v[72:75], v[0:3], v[32:39], v117
    global_load_lds_dwordx4 v118, s[22:23] offset:0 sc1
    v_smfmac_f32_16x16x64_bf16 v[72:75], v[4:7], v[40:47], v117
    ds_read_b128 v[16:19], v118 offset:4096
    s_waitcnt lgkmcnt(1)
    v_cmp_u_f32 vcc, v8, v12
    v_smfmac_f32_16x16x64_bf16 v[76:79], v[0:3], v[48:55], v117
    global_store_short v120, v114, s[24:25] sc1
    ds_read_b128 v[20:23], v118 offset:6144
    v_smfmac_f32_16x16x64_bf16 v[76:79], v[4:7], v[96:103], v117
    s_cbranch_vccnz Lfs_219
Lbk_220:
Lqj_218:
    v_smfmac_f32_16x16x64_bf16 v[64:67], v[8:11], v[160:167], v117
    ds_read_b128 v[96:99], v125 offset:12288
    ds_read_b128 v[44:47], v125 offset:15360
    v_smfmac_f32_16x16x64_bf16 v[64:67], v[12:15], v[176:183], v117
    global_load_lds_dwordx4 v118, s[22:23] offset:1024 sc1
    ds_read_b128 v[100:103], v125 offset:13312
    v_smfmac_f32_16x16x64_bf16 v[68:71], v[8:11], v[168:175], v117
    ds_read_b128 v[24:27], v118 offset:5120
    s_waitcnt lgkmcnt(4)
    v_cmp_u_f32 vcc, v16, v20
    v_smfmac_f32_16x16x64_bf16 v[68:71], v[12:15], v[184:191], v117
    ds_read_b128 v[28:31], v118 offset:7168
    ds_read_b128 v[40:43], v125 offset:14336
    v_smfmac_f32_16x16x64_bf16 v[72:75], v[8:11], a[0:7], v117
    s_cbranch_vccnz Lfs_229
Lbk_230:
    ds_read_b128 v[32:35], v125 offset:20480
    v_smfmac_f32_16x16x64_bf16 v[64:67], v[16:19], v[192:199], v117
    s_add_u32 s24, s24, 8192
    s_addc_u32 s25, s25, 0
    ds_read_b128 v[36:39], v125 offset:21504
    v_smfmac_f32_16x16x64_bf16 v[64:67], v[20:23], v[208:215], v117
    global_load_lds_dwordx4 v118, s[22:23] offset:2048 sc1
    ds_read_b128 v[48:51], v125 offset:22528
    v_smfmac_f32_16x16x64_bf16 v[68:71], v[16:19], v[200:207], v117
    s_add_u32 s26, s26, 1
    s_waitcnt lgkmcnt(4)
    v_cmp_u_f32 vcc, v24, v28
    v_smfmac_f32_16x16x64_bf16 v[68:71], v[20:23], v[216:223], v117
    ds_read_b128 v[52:55], v125 offset:23552
    v_smfmac_f32_16x16x64_bf16 v[72:75], v[16:19], v[96:103], v117
    s_cbranch_vccnz Lfs_232
Lbk_233:
    v_smfmac_f32_16x16x64_bf16 v[64:67], v[24:27], v[224:231], v117
    s_mov_b64 vcc, s[64:65]
    v_mov_b32 v112, s26
    v_smfmac_f32_16x16x64_bf16 v[64:67], v[28:31], v[240:247], v117
    global_load_lds_dwordx4 v118, s[22:23] offset:3072 sc1
    v_smfmac_f32_16x16x64_bf16 v[68:71], v[24:27], v[232:239], v117
    s_add_u32 s22, s22, 524288
    s_addc_u32 s23, s23, 0
    v_smfmac_f32_16x16x64_bf16 v[68:71], v[28:31], v[248:255], v117
    s_waitcnt lgkmcnt(2)
    v_add_f32 v64, v64, v66
    v_smfmac_f32_16x16x64_bf16 v[72:75], v[20:23], v[32:39], v117
    ds_read_b128 v[32:35], v125 offset:24576
    v_add_f32 v65, v65, v67
    v_smfmac_f32_16x16x64_bf16 v[72:75], v[12:15], a[16:23], v117
    ds_read_b128 v[36:39], v125 offset:25600
    v_cvt_pk_bf16_f32 v102, v64, v65
    v_add_f32 v68, v68, v70
    v_smfmac_f32_16x16x64_bf16 v[72:75], v[24:27], a[32:39], v117
    ds_write_b32 v121, v102 offset:9220
    v_add_f32 v69, v69, v71
    v_cvt_pk_bf16_f32 v103, v68, v69
    v_smfmac_f32_16x16x64_bf16 v[72:75], v[28:31], a[48:55], v117
    ds_write_b32 v121, v103 offset:9732
    v_smfmac_f32_16x16x64_bf16 v[76:79], v[16:19], v[40:47], v117
    ds_read_b128 v[40:43], v125 offset:26624
    s_waitcnt lgkmcnt(5)
    v_smfmac_f32_16x16x64_bf16 v[76:79], v[20:23], v[48:55], v117
    ds_read_b128 v[44:47], v125 offset:27648
    v_add_f32 v72, v72, v74
    v_smfmac_f32_16x16x64_bf16 v[76:79], v[8:11], a[8:15], v117
    ds_read_b128 v[48:51], v125 offset:4096
    v_smfmac_f32_16x16x64_bf16 v[76:79], v[12:15], a[24:31], v117
    s_waitcnt lgkmcnt(3)
    s_barrier
    v_smfmac_f32_16x16x64_bf16 v[76:79], v[24:27], a[40:47], v117
    ds_read_b64_tr_b16 v[64:65], v122 offset:8192
    ds_read_b64_tr_b16 v[66:67], v122 offset:8704
    v_smfmac_f32_16x16x64_bf16 v[76:79], v[28:31], a[56:63], v117
    ds_read_b64_tr_b16 v[68:69], v122 offset:9216
    ds_read_b64_tr_b16 v[70:71], v122 offset:9728
    v_add_f32 v73, v73, v75
    v_cvt_pk_bf16_f32 v100, v72, v73
    v_smfmac_f32_16x16x64_bf16 v[80:83], v[0:3], a[64:71], v117
    ds_write_b32 v121, v100 offset:11268
    v_smfmac_f32_16x16x64_bf16 v[84:87], v[0:3], a[72:79], v117
    s_waitcnt lgkmcnt(3)
    ds_read_b128 v[52:55], v125 offset:5120
    v_add_f32 v76, v76, v78
    v_mfma_f32_16x16x32_bf16 v[96:99], v[56:59], v[64:67], 0
    s_waitcnt lgkmcnt(2)
    v_add_f32 v77, v77, v79
    v_cvt_pk_bf16_f32 v101, v76, v77
    v_mfma_f32_16x16x32_bf16 v[96:99], v[60:63], v[68:71], v[96:99]
    ds_write_b32 v121, v101 offset:11780
    v_smfmac_f32_16x16x64_bf16 v[80:83], v[4:7], a[80:87], v117
    s_mov_b32 exec_hi, 0
    global_store_dword v110, v108, s[20:21]
    s_mov_b32 exec_hi, -1
    v_smfmac_f32_16x16x64_bf16 v[84:87], v[4:7], a[88:95], v117
    v_add_f32_dpp v96, v98, v96 quad_perm:[2,3,2,3] row_mask:0xf bank_mask:0xf
    v_add_f32_dpp v97, v99, v97 quad_perm:[2,3,2,3] row_mask:0xf bank_mask:0xf
    v_smfmac_f32_16x16x64_bf16 v[80:83], v[8:11], a[96:103], v117
    ds_write_b64 v109, v[96:97] offset:13824
    v_smfmac_f32_16x16x64_bf16 v[84:87], v[8:11], a[104:111], v117
    s_waitcnt lgkmcnt(1)
    s_barrier
    v_smfmac_f32_16x16x64_bf16 v[80:83], v[12:15], a[112:119], v117
    s_waitcnt vmcnt(7)
    ds_read_b64_tr_b16 v[72:73], v122 offset:10240
    ds_read_b64_tr_b16 v[74:75], v122 offset:10752
    v_smfmac_f32_16x16x64_bf16 v[84:87], v[12:15], a[120:127], v117
    ds_read_b64_tr_b16 v[76:77], v122 offset:11264
    ds_read_b64_tr_b16 v[78:79], v122 offset:11776
    v_smfmac_f32_16x16x64_bf16 v[80:83], v[16:19], a[128:135], v117
    ds_read_b128 v[8:11], v125 offset:18432
    v_smfmac_f32_16x16x64_bf16 v[84:87], v[16:19], a[136:143], v117
    s_waitcnt lgkmcnt(5)
    s_barrier
    s_waitcnt lgkmcnt(3)
    v_mfma_f32_16x16x32_bf16 v[0:3], v[72:75], v[64:67], 0
    ds_read_b128 v[56:59], v124 offset:12288
    s_waitcnt lgkmcnt(2)
    v_mfma_f32_16x16x32_bf16 v[0:3], v[76:79], v[68:71], v[0:3]
    ds_read_b128 v[12:15], v125 offset:19456
    v_smfmac_f32_16x16x64_bf16 v[80:83], v[20:23], a[144:151], v117
    ds_write_b32 v118, v108 offset:5120
    v_smfmac_f32_16x16x64_bf16 v[84:87], v[20:23], a[152:159], v117
    ds_write_b32 v118, v108 offset:7168
    v_add_f32_dpp v2, v0, v2 quad_perm:[0,1,0,1] row_mask:0xf bank_mask:0xf
    v_smfmac_f32_16x16x64_bf16 v[80:83], v[24:27], a[160:167], v117
    s_waitcnt lgkmcnt(3)
    v_max3_f32 v60, v56, v57, v58
    v_add_f32_dpp v3, v1, v3 quad_perm:[0,1,0,1] row_mask:0xf bank_mask:0xf
    v_smfmac_f32_16x16x64_bf16 v[84:87], v[24:27], a[168:175], v117
    v_max_f32 v60, v60, v59
    v_smfmac_f32_16x16x64_bf16 v[80:83], v[28:31], v[32:39], v117
    s_nop 0
    v_max_f32_dpp v60, v60, v60 quad_perm:[2,3,0,1] row_mask:0xf bank_mask:0xf
    v_smfmac_f32_16x16x64_bf16 v[84:87], v[28:31], v[40:47], v117
    v_max3_f32 v61, v60, v2, v3
    v_max3_f32 v62, v60, v2, v3
    v_mov_b64 v[64:65], 0
    v_mov_b64 v[66:67], 0
    v_permlane16_swap_b32 v61, v62
    v_max_f32 v60, v61, v62
    v_max_f32 v63, v61, v62
    v_pk_add_f32 v[80:81], v[80:81], v[82:83]
    v_pk_add_f32 v[84:85], v[84:85], v[86:87]
    v_permlane32_swap_b32 v60, v63
    v_max_f32 v61, v60, v63
    v_cvt_pk_bf16_f32 v114, v80, v81
    v_cvt_pk_bf16_f32 v115, v84, v85
    v_mul_f32_dpp v62, v61, v126 quad_perm:[2,3,2,3] row_mask:0xf bank_mask:0xf
    v_pk_fma_f32 v[2:3], v[2:3], s[28:29], v[62:63] op_sel_hi:[1,1,0]
    v_pk_fma_f32 v[56:57], v[56:57], s[28:29], v[62:63] op_sel_hi:[1,1,0]
    v_exp_f32 v2, v2
    v_exp_f32 v3, v3
    v_pk_fma_f32 v[58:59], v[58:59], s[28:29], v[62:63] op_sel_hi:[1,1,0]
    v_cvt_pk_bf16_f32 v80, v2, v3
    v_exp_f32 v56, v56
    v_cndmask_b32 v5, v113, v80, vcc
    v_cndmask_b32_dpp v4, v80, v113, vcc quad_perm:[2,3,2,3] row_mask:0xf bank_mask:0xf
    v_exp_f32 v57, v57
    v_exp_f32 v58, v58
    v_mfma_f32_16x16x16_bf16 v[76:79], v[4:5], v[104:105], 0
    v_cvt_pk_bf16_f32 v84, v56, v57
    v_exp_f32 v59, v59
    v_mfma_f32_16x16x16_bf16 v[72:75], v[4:5], v[114:115], 0
    v_cvt_pk_bf16_f32 v85, v58, v59
    v_mov_b32_dpp v86, v84 quad_perm:[2,3,0,1] row_mask:0xf bank_mask:0xf
    v_mov_b64 v[68:69], 0
    v_mov_b32_dpp v87, v85 quad_perm:[2,3,0,1] row_mask:0xf bank_mask:0xf
    v_mov_b64 v[70:71], 0
    v_mov_b64 v[80:81], 0
    v_mfma_f32_16x16x32_bf16 v[76:79], v[84:87], v[104:107], v[76:79]
    ds_read_b128 v[32:35], v125 offset:6144
    v_smfmac_f32_16x16x64_bf16 v[72:75], v[84:87], v[88:95], v117
    ds_read_b128 v[36:39], v125 offset:7168
    s_nop 2
    v_rcp_f32_dpp v60, v76 quad_perm:[2,3,2,3] row_mask:0xf bank_mask:0xf
    v_rcp_f32_dpp v61, v77 quad_perm:[2,3,2,3] row_mask:0xf bank_mask:0xf
    s_nop 1
    v_pk_mul_f32 v[72:73], v[72:73], v[60:61]
    v_pk_mul_f32 v[74:75], v[74:75], v[60:61]
    v_cvt_pk_bf16_f32 v56, v72, v73
    v_cvt_pk_bf16_f32 v57, v74, v75
    ds_write_b64 v121, v[56:57] offset:15872
    v_mov_b64 v[82:83], 0
    v_mov_b64 v[84:85], 0
    v_mov_b64 v[86:87], 0
    v_mov_b64 v[72:73], 0
    v_mov_b64 v[74:75], 0
    v_mov_b64 v[76:77], 0
    v_mov_b64 v[78:79], 0
    v_mov_b64 v[88:89], 0
    v_mov_b64 v[90:91], 0
    v_mov_b64 v[92:93], 0
    v_mov_b64 v[94:95], 0
    s_waitcnt vmcnt(6)
    s_waitcnt lgkmcnt(0)
    s_barrier
    ds_read_b64_tr_b16 v[96:97], v122 offset:14336
    ds_read_b64_tr_b16 v[98:99], v122 offset:14848
    ds_read_b64_tr_b16 v[100:101], v122 offset:15360
    ds_read_b64_tr_b16 v[102:103], v122 offset:15872
    ds_read_b128 v[40:43], v125 offset:16384
    ds_read_b128 v[44:47], v125 offset:17408
    s_waitcnt lgkmcnt(4)
    v_smfmac_f32_16x16x64_bf16 v[72:75], v[96:99], a[176:183], v117
    s_mov_b64 exec, s[74:75]
    global_store_short v116, v112, s[94:95] offset:1024
    s_mov_b64 exec, -1
    s_waitcnt lgkmcnt(2)
    v_smfmac_f32_16x16x64_bf16 v[72:75], v[100:103], a[192:199], v117
    ds_read_b128 v[24:27], v125 offset:28672
    v_smfmac_f32_16x16x64_bf16 v[76:79], v[96:99], a[184:191], v117
    ds_read_b128 v[28:31], v125 offset:29696
    v_smfmac_f32_16x16x64_bf16 v[76:79], v[100:103], a[200:207], v117
    ds_read_b128 v[56:59], v125 offset:30720
    v_add_f32 v72, v72, v74
    v_add_f32 v73, v73, v75
    v_cvt_pk_bf16_f32 v72, v72, v73
    v_smfmac_f32_16x16x64_bf16 v[80:83], v[96:99], a[208:215], v117
    global_store_dword v119, v72, s[14:15] offset:-4096
    ds_read_b128 v[60:63], v125 offset:31744
    s_nop 0
    v_add_f32 v76, v76, v78
    v_add_f32 v77, v77, v79
    v_cvt_pk_bf16_f32 v76, v76, v77
    v_smfmac_f32_16x16x64_bf16 v[80:83], v[100:103], a[224:231], v117
    global_store_dword v119, v76, s[30:31] offset:-4096
    v_smfmac_f32_16x16x64_bf16 v[84:87], v[96:99], a[216:223], v117
    v_smfmac_f32_16x16x64_bf16 v[84:87], v[100:103], a[232:239], v117
    v_add_f32 v80, v80, v82
    v_smfmac_f32_16x16x64_bf16 v[64:67], v[96:99], a[240:247], v117
    v_add_f32 v81, v81, v83
    v_cvt_pk_bf16_f32 v80, v80, v81
    v_smfmac_f32_16x16x64_bf16 v[64:67], v[100:103], v[48:55], v117
    global_store_dword v119, v80, s[14:15] offset:-2048
    v_add_f32 v84, v84, v86
    v_smfmac_f32_16x16x64_bf16 v[68:71], v[96:99], a[248:255], v117
    v_add_f32 v85, v85, v87
    v_cvt_pk_bf16_f32 v84, v84, v85
    v_smfmac_f32_16x16x64_bf16 v[68:71], v[100:103], v[32:39], v117
    s_waitcnt lgkmcnt(4)
    global_store_dword v119, v84, s[30:31] offset:-2048
    v_add_f32 v64, v64, v66
    v_smfmac_f32_16x16x64_bf16 v[88:91], v[96:99], v[40:47], v117
    s_waitcnt lgkmcnt(2)
    v_add_f32 v65, v65, v67
    v_cvt_pk_bf16_f32 v64, v64, v65
    v_smfmac_f32_16x16x64_bf16 v[88:91], v[100:103], v[24:31], v117
    global_store_dword v119, v64, s[14:15] offset:0
    v_add_f32 v68, v68, v70
    v_smfmac_f32_16x16x64_bf16 v[92:95], v[96:99], v[8:15], v117
    s_waitcnt lgkmcnt(0)
    v_add_f32 v69, v69, v71
    v_cvt_pk_bf16_f32 v68, v68, v69
    v_smfmac_f32_16x16x64_bf16 v[92:95], v[100:103], v[56:63], v117
    global_store_dword v119, v68, s[30:31] offset:0
    v_add_f32 v88, v88, v90
    v_add_f32 v89, v89, v91
    v_cvt_pk_bf16_f32 v88, v88, v89
    global_store_dword v119, v88, s[14:15] offset:2048
    s_mov_b32 m0, 5120
    ds_read_b128 v[32:35], v125 offset:0
    ds_read_b128 v[36:39], v125 offset:1024
    v_add_f32 v92, v92, v94
    v_add_f32 v93, v93, v95
    v_cvt_pk_bf16_f32 v92, v92, v93
    global_store_dword v119, v92, s[30:31] offset:2048
    s_barrier
    ds_read_b128 v[40:43], v125 offset:8192
    ds_read_b128 v[44:47], v125 offset:9216
    ds_read_b128 v[48:51], v125 offset:2048
    ds_read_b128 v[52:55], v125 offset:3072
    ds_read_b128 v[96:99], v125 offset:10240
    ds_read_b128 v[100:103], v125 offset:11264
    v_mov_b64 v[64:65], 0
    v_mov_b64 v[66:67], 0
    v_mov_b64 v[68:69], 0
    v_mov_b64 v[70:71], 0
    v_mov_b64 v[72:73], 0
    v_mov_b64 v[74:75], 0
    v_mov_b64 v[76:77], 0
    v_mov_b64 v[78:79], 0
    v_mov_b64 v[80:81], 0
    v_mov_b64 v[82:83], 0
    v_mov_b64 v[84:85], 0
    v_mov_b64 v[86:87], 0
    s_waitcnt vmcnt(8)
    v_xor_b32 v112, 8, v109
    ds_read_b64 v[90:91], v109 offset:31744
    ds_read_b64 v[88:89], v112 offset:30720
    ds_read_b64 v[94:95], v109 offset:32256
    ds_read_b64 v[92:93], v112 offset:31232
    ds_read_b128 v[56:59], v111 offset:28672
    ds_read_b128 v[60:63], v111 offset:29696
    s_waitcnt lgkmcnt(2)
    v_swap_b32 v89, v90
    v_swap_b32 v93, v94
    global_load_dword v0, v123, s[18:19] offset:0 sc1
    global_load_dword v1, v123, s[18:19] offset:256 sc1
    global_load_dword v2, v123, s[18:19] offset:512 sc1
    global_load_dword v3, v123, s[18:19] offset:768 sc1
    global_load_dword v4, v123, s[18:19] offset:1024 sc1
    global_load_dword v5, v123, s[18:19] offset:1280 sc1
    global_load_dword v6, v123, s[18:19] offset:1536 sc1
    global_load_dword v7, v123, s[18:19] offset:1792 sc1
    s_waitcnt vmcnt(4)
    v_mfma_f32_16x16x32_bf16 v[24:27], v[104:107], v[0:3], 0
    v_max3_u32 v28, v0, v1, v2
    s_waitcnt vmcnt(0)
    v_mfma_f32_16x16x32_bf16 v[24:27], v[104:107], v[4:7], v[24:27]
    v_max3_u32 v29, v4, v5, v6
    v_max3_u32 v28, v28, v3, v7
    v_cmp_u_f32 vcc, v28, v29
    s_nop 4
    v_cvt_pk_bf16_f32 v114, v24, v24
    s_cbranch_vccnz Lpf_236
Lpj_237:
    global_store_short v120, v114, s[12:13]
    s_cmp_eq_u32 s26, 63
    s_cbranch_scc1 Llast_213
    s_waitcnt vmcnt(0)
    global_load_lds_dwordx4 v127, s[12:13] sc1
    global_load_lds_dwordx4 v127, s[12:13] offset:2048 sc1
    s_barrier
    ds_read_b128 v[0:3], v118 offset:0
    ds_read_b128 v[4:7], v118 offset:2048
    global_load_lds_dwordx4 v127, s[12:13] sc1
    global_load_lds_dwordx4 v127, s[12:13] offset:2048 sc1
    s_waitcnt lgkmcnt(1)
    v_smfmac_f32_16x16x64_bf16 v[64:67], v[0:3], v[128:135], v117
    ds_read_b128 v[24:27], v118 offset:0
    ds_read_b128 v[8:11], v118 offset:1024
    s_waitcnt lgkmcnt(2)
    v_smfmac_f32_16x16x64_bf16 v[64:67], v[4:7], v[144:151], v117
    ds_read_b128 v[28:31], v118 offset:2048
    ds_read_b128 v[12:15], v118 offset:3072
    v_cmp_u_f32 vcc, v0, v4
    v_smfmac_f32_16x16x64_bf16 v[68:71], v[0:3], v[136:143], v117
    v_smfmac_f32_16x16x64_bf16 v[68:71], v[4:7], v[152:159], v117
    s_cbranch_vccnz Lfa_239
    global_store_short v120, v108, s[10:11]
    s_mov_b32 m0, 28672
    v_smfmac_f32_16x16x64_bf16 v[72:75], v[0:3], v[32:39], v117
    global_load_lds_dwordx4 v118, s[22:23] offset:0 sc1
    v_smfmac_f32_16x16x64_bf16 v[72:75], v[4:7], v[40:47], v117
    ds_read_b128 v[16:19], v118 offset:4096
    s_waitcnt lgkmcnt(1)
    v_cmp_u_f32 vcc, v8, v12
    v_smfmac_f32_16x16x64_bf16 v[76:79], v[0:3], v[48:55], v117
    global_store_short v120, v114, s[24:25] sc1
    ds_read_b128 v[20:23], v118 offset:6144
    v_smfmac_f32_16x16x64_bf16 v[76:79], v[4:7], v[96:103], v117
    s_cbranch_vccnz Lfs_244
Lbk_245:
Lqj_243:
    v_smfmac_f32_16x16x64_bf16 v[64:67], v[8:11], v[160:167], v117
    ds_read_b128 v[96:99], v125 offset:12288
    ds_read_b128 v[44:47], v125 offset:15360
    v_smfmac_f32_16x16x64_bf16 v[64:67], v[12:15], v[176:183], v117
    global_load_lds_dwordx4 v118, s[22:23] offset:1024 sc1
    ds_read_b128 v[100:103], v125 offset:13312
    v_smfmac_f32_16x16x64_bf16 v[68:71], v[8:11], v[168:175], v117
    ds_read_b128 v[24:27], v118 offset:5120
    s_waitcnt lgkmcnt(4)
    v_cmp_u_f32 vcc, v16, v20
    v_smfmac_f32_16x16x64_bf16 v[68:71], v[12:15], v[184:191], v117
    ds_read_b128 v[28:31], v118 offset:7168
    ds_read_b128 v[40:43], v125 offset:14336
    v_smfmac_f32_16x16x64_bf16 v[72:75], v[8:11], a[0:7], v117
    s_cbranch_vccnz Lfs_254
Lbk_255:
    ds_read_b128 v[32:35], v125 offset:20480
    v_smfmac_f32_16x16x64_bf16 v[64:67], v[16:19], v[192:199], v117
    s_add_u32 s24, s24, 8192
    s_addc_u32 s25, s25, 0
    ds_read_b128 v[36:39], v125 offset:21504
    v_smfmac_f32_16x16x64_bf16 v[64:67], v[20:23], v[208:215], v117
    global_load_lds_dwordx4 v118, s[22:23] offset:2048 sc1
    ds_read_b128 v[48:51], v125 offset:22528
    v_smfmac_f32_16x16x64_bf16 v[68:71], v[16:19], v[200:207], v117
    s_add_u32 s26, s26, 1
    s_waitcnt lgkmcnt(4)
    v_cmp_u_f32 vcc, v24, v28
    v_smfmac_f32_16x16x64_bf16 v[68:71], v[20:23], v[216:223], v117
    ds_read_b128 v[52:55], v125 offset:23552
    v_smfmac_f32_16x16x64_bf16 v[72:75], v[16:19], v[96:103], v117
    s_cbranch_vccnz Lfs_257
Lbk_258:
    v_smfmac_f32_16x16x64_bf16 v[64:67], v[24:27], v[224:231], v117
    s_mov_b64 vcc, s[64:65]
    v_mov_b32 v112, s26
    v_smfmac_f32_16x16x64_bf16 v[64:67], v[28:31], v[240:247], v117
    global_load_lds_dwordx4 v118, s[22:23] offset:3072 sc1
    v_smfmac_f32_16x16x64_bf16 v[68:71], v[24:27], v[232:239], v117
    s_add_u32 s22, s22, 524288
    s_addc_u32 s23, s23, 0
    v_smfmac_f32_16x16x64_bf16 v[68:71], v[28:31], v[248:255], v117
    s_waitcnt lgkmcnt(2)
    v_add_f32 v64, v64, v66
    v_smfmac_f32_16x16x64_bf16 v[72:75], v[20:23], v[32:39], v117
    ds_read_b128 v[32:35], v125 offset:24576
    v_add_f32 v65, v65, v67
    v_smfmac_f32_16x16x64_bf16 v[72:75], v[12:15], a[16:23], v117
    ds_read_b128 v[36:39], v125 offset:25600
    v_cvt_pk_bf16_f32 v102, v64, v65
    v_add_f32 v68, v68, v70
    v_smfmac_f32_16x16x64_bf16 v[72:75], v[24:27], a[32:39], v117
    ds_write_b32 v121, v102 offset:9220
    v_add_f32 v69, v69, v71
    v_cvt_pk_bf16_f32 v103, v68, v69
    v_smfmac_f32_16x16x64_bf16 v[72:75], v[28:31], a[48:55], v117
    ds_write_b32 v121, v103 offset:9732
    v_smfmac_f32_16x16x64_bf16 v[76:79], v[16:19], v[40:47], v117
    ds_read_b128 v[40:43], v125 offset:26624
    s_waitcnt lgkmcnt(5)
    v_smfmac_f32_16x16x64_bf16 v[76:79], v[20:23], v[48:55], v117
    ds_read_b128 v[44:47], v125 offset:27648
    v_add_f32 v72, v72, v74
    v_smfmac_f32_16x16x64_bf16 v[76:79], v[8:11], a[8:15], v117
    ds_read_b128 v[48:51], v125 offset:4096
    v_smfmac_f32_16x16x64_bf16 v[76:79], v[12:15], a[24:31], v117
    s_waitcnt lgkmcnt(3)
    s_barrier
    v_smfmac_f32_16x16x64_bf16 v[76:79], v[24:27], a[40:47], v117
    ds_read_b64_tr_b16 v[64:65], v122 offset:8192
    ds_read_b64_tr_b16 v[66:67], v122 offset:8704
    v_smfmac_f32_16x16x64_bf16 v[76:79], v[28:31], a[56:63], v117
    ds_read_b64_tr_b16 v[68:69], v122 offset:9216
    ds_read_b64_tr_b16 v[70:71], v122 offset:9728
    v_add_f32 v73, v73, v75
    v_cvt_pk_bf16_f32 v100, v72, v73
    v_smfmac_f32_16x16x64_bf16 v[80:83], v[0:3], a[64:71], v117
    ds_write_b32 v121, v100 offset:11268
    v_smfmac_f32_16x16x64_bf16 v[84:87], v[0:3], a[72:79], v117
    s_waitcnt lgkmcnt(3)
    ds_read_b128 v[52:55], v125 offset:5120
    v_add_f32 v76, v76, v78
    v_mfma_f32_16x16x32_bf16 v[96:99], v[56:59], v[64:67], 0
    s_waitcnt lgkmcnt(2)
    v_add_f32 v77, v77, v79
    v_cvt_pk_bf16_f32 v101, v76, v77
    v_mfma_f32_16x16x32_bf16 v[96:99], v[60:63], v[68:71], v[96:99]
    ds_write_b32 v121, v101 offset:11780
    v_smfmac_f32_16x16x64_bf16 v[80:83], v[4:7], a[80:87], v117
    s_mov_b32 exec_hi, 0
    global_store_dword v110, v108, s[18:19]
    s_mov_b32 exec_hi, -1
    v_smfmac_f32_16x16x64_bf16 v[84:87], v[4:7], a[88:95], v117
    v_add_f32_dpp v96, v98, v96 quad_perm:[2,3,2,3] row_mask:0xf bank_mask:0xf
    v_add_f32_dpp v97, v99, v97 quad_perm:[2,3,2,3] row_mask:0xf bank_mask:0xf
    v_smfmac_f32_16x16x64_bf16 v[80:83], v[8:11], a[96:103], v117
    ds_write_b64 v109, v[96:97] offset:13824
    v_smfmac_f32_16x16x64_bf16 v[84:87], v[8:11], a[104:111], v117
    s_waitcnt lgkmcnt(1)
    s_barrier
    v_smfmac_f32_16x16x64_bf16 v[80:83], v[12:15], a[112:119], v117
    s_waitcnt vmcnt(7)
    ds_read_b64_tr_b16 v[72:73], v122 offset:10240
    ds_read_b64_tr_b16 v[74:75], v122 offset:10752
    v_smfmac_f32_16x16x64_bf16 v[84:87], v[12:15], a[120:127], v117
    ds_read_b64_tr_b16 v[76:77], v122 offset:11264
    ds_read_b64_tr_b16 v[78:79], v122 offset:11776
    v_smfmac_f32_16x16x64_bf16 v[80:83], v[16:19], a[128:135], v117
    ds_read_b128 v[8:11], v125 offset:18432
    v_smfmac_f32_16x16x64_bf16 v[84:87], v[16:19], a[136:143], v117
    s_waitcnt lgkmcnt(5)
    s_barrier
    s_waitcnt lgkmcnt(3)
    v_mfma_f32_16x16x32_bf16 v[0:3], v[72:75], v[64:67], 0
    ds_read_b128 v[56:59], v124 offset:12288
    s_waitcnt lgkmcnt(2)
    v_mfma_f32_16x16x32_bf16 v[0:3], v[76:79], v[68:71], v[0:3]
    ds_read_b128 v[12:15], v125 offset:19456
    v_smfmac_f32_16x16x64_bf16 v[80:83], v[20:23], a[144:151], v117
    ds_write_b32 v118, v108 offset:5120
    v_smfmac_f32_16x16x64_bf16 v[84:87], v[20:23], a[152:159], v117
    ds_write_b32 v118, v108 offset:7168
    v_add_f32_dpp v2, v0, v2 quad_perm:[0,1,0,1] row_mask:0xf bank_mask:0xf
    v_smfmac_f32_16x16x64_bf16 v[80:83], v[24:27], a[160:167], v117
    s_waitcnt lgkmcnt(3)
    v_max3_f32 v60, v56, v57, v58
    v_add_f32_dpp v3, v1, v3 quad_perm:[0,1,0,1] row_mask:0xf bank_mask:0xf
    v_smfmac_f32_16x16x64_bf16 v[84:87], v[24:27], a[168:175], v117
    v_max_f32 v60, v60, v59
    v_smfmac_f32_16x16x64_bf16 v[80:83], v[28:31], v[32:39], v117
    s_nop 0
    v_max_f32_dpp v60, v60, v60 quad_perm:[2,3,0,1] row_mask:0xf bank_mask:0xf
    v_smfmac_f32_16x16x64_bf16 v[84:87], v[28:31], v[40:47], v117
    v_max3_f32 v61, v60, v2, v3
    v_max3_f32 v62, v60, v2, v3
    v_mov_b64 v[64:65], 0
    v_mov_b64 v[66:67], 0
    v_permlane16_swap_b32 v61, v62
    v_max_f32 v60, v61, v62
    v_max_f32 v63, v61, v62
    v_pk_add_f32 v[80:81], v[80:81], v[82:83]
    v_pk_add_f32 v[84:85], v[84:85], v[86:87]
    v_permlane32_swap_b32 v60, v63
    v_max_f32 v61, v60, v63
    v_cvt_pk_bf16_f32 v114, v80, v81
    v_cvt_pk_bf16_f32 v115, v84, v85
    v_mul_f32_dpp v62, v61, v126 quad_perm:[2,3,2,3] row_mask:0xf bank_mask:0xf
    v_pk_fma_f32 v[2:3], v[2:3], s[28:29], v[62:63] op_sel_hi:[1,1,0]
    v_pk_fma_f32 v[56:57], v[56:57], s[28:29], v[62:63] op_sel_hi:[1,1,0]
    v_exp_f32 v2, v2
    v_exp_f32 v3, v3
    v_pk_fma_f32 v[58:59], v[58:59], s[28:29], v[62:63] op_sel_hi:[1,1,0]
    v_cvt_pk_bf16_f32 v80, v2, v3
    v_exp_f32 v56, v56
    v_cndmask_b32 v5, v113, v80, vcc
    v_cndmask_b32_dpp v4, v80, v113, vcc quad_perm:[2,3,2,3] row_mask:0xf bank_mask:0xf
    v_exp_f32 v57, v57
    v_exp_f32 v58, v58
    v_mfma_f32_16x16x16_bf16 v[76:79], v[4:5], v[104:105], 0
    v_cvt_pk_bf16_f32 v84, v56, v57
    v_exp_f32 v59, v59
    v_mfma_f32_16x16x16_bf16 v[72:75], v[4:5], v[114:115], 0
    v_cvt_pk_bf16_f32 v85, v58, v59
    v_mov_b32_dpp v86, v84 quad_perm:[2,3,0,1] row_mask:0xf bank_mask:0xf
    v_mov_b64 v[68:69], 0
    v_mov_b32_dpp v87, v85 quad_perm:[2,3,0,1] row_mask:0xf bank_mask:0xf
    v_mov_b64 v[70:71], 0
    v_mov_b64 v[80:81], 0
    v_mfma_f32_16x16x32_bf16 v[76:79], v[84:87], v[104:107], v[76:79]
    ds_read_b128 v[32:35], v125 offset:6144
    v_smfmac_f32_16x16x64_bf16 v[72:75], v[84:87], v[88:95], v117
    ds_read_b128 v[36:39], v125 offset:7168
    s_nop 2
    v_rcp_f32_dpp v60, v76 quad_perm:[2,3,2,3] row_mask:0xf bank_mask:0xf
    v_rcp_f32_dpp v61, v77 quad_perm:[2,3,2,3] row_mask:0xf bank_mask:0xf
    s_nop 1
    v_pk_mul_f32 v[72:73], v[72:73], v[60:61]
    v_pk_mul_f32 v[74:75], v[74:75], v[60:61]
    v_cvt_pk_bf16_f32 v56, v72, v73
    v_cvt_pk_bf16_f32 v57, v74, v75
    ds_write_b64 v121, v[56:57] offset:15872
    v_mov_b64 v[82:83], 0
    v_mov_b64 v[84:85], 0
    v_mov_b64 v[86:87], 0
    v_mov_b64 v[72:73], 0
    v_mov_b64 v[74:75], 0
    v_mov_b64 v[76:77], 0
    v_mov_b64 v[78:79], 0
    v_mov_b64 v[88:89], 0
    v_mov_b64 v[90:91], 0
    v_mov_b64 v[92:93], 0
    v_mov_b64 v[94:95], 0
    s_waitcnt vmcnt(6)
    s_waitcnt lgkmcnt(0)
    s_barrier
    ds_read_b64_tr_b16 v[96:97], v122 offset:14336
    ds_read_b64_tr_b16 v[98:99], v122 offset:14848
    ds_read_b64_tr_b16 v[100:101], v122 offset:15360
    ds_read_b64_tr_b16 v[102:103], v122 offset:15872
    ds_read_b128 v[40:43], v125 offset:16384
    ds_read_b128 v[44:47], v125 offset:17408
    s_waitcnt lgkmcnt(4)
    v_smfmac_f32_16x16x64_bf16 v[72:75], v[96:99], a[176:183], v117
    s_mov_b64 exec, s[74:75]
    global_store_short v116, v112, s[94:95] offset:1024
    s_mov_b64 exec, -1
    s_waitcnt lgkmcnt(2)
    v_smfmac_f32_16x16x64_bf16 v[72:75], v[100:103], a[192:199], v117
    ds_read_b128 v[24:27], v125 offset:28672
    v_smfmac_f32_16x16x64_bf16 v[76:79], v[96:99], a[184:191], v117
    ds_read_b128 v[28:31], v125 offset:29696
    v_smfmac_f32_16x16x64_bf16 v[76:79], v[100:103], a[200:207], v117
    ds_read_b128 v[56:59], v125 offset:30720
    v_add_f32 v72, v72, v74
    v_add_f32 v73, v73, v75
    v_cvt_pk_bf16_f32 v72, v72, v73
    v_smfmac_f32_16x16x64_bf16 v[80:83], v[96:99], a[208:215], v117
    global_store_dword v119, v72, s[16:17] offset:-4096
    ds_read_b128 v[60:63], v125 offset:31744
    s_nop 0
    v_add_f32 v76, v76, v78
    v_add_f32 v77, v77, v79
    v_cvt_pk_bf16_f32 v76, v76, v77
    v_smfmac_f32_16x16x64_bf16 v[80:83], v[100:103], a[224:231], v117
    global_store_dword v119, v76, s[32:33] offset:-4096
    v_smfmac_f32_16x16x64_bf16 v[84:87], v[96:99], a[216:223], v117
    v_smfmac_f32_16x16x64_bf16 v[84:87], v[100:103], a[232:239], v117
    v_add_f32 v80, v80, v82
    v_smfmac_f32_16x16x64_bf16 v[64:67], v[96:99], a[240:247], v117
    v_add_f32 v81, v81, v83
    v_cvt_pk_bf16_f32 v80, v80, v81
    v_smfmac_f32_16x16x64_bf16 v[64:67], v[100:103], v[48:55], v117
    global_store_dword v119, v80, s[16:17] offset:-2048
    v_add_f32 v84, v84, v86
    v_smfmac_f32_16x16x64_bf16 v[68:71], v[96:99], a[248:255], v117
    v_add_f32 v85, v85, v87
    v_cvt_pk_bf16_f32 v84, v84, v85
    v_smfmac_f32_16x16x64_bf16 v[68:71], v[100:103], v[32:39], v117
    s_waitcnt lgkmcnt(4)
    global_store_dword v119, v84, s[32:33] offset:-2048
    v_add_f32 v64, v64, v66
    v_smfmac_f32_16x16x64_bf16 v[88:91], v[96:99], v[40:47], v117
    s_waitcnt lgkmcnt(2)
    v_add_f32 v65, v65, v67
    v_cvt_pk_bf16_f32 v64, v64, v65
    v_smfmac_f32_16x16x64_bf16 v[88:91], v[100:103], v[24:31], v117
    global_store_dword v119, v64, s[16:17] offset:0
    v_add_f32 v68, v68, v70
    v_smfmac_f32_16x16x64_bf16 v[92:95], v[96:99], v[8:15], v117
    s_waitcnt lgkmcnt(0)
    v_add_f32 v69, v69, v71
    v_cvt_pk_bf16_f32 v68, v68, v69
    v_smfmac_f32_16x16x64_bf16 v[92:95], v[100:103], v[56:63], v117
    global_store_dword v119, v68, s[32:33] offset:0
    v_add_f32 v88, v88, v90
    v_add_f32 v89, v89, v91
    v_cvt_pk_bf16_f32 v88, v88, v89
    global_store_dword v119, v88, s[16:17] offset:2048
    s_mov_b32 m0, 5120
    ds_read_b128 v[32:35], v125 offset:0
    ds_read_b128 v[36:39], v125 offset:1024
    v_add_f32 v92, v92, v94
    v_add_f32 v93, v93, v95
    v_cvt_pk_bf16_f32 v92, v92, v93
    global_store_dword v119, v92, s[32:33] offset:2048
    s_barrier
    ds_read_b128 v[40:43], v125 offset:8192
    ds_read_b128 v[44:47], v125 offset:9216
    ds_read_b128 v[48:51], v125 offset:2048
    ds_read_b128 v[52:55], v125 offset:3072
    ds_read_b128 v[96:99], v125 offset:10240
    ds_read_b128 v[100:103], v125 offset:11264
    v_mov_b64 v[64:65], 0
    v_mov_b64 v[66:67], 0
    v_mov_b64 v[68:69], 0
    v_mov_b64 v[70:71], 0
    v_mov_b64 v[72:73], 0
    v_mov_b64 v[74:75], 0
    v_mov_b64 v[76:77], 0
    v_mov_b64 v[78:79], 0
    v_mov_b64 v[80:81], 0
    v_mov_b64 v[82:83], 0
    v_mov_b64 v[84:85], 0
    v_mov_b64 v[86:87], 0
    s_waitcnt vmcnt(8)
    v_xor_b32 v112, 8, v109
    ds_read_b64 v[90:91], v109 offset:31744
    ds_read_b64 v[88:89], v112 offset:30720
    ds_read_b64 v[94:95], v109 offset:32256
    ds_read_b64 v[92:93], v112 offset:31232
    ds_read_b128 v[56:59], v111 offset:28672
    ds_read_b128 v[60:63], v111 offset:29696
    s_waitcnt lgkmcnt(2)
    v_swap_b32 v89, v90
    v_swap_b32 v93, v94
    global_load_dword v0, v123, s[20:21] offset:0 sc1
    global_load_dword v1, v123, s[20:21] offset:256 sc1
    global_load_dword v2, v123, s[20:21] offset:512 sc1
    global_load_dword v3, v123, s[20:21] offset:768 sc1
    global_load_dword v4, v123, s[20:21] offset:1024 sc1
    global_load_dword v5, v123, s[20:21] offset:1280 sc1
    global_load_dword v6, v123, s[20:21] offset:1536 sc1
    global_load_dword v7, v123, s[20:21] offset:1792 sc1
    s_waitcnt vmcnt(4)
    v_mfma_f32_16x16x32_bf16 v[24:27], v[104:107], v[0:3], 0
    v_max3_u32 v28, v0, v1, v2
    s_waitcnt vmcnt(0)
    v_mfma_f32_16x16x32_bf16 v[24:27], v[104:107], v[4:7], v[24:27]
    v_max3_u32 v29, v4, v5, v6
    v_max3_u32 v28, v28, v3, v7
    v_cmp_u_f32 vcc, v28, v29
    s_nop 4
    v_cvt_pk_bf16_f32 v114, v24, v24
    s_cbranch_vccnz Lpf_261
Lpj_262:
    global_store_short v120, v114, s[10:11]
    s_branch Lhl3_212
Llast_213:
    global_store_short v120, v114, s[24:25] sc1
    s_branch L_fin
Lfa_214:
    s_waitcnt lgkmcnt(1)
    ds_read_b128 v[0:3], v118 offset:0
    ds_read_b128 v[4:7], v118 offset:2048
    global_load_lds_dwordx4 v127, s[10:11] sc1
    global_load_lds_dwordx4 v127, s[10:11] offset:2048 sc1
Lqb_216:
    ds_read_b128 v[8:11], v118 offset:1024
    ds_read_b128 v[12:15], v118 offset:3072
    v_smfmac_f32_16x16x64_bf16 v[72:75], v[24:27], v[32:39], v117
    v_max_u32 v112, v24, v28
    v_cmp_eq_u32 vcc, -1, v112
    v_smfmac_f32_16x16x64_bf16 v[72:75], v[28:31], v[40:47], v117
    v_smfmac_f32_16x16x64_bf16 v[76:79], v[24:27], v[48:55], v117
    s_cbranch_vccnz Lfb_215
    v_mov_b64 v[64:65], 0
    v_mov_b64 v[66:67], 0
    v_smfmac_f32_16x16x64_bf16 v[76:79], v[28:31], v[96:103], v117
    global_store_short v120, v108, s[12:13]
    s_mov_b32 m0, 28672
    v_mov_b64 v[68:69], 0
    v_mov_b64 v[70:71], 0
    v_smfmac_f32_16x16x64_bf16 v[64:67], v[24:27], v[128:135], v117
    global_load_lds_dwordx4 v118, s[22:23] offset:0 sc1
    v_smfmac_f32_16x16x64_bf16 v[64:67], v[28:31], v[144:151], v117
    ds_read_b128 v[16:19], v118 offset:4096
    s_waitcnt lgkmcnt(1)
    v_cmp_u_f32 vcc, v8, v12
    v_smfmac_f32_16x16x64_bf16 v[68:71], v[24:27], v[136:143], v117
    global_store_short v120, v114, s[24:25] sc1
    ds_read_b128 v[20:23], v118 offset:6144
    v_smfmac_f32_16x16x64_bf16 v[68:71], v[28:31], v[152:159], v117
    s_cbranch_vccnz Lfs_222
Lbk_223:
    s_branch Lqj_218
Lfb_215:
    v_mov_b64 v[64:65], 0
    v_mov_b64 v[66:67], 0
    v_mov_b64 v[68:69], 0
    v_mov_b64 v[70:71], 0
    v_mov_b64 v[72:73], 0
    v_mov_b64 v[74:75], 0
    s_nop 0
    v_mov_b64 v[76:77], 0
    v_mov_b64 v[78:79], 0
Lr0_225:
    ds_read_b128 v[24:27], v118 offset:0
    ds_read_b128 v[28:31], v118 offset:2048
    global_load_lds_dwordx4 v127, s[10:11] sc1
    global_load_lds_dwordx4 v127, s[10:11] offset:2048 sc1
    s_waitcnt lgkmcnt(2)
    v_max_u32 v112, v0, v4
    v_cmp_eq_u32 vcc, -1, v112
    s_cbranch_vccz Lqa_217
    ds_read_b128 v[0:3], v118 offset:0
    ds_read_b128 v[4:7], v118 offset:2048
    global_load_lds_dwordx4 v127, s[10:11] sc1
    global_load_lds_dwordx4 v127, s[10:11] offset:2048 sc1
    s_waitcnt lgkmcnt(2)
    v_max_u32 v112, v24, v28
    v_cmp_eq_u32 vcc, -1, v112
    s_cbranch_vccz Lqb_216
    s_sub_u32 s27, s27, 1
    s_cbranch_scc0 Lr0_225
    s_branch L_fin
Lqa_217:
    ds_read_b128 v[8:11], v118 offset:1024
    ds_read_b128 v[12:15], v118 offset:3072
    v_smfmac_f32_16x16x64_bf16 v[64:67], v[0:3], v[128:135], v117
    v_smfmac_f32_16x16x64_bf16 v[64:67], v[4:7], v[144:151], v117
    v_smfmac_f32_16x16x64_bf16 v[68:71], v[0:3], v[136:143], v117
    v_smfmac_f32_16x16x64_bf16 v[68:71], v[4:7], v[152:159], v117
    global_store_short v120, v108, s[12:13]
    s_mov_b32 m0, 28672
    v_smfmac_f32_16x16x64_bf16 v[72:75], v[0:3], v[32:39], v117
    global_load_lds_dwordx4 v118, s[22:23] offset:0 sc1
    v_smfmac_f32_16x16x64_bf16 v[72:75], v[4:7], v[40:47], v117
    ds_read_b128 v[16:19], v118 offset:4096
    s_waitcnt lgkmcnt(1)
    v_cmp_u_f32 vcc, v8, v12
    v_smfmac_f32_16x16x64_bf16 v[76:79], v[0:3], v[48:55], v117
    global_store_short v120, v114, s[24:25] sc1
    ds_read_b128 v[20:23], v118 offset:6144
    v_smfmac_f32_16x16x64_bf16 v[76:79], v[4:7], v[96:103], v117
    s_cbranch_vccnz Lfs_226
Lbk_227:
    s_branch Lqj_218
Lpf_236:
    global_load_dword v16, v123, s[18:19] offset:0 sc1
    global_load_dword v17, v123, s[18:19] offset:256 sc1
    global_load_dword v18, v123, s[18:19] offset:512 sc1
    global_load_dword v19, v123, s[18:19] offset:768 sc1
    global_load_dword v20, v123, s[18:19] offset:1024 sc1
    global_load_dword v21, v123, s[18:19] offset:1280 sc1
    global_load_dword v22, v123, s[18:19] offset:1536 sc1
    global_load_dword v23, v123, s[18:19] offset:1792 sc1
    global_load_dword v8, v123, s[18:19] offset:0 sc1
    global_load_dword v9, v123, s[18:19] offset:256 sc1
    global_load_dword v10, v123, s[18:19] offset:512 sc1
    global_load_dword v11, v123, s[18:19] offset:768 sc1
    global_load_dword v12, v123, s[18:19] offset:1024 sc1
    global_load_dword v13, v123, s[18:19] offset:1280 sc1
    global_load_dword v14, v123, s[18:19] offset:1536 sc1
    global_load_dword v15, v123, s[18:19] offset:1792 sc1
    s_waitcnt vmcnt(12)
    v_mfma_f32_16x16x32_bf16 v[24:27], v[104:107], v[16:19], 0
    v_max3_u32 v28, v16, v17, v18
    s_waitcnt vmcnt(8)
    v_mfma_f32_16x16x32_bf16 v[24:27], v[104:107], v[20:23], v[24:27]
    v_max3_u32 v29, v20, v21, v22
    v_max3_u32 v28, v28, v19, v23
    v_max_u32 v28, v28, v29
    v_cmp_eq_u32 vcc, -1, v28
    s_nop 3
    v_cvt_pk_bf16_f32 v114, v24, v24
    s_cbranch_vccz Lpj_237
Lpl_238:
    global_load_dword v16, v123, s[18:19] offset:0 sc1
    global_load_dword v17, v123, s[18:19] offset:256 sc1
    global_load_dword v18, v123, s[18:19] offset:512 sc1
    global_load_dword v19, v123, s[18:19] offset:768 sc1
    global_load_dword v20, v123, s[18:19] offset:1024 sc1
    global_load_dword v21, v123, s[18:19] offset:1280 sc1
    global_load_dword v22, v123, s[18:19] offset:1536 sc1
    global_load_dword v23, v123, s[18:19] offset:1792 sc1
    s_waitcnt vmcnt(12)
    v_mfma_f32_16x16x32_bf16 v[24:27], v[104:107], v[8:11], 0
    v_max3_u32 v28, v8, v9, v10
    s_waitcnt vmcnt(8)
    v_mfma_f32_16x16x32_bf16 v[24:27], v[104:107], v[12:15], v[24:27]
    v_max3_u32 v29, v12, v13, v14
    v_max3_u32 v28, v28, v11, v15
    v_max_u32 v28, v28, v29
    v_cmp_eq_u32 vcc, -1, v28
    s_nop 3
    v_cvt_pk_bf16_f32 v114, v24, v24
    s_cbranch_vccz Lpj_237
    global_load_dword v8, v123, s[18:19] offset:0 sc1
    global_load_dword v9, v123, s[18:19] offset:256 sc1
    global_load_dword v10, v123, s[18:19] offset:512 sc1
    global_load_dword v11, v123, s[18:19] offset:768 sc1
    global_load_dword v12, v123, s[18:19] offset:1024 sc1
    global_load_dword v13, v123, s[18:19] offset:1280 sc1
    global_load_dword v14, v123, s[18:19] offset:1536 sc1
    global_load_dword v15, v123, s[18:19] offset:1792 sc1
    s_waitcnt vmcnt(12)
    v_mfma_f32_16x16x32_bf16 v[24:27], v[104:107], v[16:19], 0
    v_max3_u32 v28, v16, v17, v18
    s_waitcnt vmcnt(8)
    v_mfma_f32_16x16x32_bf16 v[24:27], v[104:107], v[20:23], v[24:27]
    v_max3_u32 v29, v20, v21, v22
    v_max3_u32 v28, v28, v19, v23
    v_max_u32 v28, v28, v29
    v_cmp_eq_u32 vcc, -1, v28
    s_nop 3
    v_cvt_pk_bf16_f32 v114, v24, v24
    s_cbranch_vccz Lpj_237
    s_sub_u32 s27, s27, 1
    s_cbranch_scc0 Lpl_238
    s_branch L_fin
Lfa_239:
    s_waitcnt lgkmcnt(1)
    ds_read_b128 v[0:3], v118 offset:0
    ds_read_b128 v[4:7], v118 offset:2048
    global_load_lds_dwordx4 v127, s[12:13] sc1
    global_load_lds_dwordx4 v127, s[12:13] offset:2048 sc1
Lqb_241:
    ds_read_b128 v[8:11], v118 offset:1024
    ds_read_b128 v[12:15], v118 offset:3072
    v_smfmac_f32_16x16x64_bf16 v[72:75], v[24:27], v[32:39], v117
    v_max_u32 v112, v24, v28
    v_cmp_eq_u32 vcc, -1, v112
    v_smfmac_f32_16x16x64_bf16 v[72:75], v[28:31], v[40:47], v117
    v_smfmac_f32_16x16x64_bf16 v[76:79], v[24:27], v[48:55], v117
    s_cbranch_vccnz Lfb_240
    v_mov_b64 v[64:65], 0
    v_mov_b64 v[66:67], 0
    v_smfmac_f32_16x16x64_bf16 v[76:79], v[28:31], v[96:103], v117
    global_store_short v120, v108, s[10:11]
    s_mov_b32 m0, 28672
    v_mov_b64 v[68:69], 0
    v_mov_b64 v[70:71], 0
    v_smfmac_f32_16x16x64_bf16 v[64:67], v[24:27], v[128:135], v117
    global_load_lds_dwordx4 v118, s[22:23] offset:0 sc1
    v_smfmac_f32_16x16x64_bf16 v[64:67], v[28:31], v[144:151], v117
    ds_read_b128 v[16:19], v118 offset:4096
    s_waitcnt lgkmcnt(1)
    v_cmp_u_f32 vcc, v8, v12
    v_smfmac_f32_16x16x64_bf16 v[68:71], v[24:27], v[136:143], v117
    global_store_short v120, v114, s[24:25] sc1
    ds_read_b128 v[20:23], v118 offset:6144
    v_smfmac_f32_16x16x64_bf16 v[68:71], v[28:31], v[152:159], v117
    s_cbranch_vccnz Lfs_247
Lbk_248:
    s_branch Lqj_243
Lfb_240:
    v_mov_b64 v[64:65], 0
    v_mov_b64 v[66:67], 0
    v_mov_b64 v[68:69], 0
    v_mov_b64 v[70:71], 0
    v_mov_b64 v[72:73], 0
    v_mov_b64 v[74:75], 0
    s_nop 0
    v_mov_b64 v[76:77], 0
    v_mov_b64 v[78:79], 0
Lr0_250:
    ds_read_b128 v[24:27], v118 offset:0
    ds_read_b128 v[28:31], v118 offset:2048
    global_load_lds_dwordx4 v127, s[12:13] sc1
    global_load_lds_dwordx4 v127, s[12:13] offset:2048 sc1
    s_waitcnt lgkmcnt(2)
    v_max_u32 v112, v0, v4
    v_cmp_eq_u32 vcc, -1, v112
    s_cbranch_vccz Lqa_242
    ds_read_b128 v[0:3], v118 offset:0
    ds_read_b128 v[4:7], v118 offset:2048
    global_load_lds_dwordx4 v127, s[12:13] sc1
    global_load_lds_dwordx4 v127, s[12:13] offset:2048 sc1
    s_waitcnt lgkmcnt(2)
    v_max_u32 v112, v24, v28
    v_cmp_eq_u32 vcc, -1, v112
    s_cbranch_vccz Lqb_241
    s_sub_u32 s27, s27, 1
    s_cbranch_scc0 Lr0_250
    s_branch L_fin
Lqa_242:
    ds_read_b128 v[8:11], v118 offset:1024
    ds_read_b128 v[12:15], v118 offset:3072
    v_smfmac_f32_16x16x64_bf16 v[64:67], v[0:3], v[128:135], v117
    v_smfmac_f32_16x16x64_bf16 v[64:67], v[4:7], v[144:151], v117
    v_smfmac_f32_16x16x64_bf16 v[68:71], v[0:3], v[136:143], v117
    v_smfmac_f32_16x16x64_bf16 v[68:71], v[4:7], v[152:159], v117
    global_store_short v120, v108, s[10:11]
    s_mov_b32 m0, 28672
    v_smfmac_f32_16x16x64_bf16 v[72:75], v[0:3], v[32:39], v117
    global_load_lds_dwordx4 v118, s[22:23] offset:0 sc1
    v_smfmac_f32_16x16x64_bf16 v[72:75], v[4:7], v[40:47], v117
    ds_read_b128 v[16:19], v118 offset:4096
    s_waitcnt lgkmcnt(1)
    v_cmp_u_f32 vcc, v8, v12
    v_smfmac_f32_16x16x64_bf16 v[76:79], v[0:3], v[48:55], v117
    global_store_short v120, v114, s[24:25] sc1
    ds_read_b128 v[20:23], v118 offset:6144
    v_smfmac_f32_16x16x64_bf16 v[76:79], v[4:7], v[96:103], v117
    s_cbranch_vccnz Lfs_251
Lbk_252:
    s_branch Lqj_243
Lpf_261:
    global_load_dword v16, v123, s[20:21] offset:0 sc1
    global_load_dword v17, v123, s[20:21] offset:256 sc1
    global_load_dword v18, v123, s[20:21] offset:512 sc1
    global_load_dword v19, v123, s[20:21] offset:768 sc1
    global_load_dword v20, v123, s[20:21] offset:1024 sc1
    global_load_dword v21, v123, s[20:21] offset:1280 sc1
    global_load_dword v22, v123, s[20:21] offset:1536 sc1
    global_load_dword v23, v123, s[20:21] offset:1792 sc1
    global_load_dword v8, v123, s[20:21] offset:0 sc1
    global_load_dword v9, v123, s[20:21] offset:256 sc1
    global_load_dword v10, v123, s[20:21] offset:512 sc1
    global_load_dword v11, v123, s[20:21] offset:768 sc1
    global_load_dword v12, v123, s[20:21] offset:1024 sc1
    global_load_dword v13, v123, s[20:21] offset:1280 sc1
    global_load_dword v14, v123, s[20:21] offset:1536 sc1
    global_load_dword v15, v123, s[20:21] offset:1792 sc1
    s_waitcnt vmcnt(12)
    v_mfma_f32_16x16x32_bf16 v[24:27], v[104:107], v[16:19], 0
    v_max3_u32 v28, v16, v17, v18
    s_waitcnt vmcnt(8)
    v_mfma_f32_16x16x32_bf16 v[24:27], v[104:107], v[20:23], v[24:27]
    v_max3_u32 v29, v20, v21, v22
    v_max3_u32 v28, v28, v19, v23
    v_max_u32 v28, v28, v29
    v_cmp_eq_u32 vcc, -1, v28
    s_nop 3
    v_cvt_pk_bf16_f32 v114, v24, v24
    s_cbranch_vccz Lpj_262
Lpl_263:
    global_load_dword v16, v123, s[20:21] offset:0 sc1
    global_load_dword v17, v123, s[20:21] offset:256 sc1
    global_load_dword v18, v123, s[20:21] offset:512 sc1
    global_load_dword v19, v123, s[20:21] offset:768 sc1
    global_load_dword v20, v123, s[20:21] offset:1024 sc1
    global_load_dword v21, v123, s[20:21] offset:1280 sc1
    global_load_dword v22, v123, s[20:21] offset:1536 sc1
    global_load_dword v23, v123, s[20:21] offset:1792 sc1
    s_waitcnt vmcnt(12)
    v_mfma_f32_16x16x32_bf16 v[24:27], v[104:107], v[8:11], 0
    v_max3_u32 v28, v8, v9, v10
    s_waitcnt vmcnt(8)
    v_mfma_f32_16x16x32_bf16 v[24:27], v[104:107], v[12:15], v[24:27]
    v_max3_u32 v29, v12, v13, v14
    v_max3_u32 v28, v28, v11, v15
    v_max_u32 v28, v28, v29
    v_cmp_eq_u32 vcc, -1, v28
    s_nop 3
    v_cvt_pk_bf16_f32 v114, v24, v24
    s_cbranch_vccz Lpj_262
    global_load_dword v8, v123, s[20:21] offset:0 sc1
    global_load_dword v9, v123, s[20:21] offset:256 sc1
    global_load_dword v10, v123, s[20:21] offset:512 sc1
    global_load_dword v11, v123, s[20:21] offset:768 sc1
    global_load_dword v12, v123, s[20:21] offset:1024 sc1
    global_load_dword v13, v123, s[20:21] offset:1280 sc1
    global_load_dword v14, v123, s[20:21] offset:1536 sc1
    global_load_dword v15, v123, s[20:21] offset:1792 sc1
    s_waitcnt vmcnt(12)
    v_mfma_f32_16x16x32_bf16 v[24:27], v[104:107], v[16:19], 0
    v_max3_u32 v28, v16, v17, v18
    s_waitcnt vmcnt(8)
    v_mfma_f32_16x16x32_bf16 v[24:27], v[104:107], v[20:23], v[24:27]
    v_max3_u32 v29, v20, v21, v22
    v_max3_u32 v28, v28, v19, v23
    v_max_u32 v28, v28, v29
    v_cmp_eq_u32 vcc, -1, v28
    s_nop 3
    v_cvt_pk_bf16_f32 v114, v24, v24
    s_cbranch_vccz Lpj_262
    s_sub_u32 s27, s27, 1
    s_cbranch_scc0 Lpl_263
    s_branch L_fin
Lfs_219:
Lfl_221:
    ds_read_b128 v[8:11], v118 offset:1024
    ds_read_b128 v[12:15], v118 offset:3072
    s_sub_u32 s27, s27, 1
    s_waitcnt lgkmcnt(0)
    v_max_u32 v112, v8, v12
    v_cmp_eq_u32 vcc, -1, v112
    s_cbranch_vccz Lbk_220
    s_cbranch_scc0 Lfl_221
    s_branch L_fin
Lfs_222:
Lfl_224:
    ds_read_b128 v[8:11], v118 offset:1024
    ds_read_b128 v[12:15], v118 offset:3072
    s_sub_u32 s27, s27, 1
    s_waitcnt lgkmcnt(0)
    v_max_u32 v112, v8, v12
    v_cmp_eq_u32 vcc, -1, v112
    s_cbranch_vccz Lbk_223
    s_cbranch_scc0 Lfl_224
    s_branch L_fin
Lfs_226:
Lfl_228:
    ds_read_b128 v[8:11], v118 offset:1024
    ds_read_b128 v[12:15], v118 offset:3072
    s_sub_u32 s27, s27, 1
    s_waitcnt lgkmcnt(0)
    v_max_u32 v112, v8, v12
    v_cmp_eq_u32 vcc, -1, v112
    s_cbranch_vccz Lbk_227
    s_cbranch_scc0 Lfl_228
    s_branch L_fin
Lfs_229:
Lfl_231:
    ds_read_b128 v[16:19], v118 offset:4096
    ds_read_b128 v[20:23], v118 offset:6144
    s_sub_u32 s27, s27, 1
    s_waitcnt lgkmcnt(0)
    v_max_u32 v112, v16, v20
    v_cmp_eq_u32 vcc, -1, v112
    s_cbranch_vccz Lbk_230
    s_cbranch_scc0 Lfl_231
    s_branch L_fin
Lfs_232:
Lfl_234:
    ds_read_b128 v[24:27], v118 offset:5120
    ds_read_b128 v[28:31], v118 offset:7168
    s_sub_u32 s27, s27, 1
    s_waitcnt lgkmcnt(0)
    v_max_u32 v112, v24, v28
    v_cmp_eq_u32 vcc, -1, v112
    s_cbranch_vccz Lbk_233
    s_waitcnt vmcnt(5)
    ds_read_b128 v[24:27], v118 offset:5120
    ds_read_b128 v[28:31], v118 offset:7168
    s_sub_u32 s27, s27, 1
    s_waitcnt lgkmcnt(0)
    v_max_u32 v112, v24, v28
    v_cmp_eq_u32 vcc, -1, v112
    s_cbranch_vccz Lbk_233
Lfl_235:
    s_mov_b32 s40, m0
    s_mov_b32 m0, 5120
    s_nop 0
    global_load_lds_dwordx4 v127, s[10:11] sc1
    global_load_lds_dwordx4 v127, s[10:11] offset:2048 sc1
    s_waitcnt vmcnt(0)
    s_mov_b32 m0, s40
    ds_read_b128 v[24:27], v118 offset:5120
    ds_read_b128 v[28:31], v118 offset:7168
    s_sub_u32 s27, s27, 1
    s_waitcnt lgkmcnt(0)
    v_max_u32 v112, v24, v28
    v_cmp_eq_u32 vcc, -1, v112
    s_cbranch_vccz Lbk_233
    s_cbranch_scc0 Lfl_235
    s_branch L_fin
Lfs_244:
Lfl_246:
    ds_read_b128 v[8:11], v118 offset:1024
    ds_read_b128 v[12:15], v118 offset:3072
    s_sub_u32 s27, s27, 1
    s_waitcnt lgkmcnt(0)
    v_max_u32 v112, v8, v12
    v_cmp_eq_u32 vcc, -1, v112
    s_cbranch_vccz Lbk_245
    s_cbranch_scc0 Lfl_246
    s_branch L_fin
Lfs_247:
Lfl_249:
    ds_read_b128 v[8:11], v118 offset:1024
    ds_read_b128 v[12:15], v118 offset:3072
    s_sub_u32 s27, s27, 1
    s_waitcnt lgkmcnt(0)
    v_max_u32 v112, v8, v12
    v_cmp_eq_u32 vcc, -1, v112
    s_cbranch_vccz Lbk_248
    s_cbranch_scc0 Lfl_249
    s_branch L_fin
Lfs_251:
Lfl_253:
    ds_read_b128 v[8:11], v118 offset:1024
    ds_read_b128 v[12:15], v118 offset:3072
    s_sub_u32 s27, s27, 1
    s_waitcnt lgkmcnt(0)
    v_max_u32 v112, v8, v12
    v_cmp_eq_u32 vcc, -1, v112
    s_cbranch_vccz Lbk_252
    s_cbranch_scc0 Lfl_253
    s_branch L_fin
Lfs_254:
Lfl_256:
    ds_read_b128 v[16:19], v118 offset:4096
    ds_read_b128 v[20:23], v118 offset:6144
    s_sub_u32 s27, s27, 1
    s_waitcnt lgkmcnt(0)
    v_max_u32 v112, v16, v20
    v_cmp_eq_u32 vcc, -1, v112
    s_cbranch_vccz Lbk_255
    s_cbranch_scc0 Lfl_256
    s_branch L_fin
Lfs_257:
Lfl_259:
    ds_read_b128 v[24:27], v118 offset:5120
    ds_read_b128 v[28:31], v118 offset:7168
    s_sub_u32 s27, s27, 1
    s_waitcnt lgkmcnt(0)
    v_max_u32 v112, v24, v28
    v_cmp_eq_u32 vcc, -1, v112
    s_cbranch_vccz Lbk_258
    s_waitcnt vmcnt(5)
    ds_read_b128 v[24:27], v118 offset:5120
    ds_read_b128 v[28:31], v118 offset:7168
    s_sub_u32 s27, s27, 1
    s_waitcnt lgkmcnt(0)
    v_max_u32 v112, v24, v28
    v_cmp_eq_u32 vcc, -1, v112
    s_cbranch_vccz Lbk_258
Lfl_260:
    s_mov_b32 s40, m0
    s_mov_b32 m0, 5120
    s_nop 0
    global_load_lds_dwordx4 v127, s[12:13] sc1
    global_load_lds_dwordx4 v127, s[12:13] offset:2048 sc1
    s_waitcnt vmcnt(0)
    s_mov_b32 m0, s40
    ds_read_b128 v[24:27], v118 offset:5120
    ds_read_b128 v[28:31], v118 offset:7168
    s_sub_u32 s27, s27, 1
    s_waitcnt lgkmcnt(0)
    v_max_u32 v112, v24, v28
    v_cmp_eq_u32 vcc, -1, v112
    s_cbranch_vccz Lbk_258
    s_cbranch_scc0 Lfl_260
    s_branch L_fin
L_slow:
    s_mov_b32 s64, 0xcccccccc
    s_mov_b32 s65, 0xcccccccc
    s_mov_b32 s74, 0x10001
    s_mov_b32 s75, 0x10001
    s_cmp_eq_u32 s9, 1
    s_cbranch_scc1 Lwv_265
    s_cmp_eq_u32 s9, 2
    s_cbranch_scc1 Lwv_266
    s_cmp_eq_u32 s9, 3
    s_cbranch_scc1 Lwv_267
Lwv_264:
    s_mov_b32 m0, 0
    ds_read_b128 v[32:35], v125 offset:0
    ds_read_b128 v[36:39], v125 offset:1024
    ds_read_b128 v[40:43], v125 offset:8192
    ds_read_b128 v[44:47], v125 offset:9216
    ds_read_b128 v[48:51], v125 offset:2048
    ds_read_b128 v[52:55], v125 offset:3072
    ds_read_b128 v[96:99], v125 offset:10240
    ds_read_b128 v[100:103], v125 offset:11264
    v_mov_b32 v115, s26
    v_and_b32 v116, 768, v118
Lhl0_268:
    v_xor_b32 v112, 8, v109
    ds_read_b64 v[90:91], v109 offset:19456
    ds_read_b64 v[88:89], v112 offset:18432
    ds_read_b64 v[94:95], v109 offset:19968
    ds_read_b64 v[92:93], v112 offset:18944
    ds_read_b128 v[56:59], v111 offset:16384
    ds_read_b128 v[60:63], v111 offset:17408
    s_waitcnt vmcnt(0)
    global_load_lds_dwordx4 v127, s[10:11] sc1
    global_load_lds_dwordx4 v127, s[10:11] offset:2048 sc1
    v_mov_b64 v[64:65], 0
    v_mov_b64 v[66:67], 0
    v_mov_b64 v[68:69], 0
    v_mov_b64 v[70:71], 0
    v_mov_b64 v[72:73], 0
    v_mov_b64 v[74:75], 0
    v_mov_b64 v[76:77], 0
    v_mov_b64 v[78:79], 0
    v_mov_b64 v[80:81], 0
    v_mov_b64 v[82:83], 0
    v_mov_b64 v[84:85], 0
    v_mov_b64 v[86:87], 0
    s_waitcnt lgkmcnt(2)
    v_swap_b32 v89, v90
    v_swap_b32 v93, v94
    global_load_lds_dwordx4 v127, s[10:11] sc1
    global_load_lds_dwordx4 v127, s[10:11] offset:2048 sc1
    s_waitcnt vmcnt(2)
    s_barrier
    ds_read_b128 v[0:3], v118 offset:0
    ds_read_b128 v[4:7], v118 offset:2048
    s_waitcnt lgkmcnt(1)
    v_smfmac_f32_16x16x64_bf16 v[64:67], v[0:3], v[128:135], v117
    ds_read_b128 v[24:27], v118 offset:0
    ds_read_b128 v[8:11], v118 offset:1024
    s_waitcnt lgkmcnt(2)
    v_smfmac_f32_16x16x64_bf16 v[64:67], v[4:7], v[144:151], v117
    ds_read_b128 v[28:31], v118 offset:2048
    ds_read_b128 v[12:15], v118 offset:3072
    v_cmp_u_f32 vcc, v0, v4
    v_smfmac_f32_16x16x64_bf16 v[68:71], v[0:3], v[136:143], v117
    v_smfmac_f32_16x16x64_bf16 v[68:71], v[4:7], v[152:159], v117
    s_cbranch_vccnz Lfa_270
    global_store_short v120, v108, s[12:13] sc1
    s_mov_b32 m0, 16384
    v_smfmac_f32_16x16x64_bf16 v[72:75], v[0:3], v[32:39], v117
    global_load_lds_dwordx4 v118, s[22:23] offset:0 sc1
    v_smfmac_f32_16x16x64_bf16 v[72:75], v[4:7], v[40:47], v117
    ds_read_b128 v[16:19], v118 offset:4096
    s_waitcnt lgkmcnt(1)
    v_cmp_u_f32 vcc, v8, v12
    v_smfmac_f32_16x16x64_bf16 v[76:79], v[0:3], v[48:55], v117
    global_store_short v120, v114, s[24:25] sc1
    ds_read_b128 v[20:23], v118 offset:6144
    v_smfmac_f32_16x16x64_bf16 v[76:79], v[4:7], v[96:103], v117
    s_cbranch_vccnz Lfs_275
Lbk_276:
Lqj_274:
    v_smfmac_f32_16x16x64_bf16 v[64:67], v[8:11], v[160:167], v117
    ds_read_b128 v[96:99], v125 offset:12288
    ds_read_b128 v[44:47], v125 offset:15360
    v_smfmac_f32_16x16x64_bf16 v[64:67], v[12:15], v[176:183], v117
    global_load_lds_dwordx4 v118, s[22:23] offset:1024 sc1
    ds_read_b128 v[100:103], v125 offset:13312
    v_smfmac_f32_16x16x64_bf16 v[68:71], v[8:11], v[168:175], v117
    ds_read_b128 v[24:27], v118 offset:5120
    s_waitcnt lgkmcnt(4)
    v_cmp_u_f32 vcc, v16, v20
    v_smfmac_f32_16x16x64_bf16 v[68:71], v[12:15], v[184:191], v117
    ds_read_b128 v[28:31], v118 offset:7168
    ds_read_b128 v[40:43], v125 offset:14336
    v_smfmac_f32_16x16x64_bf16 v[72:75], v[8:11], a[0:7], v117
    s_cbranch_vccnz Lfs_285
Lbk_286:
    ds_read_b128 v[32:35], v125 offset:20480
    v_smfmac_f32_16x16x64_bf16 v[64:67], v[16:19], v[192:199], v117
    s_add_u32 s24, s24, 8192
    s_addc_u32 s25, s25, 0
    ds_read_b128 v[36:39], v125 offset:21504
    v_smfmac_f32_16x16x64_bf16 v[64:67], v[20:23], v[208:215], v117
    global_load_lds_dwordx4 v118, s[22:23] offset:2048 sc1
    ds_read_b128 v[48:51], v125 offset:22528
    v_smfmac_f32_16x16x64_bf16 v[68:71], v[16:19], v[200:207], v117
    s_add_u32 s26, s26, 1
    s_waitcnt lgkmcnt(4)
    v_cmp_u_f32 vcc, v24, v28
    v_smfmac_f32_16x16x64_bf16 v[68:71], v[20:23], v[216:223], v117
    ds_read_b128 v[52:55], v125 offset:23552
    v_smfmac_f32_16x16x64_bf16 v[72:75], v[16:19], v[96:103], v117
    s_cbranch_vccnz Lfs_288
Lbk_289:
    v_smfmac_f32_16x16x64_bf16 v[64:67], v[24:27], v[224:231], v117
    s_mov_b64 vcc, s[64:65]
    v_smfmac_f32_16x16x64_bf16 v[64:67], v[28:31], v[240:247], v117
    global_load_lds_dwordx4 v118, s[22:23] offset:3072 sc1
    v_smfmac_f32_16x16x64_bf16 v[68:71], v[24:27], v[232:239], v117
    s_add_u32 s22, s22, 524288
    s_addc_u32 s23, s23, 0
    v_smfmac_f32_16x16x64_bf16 v[68:71], v[28:31], v[248:255], v117
    s_waitcnt lgkmcnt(2)
    v_add_f32 v64, v64, v66
    v_smfmac_f32_16x16x64_bf16 v[72:75], v[20:23], v[32:39], v117
    ds_read_b128 v[32:35], v125 offset:24576
    v_add_f32 v65, v65, v67
    v_smfmac_f32_16x16x64_bf16 v[72:75], v[12:15], a[16:23], v117
    ds_read_b128 v[36:39], v125 offset:25600
    v_cvt_pk_bf16_f32 v102, v64, v65
    v_add_f32 v68, v68, v70
    v_smfmac_f32_16x16x64_bf16 v[72:75], v[24:27], a[32:39], v117
    ds_write_b32 v121, v102 offset:8192
    v_add_f32 v69, v69, v71
    v_cvt_pk_bf16_f32 v103, v68, v69
    v_smfmac_f32_16x16x64_bf16 v[72:75], v[28:31], a[48:55], v117
    ds_write_b32 v121, v103 offset:8704
    v_smfmac_f32_16x16x64_bf16 v[76:79], v[16:19], v[40:47], v117
    ds_read_b128 v[40:43], v125 offset:26624
    s_waitcnt lgkmcnt(5)
    v_smfmac_f32_16x16x64_bf16 v[76:79], v[20:23], v[48:55], v117
    ds_read_b128 v[44:47], v125 offset:27648
    v_add_f32 v72, v72, v74
    v_smfmac_f32_16x16x64_bf16 v[76:79], v[8:11], a[8:15], v117
    ds_read_b128 v[48:51], v125 offset:4096
    v_smfmac_f32_16x16x64_bf16 v[76:79], v[12:15], a[24:31], v117
    s_waitcnt lgkmcnt(3)
    s_barrier
    v_smfmac_f32_16x16x64_bf16 v[76:79], v[24:27], a[40:47], v117
    ds_read_b64_tr_b16 v[64:65], v122 offset:8192
    ds_read_b64_tr_b16 v[66:67], v122 offset:8704
    v_smfmac_f32_16x16x64_bf16 v[76:79], v[28:31], a[56:63], v117
    ds_read_b64_tr_b16 v[68:69], v122 offset:9216
    ds_read_b64_tr_b16 v[70:71], v122 offset:9728
    v_add_f32 v73, v73, v75
    v_cvt_pk_bf16_f32 v100, v72, v73
    v_smfmac_f32_16x16x64_bf16 v[80:83], v[0:3], a[64:71], v117
    ds_write_b32 v121, v100 offset:10240
    v_smfmac_f32_16x16x64_bf16 v[84:87], v[0:3], a[72:79], v117
    s_waitcnt lgkmcnt(3)
    ds_read_b128 v[52:55], v125 offset:5120
    v_add_f32 v76, v76, v78
    v_mfma_f32_16x16x32_bf16 v[96:99], v[56:59], v[64:67], 0
    s_waitcnt lgkmcnt(2)
    v_add_f32 v77, v77, v79
    v_cvt_pk_bf16_f32 v101, v76, v77
    v_mfma_f32_16x16x32_bf16 v[96:99], v[60:63], v[68:71], v[96:99]
    ds_write_b32 v121, v101 offset:10752
    v_smfmac_f32_16x16x64_bf16 v[80:83], v[4:7], a[80:87], v117
    s_mov_b32 exec_hi, 0
    global_store_dword v110, v108, s[20:21] sc1
    s_mov_b32 exec_hi, -1
    v_smfmac_f32_16x16x64_bf16 v[84:87], v[4:7], a[88:95], v117
    v_add_f32_dpp v98, v96, v98 quad_perm:[0,1,0,1] row_mask:0xf bank_mask:0xf
    v_add_f32_dpp v99, v97, v99 quad_perm:[0,1,0,1] row_mask:0xf bank_mask:0xf
    v_smfmac_f32_16x16x64_bf16 v[80:83], v[8:11], a[96:103], v117
    ds_write_b64 v109, v[98:99] offset:12288
    v_smfmac_f32_16x16x64_bf16 v[84:87], v[8:11], a[104:111], v117
    s_waitcnt lgkmcnt(1)
    s_barrier
    v_smfmac_f32_16x16x64_bf16 v[80:83], v[12:15], a[112:119], v117
    ds_read_b64_tr_b16 v[72:73], v122 offset:10240
    ds_read_b64_tr_b16 v[74:75], v122 offset:10752
    v_smfmac_f32_16x16x64_bf16 v[84:87], v[12:15], a[120:127], v117
    ds_read_b64_tr_b16 v[76:77], v122 offset:11264
    ds_read_b64_tr_b16 v[78:79], v122 offset:11776
    v_smfmac_f32_16x16x64_bf16 v[80:83], v[16:19], a[128:135], v117
    ds_read_b128 v[8:11], v125 offset:18432
    v_smfmac_f32_16x16x64_bf16 v[84:87], v[16:19], a[136:143], v117
    s_waitcnt lgkmcnt(5)
    s_barrier
    s_waitcnt lgkmcnt(3)
    v_mfma_f32_16x16x32_bf16 v[0:3], v[72:75], v[64:67], 0
    ds_read_b128 v[56:59], v124 offset:12288
    s_waitcnt lgkmcnt(2)
    v_mfma_f32_16x16x32_bf16 v[0:3], v[76:79], v[68:71], v[0:3]
    ds_read_b128 v[12:15], v125 offset:19456
    v_smfmac_f32_16x16x64_bf16 v[80:83], v[20:23], a[144:151], v117
    v_smfmac_f32_16x16x64_bf16 v[84:87], v[20:23], a[152:159], v117
    v_add_f32_dpp v2, v0, v2 quad_perm:[0,1,0,1] row_mask:0xf bank_mask:0xf
    v_smfmac_f32_16x16x64_bf16 v[80:83], v[24:27], a[160:167], v117
    s_waitcnt lgkmcnt(1)
    v_max3_f32 v60, v56, v57, v58
    v_add_f32_dpp v3, v1, v3 quad_perm:[0,1,0,1] row_mask:0xf bank_mask:0xf
    v_smfmac_f32_16x16x64_bf16 v[84:87], v[24:27], a[168:175], v117
    v_max_f32 v60, v60, v59
    v_smfmac_f32_16x16x64_bf16 v[80:83], v[28:31], v[32:39], v117
    s_nop 0
    v_max_f32_dpp v60, v60, v60 quad_perm:[2,3,0,1] row_mask:0xf bank_mask:0xf
    v_smfmac_f32_16x16x64_bf16 v[84:87], v[28:31], v[40:47], v117
    v_max3_f32 v61, v60, v2, v3
    v_max3_f32 v62, v60, v2, v3
    v_mov_b64 v[64:65], 0
    v_mov_b64 v[66:67], 0
    v_permlane16_swap_b32 v61, v62
    v_max_f32 v60, v61, v62
    v_max_f32 v63, v61, v62
    v_pk_add_f32 v[80:81], v[80:81], v[82:83]
    v_pk_add_f32 v[84:85], v[84:85], v[86:87]
    v_permlane32_swap_b32 v60, v63
    v_max_f32 v61, v60, v63
    v_cvt_pk_bf16_f32 v114, v80, v81
    v_cvt_pk_bf16_f32 v115, v84, v85
    v_mul_f32_dpp v62, v61, v126 quad_perm:[2,3,2,3] row_mask:0xf bank_mask:0xf
    v_pk_fma_f32 v[2:3], v[2:3], s[28:29], v[62:63] op_sel_hi:[1,1,0]
    v_pk_fma_f32 v[56:57], v[56:57], s[28:29], v[62:63] op_sel_hi:[1,1,0]
    v_exp_f32 v2, v2
    v_exp_f32 v3, v3
    v_pk_fma_f32 v[58:59], v[58:59], s[28:29], v[62:63] op_sel_hi:[1,1,0]
    v_cvt_pk_bf16_f32 v80, v2, v3
    v_exp_f32 v56, v56
    v_cndmask_b32 v5, v113, v80, vcc
    v_cndmask_b32_dpp v4, v80, v113, vcc quad_perm:[2,3,2,3] row_mask:0xf bank_mask:0xf
    v_exp_f32 v57, v57
    v_exp_f32 v58, v58
    v_mfma_f32_16x16x16_bf16 v[76:79], v[4:5], v[104:105], 0
    v_cvt_pk_bf16_f32 v84, v56, v57
    v_exp_f32 v59, v59
    v_mfma_f32_16x16x16_bf16 v[72:75], v[4:5], v[114:115], 0
    v_cvt_pk_bf16_f32 v85, v58, v59
    v_mov_b32_dpp v86, v84 quad_perm:[2,3,0,1] row_mask:0xf bank_mask:0xf
    v_mov_b64 v[68:69], 0
    v_mov_b32_dpp v87, v85 quad_perm:[2,3,0,1] row_mask:0xf bank_mask:0xf
    v_mov_b64 v[70:71], 0
    v_mov_b64 v[80:81], 0
    v_mfma_f32_16x16x32_bf16 v[76:79], v[84:87], v[104:107], v[76:79]
    ds_read_b128 v[32:35], v125 offset:6144
    v_smfmac_f32_16x16x64_bf16 v[72:75], v[84:87], v[88:95], v117
    ds_read_b128 v[36:39], v125 offset:7168
    s_nop 2
    v_rcp_f32_dpp v60, v76 quad_perm:[2,3,2,3] row_mask:0xf bank_mask:0xf
    v_rcp_f32_dpp v61, v77 quad_perm:[2,3,2,3] row_mask:0xf bank_mask:0xf
    s_nop 1
    v_pk_mul_f32 v[72:73], v[72:73], v[60:61]
    v_pk_mul_f32 v[74:75], v[74:75], v[60:61]
    v_cvt_pk_bf16_f32 v56, v72, v73
    v_cvt_pk_bf16_f32 v57, v74, v75
    ds_write_b64 v121, v[56:57] offset:14336
    v_mov_b64 v[82:83], 0
    v_mov_b64 v[84:85], 0
    v_mov_b64 v[86:87], 0
    v_mov_b64 v[72:73], 0
    v_mov_b64 v[74:75], 0
    v_mov_b64 v[76:77], 0
    v_mov_b64 v[78:79], 0
    v_mov_b64 v[88:89], 0
    v_mov_b64 v[90:91], 0
    v_mov_b64 v[92:93], 0
    v_mov_b64 v[94:95], 0
    s_waitcnt vmcnt(6)
    s_waitcnt lgkmcnt(0)
    s_barrier
    ds_read_b64_tr_b16 v[96:97], v122 offset:14336
    ds_read_b64_tr_b16 v[98:99], v122 offset:14848
    ds_read_b64_tr_b16 v[100:101], v122 offset:15360
    ds_read_b64_tr_b16 v[102:103], v122 offset:15872
    ds_read_b128 v[40:43], v125 offset:16384
    ds_read_b128 v[44:47], v125 offset:17408
    s_waitcnt lgkmcnt(4)
    v_smfmac_f32_16x16x64_bf16 v[72:75], v[96:99], a[176:183], v117
    ds_read_b128 v[24:27], v125 offset:28672
    s_waitcnt lgkmcnt(3)
    v_smfmac_f32_16x16x64_bf16 v[72:75], v[100:103], a[192:199], v117
    ds_read_b128 v[28:31], v125 offset:29696
    v_smfmac_f32_16x16x64_bf16 v[76:79], v[96:99], a[184:191], v117
    ds_read_b128 v[56:59], v125 offset:30720
    v_smfmac_f32_16x16x64_bf16 v[76:79], v[100:103], a[200:207], v117
    ds_read_b128 v[60:63], v125 offset:31744
    v_add_f32 v72, v72, v74
    v_add_f32 v73, v73, v75
    v_cvt_pk_bf16_f32 v72, v72, v73
    v_smfmac_f32_16x16x64_bf16 v[80:83], v[96:99], a[208:215], v117
    global_store_dword v119, v72, s[14:15] offset:-4096 sc1
    s_nop 1
    v_add_f32 v76, v76, v78
    v_add_f32 v77, v77, v79
    v_cvt_pk_bf16_f32 v76, v76, v77
    v_smfmac_f32_16x16x64_bf16 v[80:83], v[100:103], a[224:231], v117
    global_store_dword v119, v76, s[30:31] offset:-4096 sc1
    v_smfmac_f32_16x16x64_bf16 v[84:87], v[96:99], a[216:223], v117
    v_smfmac_f32_16x16x64_bf16 v[84:87], v[100:103], a[232:239], v117
    v_add_f32 v80, v80, v82
    v_smfmac_f32_16x16x64_bf16 v[64:67], v[96:99], a[240:247], v117
    v_add_f32 v81, v81, v83
    v_cvt_pk_bf16_f32 v80, v80, v81
    v_smfmac_f32_16x16x64_bf16 v[64:67], v[100:103], v[48:55], v117
    global_store_dword v119, v80, s[14:15] offset:-2048 sc1
    v_add_f32 v84, v84, v86
    v_smfmac_f32_16x16x64_bf16 v[68:71], v[96:99], a[248:255], v117
    v_add_f32 v85, v85, v87
    v_cvt_pk_bf16_f32 v84, v84, v85
    v_smfmac_f32_16x16x64_bf16 v[68:71], v[100:103], v[32:39], v117
    s_waitcnt lgkmcnt(4)
    global_store_dword v119, v84, s[30:31] offset:-2048 sc1
    v_add_f32 v64, v64, v66
    v_smfmac_f32_16x16x64_bf16 v[88:91], v[96:99], v[40:47], v117
    s_waitcnt lgkmcnt(2)
    v_add_f32 v65, v65, v67
    v_cvt_pk_bf16_f32 v64, v64, v65
    v_smfmac_f32_16x16x64_bf16 v[88:91], v[100:103], v[24:31], v117
    global_store_dword v119, v64, s[14:15] offset:0 sc1
    v_add_f32 v68, v68, v70
    v_smfmac_f32_16x16x64_bf16 v[92:95], v[96:99], v[8:15], v117
    s_waitcnt lgkmcnt(0)
    v_add_f32 v69, v69, v71
    v_cvt_pk_bf16_f32 v68, v68, v69
    v_smfmac_f32_16x16x64_bf16 v[92:95], v[100:103], v[56:63], v117
    global_store_dword v119, v68, s[30:31] offset:0 sc1
    v_add_f32 v88, v88, v90
    v_add_f32 v89, v89, v91
    v_cvt_pk_bf16_f32 v88, v88, v89
    global_store_dword v119, v88, s[14:15] offset:2048 sc1
    s_mov_b32 m0, 0
    ds_read_b128 v[32:35], v125 offset:0
    ds_read_b128 v[36:39], v125 offset:1024
    v_add_f32 v92, v92, v94
    v_add_f32 v93, v93, v95
    v_cvt_pk_bf16_f32 v92, v92, v93
    global_store_dword v119, v92, s[30:31] offset:2048 sc1
    global_load_dword v0, v123, s[18:19] offset:0 sc1
    global_load_dword v1, v123, s[18:19] offset:256 sc1
    global_load_dword v2, v123, s[18:19] offset:512 sc1
    global_load_dword v3, v123, s[18:19] offset:768 sc1
    global_load_dword v4, v123, s[18:19] offset:1024 sc1
    global_load_dword v5, v123, s[18:19] offset:1280 sc1
    global_load_dword v6, v123, s[18:19] offset:1536 sc1
    global_load_dword v7, v123, s[18:19] offset:1792 sc1
    ds_read_b128 v[40:43], v125 offset:8192
    ds_read_b128 v[44:47], v125 offset:9216
    ds_read_b128 v[48:51], v125 offset:2048
    ds_read_b128 v[52:55], v125 offset:3072
    ds_read_b128 v[96:99], v125 offset:10240
    ds_read_b128 v[100:103], v125 offset:11264
    v_mov_b32 v115, s26
    s_waitcnt vmcnt(4)
    v_mfma_f32_16x16x32_bf16 v[24:27], v[104:107], v[0:3], 0
    v_max3_u32 v28, v0, v1, v2
    s_waitcnt vmcnt(0)
    v_mfma_f32_16x16x32_bf16 v[24:27], v[104:107], v[4:7], v[24:27]
    v_max3_u32 v29, v4, v5, v6
    v_max3_u32 v28, v28, v3, v7
    v_cmp_u_f32 vcc, v28, v29
    s_nop 4
    v_cvt_pk_bf16_f32 v114, v24, v24
    s_cbranch_vccnz Lpf_291
Lpj_292:
    global_store_short v120, v114, s[12:13] sc1
    s_cmp_eq_u32 s26, 63
    s_cbranch_scc1 Llast_269
    v_xor_b32 v112, 8, v109
    ds_read_b64 v[90:91], v109 offset:19456
    ds_read_b64 v[88:89], v112 offset:18432
    ds_read_b64 v[94:95], v109 offset:19968
    ds_read_b64 v[92:93], v112 offset:18944
    ds_read_b128 v[56:59], v111 offset:16384
    ds_read_b128 v[60:63], v111 offset:17408
    s_waitcnt vmcnt(0)
    global_load_lds_dwordx4 v127, s[12:13] sc1
    global_load_lds_dwordx4 v127, s[12:13] offset:2048 sc1
    v_mov_b64 v[64:65], 0
    v_mov_b64 v[66:67], 0
    v_mov_b64 v[68:69], 0
    v_mov_b64 v[70:71], 0
    v_mov_b64 v[72:73], 0
    v_mov_b64 v[74:75], 0
    v_mov_b64 v[76:77], 0
    v_mov_b64 v[78:79], 0
    v_mov_b64 v[80:81], 0
    v_mov_b64 v[82:83], 0
    v_mov_b64 v[84:85], 0
    v_mov_b64 v[86:87], 0
    s_waitcnt lgkmcnt(2)
    v_swap_b32 v89, v90
    v_swap_b32 v93, v94
    global_load_lds_dwordx4 v127, s[12:13] sc1
    global_load_lds_dwordx4 v127, s[12:13] offset:2048 sc1
    s_waitcnt vmcnt(2)
    s_barrier
    ds_read_b128 v[0:3], v118 offset:0
    ds_read_b128 v[4:7], v118 offset:2048
    s_waitcnt lgkmcnt(1)
    v_smfmac_f32_16x16x64_bf16 v[64:67], v[0:3], v[128:135], v117
    ds_read_b128 v[24:27], v118 offset:0
    ds_read_b128 v[8:11], v118 offset:1024
    s_waitcnt lgkmcnt(2)
    v_smfmac_f32_16x16x64_bf16 v[64:67], v[4:7], v[144:151], v117
    ds_read_b128 v[28:31], v118 offset:2048
    ds_read_b128 v[12:15], v118 offset:3072
    v_cmp_u_f32 vcc, v0, v4
    v_smfmac_f32_16x16x64_bf16 v[68:71], v[0:3], v[136:143], v117
    v_smfmac_f32_16x16x64_bf16 v[68:71], v[4:7], v[152:159], v117
    s_cbranch_vccnz Lfa_294
    global_store_short v120, v108, s[10:11] sc1
    s_mov_b32 m0, 16384
    v_smfmac_f32_16x16x64_bf16 v[72:75], v[0:3], v[32:39], v117
    global_load_lds_dwordx4 v118, s[22:23] offset:0 sc1
    v_smfmac_f32_16x16x64_bf16 v[72:75], v[4:7], v[40:47], v117
    ds_read_b128 v[16:19], v118 offset:4096
    s_waitcnt lgkmcnt(1)
    v_cmp_u_f32 vcc, v8, v12
    v_smfmac_f32_16x16x64_bf16 v[76:79], v[0:3], v[48:55], v117
    global_store_short v120, v114, s[24:25] sc1
    ds_read_b128 v[20:23], v118 offset:6144
    v_smfmac_f32_16x16x64_bf16 v[76:79], v[4:7], v[96:103], v117
    s_cbranch_vccnz Lfs_299
Lbk_300:
Lqj_298:
    v_smfmac_f32_16x16x64_bf16 v[64:67], v[8:11], v[160:167], v117
    ds_read_b128 v[96:99], v125 offset:12288
    ds_read_b128 v[44:47], v125 offset:15360
    v_smfmac_f32_16x16x64_bf16 v[64:67], v[12:15], v[176:183], v117
    global_load_lds_dwordx4 v118, s[22:23] offset:1024 sc1
    ds_read_b128 v[100:103], v125 offset:13312
    v_smfmac_f32_16x16x64_bf16 v[68:71], v[8:11], v[168:175], v117
    ds_read_b128 v[24:27], v118 offset:5120
    s_waitcnt lgkmcnt(4)
    v_cmp_u_f32 vcc, v16, v20
    v_smfmac_f32_16x16x64_bf16 v[68:71], v[12:15], v[184:191], v117
    ds_read_b128 v[28:31], v118 offset:7168
    ds_read_b128 v[40:43], v125 offset:14336
    v_smfmac_f32_16x16x64_bf16 v[72:75], v[8:11], a[0:7], v117
    s_cbranch_vccnz Lfs_309
Lbk_310:
    ds_read_b128 v[32:35], v125 offset:20480
    v_smfmac_f32_16x16x64_bf16 v[64:67], v[16:19], v[192:199], v117
    s_add_u32 s24, s24, 8192
    s_addc_u32 s25, s25, 0
    ds_read_b128 v[36:39], v125 offset:21504
    v_smfmac_f32_16x16x64_bf16 v[64:67], v[20:23], v[208:215], v117
    global_load_lds_dwordx4 v118, s[22:23] offset:2048 sc1
    ds_read_b128 v[48:51], v125 offset:22528
    v_smfmac_f32_16x16x64_bf16 v[68:71], v[16:19], v[200:207], v117
    s_add_u32 s26, s26, 1
    s_waitcnt lgkmcnt(4)
    v_cmp_u_f32 vcc, v24, v28
    v_smfmac_f32_16x16x64_bf16 v[68:71], v[20:23], v[216:223], v117
    ds_read_b128 v[52:55], v125 offset:23552
    v_smfmac_f32_16x16x64_bf16 v[72:75], v[16:19], v[96:103], v117
    s_cbranch_vccnz Lfs_312
Lbk_313:
    v_smfmac_f32_16x16x64_bf16 v[64:67], v[24:27], v[224:231], v117
    s_mov_b64 vcc, s[64:65]
    v_smfmac_f32_16x16x64_bf16 v[64:67], v[28:31], v[240:247], v117
    global_load_lds_dwordx4 v118, s[22:23] offset:3072 sc1
    v_smfmac_f32_16x16x64_bf16 v[68:71], v[24:27], v[232:239], v117
    s_add_u32 s22, s22, 524288
    s_addc_u32 s23, s23, 0
    v_smfmac_f32_16x16x64_bf16 v[68:71], v[28:31], v[248:255], v117
    s_waitcnt lgkmcnt(2)
    v_add_f32 v64, v64, v66
    v_smfmac_f32_16x16x64_bf16 v[72:75], v[20:23], v[32:39], v117
    ds_read_b128 v[32:35], v125 offset:24576
    v_add_f32 v65, v65, v67
    v_smfmac_f32_16x16x64_bf16 v[72:75], v[12:15], a[16:23], v117
    ds_read_b128 v[36:39], v125 offset:25600
    v_cvt_pk_bf16_f32 v102, v64, v65
    v_add_f32 v68, v68, v70
    v_smfmac_f32_16x16x64_bf16 v[72:75], v[24:27], a[32:39], v117
    ds_write_b32 v121, v102 offset:8192
    v_add_f32 v69, v69, v71
    v_cvt_pk_bf16_f32 v103, v68, v69
    v_smfmac_f32_16x16x64_bf16 v[72:75], v[28:31], a[48:55], v117
    ds_write_b32 v121, v103 offset:8704
    v_smfmac_f32_16x16x64_bf16 v[76:79], v[16:19], v[40:47], v117
    ds_read_b128 v[40:43], v125 offset:26624
    s_waitcnt lgkmcnt(5)
    v_smfmac_f32_16x16x64_bf16 v[76:79], v[20:23], v[48:55], v117
    ds_read_b128 v[44:47], v125 offset:27648
    v_add_f32 v72, v72, v74
    v_smfmac_f32_16x16x64_bf16 v[76:79], v[8:11], a[8:15], v117
    ds_read_b128 v[48:51], v125 offset:4096
    v_smfmac_f32_16x16x64_bf16 v[76:79], v[12:15], a[24:31], v117
    s_waitcnt lgkmcnt(3)
    s_barrier
    v_smfmac_f32_16x16x64_bf16 v[76:79], v[24:27], a[40:47], v117
    ds_read_b64_tr_b16 v[64:65], v122 offset:8192
    ds_read_b64_tr_b16 v[66:67], v122 offset:8704
    v_smfmac_f32_16x16x64_bf16 v[76:79], v[28:31], a[56:63], v117
    ds_read_b64_tr_b16 v[68:69], v122 offset:9216
    ds_read_b64_tr_b16 v[70:71], v122 offset:9728
    v_add_f32 v73, v73, v75
    v_cvt_pk_bf16_f32 v100, v72, v73
    v_smfmac_f32_16x16x64_bf16 v[80:83], v[0:3], a[64:71], v117
    ds_write_b32 v121, v100 offset:10240
    v_smfmac_f32_16x16x64_bf16 v[84:87], v[0:3], a[72:79], v117
    s_waitcnt lgkmcnt(3)
    ds_read_b128 v[52:55], v125 offset:5120
    v_add_f32 v76, v76, v78
    v_mfma_f32_16x16x32_bf16 v[96:99], v[56:59], v[64:67], 0
    s_waitcnt lgkmcnt(2)
    v_add_f32 v77, v77, v79
    v_cvt_pk_bf16_f32 v101, v76, v77
    v_mfma_f32_16x16x32_bf16 v[96:99], v[60:63], v[68:71], v[96:99]
    ds_write_b32 v121, v101 offset:10752
    v_smfmac_f32_16x16x64_bf16 v[80:83], v[4:7], a[80:87], v117
    s_mov_b32 exec_hi, 0
    global_store_dword v110, v108, s[18:19] sc1
    s_mov_b32 exec_hi, -1
    v_smfmac_f32_16x16x64_bf16 v[84:87], v[4:7], a[88:95], v117
    v_add_f32_dpp v98, v96, v98 quad_perm:[0,1,0,1] row_mask:0xf bank_mask:0xf
    v_add_f32_dpp v99, v97, v99 quad_perm:[0,1,0,1] row_mask:0xf bank_mask:0xf
    v_smfmac_f32_16x16x64_bf16 v[80:83], v[8:11], a[96:103], v117
    ds_write_b64 v109, v[98:99] offset:12288
    v_smfmac_f32_16x16x64_bf16 v[84:87], v[8:11], a[104:111], v117
    s_waitcnt lgkmcnt(1)
    s_barrier
    v_smfmac_f32_16x16x64_bf16 v[80:83], v[12:15], a[112:119], v117
    ds_read_b64_tr_b16 v[72:73], v122 offset:10240
    ds_read_b64_tr_b16 v[74:75], v122 offset:10752
    v_smfmac_f32_16x16x64_bf16 v[84:87], v[12:15], a[120:127], v117
    ds_read_b64_tr_b16 v[76:77], v122 offset:11264
    ds_read_b64_tr_b16 v[78:79], v122 offset:11776
    v_smfmac_f32_16x16x64_bf16 v[80:83], v[16:19], a[128:135], v117
    ds_read_b128 v[8:11], v125 offset:18432
    v_smfmac_f32_16x16x64_bf16 v[84:87], v[16:19], a[136:143], v117
    s_waitcnt lgkmcnt(5)
    s_barrier
    s_waitcnt lgkmcnt(3)
    v_mfma_f32_16x16x32_bf16 v[0:3], v[72:75], v[64:67], 0
    ds_read_b128 v[56:59], v124 offset:12288
    s_waitcnt lgkmcnt(2)
    v_mfma_f32_16x16x32_bf16 v[0:3], v[76:79], v[68:71], v[0:3]
    ds_read_b128 v[12:15], v125 offset:19456
    v_smfmac_f32_16x16x64_bf16 v[80:83], v[20:23], a[144:151], v117
    v_smfmac_f32_16x16x64_bf16 v[84:87], v[20:23], a[152:159], v117
    v_add_f32_dpp v2, v0, v2 quad_perm:[0,1,0,1] row_mask:0xf bank_mask:0xf
    v_smfmac_f32_16x16x64_bf16 v[80:83], v[24:27], a[160:167], v117
    s_waitcnt lgkmcnt(1)
    v_max3_f32 v60, v56, v57, v58
    v_add_f32_dpp v3, v1, v3 quad_perm:[0,1,0,1] row_mask:0xf bank_mask:0xf
    v_smfmac_f32_16x16x64_bf16 v[84:87], v[24:27], a[168:175], v117
    v_max_f32 v60, v60, v59
    v_smfmac_f32_16x16x64_bf16 v[80:83], v[28:31], v[32:39], v117
    s_nop 0
    v_max_f32_dpp v60, v60, v60 quad_perm:[2,3,0,1] row_mask:0xf bank_mask:0xf
    v_smfmac_f32_16x16x64_bf16 v[84:87], v[28:31], v[40:47], v117
    v_max3_f32 v61, v60, v2, v3
    v_max3_f32 v62, v60, v2, v3
    v_mov_b64 v[64:65], 0
    v_mov_b64 v[66:67], 0
    v_permlane16_swap_b32 v61, v62
    v_max_f32 v60, v61, v62
    v_max_f32 v63, v61, v62
    v_pk_add_f32 v[80:81], v[80:81], v[82:83]
    v_pk_add_f32 v[84:85], v[84:85], v[86:87]
    v_permlane32_swap_b32 v60, v63
    v_max_f32 v61, v60, v63
    v_cvt_pk_bf16_f32 v114, v80, v81
    v_cvt_pk_bf16_f32 v115, v84, v85
    v_mul_f32_dpp v62, v61, v126 quad_perm:[2,3,2,3] row_mask:0xf bank_mask:0xf
    v_pk_fma_f32 v[2:3], v[2:3], s[28:29], v[62:63] op_sel_hi:[1,1,0]
    v_pk_fma_f32 v[56:57], v[56:57], s[28:29], v[62:63] op_sel_hi:[1,1,0]
    v_exp_f32 v2, v2
    v_exp_f32 v3, v3
    v_pk_fma_f32 v[58:59], v[58:59], s[28:29], v[62:63] op_sel_hi:[1,1,0]
    v_cvt_pk_bf16_f32 v80, v2, v3
    v_exp_f32 v56, v56
    v_cndmask_b32 v5, v113, v80, vcc
    v_cndmask_b32_dpp v4, v80, v113, vcc quad_perm:[2,3,2,3] row_mask:0xf bank_mask:0xf
    v_exp_f32 v57, v57
    v_exp_f32 v58, v58
    v_mfma_f32_16x16x16_bf16 v[76:79], v[4:5], v[104:105], 0
    v_cvt_pk_bf16_f32 v84, v56, v57
    v_exp_f32 v59, v59
    v_mfma_f32_16x16x16_bf16 v[72:75], v[4:5], v[114:115], 0
    v_cvt_pk_bf16_f32 v85, v58, v59
    v_mov_b32_dpp v86, v84 quad_perm:[2,3,0,1] row_mask:0xf bank_mask:0xf
    v_mov_b64 v[68:69], 0
    v_mov_b32_dpp v87, v85 quad_perm:[2,3,0,1] row_mask:0xf bank_mask:0xf
    v_mov_b64 v[70:71], 0
    v_mov_b64 v[80:81], 0
    v_mfma_f32_16x16x32_bf16 v[76:79], v[84:87], v[104:107], v[76:79]
    ds_read_b128 v[32:35], v125 offset:6144
    v_smfmac_f32_16x16x64_bf16 v[72:75], v[84:87], v[88:95], v117
    ds_read_b128 v[36:39], v125 offset:7168
    s_nop 2
    v_rcp_f32_dpp v60, v76 quad_perm:[2,3,2,3] row_mask:0xf bank_mask:0xf
    v_rcp_f32_dpp v61, v77 quad_perm:[2,3,2,3] row_mask:0xf bank_mask:0xf
    s_nop 1
    v_pk_mul_f32 v[72:73], v[72:73], v[60:61]
    v_pk_mul_f32 v[74:75], v[74:75], v[60:61]
    v_cvt_pk_bf16_f32 v56, v72, v73
    v_cvt_pk_bf16_f32 v57, v74, v75
    ds_write_b64 v121, v[56:57] offset:14336
    v_mov_b64 v[82:83], 0
    v_mov_b64 v[84:85], 0
    v_mov_b64 v[86:87], 0
    v_mov_b64 v[72:73], 0
    v_mov_b64 v[74:75], 0
    v_mov_b64 v[76:77], 0
    v_mov_b64 v[78:79], 0
    v_mov_b64 v[88:89], 0
    v_mov_b64 v[90:91], 0
    v_mov_b64 v[92:93], 0
    v_mov_b64 v[94:95], 0
    s_waitcnt vmcnt(6)
    s_waitcnt lgkmcnt(0)
    s_barrier
    ds_read_b64_tr_b16 v[96:97], v122 offset:14336
    ds_read_b64_tr_b16 v[98:99], v122 offset:14848
    ds_read_b64_tr_b16 v[100:101], v122 offset:15360
    ds_read_b64_tr_b16 v[102:103], v122 offset:15872
    ds_read_b128 v[40:43], v125 offset:16384
    ds_read_b128 v[44:47], v125 offset:17408
    s_waitcnt lgkmcnt(4)
    v_smfmac_f32_16x16x64_bf16 v[72:75], v[96:99], a[176:183], v117
    ds_read_b128 v[24:27], v125 offset:28672
    s_waitcnt lgkmcnt(3)
    v_smfmac_f32_16x16x64_bf16 v[72:75], v[100:103], a[192:199], v117
    ds_read_b128 v[28:31], v125 offset:29696
    v_smfmac_f32_16x16x64_bf16 v[76:79], v[96:99], a[184:191], v117
    ds_read_b128 v[56:59], v125 offset:30720
    v_smfmac_f32_16x16x64_bf16 v[76:79], v[100:103], a[200:207], v117
    ds_read_b128 v[60:63], v125 offset:31744
    v_add_f32 v72, v72, v74
    v_add_f32 v73, v73, v75
    v_cvt_pk_bf16_f32 v72, v72, v73
    v_smfmac_f32_16x16x64_bf16 v[80:83], v[96:99], a[208:215], v117
    global_store_dword v119, v72, s[16:17] offset:-4096 sc1
    s_nop 1
    v_add_f32 v76, v76, v78
    v_add_f32 v77, v77, v79
    v_cvt_pk_bf16_f32 v76, v76, v77
    v_smfmac_f32_16x16x64_bf16 v[80:83], v[100:103], a[224:231], v117
    global_store_dword v119, v76, s[32:33] offset:-4096 sc1
    v_smfmac_f32_16x16x64_bf16 v[84:87], v[96:99], a[216:223], v117
    v_smfmac_f32_16x16x64_bf16 v[84:87], v[100:103], a[232:239], v117
    v_add_f32 v80, v80, v82
    v_smfmac_f32_16x16x64_bf16 v[64:67], v[96:99], a[240:247], v117
    v_add_f32 v81, v81, v83
    v_cvt_pk_bf16_f32 v80, v80, v81
    v_smfmac_f32_16x16x64_bf16 v[64:67], v[100:103], v[48:55], v117
    global_store_dword v119, v80, s[16:17] offset:-2048 sc1
    v_add_f32 v84, v84, v86
    v_smfmac_f32_16x16x64_bf16 v[68:71], v[96:99], a[248:255], v117
    v_add_f32 v85, v85, v87
    v_cvt_pk_bf16_f32 v84, v84, v85
    v_smfmac_f32_16x16x64_bf16 v[68:71], v[100:103], v[32:39], v117
    s_waitcnt lgkmcnt(4)
    global_store_dword v119, v84, s[32:33] offset:-2048 sc1
    v_add_f32 v64, v64, v66
    v_smfmac_f32_16x16x64_bf16 v[88:91], v[96:99], v[40:47], v117
    s_waitcnt lgkmcnt(2)
    v_add_f32 v65, v65, v67
    v_cvt_pk_bf16_f32 v64, v64, v65
    v_smfmac_f32_16x16x64_bf16 v[88:91], v[100:103], v[24:31], v117
    global_store_dword v119, v64, s[16:17] offset:0 sc1
    v_add_f32 v68, v68, v70
    v_smfmac_f32_16x16x64_bf16 v[92:95], v[96:99], v[8:15], v117
    s_waitcnt lgkmcnt(0)
    v_add_f32 v69, v69, v71
    v_cvt_pk_bf16_f32 v68, v68, v69
    v_smfmac_f32_16x16x64_bf16 v[92:95], v[100:103], v[56:63], v117
    global_store_dword v119, v68, s[32:33] offset:0 sc1
    v_add_f32 v88, v88, v90
    v_add_f32 v89, v89, v91
    v_cvt_pk_bf16_f32 v88, v88, v89
    global_store_dword v119, v88, s[16:17] offset:2048 sc1
    s_mov_b32 m0, 0
    ds_read_b128 v[32:35], v125 offset:0
    ds_read_b128 v[36:39], v125 offset:1024
    v_add_f32 v92, v92, v94
    v_add_f32 v93, v93, v95
    v_cvt_pk_bf16_f32 v92, v92, v93
    global_store_dword v119, v92, s[32:33] offset:2048 sc1
    global_load_dword v0, v123, s[20:21] offset:0 sc1
    global_load_dword v1, v123, s[20:21] offset:256 sc1
    global_load_dword v2, v123, s[20:21] offset:512 sc1
    global_load_dword v3, v123, s[20:21] offset:768 sc1
    global_load_dword v4, v123, s[20:21] offset:1024 sc1
    global_load_dword v5, v123, s[20:21] offset:1280 sc1
    global_load_dword v6, v123, s[20:21] offset:1536 sc1
    global_load_dword v7, v123, s[20:21] offset:1792 sc1
    ds_read_b128 v[40:43], v125 offset:8192
    ds_read_b128 v[44:47], v125 offset:9216
    ds_read_b128 v[48:51], v125 offset:2048
    ds_read_b128 v[52:55], v125 offset:3072
    ds_read_b128 v[96:99], v125 offset:10240
    ds_read_b128 v[100:103], v125 offset:11264
    v_mov_b32 v115, s26
    s_waitcnt vmcnt(4)
    v_mfma_f32_16x16x32_bf16 v[24:27], v[104:107], v[0:3], 0
    v_max3_u32 v28, v0, v1, v2
    s_waitcnt vmcnt(0)
    v_mfma_f32_16x16x32_bf16 v[24:27], v[104:107], v[4:7], v[24:27]
    v_max3_u32 v29, v4, v5, v6
    v_max3_u32 v28, v28, v3, v7
    v_cmp_u_f32 vcc, v28, v29
    s_nop 4
    v_cvt_pk_bf16_f32 v114, v24, v24
    s_cbranch_vccnz Lpf_315
Lpj_316:
    global_store_short v120, v114, s[10:11] sc1
    s_branch Lhl0_268
Llast_269:
    global_store_short v120, v114, s[24:25] sc1
    s_branch L_fin
Lfa_270:
    s_waitcnt lgkmcnt(1)
    ds_read_b128 v[0:3], v118 offset:0
    ds_read_b128 v[4:7], v118 offset:2048
    global_load_lds_dwordx4 v127, s[10:11] sc1
    global_load_lds_dwordx4 v127, s[10:11] offset:2048 sc1
Lqb_272:
    ds_read_b128 v[8:11], v118 offset:1024
    ds_read_b128 v[12:15], v118 offset:3072
    v_smfmac_f32_16x16x64_bf16 v[72:75], v[24:27], v[32:39], v117
    v_max_u32 v112, v24, v28
    v_cmp_eq_u32 vcc, -1, v112
    v_smfmac_f32_16x16x64_bf16 v[72:75], v[28:31], v[40:47], v117
    v_smfmac_f32_16x16x64_bf16 v[76:79], v[24:27], v[48:55], v117
    s_cbranch_vccnz Lfb_271
    v_mov_b64 v[64:65], 0
    v_mov_b64 v[66:67], 0
    v_smfmac_f32_16x16x64_bf16 v[76:79], v[28:31], v[96:103], v117
    global_store_short v120, v108, s[12:13] sc1
    s_mov_b32 m0, 16384
    v_mov_b64 v[68:69], 0
    v_mov_b64 v[70:71], 0
    v_smfmac_f32_16x16x64_bf16 v[64:67], v[24:27], v[128:135], v117
    global_load_lds_dwordx4 v118, s[22:23] offset:0 sc1
    v_smfmac_f32_16x16x64_bf16 v[64:67], v[28:31], v[144:151], v117
    ds_read_b128 v[16:19], v118 offset:4096
    s_waitcnt lgkmcnt(1)
    v_cmp_u_f32 vcc, v8, v12
    v_smfmac_f32_16x16x64_bf16 v[68:71], v[24:27], v[136:143], v117
    global_store_short v120, v114, s[24:25] sc1
    ds_read_b128 v[20:23], v118 offset:6144
    v_smfmac_f32_16x16x64_bf16 v[68:71], v[28:31], v[152:159], v117
    s_cbranch_vccnz Lfs_278
Lbk_279:
    s_branch Lqj_274
Lfb_271:
    v_mov_b64 v[64:65], 0
    v_mov_b64 v[66:67], 0
    v_mov_b64 v[68:69], 0
    v_mov_b64 v[70:71], 0
    v_mov_b64 v[72:73], 0
    v_mov_b64 v[74:75], 0
    s_nop 0
    v_mov_b64 v[76:77], 0
    v_mov_b64 v[78:79], 0
Lr0_281:
    ds_read_b128 v[24:27], v118 offset:0
    ds_read_b128 v[28:31], v118 offset:2048
    global_load_lds_dwordx4 v127, s[10:11] sc1
    global_load_lds_dwordx4 v127, s[10:11] offset:2048 sc1
    s_waitcnt lgkmcnt(2)
    v_max_u32 v112, v0, v4
    v_cmp_eq_u32 vcc, -1, v112
    s_cbranch_vccz Lqa_273
    ds_read_b128 v[0:3], v118 offset:0
    ds_read_b128 v[4:7], v118 offset:2048
    global_load_lds_dwordx4 v127, s[10:11] sc1
    global_load_lds_dwordx4 v127, s[10:11] offset:2048 sc1
    s_waitcnt lgkmcnt(2)
    v_max_u32 v112, v24, v28
    v_cmp_eq_u32 vcc, -1, v112
    s_cbranch_vccz Lqb_272
    s_sub_u32 s27, s27, 1
    s_cbranch_scc0 Lr0_281
    s_branch L_fin
Lqa_273:
    ds_read_b128 v[8:11], v118 offset:1024
    ds_read_b128 v[12:15], v118 offset:3072
    v_smfmac_f32_16x16x64_bf16 v[64:67], v[0:3], v[128:135], v117
    v_smfmac_f32_16x16x64_bf16 v[64:67], v[4:7], v[144:151], v117
    v_smfmac_f32_16x16x64_bf16 v[68:71], v[0:3], v[136:143], v117
    v_smfmac_f32_16x16x64_bf16 v[68:71], v[4:7], v[152:159], v117
    global_store_short v120, v108, s[12:13] sc1
    s_mov_b32 m0, 16384
    v_smfmac_f32_16x16x64_bf16 v[72:75], v[0:3], v[32:39], v117
    global_load_lds_dwordx4 v118, s[22:23] offset:0 sc1
    v_smfmac_f32_16x16x64_bf16 v[72:75], v[4:7], v[40:47], v117
    ds_read_b128 v[16:19], v118 offset:4096
    s_waitcnt lgkmcnt(1)
    v_cmp_u_f32 vcc, v8, v12
    v_smfmac_f32_16x16x64_bf16 v[76:79], v[0:3], v[48:55], v117
    global_store_short v120, v114, s[24:25] sc1
    ds_read_b128 v[20:23], v118 offset:6144
    v_smfmac_f32_16x16x64_bf16 v[76:79], v[4:7], v[96:103], v117
    s_cbranch_vccnz Lfs_282
Lbk_283:
    s_branch Lqj_274
Lpf_291:
    global_load_dword v16, v123, s[18:19] offset:0 sc1
    global_load_dword v17, v123, s[18:19] offset:256 sc1
    global_load_dword v18, v123, s[18:19] offset:512 sc1
    global_load_dword v19, v123, s[18:19] offset:768 sc1
    global_load_dword v20, v123, s[18:19] offset:1024 sc1
    global_load_dword v21, v123, s[18:19] offset:1280 sc1
    global_load_dword v22, v123, s[18:19] offset:1536 sc1
    global_load_dword v23, v123, s[18:19] offset:1792 sc1
    global_load_dword v8, v123, s[18:19] offset:0 sc1
    global_load_dword v9, v123, s[18:19] offset:256 sc1
    global_load_dword v10, v123, s[18:19] offset:512 sc1
    global_load_dword v11, v123, s[18:19] offset:768 sc1
    global_load_dword v12, v123, s[18:19] offset:1024 sc1
    global_load_dword v13, v123, s[18:19] offset:1280 sc1
    global_load_dword v14, v123, s[18:19] offset:1536 sc1
    global_load_dword v15, v123, s[18:19] offset:1792 sc1
    s_waitcnt vmcnt(12)
    v_mfma_f32_16x16x32_bf16 v[24:27], v[104:107], v[16:19], 0
    v_max3_u32 v28, v16, v17, v18
    s_waitcnt vmcnt(8)
    v_mfma_f32_16x16x32_bf16 v[24:27], v[104:107], v[20:23], v[24:27]
    v_max3_u32 v29, v20, v21, v22
    v_max3_u32 v28, v28, v19, v23
    v_max_u32 v28, v28, v29
    v_cmp_eq_u32 vcc, -1, v28
    s_nop 3
    v_cvt_pk_bf16_f32 v114, v24, v24
    s_cbranch_vccz Lpj_292
Lpl_293:
    global_load_dword v16, v123, s[18:19] offset:0 sc1
    global_load_dword v17, v123, s[18:19] offset:256 sc1
    global_load_dword v18, v123, s[18:19] offset:512 sc1
    global_load_dword v19, v123, s[18:19] offset:768 sc1
    global_load_dword v20, v123, s[18:19] offset:1024 sc1
    global_load_dword v21, v123, s[18:19] offset:1280 sc1
    global_load_dword v22, v123, s[18:19] offset:1536 sc1
    global_load_dword v23, v123, s[18:19] offset:1792 sc1
    s_waitcnt vmcnt(12)
    v_mfma_f32_16x16x32_bf16 v[24:27], v[104:107], v[8:11], 0
    v_max3_u32 v28, v8, v9, v10
    s_waitcnt vmcnt(8)
    v_mfma_f32_16x16x32_bf16 v[24:27], v[104:107], v[12:15], v[24:27]
    v_max3_u32 v29, v12, v13, v14
    v_max3_u32 v28, v28, v11, v15
    v_max_u32 v28, v28, v29
    v_cmp_eq_u32 vcc, -1, v28
    s_nop 3
    v_cvt_pk_bf16_f32 v114, v24, v24
    s_cbranch_vccz Lpj_292
    global_load_dword v8, v123, s[18:19] offset:0 sc1
    global_load_dword v9, v123, s[18:19] offset:256 sc1
    global_load_dword v10, v123, s[18:19] offset:512 sc1
    global_load_dword v11, v123, s[18:19] offset:768 sc1
    global_load_dword v12, v123, s[18:19] offset:1024 sc1
    global_load_dword v13, v123, s[18:19] offset:1280 sc1
    global_load_dword v14, v123, s[18:19] offset:1536 sc1
    global_load_dword v15, v123, s[18:19] offset:1792 sc1
    s_waitcnt vmcnt(12)
    v_mfma_f32_16x16x32_bf16 v[24:27], v[104:107], v[16:19], 0
    v_max3_u32 v28, v16, v17, v18
    s_waitcnt vmcnt(8)
    v_mfma_f32_16x16x32_bf16 v[24:27], v[104:107], v[20:23], v[24:27]
    v_max3_u32 v29, v20, v21, v22
    v_max3_u32 v28, v28, v19, v23
    v_max_u32 v28, v28, v29
    v_cmp_eq_u32 vcc, -1, v28
    s_nop 3
    v_cvt_pk_bf16_f32 v114, v24, v24
    s_cbranch_vccz Lpj_292
    s_sub_u32 s27, s27, 1
    s_cbranch_scc0 Lpl_293
    s_branch L_fin
Lfa_294:
    s_waitcnt lgkmcnt(1)
    ds_read_b128 v[0:3], v118 offset:0
    ds_read_b128 v[4:7], v118 offset:2048
    global_load_lds_dwordx4 v127, s[12:13] sc1
    global_load_lds_dwordx4 v127, s[12:13] offset:2048 sc1
Lqb_296:
    ds_read_b128 v[8:11], v118 offset:1024
    ds_read_b128 v[12:15], v118 offset:3072
    v_smfmac_f32_16x16x64_bf16 v[72:75], v[24:27], v[32:39], v117
    v_max_u32 v112, v24, v28
    v_cmp_eq_u32 vcc, -1, v112
    v_smfmac_f32_16x16x64_bf16 v[72:75], v[28:31], v[40:47], v117
    v_smfmac_f32_16x16x64_bf16 v[76:79], v[24:27], v[48:55], v117
    s_cbranch_vccnz Lfb_295
    v_mov_b64 v[64:65], 0
    v_mov_b64 v[66:67], 0
    v_smfmac_f32_16x16x64_bf16 v[76:79], v[28:31], v[96:103], v117
    global_store_short v120, v108, s[10:11] sc1
    s_mov_b32 m0, 16384
    v_mov_b64 v[68:69], 0
    v_mov_b64 v[70:71], 0
    v_smfmac_f32_16x16x64_bf16 v[64:67], v[24:27], v[128:135], v117
    global_load_lds_dwordx4 v118, s[22:23] offset:0 sc1
    v_smfmac_f32_16x16x64_bf16 v[64:67], v[28:31], v[144:151], v117
    ds_read_b128 v[16:19], v118 offset:4096
    s_waitcnt lgkmcnt(1)
    v_cmp_u_f32 vcc, v8, v12
    v_smfmac_f32_16x16x64_bf16 v[68:71], v[24:27], v[136:143], v117
    global_store_short v120, v114, s[24:25] sc1
    ds_read_b128 v[20:23], v118 offset:6144
    v_smfmac_f32_16x16x64_bf16 v[68:71], v[28:31], v[152:159], v117
    s_cbranch_vccnz Lfs_302
Lbk_303:
    s_branch Lqj_298
Lfb_295:
    v_mov_b64 v[64:65], 0
    v_mov_b64 v[66:67], 0
    v_mov_b64 v[68:69], 0
    v_mov_b64 v[70:71], 0
    v_mov_b64 v[72:73], 0
    v_mov_b64 v[74:75], 0
    s_nop 0
    v_mov_b64 v[76:77], 0
    v_mov_b64 v[78:79], 0
Lr0_305:
    ds_read_b128 v[24:27], v118 offset:0
    ds_read_b128 v[28:31], v118 offset:2048
    global_load_lds_dwordx4 v127, s[12:13] sc1
    global_load_lds_dwordx4 v127, s[12:13] offset:2048 sc1
    s_waitcnt lgkmcnt(2)
    v_max_u32 v112, v0, v4
    v_cmp_eq_u32 vcc, -1, v112
    s_cbranch_vccz Lqa_297
    ds_read_b128 v[0:3], v118 offset:0
    ds_read_b128 v[4:7], v118 offset:2048
    global_load_lds_dwordx4 v127, s[12:13] sc1
    global_load_lds_dwordx4 v127, s[12:13] offset:2048 sc1
    s_waitcnt lgkmcnt(2)
    v_max_u32 v112, v24, v28
    v_cmp_eq_u32 vcc, -1, v112
    s_cbranch_vccz Lqb_296
    s_sub_u32 s27, s27, 1
    s_cbranch_scc0 Lr0_305
    s_branch L_fin
Lqa_297:
    ds_read_b128 v[8:11], v118 offset:1024
    ds_read_b128 v[12:15], v118 offset:3072
    v_smfmac_f32_16x16x64_bf16 v[64:67], v[0:3], v[128:135], v117
    v_smfmac_f32_16x16x64_bf16 v[64:67], v[4:7], v[144:151], v117
    v_smfmac_f32_16x16x64_bf16 v[68:71], v[0:3], v[136:143], v117
    v_smfmac_f32_16x16x64_bf16 v[68:71], v[4:7], v[152:159], v117
    global_store_short v120, v108, s[10:11] sc1
    s_mov_b32 m0, 16384
    v_smfmac_f32_16x16x64_bf16 v[72:75], v[0:3], v[32:39], v117
    global_load_lds_dwordx4 v118, s[22:23] offset:0 sc1
    v_smfmac_f32_16x16x64_bf16 v[72:75], v[4:7], v[40:47], v117
    ds_read_b128 v[16:19], v118 offset:4096
    s_waitcnt lgkmcnt(1)
    v_cmp_u_f32 vcc, v8, v12
    v_smfmac_f32_16x16x64_bf16 v[76:79], v[0:3], v[48:55], v117
    global_store_short v120, v114, s[24:25] sc1
    ds_read_b128 v[20:23], v118 offset:6144
    v_smfmac_f32_16x16x64_bf16 v[76:79], v[4:7], v[96:103], v117
    s_cbranch_vccnz Lfs_306
Lbk_307:
    s_branch Lqj_298
Lpf_315:
    global_load_dword v16, v123, s[20:21] offset:0 sc1
    global_load_dword v17, v123, s[20:21] offset:256 sc1
    global_load_dword v18, v123, s[20:21] offset:512 sc1
    global_load_dword v19, v123, s[20:21] offset:768 sc1
    global_load_dword v20, v123, s[20:21] offset:1024 sc1
    global_load_dword v21, v123, s[20:21] offset:1280 sc1
    global_load_dword v22, v123, s[20:21] offset:1536 sc1
    global_load_dword v23, v123, s[20:21] offset:1792 sc1
    global_load_dword v8, v123, s[20:21] offset:0 sc1
    global_load_dword v9, v123, s[20:21] offset:256 sc1
    global_load_dword v10, v123, s[20:21] offset:512 sc1
    global_load_dword v11, v123, s[20:21] offset:768 sc1
    global_load_dword v12, v123, s[20:21] offset:1024 sc1
    global_load_dword v13, v123, s[20:21] offset:1280 sc1
    global_load_dword v14, v123, s[20:21] offset:1536 sc1
    global_load_dword v15, v123, s[20:21] offset:1792 sc1
    s_waitcnt vmcnt(12)
    v_mfma_f32_16x16x32_bf16 v[24:27], v[104:107], v[16:19], 0
    v_max3_u32 v28, v16, v17, v18
    s_waitcnt vmcnt(8)
    v_mfma_f32_16x16x32_bf16 v[24:27], v[104:107], v[20:23], v[24:27]
    v_max3_u32 v29, v20, v21, v22
    v_max3_u32 v28, v28, v19, v23
    v_max_u32 v28, v28, v29
    v_cmp_eq_u32 vcc, -1, v28
    s_nop 3
    v_cvt_pk_bf16_f32 v114, v24, v24
    s_cbranch_vccz Lpj_316
Lpl_317:
    global_load_dword v16, v123, s[20:21] offset:0 sc1
    global_load_dword v17, v123, s[20:21] offset:256 sc1
    global_load_dword v18, v123, s[20:21] offset:512 sc1
    global_load_dword v19, v123, s[20:21] offset:768 sc1
    global_load_dword v20, v123, s[20:21] offset:1024 sc1
    global_load_dword v21, v123, s[20:21] offset:1280 sc1
    global_load_dword v22, v123, s[20:21] offset:1536 sc1
    global_load_dword v23, v123, s[20:21] offset:1792 sc1
    s_waitcnt vmcnt(12)
    v_mfma_f32_16x16x32_bf16 v[24:27], v[104:107], v[8:11], 0
    v_max3_u32 v28, v8, v9, v10
    s_waitcnt vmcnt(8)
    v_mfma_f32_16x16x32_bf16 v[24:27], v[104:107], v[12:15], v[24:27]
    v_max3_u32 v29, v12, v13, v14
    v_max3_u32 v28, v28, v11, v15
    v_max_u32 v28, v28, v29
    v_cmp_eq_u32 vcc, -1, v28
    s_nop 3
    v_cvt_pk_bf16_f32 v114, v24, v24
    s_cbranch_vccz Lpj_316
    global_load_dword v8, v123, s[20:21] offset:0 sc1
    global_load_dword v9, v123, s[20:21] offset:256 sc1
    global_load_dword v10, v123, s[20:21] offset:512 sc1
    global_load_dword v11, v123, s[20:21] offset:768 sc1
    global_load_dword v12, v123, s[20:21] offset:1024 sc1
    global_load_dword v13, v123, s[20:21] offset:1280 sc1
    global_load_dword v14, v123, s[20:21] offset:1536 sc1
    global_load_dword v15, v123, s[20:21] offset:1792 sc1
    s_waitcnt vmcnt(12)
    v_mfma_f32_16x16x32_bf16 v[24:27], v[104:107], v[16:19], 0
    v_max3_u32 v28, v16, v17, v18
    s_waitcnt vmcnt(8)
    v_mfma_f32_16x16x32_bf16 v[24:27], v[104:107], v[20:23], v[24:27]
    v_max3_u32 v29, v20, v21, v22
    v_max3_u32 v28, v28, v19, v23
    v_max_u32 v28, v28, v29
    v_cmp_eq_u32 vcc, -1, v28
    s_nop 3
    v_cvt_pk_bf16_f32 v114, v24, v24
    s_cbranch_vccz Lpj_316
    s_sub_u32 s27, s27, 1
    s_cbranch_scc0 Lpl_317
    s_branch L_fin
Lfs_275:
Lfl_277:
    ds_read_b128 v[8:11], v118 offset:1024
    ds_read_b128 v[12:15], v118 offset:3072
    s_sub_u32 s27, s27, 1
    s_waitcnt lgkmcnt(0)
    v_max_u32 v112, v8, v12
    v_cmp_eq_u32 vcc, -1, v112
    s_cbranch_vccz Lbk_276
    s_cbranch_scc0 Lfl_277
    s_branch L_fin
Lfs_278:
Lfl_280:
    ds_read_b128 v[8:11], v118 offset:1024
    ds_read_b128 v[12:15], v118 offset:3072
    s_sub_u32 s27, s27, 1
    s_waitcnt lgkmcnt(0)
    v_max_u32 v112, v8, v12
    v_cmp_eq_u32 vcc, -1, v112
    s_cbranch_vccz Lbk_279
    s_cbranch_scc0 Lfl_280
    s_branch L_fin
Lfs_282:
Lfl_284:
    ds_read_b128 v[8:11], v118 offset:1024
    ds_read_b128 v[12:15], v118 offset:3072
    s_sub_u32 s27, s27, 1
    s_waitcnt lgkmcnt(0)
    v_max_u32 v112, v8, v12
    v_cmp_eq_u32 vcc, -1, v112
    s_cbranch_vccz Lbk_283
    s_cbranch_scc0 Lfl_284
    s_branch L_fin
Lfs_285:
Lfl_287:
    ds_read_b128 v[16:19], v118 offset:4096
    ds_read_b128 v[20:23], v118 offset:6144
    s_sub_u32 s27, s27, 1
    s_waitcnt lgkmcnt(0)
    v_max_u32 v112, v16, v20
    v_cmp_eq_u32 vcc, -1, v112
    s_cbranch_vccz Lbk_286
    s_cbranch_scc0 Lfl_287
    s_branch L_fin
Lfs_288:
Lfl_290:
    ds_read_b128 v[24:27], v118 offset:5120
    ds_read_b128 v[28:31], v118 offset:7168
    s_sub_u32 s27, s27, 1
    s_waitcnt lgkmcnt(0)
    v_max_u32 v112, v24, v28
    v_cmp_eq_u32 vcc, -1, v112
    s_cbranch_vccz Lbk_289
    s_cbranch_scc0 Lfl_290
    s_branch L_fin
Lfs_299:
Lfl_301:
    ds_read_b128 v[8:11], v118 offset:1024
    ds_read_b128 v[12:15], v118 offset:3072
    s_sub_u32 s27, s27, 1
    s_waitcnt lgkmcnt(0)
    v_max_u32 v112, v8, v12
    v_cmp_eq_u32 vcc, -1, v112
    s_cbranch_vccz Lbk_300
    s_cbranch_scc0 Lfl_301
    s_branch L_fin
Lfs_302:
Lfl_304:
    ds_read_b128 v[8:11], v118 offset:1024
    ds_read_b128 v[12:15], v118 offset:3072
    s_sub_u32 s27, s27, 1
    s_waitcnt lgkmcnt(0)
    v_max_u32 v112, v8, v12
    v_cmp_eq_u32 vcc, -1, v112
    s_cbranch_vccz Lbk_303
    s_cbranch_scc0 Lfl_304
    s_branch L_fin
Lfs_306:
Lfl_308:
    ds_read_b128 v[8:11], v118 offset:1024
    ds_read_b128 v[12:15], v118 offset:3072
    s_sub_u32 s27, s27, 1
    s_waitcnt lgkmcnt(0)
    v_max_u32 v112, v8, v12
    v_cmp_eq_u32 vcc, -1, v112
    s_cbranch_vccz Lbk_307
    s_cbranch_scc0 Lfl_308
    s_branch L_fin
Lfs_309:
Lfl_311:
    ds_read_b128 v[16:19], v118 offset:4096
    ds_read_b128 v[20:23], v118 offset:6144
    s_sub_u32 s27, s27, 1
    s_waitcnt lgkmcnt(0)
    v_max_u32 v112, v16, v20
    v_cmp_eq_u32 vcc, -1, v112
    s_cbranch_vccz Lbk_310
    s_cbranch_scc0 Lfl_311
    s_branch L_fin
Lfs_312:
Lfl_314:
    ds_read_b128 v[24:27], v118 offset:5120
    ds_read_b128 v[28:31], v118 offset:7168
    s_sub_u32 s27, s27, 1
    s_waitcnt lgkmcnt(0)
    v_max_u32 v112, v24, v28
    v_cmp_eq_u32 vcc, -1, v112
    s_cbranch_vccz Lbk_313
    s_cbranch_scc0 Lfl_314
    s_branch L_fin
Lwv_265:
    s_mov_b32 m0, 1024
    ds_read_b128 v[32:35], v125 offset:0
    ds_read_b128 v[36:39], v125 offset:1024
    ds_read_b128 v[40:43], v125 offset:8192
    ds_read_b128 v[44:47], v125 offset:9216
    ds_read_b128 v[48:51], v125 offset:2048
    ds_read_b128 v[52:55], v125 offset:3072
    ds_read_b128 v[96:99], v125 offset:10240
    ds_read_b128 v[100:103], v125 offset:11264
    v_mov_b64 v[64:65], 0
    v_mov_b64 v[66:67], 0
    v_mov_b64 v[68:69], 0
    v_mov_b64 v[70:71], 0
Lhl1_318:
    s_add_u32 s40, s26, 1
    s_lshr_b32 s40, s40, 1
    s_min_u32 s40, s40, 31
    v_cmp_ge_u32 vcc, s40, v116
    v_xor_b32 v112, 8, v109
    ds_read_b64 v[90:91], v109 offset:23552
    ds_read_b64 v[88:89], v112 offset:22528
    ds_read_b64 v[94:95], v109 offset:24064
    ds_read_b64 v[92:93], v112 offset:23040
    ds_read_b128 v[56:59], v111 offset:20480
    ds_read_b128 v[60:63], v111 offset:21504
    s_cbranch_vccnz Lkf_320
Lkr_321:
    v_mov_b64 v[72:73], 0
    v_mov_b64 v[74:75], 0
    v_mov_b64 v[76:77], 0
    v_mov_b64 v[78:79], 0
    v_mov_b64 v[80:81], 0
    v_mov_b64 v[82:83], 0
    v_mov_b64 v[84:85], 0
    v_mov_b64 v[86:87], 0
    s_waitcnt lgkmcnt(2)
    v_swap_b32 v89, v90
    v_swap_b32 v93, v94
    s_waitcnt vmcnt(0)
    global_load_lds_dwordx4 v127, s[10:11] sc1
    global_load_lds_dwordx4 v127, s[10:11] offset:2048 sc1
    s_barrier
    ds_read_b128 v[0:3], v118 offset:0
    ds_read_b128 v[4:7], v118 offset:2048
    global_load_lds_dwordx4 v127, s[10:11] sc1
    global_load_lds_dwordx4 v127, s[10:11] offset:2048 sc1
    s_waitcnt lgkmcnt(1)
    v_smfmac_f32_16x16x64_bf16 v[64:67], v[0:3], v[128:135], v117
    ds_read_b128 v[24:27], v118 offset:0
    ds_read_b128 v[8:11], v118 offset:1024
    s_waitcnt lgkmcnt(2)
    v_smfmac_f32_16x16x64_bf16 v[64:67], v[4:7], v[144:151], v117
    ds_read_b128 v[28:31], v118 offset:2048
    ds_read_b128 v[12:15], v118 offset:3072
    v_cmp_u_f32 vcc, v0, v4
    v_smfmac_f32_16x16x64_bf16 v[68:71], v[0:3], v[136:143], v117
    v_smfmac_f32_16x16x64_bf16 v[68:71], v[4:7], v[152:159], v117
    s_cbranch_vccnz Lfa_322
    global_store_short v120, v108, s[12:13] sc1
    s_mov_b32 m0, 20480
    v_smfmac_f32_16x16x64_bf16 v[72:75], v[0:3], v[32:39], v117
    global_load_lds_dwordx4 v118, s[22:23] offset:0 sc1
    v_smfmac_f32_16x16x64_bf16 v[72:75], v[4:7], v[40:47], v117
    ds_read_b128 v[16:19], v118 offset:4096
    s_waitcnt lgkmcnt(1)
    v_cmp_u_f32 vcc, v8, v12
    v_smfmac_f32_16x16x64_bf16 v[76:79], v[0:3], v[48:55], v117
    global_store_short v120, v114, s[24:25] sc1
    ds_read_b128 v[20:23], v118 offset:6144
    v_smfmac_f32_16x16x64_bf16 v[76:79], v[4:7], v[96:103], v117
    s_cbranch_vccnz Lfs_327
Lbk_328:
Lqj_326:
    v_smfmac_f32_16x16x64_bf16 v[64:67], v[8:11], v[160:167], v117
    ds_read_b128 v[96:99], v125 offset:12288
    ds_read_b128 v[44:47], v125 offset:15360
    v_and_b32 v116, 12, v123
    v_smfmac_f32_16x16x64_bf16 v[64:67], v[12:15], v[176:183], v117
    global_load_lds_dwordx4 v118, s[22:23] offset:1024 sc1
    ds_read_b128 v[100:103], v125 offset:13312
    v_smfmac_f32_16x16x64_bf16 v[68:71], v[8:11], v[168:175], v117
    ds_read_b128 v[24:27], v118 offset:5120
    s_waitcnt lgkmcnt(4)
    v_cmp_u_f32 vcc, v16, v20
    v_smfmac_f32_16x16x64_bf16 v[68:71], v[12:15], v[184:191], v117
    ds_read_b128 v[28:31], v118 offset:7168
    ds_read_b128 v[40:43], v125 offset:14336
    v_smfmac_f32_16x16x64_bf16 v[72:75], v[8:11], a[0:7], v117
    s_cbranch_vccnz Lfs_340
Lbk_341:
    ds_read_b128 v[32:35], v125 offset:20480
    v_smfmac_f32_16x16x64_bf16 v[64:67], v[16:19], v[192:199], v117
    s_add_u32 s24, s24, 8192
    s_addc_u32 s25, s25, 0
    ds_read_b128 v[36:39], v125 offset:21504
    v_smfmac_f32_16x16x64_bf16 v[64:67], v[20:23], v[208:215], v117
    global_load_lds_dwordx4 v118, s[22:23] offset:2048 sc1
    ds_read_b128 v[48:51], v125 offset:22528
    v_smfmac_f32_16x16x64_bf16 v[68:71], v[16:19], v[200:207], v117
    s_add_u32 s26, s26, 1
    s_waitcnt lgkmcnt(4)
    v_cmp_u_f32 vcc, v24, v28
    v_smfmac_f32_16x16x64_bf16 v[68:71], v[20:23], v[216:223], v117
    global_load_dword v116, v116, s[36:37] offset:-4 sc1
    ds_read_b128 v[52:55], v125 offset:23552
    v_smfmac_f32_16x16x64_bf16 v[72:75], v[16:19], v[96:103], v117
    s_cbranch_vccnz Lfs_343
Lbk_344:
    v_smfmac_f32_16x16x64_bf16 v[64:67], v[24:27], v[224:231], v117
    s_mov_b64 vcc, s[64:65]
    v_smfmac_f32_16x16x64_bf16 v[64:67], v[28:31], v[240:247], v117
    global_load_lds_dwordx4 v118, s[22:23] offset:3072 sc1
    v_smfmac_f32_16x16x64_bf16 v[68:71], v[24:27], v[232:239], v117
    s_add_u32 s22, s22, 524288
    s_addc_u32 s23, s23, 0
    v_smfmac_f32_16x16x64_bf16 v[68:71], v[28:31], v[248:255], v117
    s_waitcnt lgkmcnt(2)
    v_add_f32 v64, v64, v66
    v_smfmac_f32_16x16x64_bf16 v[72:75], v[20:23], v[32:39], v117
    ds_read_b128 v[32:35], v125 offset:24576
    v_add_f32 v65, v65, v67
    v_smfmac_f32_16x16x64_bf16 v[72:75], v[12:15], a[16:23], v117
    ds_read_b128 v[36:39], v125 offset:25600
    v_cvt_pk_bf16_f32 v102, v64, v65
    v_add_f32 v68, v68, v70
    v_smfmac_f32_16x16x64_bf16 v[72:75], v[24:27], a[32:39], v117
    ds_write_b32 v121, v102 offset:9216
    v_add_f32 v69, v69, v71
    v_cvt_pk_bf16_f32 v103, v68, v69
    v_smfmac_f32_16x16x64_bf16 v[72:75], v[28:31], a[48:55], v117
    ds_write_b32 v121, v103 offset:9728
    v_smfmac_f32_16x16x64_bf16 v[76:79], v[16:19], v[40:47], v117
    ds_read_b128 v[40:43], v125 offset:26624
    s_waitcnt lgkmcnt(5)
    v_smfmac_f32_16x16x64_bf16 v[76:79], v[20:23], v[48:55], v117
    ds_read_b128 v[44:47], v125 offset:27648
    v_add_f32 v72, v72, v74
    v_smfmac_f32_16x16x64_bf16 v[76:79], v[8:11], a[8:15], v117
    ds_read_b128 v[48:51], v125 offset:4096
    v_smfmac_f32_16x16x64_bf16 v[76:79], v[12:15], a[24:31], v117
    s_waitcnt lgkmcnt(3)
    s_barrier
    v_smfmac_f32_16x16x64_bf16 v[76:79], v[24:27], a[40:47], v117
    ds_read_b64_tr_b16 v[64:65], v122 offset:8192
    ds_read_b64_tr_b16 v[66:67], v122 offset:8704
    v_smfmac_f32_16x16x64_bf16 v[76:79], v[28:31], a[56:63], v117
    ds_read_b64_tr_b16 v[68:69], v122 offset:9216
    ds_read_b64_tr_b16 v[70:71], v122 offset:9728
    v_add_f32 v73, v73, v75
    v_cvt_pk_bf16_f32 v100, v72, v73
    v_smfmac_f32_16x16x64_bf16 v[80:83], v[0:3], a[64:71], v117
    ds_write_b32 v121, v100 offset:11264
    v_smfmac_f32_16x16x64_bf16 v[84:87], v[0:3], a[72:79], v117
    s_waitcnt lgkmcnt(3)
    ds_read_b128 v[52:55], v125 offset:5120
    v_add_f32 v76, v76, v78
    v_mfma_f32_16x16x32_bf16 v[96:99], v[56:59], v[64:67], 0
    s_waitcnt lgkmcnt(2)
    v_add_f32 v77, v77, v79
    v_cvt_pk_bf16_f32 v101, v76, v77
    v_mfma_f32_16x16x32_bf16 v[96:99], v[60:63], v[68:71], v[96:99]
    ds_write_b32 v121, v101 offset:11776
    v_smfmac_f32_16x16x64_bf16 v[80:83], v[4:7], a[80:87], v117
    s_mov_b32 exec_hi, 0
    global_store_dword v110, v108, s[20:21] sc1
    s_mov_b32 exec_hi, -1
    v_smfmac_f32_16x16x64_bf16 v[84:87], v[4:7], a[88:95], v117
    v_add_f32_dpp v98, v96, v98 quad_perm:[0,1,0,1] row_mask:0xf bank_mask:0xf
    v_add_f32_dpp v99, v97, v99 quad_perm:[0,1,0,1] row_mask:0xf bank_mask:0xf
    v_smfmac_f32_16x16x64_bf16 v[80:83], v[8:11], a[96:103], v117
    ds_write_b64 v109, v[98:99] offset:12800
    v_smfmac_f32_16x16x64_bf16 v[84:87], v[8:11], a[104:111], v117
    s_waitcnt lgkmcnt(1)
    s_barrier
    v_smfmac_f32_16x16x64_bf16 v[80:83], v[12:15], a[112:119], v117
    s_waitcnt vmcnt(8)
    ds_read_b64_tr_b16 v[72:73], v122 offset:10240
    ds_read_b64_tr_b16 v[74:75], v122 offset:10752
    v_smfmac_f32_16x16x64_bf16 v[84:87], v[12:15], a[120:127], v117
    ds_read_b64_tr_b16 v[76:77], v122 offset:11264
    ds_read_b64_tr_b16 v[78:79], v122 offset:11776
    v_smfmac_f32_16x16x64_bf16 v[80:83], v[16:19], a[128:135], v117
    ds_read_b128 v[8:11], v125 offset:18432
    v_smfmac_f32_16x16x64_bf16 v[84:87], v[16:19], a[136:143], v117
    s_waitcnt lgkmcnt(5)
    s_barrier
    s_waitcnt lgkmcnt(3)
    v_mfma_f32_16x16x32_bf16 v[0:3], v[72:75], v[64:67], 0
    ds_read_b128 v[56:59], v124 offset:12288
    s_waitcnt lgkmcnt(2)
    v_mfma_f32_16x16x32_bf16 v[0:3], v[76:79], v[68:71], v[0:3]
    ds_read_b128 v[12:15], v125 offset:19456
    v_smfmac_f32_16x16x64_bf16 v[80:83], v[20:23], a[144:151], v117
    ds_write_b32 v118, v108 offset:1024
    v_smfmac_f32_16x16x64_bf16 v[84:87], v[20:23], a[152:159], v117
    ds_write_b32 v118, v108 offset:3072
    v_add_f32_dpp v2, v0, v2 quad_perm:[0,1,0,1] row_mask:0xf bank_mask:0xf
    v_smfmac_f32_16x16x64_bf16 v[80:83], v[24:27], a[160:167], v117
    s_waitcnt lgkmcnt(3)
    v_max3_f32 v60, v56, v57, v58
    v_add_f32_dpp v3, v1, v3 quad_perm:[0,1,0,1] row_mask:0xf bank_mask:0xf
    v_smfmac_f32_16x16x64_bf16 v[84:87], v[24:27], a[168:175], v117
    v_max_f32 v60, v60, v59
    v_smfmac_f32_16x16x64_bf16 v[80:83], v[28:31], v[32:39], v117
    s_nop 0
    v_max_f32_dpp v60, v60, v60 quad_perm:[2,3,0,1] row_mask:0xf bank_mask:0xf
    v_smfmac_f32_16x16x64_bf16 v[84:87], v[28:31], v[40:47], v117
    v_max3_f32 v61, v60, v2, v3
    v_max3_f32 v62, v60, v2, v3
    v_mov_b64 v[64:65], 0
    v_mov_b64 v[66:67], 0
    v_permlane16_swap_b32 v61, v62
    v_max_f32 v60, v61, v62
    v_max_f32 v63, v61, v62
    v_pk_add_f32 v[80:81], v[80:81], v[82:83]
    v_pk_add_f32 v[84:85], v[84:85], v[86:87]
    v_permlane32_swap_b32 v60, v63
    v_max_f32 v61, v60, v63
    v_cvt_pk_bf16_f32 v114, v80, v81
    v_cvt_pk_bf16_f32 v115, v84, v85
    v_mul_f32_dpp v62, v61, v126 quad_perm:[2,3,2,3] row_mask:0xf bank_mask:0xf
    v_pk_fma_f32 v[2:3], v[2:3], s[28:29], v[62:63] op_sel_hi:[1,1,0]
    v_pk_fma_f32 v[56:57], v[56:57], s[28:29], v[62:63] op_sel_hi:[1,1,0]
    v_exp_f32 v2, v2
    v_exp_f32 v3, v3
    v_pk_fma_f32 v[58:59], v[58:59], s[28:29], v[62:63] op_sel_hi:[1,1,0]
    v_cvt_pk_bf16_f32 v80, v2, v3
    v_exp_f32 v56, v56
    v_cndmask_b32 v5, v113, v80, vcc
    v_cndmask_b32_dpp v4, v80, v113, vcc quad_perm:[2,3,2,3] row_mask:0xf bank_mask:0xf
    v_exp_f32 v57, v57
    v_exp_f32 v58, v58
    v_mfma_f32_16x16x16_bf16 v[76:79], v[4:5], v[104:105], 0
    v_cvt_pk_bf16_f32 v84, v56, v57
    v_exp_f32 v59, v59
    v_mfma_f32_16x16x16_bf16 v[72:75], v[4:5], v[114:115], 0
    v_cvt_pk_bf16_f32 v85, v58, v59
    v_mov_b32_dpp v86, v84 quad_perm:[2,3,0,1] row_mask:0xf bank_mask:0xf
    v_mov_b64 v[68:69], 0
    v_mov_b32_dpp v87, v85 quad_perm:[2,3,0,1] row_mask:0xf bank_mask:0xf
    v_mov_b64 v[70:71], 0
    v_mov_b64 v[80:81], 0
    v_mfma_f32_16x16x32_bf16 v[76:79], v[84:87], v[104:107], v[76:79]
    ds_read_b128 v[32:35], v125 offset:6144
    v_smfmac_f32_16x16x64_bf16 v[72:75], v[84:87], v[88:95], v117
    ds_read_b128 v[36:39], v125 offset:7168
    s_nop 2
    v_rcp_f32_dpp v60, v76 quad_perm:[2,3,2,3] row_mask:0xf bank_mask:0xf
    v_rcp_f32_dpp v61, v77 quad_perm:[2,3,2,3] row_mask:0xf bank_mask:0xf
    s_nop 1
    v_pk_mul_f32 v[72:73], v[72:73], v[60:61]
    v_pk_mul_f32 v[74:75], v[74:75], v[60:61]
    v_cvt_pk_bf16_f32 v56, v72, v73
    v_cvt_pk_bf16_f32 v57, v74, v75
    ds_write_b64 v121, v[56:57] offset:14848
    v_mov_b64 v[82:83], 0
    v_mov_b64 v[84:85], 0
    v_mov_b64 v[86:87], 0
    v_mov_b64 v[72:73], 0
    v_mov_b64 v[74:75], 0
    v_mov_b64 v[76:77], 0
    v_mov_b64 v[78:79], 0
    v_mov_b64 v[88:89], 0
    v_mov_b64 v[90:91], 0
    v_mov_b64 v[92:93], 0
    v_mov_b64 v[94:95], 0
    s_waitcnt vmcnt(7)
    s_waitcnt lgkmcnt(0)
    s_barrier
    ds_read_b64_tr_b16 v[96:97], v122 offset:14336
    ds_read_b64_tr_b16 v[98:99], v122 offset:14848
    ds_read_b64_tr_b16 v[100:101], v122 offset:15360
    ds_read_b64_tr_b16 v[102:103], v122 offset:15872
    ds_read_b128 v[40:43], v125 offset:16384
    ds_read_b128 v[44:47], v125 offset:17408
    s_waitcnt lgkmcnt(4)
    v_smfmac_f32_16x16x64_bf16 v[72:75], v[96:99], a[176:183], v117
    ds_read_b128 v[24:27], v125 offset:28672
    s_waitcnt lgkmcnt(3)
    v_smfmac_f32_16x16x64_bf16 v[72:75], v[100:103], a[192:199], v117
    ds_read_b128 v[28:31], v125 offset:29696
    v_smfmac_f32_16x16x64_bf16 v[76:79], v[96:99], a[184:191], v117
    ds_read_b128 v[56:59], v125 offset:30720
    v_smfmac_f32_16x16x64_bf16 v[76:79], v[100:103], a[200:207], v117
    ds_read_b128 v[60:63], v125 offset:31744
    v_add_f32 v72, v72, v74
    v_add_f32 v73, v73, v75
    v_cvt_pk_bf16_f32 v72, v72, v73
    v_smfmac_f32_16x16x64_bf16 v[80:83], v[96:99], a[208:215], v117
    global_store_dword v119, v72, s[14:15] offset:-4096 sc1
    s_nop 1
    v_add_f32 v76, v76, v78
    v_add_f32 v77, v77, v79
    v_cvt_pk_bf16_f32 v76, v76, v77
    v_smfmac_f32_16x16x64_bf16 v[80:83], v[100:103], a[224:231], v117
    global_store_dword v119, v76, s[30:31] offset:-4096 sc1
    v_smfmac_f32_16x16x64_bf16 v[84:87], v[96:99], a[216:223], v117
    v_smfmac_f32_16x16x64_bf16 v[84:87], v[100:103], a[232:239], v117
    v_add_f32 v80, v80, v82
    v_smfmac_f32_16x16x64_bf16 v[64:67], v[96:99], a[240:247], v117
    v_add_f32 v81, v81, v83
    v_cvt_pk_bf16_f32 v80, v80, v81
    v_smfmac_f32_16x16x64_bf16 v[64:67], v[100:103], v[48:55], v117
    global_store_dword v119, v80, s[14:15] offset:-2048 sc1
    v_add_f32 v84, v84, v86
    v_smfmac_f32_16x16x64_bf16 v[68:71], v[96:99], a[248:255], v117
    v_add_f32 v85, v85, v87
    v_cvt_pk_bf16_f32 v84, v84, v85
    v_smfmac_f32_16x16x64_bf16 v[68:71], v[100:103], v[32:39], v117
    s_waitcnt lgkmcnt(4)
    global_store_dword v119, v84, s[30:31] offset:-2048 sc1
    v_add_f32 v64, v64, v66
    v_smfmac_f32_16x16x64_bf16 v[88:91], v[96:99], v[40:47], v117
    s_waitcnt lgkmcnt(2)
    v_add_f32 v65, v65, v67
    v_cvt_pk_bf16_f32 v64, v64, v65
    v_smfmac_f32_16x16x64_bf16 v[88:91], v[100:103], v[24:31], v117
    global_store_dword v119, v64, s[14:15] offset:0 sc1
    v_add_f32 v68, v68, v70
    v_smfmac_f32_16x16x64_bf16 v[92:95], v[96:99], v[8:15], v117
    s_waitcnt lgkmcnt(0)
    v_add_f32 v69, v69, v71
    v_cvt_pk_bf16_f32 v68, v68, v69
    v_smfmac_f32_16x16x64_bf16 v[92:95], v[100:103], v[56:63], v117
    global_store_dword v119, v68, s[30:31] offset:0 sc1
    v_add_f32 v88, v88, v90
    v_add_f32 v89, v89, v91
    v_cvt_pk_bf16_f32 v88, v88, v89
    global_store_dword v119, v88, s[14:15] offset:2048 sc1
    s_mov_b32 m0, 1024
    ds_read_b128 v[32:35], v125 offset:0
    ds_read_b128 v[36:39], v125 offset:1024
    v_add_f32 v92, v92, v94
    v_add_f32 v93, v93, v95
    v_cvt_pk_bf16_f32 v92, v92, v93
    global_store_dword v119, v92, s[30:31] offset:2048 sc1
    ds_read_b128 v[40:43], v125 offset:8192
    ds_read_b128 v[44:47], v125 offset:9216
    ds_read_b128 v[48:51], v125 offset:2048
    ds_read_b128 v[52:55], v125 offset:3072
    ds_read_b128 v[96:99], v125 offset:10240
    ds_read_b128 v[100:103], v125 offset:11264
    global_load_dword v0, v123, s[18:19] offset:0 sc1
    global_load_dword v1, v123, s[18:19] offset:256 sc1
    global_load_dword v2, v123, s[18:19] offset:512 sc1
    global_load_dword v3, v123, s[18:19] offset:768 sc1
    global_load_dword v4, v123, s[18:19] offset:1024 sc1
    global_load_dword v5, v123, s[18:19] offset:1280 sc1
    global_load_dword v6, v123, s[18:19] offset:1536 sc1
    global_load_dword v7, v123, s[18:19] offset:1792 sc1
    v_mov_b64 v[64:65], 0
    v_mov_b64 v[66:67], 0
    v_mov_b64 v[68:69], 0
    v_mov_b64 v[70:71], 0
    s_waitcnt vmcnt(4)
    v_mfma_f32_16x16x32_bf16 v[24:27], v[104:107], v[0:3], 0
    v_max3_u32 v28, v0, v1, v2
    s_waitcnt vmcnt(0)
    v_mfma_f32_16x16x32_bf16 v[24:27], v[104:107], v[4:7], v[24:27]
    v_max3_u32 v29, v4, v5, v6
    v_max3_u32 v28, v28, v3, v7
    v_cmp_u_f32 vcc, v28, v29
    s_nop 4
    v_cvt_pk_bf16_f32 v114, v24, v24
    s_cbranch_vccnz Lpf_346
Lpj_347:
    global_store_short v120, v114, s[12:13] sc1
    s_cmp_eq_u32 s26, 63
    s_cbranch_scc1 Llast_319
    s_add_u32 s40, s26, 1
    s_lshr_b32 s40, s40, 1
    s_min_u32 s40, s40, 31
    v_cmp_ge_u32 vcc, s40, v116
    v_xor_b32 v112, 8, v109
    ds_read_b64 v[90:91], v109 offset:23552
    ds_read_b64 v[88:89], v112 offset:22528
    ds_read_b64 v[94:95], v109 offset:24064
    ds_read_b64 v[92:93], v112 offset:23040
    ds_read_b128 v[56:59], v111 offset:20480
    ds_read_b128 v[60:63], v111 offset:21504
    s_cbranch_vccnz Lkf_349
Lkr_350:
    v_mov_b64 v[72:73], 0
    v_mov_b64 v[74:75], 0
    v_mov_b64 v[76:77], 0
    v_mov_b64 v[78:79], 0
    v_mov_b64 v[80:81], 0
    v_mov_b64 v[82:83], 0
    v_mov_b64 v[84:85], 0
    v_mov_b64 v[86:87], 0
    s_waitcnt lgkmcnt(2)
    v_swap_b32 v89, v90
    v_swap_b32 v93, v94
    s_waitcnt vmcnt(0)
    global_load_lds_dwordx4 v127, s[12:13] sc1
    global_load_lds_dwordx4 v127, s[12:13] offset:2048 sc1
    s_barrier
    ds_read_b128 v[0:3], v118 offset:0
    ds_read_b128 v[4:7], v118 offset:2048
    global_load_lds_dwordx4 v127, s[12:13] sc1
    global_load_lds_dwordx4 v127, s[12:13] offset:2048 sc1
    s_waitcnt lgkmcnt(1)
    v_smfmac_f32_16x16x64_bf16 v[64:67], v[0:3], v[128:135], v117
    ds_read_b128 v[24:27], v118 offset:0
    ds_read_b128 v[8:11], v118 offset:1024
    s_waitcnt lgkmcnt(2)
    v_smfmac_f32_16x16x64_bf16 v[64:67], v[4:7], v[144:151], v117
    ds_read_b128 v[28:31], v118 offset:2048
    ds_read_b128 v[12:15], v118 offset:3072
    v_cmp_u_f32 vcc, v0, v4
    v_smfmac_f32_16x16x64_bf16 v[68:71], v[0:3], v[136:143], v117
    v_smfmac_f32_16x16x64_bf16 v[68:71], v[4:7], v[152:159], v117
    s_cbranch_vccnz Lfa_351
    global_store_short v120, v108, s[10:11] sc1
    s_mov_b32 m0, 20480
    v_smfmac_f32_16x16x64_bf16 v[72:75], v[0:3], v[32:39], v117
    global_load_lds_dwordx4 v118, s[22:23] offset:0 sc1
    v_smfmac_f32_16x16x64_bf16 v[72:75], v[4:7], v[40:47], v117
    ds_read_b128 v[16:19], v118 offset:4096
    s_waitcnt lgkmcnt(1)
    v_cmp_u_f32 vcc, v8, v12
    v_smfmac_f32_16x16x64_bf16 v[76:79], v[0:3], v[48:55], v117
    global_store_short v120, v114, s[24:25] sc1
    ds_read_b128 v[20:23], v118 offset:6144
    v_smfmac_f32_16x16x64_bf16 v[76:79], v[4:7], v[96:103], v117
    s_cbranch_vccnz Lfs_356
Lbk_357:
Lqj_355:
    v_smfmac_f32_16x16x64_bf16 v[64:67], v[8:11], v[160:167], v117
    ds_read_b128 v[96:99], v125 offset:12288
    ds_read_b128 v[44:47], v125 offset:15360
    v_and_b32 v116, 12, v123
    v_smfmac_f32_16x16x64_bf16 v[64:67], v[12:15], v[176:183], v117
    global_load_lds_dwordx4 v118, s[22:23] offset:1024 sc1
    ds_read_b128 v[100:103], v125 offset:13312
    v_smfmac_f32_16x16x64_bf16 v[68:71], v[8:11], v[168:175], v117
    ds_read_b128 v[24:27], v118 offset:5120
    s_waitcnt lgkmcnt(4)
    v_cmp_u_f32 vcc, v16, v20
    v_smfmac_f32_16x16x64_bf16 v[68:71], v[12:15], v[184:191], v117
    ds_read_b128 v[28:31], v118 offset:7168
    ds_read_b128 v[40:43], v125 offset:14336
    v_smfmac_f32_16x16x64_bf16 v[72:75], v[8:11], a[0:7], v117
    s_cbranch_vccnz Lfs_369
Lbk_370:
    ds_read_b128 v[32:35], v125 offset:20480
    v_smfmac_f32_16x16x64_bf16 v[64:67], v[16:19], v[192:199], v117
    s_add_u32 s24, s24, 8192
    s_addc_u32 s25, s25, 0
    ds_read_b128 v[36:39], v125 offset:21504
    v_smfmac_f32_16x16x64_bf16 v[64:67], v[20:23], v[208:215], v117
    global_load_lds_dwordx4 v118, s[22:23] offset:2048 sc1
    ds_read_b128 v[48:51], v125 offset:22528
    v_smfmac_f32_16x16x64_bf16 v[68:71], v[16:19], v[200:207], v117
    s_add_u32 s26, s26, 1
    s_waitcnt lgkmcnt(4)
    v_cmp_u_f32 vcc, v24, v28
    v_smfmac_f32_16x16x64_bf16 v[68:71], v[20:23], v[216:223], v117
    global_load_dword v116, v116, s[36:37] offset:12 sc1
    ds_read_b128 v[52:55], v125 offset:23552
    v_smfmac_f32_16x16x64_bf16 v[72:75], v[16:19], v[96:103], v117
    s_cbranch_vccnz Lfs_372
Lbk_373:
    v_smfmac_f32_16x16x64_bf16 v[64:67], v[24:27], v[224:231], v117
    s_mov_b64 vcc, s[64:65]
    v_smfmac_f32_16x16x64_bf16 v[64:67], v[28:31], v[240:247], v117
    global_load_lds_dwordx4 v118, s[22:23] offset:3072 sc1
    v_smfmac_f32_16x16x64_bf16 v[68:71], v[24:27], v[232:239], v117
    s_add_u32 s22, s22, 524288
    s_addc_u32 s23, s23, 0
    v_smfmac_f32_16x16x64_bf16 v[68:71], v[28:31], v[248:255], v117
    s_waitcnt lgkmcnt(2)
    v_add_f32 v64, v64, v66
    v_smfmac_f32_16x16x64_bf16 v[72:75], v[20:23], v[32:39], v117
    ds_read_b128 v[32:35], v125 offset:24576
    v_add_f32 v65, v65, v67
    v_smfmac_f32_16x16x64_bf16 v[72:75], v[12:15], a[16:23], v117
    ds_read_b128 v[36:39], v125 offset:25600
    v_cvt_pk_bf16_f32 v102, v64, v65
    v_add_f32 v68, v68, v70
    v_smfmac_f32_16x16x64_bf16 v[72:75], v[24:27], a[32:39], v117
    ds_write_b32 v121, v102 offset:9216
    v_add_f32 v69, v69, v71
    v_cvt_pk_bf16_f32 v103, v68, v69
    v_smfmac_f32_16x16x64_bf16 v[72:75], v[28:31], a[48:55], v117
    ds_write_b32 v121, v103 offset:9728
    v_smfmac_f32_16x16x64_bf16 v[76:79], v[16:19], v[40:47], v117
    ds_read_b128 v[40:43], v125 offset:26624
    s_waitcnt lgkmcnt(5)
    v_smfmac_f32_16x16x64_bf16 v[76:79], v[20:23], v[48:55], v117
    ds_read_b128 v[44:47], v125 offset:27648
    v_add_f32 v72, v72, v74
    v_smfmac_f32_16x16x64_bf16 v[76:79], v[8:11], a[8:15], v117
    ds_read_b128 v[48:51], v125 offset:4096
    v_smfmac_f32_16x16x64_bf16 v[76:79], v[12:15], a[24:31], v117
    s_waitcnt lgkmcnt(3)
    s_barrier
    v_smfmac_f32_16x16x64_bf16 v[76:79], v[24:27], a[40:47], v117
    ds_read_b64_tr_b16 v[64:65], v122 offset:8192
    ds_read_b64_tr_b16 v[66:67], v122 offset:8704
    v_smfmac_f32_16x16x64_bf16 v[76:79], v[28:31], a[56:63], v117
    ds_read_b64_tr_b16 v[68:69], v122 offset:9216
    ds_read_b64_tr_b16 v[70:71], v122 offset:9728
    v_add_f32 v73, v73, v75
    v_cvt_pk_bf16_f32 v100, v72, v73
    v_smfmac_f32_16x16x64_bf16 v[80:83], v[0:3], a[64:71], v117
    ds_write_b32 v121, v100 offset:11264
    v_smfmac_f32_16x16x64_bf16 v[84:87], v[0:3], a[72:79], v117
    s_waitcnt lgkmcnt(3)
    ds_read_b128 v[52:55], v125 offset:5120
    v_add_f32 v76, v76, v78
    v_mfma_f32_16x16x32_bf16 v[96:99], v[56:59], v[64:67], 0
    s_waitcnt lgkmcnt(2)
    v_add_f32 v77, v77, v79
    v_cvt_pk_bf16_f32 v101, v76, v77
    v_mfma_f32_16x16x32_bf16 v[96:99], v[60:63], v[68:71], v[96:99]
    ds_write_b32 v121, v101 offset:11776
    v_smfmac_f32_16x16x64_bf16 v[80:83], v[4:7], a[80:87], v117
    s_mov_b32 exec_hi, 0
    global_store_dword v110, v108, s[18:19] sc1
    s_mov_b32 exec_hi, -1
    v_smfmac_f32_16x16x64_bf16 v[84:87], v[4:7], a[88:95], v117
    v_add_f32_dpp v98, v96, v98 quad_perm:[0,1,0,1] row_mask:0xf bank_mask:0xf
    v_add_f32_dpp v99, v97, v99 quad_perm:[0,1,0,1] row_mask:0xf bank_mask:0xf
    v_smfmac_f32_16x16x64_bf16 v[80:83], v[8:11], a[96:103], v117
    ds_write_b64 v109, v[98:99] offset:12800
    v_smfmac_f32_16x16x64_bf16 v[84:87], v[8:11], a[104:111], v117
    s_waitcnt lgkmcnt(1)
    s_barrier
    v_smfmac_f32_16x16x64_bf16 v[80:83], v[12:15], a[112:119], v117
    s_waitcnt vmcnt(8)
    ds_read_b64_tr_b16 v[72:73], v122 offset:10240
    ds_read_b64_tr_b16 v[74:75], v122 offset:10752
    v_smfmac_f32_16x16x64_bf16 v[84:87], v[12:15], a[120:127], v117
    ds_read_b64_tr_b16 v[76:77], v122 offset:11264
    ds_read_b64_tr_b16 v[78:79], v122 offset:11776
    v_smfmac_f32_16x16x64_bf16 v[80:83], v[16:19], a[128:135], v117
    ds_read_b128 v[8:11], v125 offset:18432
    v_smfmac_f32_16x16x64_bf16 v[84:87], v[16:19], a[136:143], v117
    s_waitcnt lgkmcnt(5)
    s_barrier
    s_waitcnt lgkmcnt(3)
    v_mfma_f32_16x16x32_bf16 v[0:3], v[72:75], v[64:67], 0
    ds_read_b128 v[56:59], v124 offset:12288
    s_waitcnt lgkmcnt(2)
    v_mfma_f32_16x16x32_bf16 v[0:3], v[76:79], v[68:71], v[0:3]
    ds_read_b128 v[12:15], v125 offset:19456
    v_smfmac_f32_16x16x64_bf16 v[80:83], v[20:23], a[144:151], v117
    ds_write_b32 v118, v108 offset:1024
    v_smfmac_f32_16x16x64_bf16 v[84:87], v[20:23], a[152:159], v117
    ds_write_b32 v118, v108 offset:3072
    v_add_f32_dpp v2, v0, v2 quad_perm:[0,1,0,1] row_mask:0xf bank_mask:0xf
    v_smfmac_f32_16x16x64_bf16 v[80:83], v[24:27], a[160:167], v117
    s_waitcnt lgkmcnt(3)
    v_max3_f32 v60, v56, v57, v58
    v_add_f32_dpp v3, v1, v3 quad_perm:[0,1,0,1] row_mask:0xf bank_mask:0xf
    v_smfmac_f32_16x16x64_bf16 v[84:87], v[24:27], a[168:175], v117
    v_max_f32 v60, v60, v59
    v_smfmac_f32_16x16x64_bf16 v[80:83], v[28:31], v[32:39], v117
    s_nop 0
    v_max_f32_dpp v60, v60, v60 quad_perm:[2,3,0,1] row_mask:0xf bank_mask:0xf
    v_smfmac_f32_16x16x64_bf16 v[84:87], v[28:31], v[40:47], v117
    v_max3_f32 v61, v60, v2, v3
    v_max3_f32 v62, v60, v2, v3
    v_mov_b64 v[64:65], 0
    v_mov_b64 v[66:67], 0
    v_permlane16_swap_b32 v61, v62
    v_max_f32 v60, v61, v62
    v_max_f32 v63, v61, v62
    v_pk_add_f32 v[80:81], v[80:81], v[82:83]
    v_pk_add_f32 v[84:85], v[84:85], v[86:87]
    v_permlane32_swap_b32 v60, v63
    v_max_f32 v61, v60, v63
    v_cvt_pk_bf16_f32 v114, v80, v81
    v_cvt_pk_bf16_f32 v115, v84, v85
    v_mul_f32_dpp v62, v61, v126 quad_perm:[2,3,2,3] row_mask:0xf bank_mask:0xf
    v_pk_fma_f32 v[2:3], v[2:3], s[28:29], v[62:63] op_sel_hi:[1,1,0]
    v_pk_fma_f32 v[56:57], v[56:57], s[28:29], v[62:63] op_sel_hi:[1,1,0]
    v_exp_f32 v2, v2
    v_exp_f32 v3, v3
    v_pk_fma_f32 v[58:59], v[58:59], s[28:29], v[62:63] op_sel_hi:[1,1,0]
    v_cvt_pk_bf16_f32 v80, v2, v3
    v_exp_f32 v56, v56
    v_cndmask_b32 v5, v113, v80, vcc
    v_cndmask_b32_dpp v4, v80, v113, vcc quad_perm:[2,3,2,3] row_mask:0xf bank_mask:0xf
    v_exp_f32 v57, v57
    v_exp_f32 v58, v58
    v_mfma_f32_16x16x16_bf16 v[76:79], v[4:5], v[104:105], 0
    v_cvt_pk_bf16_f32 v84, v56, v57
    v_exp_f32 v59, v59
    v_mfma_f32_16x16x16_bf16 v[72:75], v[4:5], v[114:115], 0
    v_cvt_pk_bf16_f32 v85, v58, v59
    v_mov_b32_dpp v86, v84 quad_perm:[2,3,0,1] row_mask:0xf bank_mask:0xf
    v_mov_b64 v[68:69], 0
    v_mov_b32_dpp v87, v85 quad_perm:[2,3,0,1] row_mask:0xf bank_mask:0xf
    v_mov_b64 v[70:71], 0
    v_mov_b64 v[80:81], 0
    v_mfma_f32_16x16x32_bf16 v[76:79], v[84:87], v[104:107], v[76:79]
    ds_read_b128 v[32:35], v125 offset:6144
    v_smfmac_f32_16x16x64_bf16 v[72:75], v[84:87], v[88:95], v117
    ds_read_b128 v[36:39], v125 offset:7168
    s_nop 2
    v_rcp_f32_dpp v60, v76 quad_perm:[2,3,2,3] row_mask:0xf bank_mask:0xf
    v_rcp_f32_dpp v61, v77 quad_perm:[2,3,2,3] row_mask:0xf bank_mask:0xf
    s_nop 1
    v_pk_mul_f32 v[72:73], v[72:73], v[60:61]
    v_pk_mul_f32 v[74:75], v[74:75], v[60:61]
    v_cvt_pk_bf16_f32 v56, v72, v73
    v_cvt_pk_bf16_f32 v57, v74, v75
    ds_write_b64 v121, v[56:57] offset:14848
    v_mov_b64 v[82:83], 0
    v_mov_b64 v[84:85], 0
    v_mov_b64 v[86:87], 0
    v_mov_b64 v[72:73], 0
    v_mov_b64 v[74:75], 0
    v_mov_b64 v[76:77], 0
    v_mov_b64 v[78:79], 0
    v_mov_b64 v[88:89], 0
    v_mov_b64 v[90:91], 0
    v_mov_b64 v[92:93], 0
    v_mov_b64 v[94:95], 0
    s_waitcnt vmcnt(7)
    s_waitcnt lgkmcnt(0)
    s_barrier
    ds_read_b64_tr_b16 v[96:97], v122 offset:14336
    ds_read_b64_tr_b16 v[98:99], v122 offset:14848
    ds_read_b64_tr_b16 v[100:101], v122 offset:15360
    ds_read_b64_tr_b16 v[102:103], v122 offset:15872
    ds_read_b128 v[40:43], v125 offset:16384
    ds_read_b128 v[44:47], v125 offset:17408
    s_waitcnt lgkmcnt(4)
    v_smfmac_f32_16x16x64_bf16 v[72:75], v[96:99], a[176:183], v117
    ds_read_b128 v[24:27], v125 offset:28672
    s_waitcnt lgkmcnt(3)
    v_smfmac_f32_16x16x64_bf16 v[72:75], v[100:103], a[192:199], v117
    ds_read_b128 v[28:31], v125 offset:29696
    v_smfmac_f32_16x16x64_bf16 v[76:79], v[96:99], a[184:191], v117
    ds_read_b128 v[56:59], v125 offset:30720
    v_smfmac_f32_16x16x64_bf16 v[76:79], v[100:103], a[200:207], v117
    ds_read_b128 v[60:63], v125 offset:31744
    v_add_f32 v72, v72, v74
    v_add_f32 v73, v73, v75
    v_cvt_pk_bf16_f32 v72, v72, v73
    v_smfmac_f32_16x16x64_bf16 v[80:83], v[96:99], a[208:215], v117
    global_store_dword v119, v72, s[16:17] offset:-4096 sc1
    s_nop 1
    v_add_f32 v76, v76, v78
    v_add_f32 v77, v77, v79
    v_cvt_pk_bf16_f32 v76, v76, v77
    v_smfmac_f32_16x16x64_bf16 v[80:83], v[100:103], a[224:231], v117
    global_store_dword v119, v76, s[32:33] offset:-4096 sc1
    v_smfmac_f32_16x16x64_bf16 v[84:87], v[96:99], a[216:223], v117
    v_smfmac_f32_16x16x64_bf16 v[84:87], v[100:103], a[232:239], v117
    v_add_f32 v80, v80, v82
    v_smfmac_f32_16x16x64_bf16 v[64:67], v[96:99], a[240:247], v117
    v_add_f32 v81, v81, v83
    v_cvt_pk_bf16_f32 v80, v80, v81
    v_smfmac_f32_16x16x64_bf16 v[64:67], v[100:103], v[48:55], v117
    global_store_dword v119, v80, s[16:17] offset:-2048 sc1
    v_add_f32 v84, v84, v86
    v_smfmac_f32_16x16x64_bf16 v[68:71], v[96:99], a[248:255], v117
    v_add_f32 v85, v85, v87
    v_cvt_pk_bf16_f32 v84, v84, v85
    v_smfmac_f32_16x16x64_bf16 v[68:71], v[100:103], v[32:39], v117
    s_waitcnt lgkmcnt(4)
    global_store_dword v119, v84, s[32:33] offset:-2048 sc1
    v_add_f32 v64, v64, v66
    v_smfmac_f32_16x16x64_bf16 v[88:91], v[96:99], v[40:47], v117
    s_waitcnt lgkmcnt(2)
    v_add_f32 v65, v65, v67
    v_cvt_pk_bf16_f32 v64, v64, v65
    v_smfmac_f32_16x16x64_bf16 v[88:91], v[100:103], v[24:31], v117
    global_store_dword v119, v64, s[16:17] offset:0 sc1
    v_add_f32 v68, v68, v70
    v_smfmac_f32_16x16x64_bf16 v[92:95], v[96:99], v[8:15], v117
    s_waitcnt lgkmcnt(0)
    v_add_f32 v69, v69, v71
    v_cvt_pk_bf16_f32 v68, v68, v69
    v_smfmac_f32_16x16x64_bf16 v[92:95], v[100:103], v[56:63], v117
    global_store_dword v119, v68, s[32:33] offset:0 sc1
    v_add_f32 v88, v88, v90
    v_add_f32 v89, v89, v91
    v_cvt_pk_bf16_f32 v88, v88, v89
    global_store_dword v119, v88, s[16:17] offset:2048 sc1
    s_mov_b32 m0, 1024
    ds_read_b128 v[32:35], v125 offset:0
    ds_read_b128 v[36:39], v125 offset:1024
    v_add_f32 v92, v92, v94
    v_add_f32 v93, v93, v95
    v_cvt_pk_bf16_f32 v92, v92, v93
    global_store_dword v119, v92, s[32:33] offset:2048 sc1
    ds_read_b128 v[40:43], v125 offset:8192
    ds_read_b128 v[44:47], v125 offset:9216
    ds_read_b128 v[48:51], v125 offset:2048
    ds_read_b128 v[52:55], v125 offset:3072
    ds_read_b128 v[96:99], v125 offset:10240
    ds_read_b128 v[100:103], v125 offset:11264
    global_load_dword v0, v123, s[20:21] offset:0 sc1
    global_load_dword v1, v123, s[20:21] offset:256 sc1
    global_load_dword v2, v123, s[20:21] offset:512 sc1
    global_load_dword v3, v123, s[20:21] offset:768 sc1
    global_load_dword v4, v123, s[20:21] offset:1024 sc1
    global_load_dword v5, v123, s[20:21] offset:1280 sc1
    global_load_dword v6, v123, s[20:21] offset:1536 sc1
    global_load_dword v7, v123, s[20:21] offset:1792 sc1
    v_mov_b64 v[64:65], 0
    v_mov_b64 v[66:67], 0
    v_mov_b64 v[68:69], 0
    v_mov_b64 v[70:71], 0
    s_waitcnt vmcnt(4)
    v_mfma_f32_16x16x32_bf16 v[24:27], v[104:107], v[0:3], 0
    v_max3_u32 v28, v0, v1, v2
    s_waitcnt vmcnt(0)
    v_mfma_f32_16x16x32_bf16 v[24:27], v[104:107], v[4:7], v[24:27]
    v_max3_u32 v29, v4, v5, v6
    v_max3_u32 v28, v28, v3, v7
    v_cmp_u_f32 vcc, v28, v29
    s_nop 4
    v_cvt_pk_bf16_f32 v114, v24, v24
    s_cbranch_vccnz Lpf_375
Lpj_376:
    global_store_short v120, v114, s[10:11] sc1
    s_branch Lhl1_318
Llast_319:
    global_store_short v120, v114, s[24:25] sc1
    s_branch L_fin
Lfa_322:
    s_waitcnt lgkmcnt(1)
    ds_read_b128 v[0:3], v118 offset:0
    ds_read_b128 v[4:7], v118 offset:2048
    global_load_lds_dwordx4 v127, s[10:11] sc1
    global_load_lds_dwordx4 v127, s[10:11] offset:2048 sc1
Lqb_324:
    ds_read_b128 v[8:11], v118 offset:1024
    ds_read_b128 v[12:15], v118 offset:3072
    v_smfmac_f32_16x16x64_bf16 v[72:75], v[24:27], v[32:39], v117
    v_max_u32 v112, v24, v28
    v_cmp_eq_u32 vcc, -1, v112
    v_smfmac_f32_16x16x64_bf16 v[72:75], v[28:31], v[40:47], v117
    v_smfmac_f32_16x16x64_bf16 v[76:79], v[24:27], v[48:55], v117
    s_cbranch_vccnz Lfb_323
    v_mov_b64 v[64:65], 0
    v_mov_b64 v[66:67], 0
    v_smfmac_f32_16x16x64_bf16 v[76:79], v[28:31], v[96:103], v117
    global_store_short v120, v108, s[12:13] sc1
    s_mov_b32 m0, 20480
    v_mov_b64 v[68:69], 0
    v_mov_b64 v[70:71], 0
    v_smfmac_f32_16x16x64_bf16 v[64:67], v[24:27], v[128:135], v117
    global_load_lds_dwordx4 v118, s[22:23] offset:0 sc1
    v_smfmac_f32_16x16x64_bf16 v[64:67], v[28:31], v[144:151], v117
    ds_read_b128 v[16:19], v118 offset:4096
    s_waitcnt lgkmcnt(1)
    v_cmp_u_f32 vcc, v8, v12
    v_smfmac_f32_16x16x64_bf16 v[68:71], v[24:27], v[136:143], v117
    global_store_short v120, v114, s[24:25] sc1
    ds_read_b128 v[20:23], v118 offset:6144
    v_smfmac_f32_16x16x64_bf16 v[68:71], v[28:31], v[152:159], v117
    s_cbranch_vccnz Lfs_331
Lbk_332:
    s_branch Lqj_326
Lfb_323:
    v_mov_b64 v[64:65], 0
    v_mov_b64 v[66:67], 0
    v_mov_b64 v[68:69], 0
    v_mov_b64 v[70:71], 0
    v_mov_b64 v[72:73], 0
    v_mov_b64 v[74:75], 0
    s_nop 0
    v_mov_b64 v[76:77], 0
    v_mov_b64 v[78:79], 0
Lr0_335:
    ds_read_b128 v[24:27], v118 offset:0
    ds_read_b128 v[28:31], v118 offset:2048
    global_load_lds_dwordx4 v127, s[10:11] sc1
    global_load_lds_dwordx4 v127, s[10:11] offset:2048 sc1
    s_waitcnt lgkmcnt(2)
    v_max_u32 v112, v0, v4
    v_cmp_eq_u32 vcc, -1, v112
    s_cbranch_vccz Lqa_325
    ds_read_b128 v[0:3], v118 offset:0
    ds_read_b128 v[4:7], v118 offset:2048
    global_load_lds_dwordx4 v127, s[10:11] sc1
    global_load_lds_dwordx4 v127, s[10:11] offset:2048 sc1
    s_waitcnt lgkmcnt(2)
    v_max_u32 v112, v24, v28
    v_cmp_eq_u32 vcc, -1, v112
    s_cbranch_vccz Lqb_324
    s_sub_u32 s27, s27, 1
    s_cbranch_scc0 Lr0_335
    s_branch L_fin
Lqa_325:
    ds_read_b128 v[8:11], v118 offset:1024
    ds_read_b128 v[12:15], v118 offset:3072
    v_smfmac_f32_16x16x64_bf16 v[64:67], v[0:3], v[128:135], v117
    v_smfmac_f32_16x16x64_bf16 v[64:67], v[4:7], v[144:151], v117
    v_smfmac_f32_16x16x64_bf16 v[68:71], v[0:3], v[136:143], v117
    v_smfmac_f32_16x16x64_bf16 v[68:71], v[4:7], v[152:159], v117
    global_store_short v120, v108, s[12:13] sc1
    s_mov_b32 m0, 20480
    v_smfmac_f32_16x16x64_bf16 v[72:75], v[0:3], v[32:39], v117
    global_load_lds_dwordx4 v118, s[22:23] offset:0 sc1
    v_smfmac_f32_16x16x64_bf16 v[72:75], v[4:7], v[40:47], v117
    ds_read_b128 v[16:19], v118 offset:4096
    s_waitcnt lgkmcnt(1)
    v_cmp_u_f32 vcc, v8, v12
    v_smfmac_f32_16x16x64_bf16 v[76:79], v[0:3], v[48:55], v117
    global_store_short v120, v114, s[24:25] sc1
    ds_read_b128 v[20:23], v118 offset:6144
    v_smfmac_f32_16x16x64_bf16 v[76:79], v[4:7], v[96:103], v117
    s_cbranch_vccnz Lfs_336
Lbk_337:
    s_branch Lqj_326
Lpf_346:
    global_load_dword v16, v123, s[18:19] offset:0 sc1
    global_load_dword v17, v123, s[18:19] offset:256 sc1
    global_load_dword v18, v123, s[18:19] offset:512 sc1
    global_load_dword v19, v123, s[18:19] offset:768 sc1
    global_load_dword v20, v123, s[18:19] offset:1024 sc1
    global_load_dword v21, v123, s[18:19] offset:1280 sc1
    global_load_dword v22, v123, s[18:19] offset:1536 sc1
    global_load_dword v23, v123, s[18:19] offset:1792 sc1
    global_load_dword v8, v123, s[18:19] offset:0 sc1
    global_load_dword v9, v123, s[18:19] offset:256 sc1
    global_load_dword v10, v123, s[18:19] offset:512 sc1
    global_load_dword v11, v123, s[18:19] offset:768 sc1
    global_load_dword v12, v123, s[18:19] offset:1024 sc1
    global_load_dword v13, v123, s[18:19] offset:1280 sc1
    global_load_dword v14, v123, s[18:19] offset:1536 sc1
    global_load_dword v15, v123, s[18:19] offset:1792 sc1
    s_waitcnt vmcnt(12)
    v_mfma_f32_16x16x32_bf16 v[24:27], v[104:107], v[16:19], 0
    v_max3_u32 v28, v16, v17, v18
    s_waitcnt vmcnt(8)
    v_mfma_f32_16x16x32_bf16 v[24:27], v[104:107], v[20:23], v[24:27]
    v_max3_u32 v29, v20, v21, v22
    v_max3_u32 v28, v28, v19, v23
    v_max_u32 v28, v28, v29
    v_cmp_eq_u32 vcc, -1, v28
    s_nop 3
    v_cvt_pk_bf16_f32 v114, v24, v24
    s_cbranch_vccz Lpj_347
Lpl_348:
    global_load_dword v16, v123, s[18:19] offset:0 sc1
    global_load_dword v17, v123, s[18:19] offset:256 sc1
    global_load_dword v18, v123, s[18:19] offset:512 sc1
    global_load_dword v19, v123, s[18:19] offset:768 sc1
    global_load_dword v20, v123, s[18:19] offset:1024 sc1
    global_load_dword v21, v123, s[18:19] offset:1280 sc1
    global_load_dword v22, v123, s[18:19] offset:1536 sc1
    global_load_dword v23, v123, s[18:19] offset:1792 sc1
    s_waitcnt vmcnt(12)
    v_mfma_f32_16x16x32_bf16 v[24:27], v[104:107], v[8:11], 0
    v_max3_u32 v28, v8, v9, v10
    s_waitcnt vmcnt(8)
    v_mfma_f32_16x16x32_bf16 v[24:27], v[104:107], v[12:15], v[24:27]
    v_max3_u32 v29, v12, v13, v14
    v_max3_u32 v28, v28, v11, v15
    v_max_u32 v28, v28, v29
    v_cmp_eq_u32 vcc, -1, v28
    s_nop 3
    v_cvt_pk_bf16_f32 v114, v24, v24
    s_cbranch_vccz Lpj_347
    global_load_dword v8, v123, s[18:19] offset:0 sc1
    global_load_dword v9, v123, s[18:19] offset:256 sc1
    global_load_dword v10, v123, s[18:19] offset:512 sc1
    global_load_dword v11, v123, s[18:19] offset:768 sc1
    global_load_dword v12, v123, s[18:19] offset:1024 sc1
    global_load_dword v13, v123, s[18:19] offset:1280 sc1
    global_load_dword v14, v123, s[18:19] offset:1536 sc1
    global_load_dword v15, v123, s[18:19] offset:1792 sc1
    s_waitcnt vmcnt(12)
    v_mfma_f32_16x16x32_bf16 v[24:27], v[104:107], v[16:19], 0
    v_max3_u32 v28, v16, v17, v18
    s_waitcnt vmcnt(8)
    v_mfma_f32_16x16x32_bf16 v[24:27], v[104:107], v[20:23], v[24:27]
    v_max3_u32 v29, v20, v21, v22
    v_max3_u32 v28, v28, v19, v23
    v_max_u32 v28, v28, v29
    v_cmp_eq_u32 vcc, -1, v28
    s_nop 3
    v_cvt_pk_bf16_f32 v114, v24, v24
    s_cbranch_vccz Lpj_347
    s_sub_u32 s27, s27, 1
    s_cbranch_scc0 Lpl_348
    s_branch L_fin
Lfa_351:
    s_waitcnt lgkmcnt(1)
    ds_read_b128 v[0:3], v118 offset:0
    ds_read_b128 v[4:7], v118 offset:2048
    global_load_lds_dwordx4 v127, s[12:13] sc1
    global_load_lds_dwordx4 v127, s[12:13] offset:2048 sc1
Lqb_353:
    ds_read_b128 v[8:11], v118 offset:1024
    ds_read_b128 v[12:15], v118 offset:3072
    v_smfmac_f32_16x16x64_bf16 v[72:75], v[24:27], v[32:39], v117
    v_max_u32 v112, v24, v28
    v_cmp_eq_u32 vcc, -1, v112
    v_smfmac_f32_16x16x64_bf16 v[72:75], v[28:31], v[40:47], v117
    v_smfmac_f32_16x16x64_bf16 v[76:79], v[24:27], v[48:55], v117
    s_cbranch_vccnz Lfb_352
    v_mov_b64 v[64:65], 0
    v_mov_b64 v[66:67], 0
    v_smfmac_f32_16x16x64_bf16 v[76:79], v[28:31], v[96:103], v117
    global_store_short v120, v108, s[10:11] sc1
    s_mov_b32 m0, 20480
    v_mov_b64 v[68:69], 0
    v_mov_b64 v[70:71], 0
    v_smfmac_f32_16x16x64_bf16 v[64:67], v[24:27], v[128:135], v117
    global_load_lds_dwordx4 v118, s[22:23] offset:0 sc1
    v_smfmac_f32_16x16x64_bf16 v[64:67], v[28:31], v[144:151], v117
    ds_read_b128 v[16:19], v118 offset:4096
    s_waitcnt lgkmcnt(1)
    v_cmp_u_f32 vcc, v8, v12
    v_smfmac_f32_16x16x64_bf16 v[68:71], v[24:27], v[136:143], v117
    global_store_short v120, v114, s[24:25] sc1
    ds_read_b128 v[20:23], v118 offset:6144
    v_smfmac_f32_16x16x64_bf16 v[68:71], v[28:31], v[152:159], v117
    s_cbranch_vccnz Lfs_360
Lbk_361:
    s_branch Lqj_355
Lfb_352:
    v_mov_b64 v[64:65], 0
    v_mov_b64 v[66:67], 0
    v_mov_b64 v[68:69], 0
    v_mov_b64 v[70:71], 0
    v_mov_b64 v[72:73], 0
    v_mov_b64 v[74:75], 0
    s_nop 0
    v_mov_b64 v[76:77], 0
    v_mov_b64 v[78:79], 0
Lr0_364:
    ds_read_b128 v[24:27], v118 offset:0
    ds_read_b128 v[28:31], v118 offset:2048
    global_load_lds_dwordx4 v127, s[12:13] sc1
    global_load_lds_dwordx4 v127, s[12:13] offset:2048 sc1
    s_waitcnt lgkmcnt(2)
    v_max_u32 v112, v0, v4
    v_cmp_eq_u32 vcc, -1, v112
    s_cbranch_vccz Lqa_354
    ds_read_b128 v[0:3], v118 offset:0
    ds_read_b128 v[4:7], v118 offset:2048
    global_load_lds_dwordx4 v127, s[12:13] sc1
    global_load_lds_dwordx4 v127, s[12:13] offset:2048 sc1
    s_waitcnt lgkmcnt(2)
    v_max_u32 v112, v24, v28
    v_cmp_eq_u32 vcc, -1, v112
    s_cbranch_vccz Lqb_353
    s_sub_u32 s27, s27, 1
    s_cbranch_scc0 Lr0_364
    s_branch L_fin
Lqa_354:
    ds_read_b128 v[8:11], v118 offset:1024
    ds_read_b128 v[12:15], v118 offset:3072
    v_smfmac_f32_16x16x64_bf16 v[64:67], v[0:3], v[128:135], v117
    v_smfmac_f32_16x16x64_bf16 v[64:67], v[4:7], v[144:151], v117
    v_smfmac_f32_16x16x64_bf16 v[68:71], v[0:3], v[136:143], v117
    v_smfmac_f32_16x16x64_bf16 v[68:71], v[4:7], v[152:159], v117
    global_store_short v120, v108, s[10:11] sc1
    s_mov_b32 m0, 20480
    v_smfmac_f32_16x16x64_bf16 v[72:75], v[0:3], v[32:39], v117
    global_load_lds_dwordx4 v118, s[22:23] offset:0 sc1
    v_smfmac_f32_16x16x64_bf16 v[72:75], v[4:7], v[40:47], v117
    ds_read_b128 v[16:19], v118 offset:4096
    s_waitcnt lgkmcnt(1)
    v_cmp_u_f32 vcc, v8, v12
    v_smfmac_f32_16x16x64_bf16 v[76:79], v[0:3], v[48:55], v117
    global_store_short v120, v114, s[24:25] sc1
    ds_read_b128 v[20:23], v118 offset:6144
    v_smfmac_f32_16x16x64_bf16 v[76:79], v[4:7], v[96:103], v117
    s_cbranch_vccnz Lfs_365
Lbk_366:
    s_branch Lqj_355
Lpf_375:
    global_load_dword v16, v123, s[20:21] offset:0 sc1
    global_load_dword v17, v123, s[20:21] offset:256 sc1
    global_load_dword v18, v123, s[20:21] offset:512 sc1
    global_load_dword v19, v123, s[20:21] offset:768 sc1
    global_load_dword v20, v123, s[20:21] offset:1024 sc1
    global_load_dword v21, v123, s[20:21] offset:1280 sc1
    global_load_dword v22, v123, s[20:21] offset:1536 sc1
    global_load_dword v23, v123, s[20:21] offset:1792 sc1
    global_load_dword v8, v123, s[20:21] offset:0 sc1
    global_load_dword v9, v123, s[20:21] offset:256 sc1
    global_load_dword v10, v123, s[20:21] offset:512 sc1
    global_load_dword v11, v123, s[20:21] offset:768 sc1
    global_load_dword v12, v123, s[20:21] offset:1024 sc1
    global_load_dword v13, v123, s[20:21] offset:1280 sc1
    global_load_dword v14, v123, s[20:21] offset:1536 sc1
    global_load_dword v15, v123, s[20:21] offset:1792 sc1
    s_waitcnt vmcnt(12)
    v_mfma_f32_16x16x32_bf16 v[24:27], v[104:107], v[16:19], 0
    v_max3_u32 v28, v16, v17, v18
    s_waitcnt vmcnt(8)
    v_mfma_f32_16x16x32_bf16 v[24:27], v[104:107], v[20:23], v[24:27]
    v_max3_u32 v29, v20, v21, v22
    v_max3_u32 v28, v28, v19, v23
    v_max_u32 v28, v28, v29
    v_cmp_eq_u32 vcc, -1, v28
    s_nop 3
    v_cvt_pk_bf16_f32 v114, v24, v24
    s_cbranch_vccz Lpj_376
Lpl_377:
    global_load_dword v16, v123, s[20:21] offset:0 sc1
    global_load_dword v17, v123, s[20:21] offset:256 sc1
    global_load_dword v18, v123, s[20:21] offset:512 sc1
    global_load_dword v19, v123, s[20:21] offset:768 sc1
    global_load_dword v20, v123, s[20:21] offset:1024 sc1
    global_load_dword v21, v123, s[20:21] offset:1280 sc1
    global_load_dword v22, v123, s[20:21] offset:1536 sc1
    global_load_dword v23, v123, s[20:21] offset:1792 sc1
    s_waitcnt vmcnt(12)
    v_mfma_f32_16x16x32_bf16 v[24:27], v[104:107], v[8:11], 0
    v_max3_u32 v28, v8, v9, v10
    s_waitcnt vmcnt(8)
    v_mfma_f32_16x16x32_bf16 v[24:27], v[104:107], v[12:15], v[24:27]
    v_max3_u32 v29, v12, v13, v14
    v_max3_u32 v28, v28, v11, v15
    v_max_u32 v28, v28, v29
    v_cmp_eq_u32 vcc, -1, v28
    s_nop 3
    v_cvt_pk_bf16_f32 v114, v24, v24
    s_cbranch_vccz Lpj_376
    global_load_dword v8, v123, s[20:21] offset:0 sc1
    global_load_dword v9, v123, s[20:21] offset:256 sc1
    global_load_dword v10, v123, s[20:21] offset:512 sc1
    global_load_dword v11, v123, s[20:21] offset:768 sc1
    global_load_dword v12, v123, s[20:21] offset:1024 sc1
    global_load_dword v13, v123, s[20:21] offset:1280 sc1
    global_load_dword v14, v123, s[20:21] offset:1536 sc1
    global_load_dword v15, v123, s[20:21] offset:1792 sc1
    s_waitcnt vmcnt(12)
    v_mfma_f32_16x16x32_bf16 v[24:27], v[104:107], v[16:19], 0
    v_max3_u32 v28, v16, v17, v18
    s_waitcnt vmcnt(8)
    v_mfma_f32_16x16x32_bf16 v[24:27], v[104:107], v[20:23], v[24:27]
    v_max3_u32 v29, v20, v21, v22
    v_max3_u32 v28, v28, v19, v23
    v_max_u32 v28, v28, v29
    v_cmp_eq_u32 vcc, -1, v28
    s_nop 3
    v_cvt_pk_bf16_f32 v114, v24, v24
    s_cbranch_vccz Lpj_376
    s_sub_u32 s27, s27, 1
    s_cbranch_scc0 Lpl_377
    s_branch L_fin
Lkf_320:
    v_and_b32 v116, 12, v123
    global_load_dword v116, v116, s[36:37] offset:12 sc1
    s_sub_u32 s27, s27, 1
    s_cbranch_scc1 L_fin
    s_waitcnt vmcnt(0)
    v_cmp_ge_u32 vcc, s40, v116
    s_cbranch_vccnz Lkf_320
    s_branch Lkr_321
Lfs_327:
Lfl_329:
    ds_read_b128 v[8:11], v118 offset:1024
    ds_read_b128 v[12:15], v118 offset:3072
    s_sub_u32 s27, s27, 1
    s_waitcnt lgkmcnt(0)
    v_max_u32 v112, v8, v12
    v_cmp_eq_u32 vcc, -1, v112
    s_cbranch_vccz Lbk_328
    s_waitcnt vmcnt(3)
    ds_read_b128 v[8:11], v118 offset:1024
    ds_read_b128 v[12:15], v118 offset:3072
    s_sub_u32 s27, s27, 1
    s_waitcnt lgkmcnt(0)
    v_max_u32 v112, v8, v12
    v_cmp_eq_u32 vcc, -1, v112
    s_cbranch_vccz Lbk_328
Lfl_330:
    s_mov_b32 s40, m0
    s_mov_b32 m0, 1024
    s_nop 0
    global_load_lds_dwordx4 v127, s[10:11] sc1
    global_load_lds_dwordx4 v127, s[10:11] offset:2048 sc1
    s_waitcnt vmcnt(0)
    s_mov_b32 m0, s40
    ds_read_b128 v[8:11], v118 offset:1024
    ds_read_b128 v[12:15], v118 offset:3072
    s_sub_u32 s27, s27, 1
    s_waitcnt lgkmcnt(0)
    v_max_u32 v112, v8, v12
    v_cmp_eq_u32 vcc, -1, v112
    s_cbranch_vccz Lbk_328
    s_cbranch_scc0 Lfl_330
    s_branch L_fin
Lfs_331:
Lfl_333:
    ds_read_b128 v[8:11], v118 offset:1024
    ds_read_b128 v[12:15], v118 offset:3072
    s_sub_u32 s27, s27, 1
    s_waitcnt lgkmcnt(0)
    v_max_u32 v112, v8, v12
    v_cmp_eq_u32 vcc, -1, v112
    s_cbranch_vccz Lbk_332
    s_waitcnt vmcnt(3)
    ds_read_b128 v[8:11], v118 offset:1024
    ds_read_b128 v[12:15], v118 offset:3072
    s_sub_u32 s27, s27, 1
    s_waitcnt lgkmcnt(0)
    v_max_u32 v112, v8, v12
    v_cmp_eq_u32 vcc, -1, v112
    s_cbranch_vccz Lbk_332
Lfl_334:
    s_mov_b32 s40, m0
    s_mov_b32 m0, 1024
    s_nop 0
    global_load_lds_dwordx4 v127, s[10:11] sc1
    global_load_lds_dwordx4 v127, s[10:11] offset:2048 sc1
    s_waitcnt vmcnt(0)
    s_mov_b32 m0, s40
    ds_read_b128 v[8:11], v118 offset:1024
    ds_read_b128 v[12:15], v118 offset:3072
    s_sub_u32 s27, s27, 1
    s_waitcnt lgkmcnt(0)
    v_max_u32 v112, v8, v12
    v_cmp_eq_u32 vcc, -1, v112
    s_cbranch_vccz Lbk_332
    s_cbranch_scc0 Lfl_334
    s_branch L_fin
Lfs_336:
Lfl_338:
    ds_read_b128 v[8:11], v118 offset:1024
    ds_read_b128 v[12:15], v118 offset:3072
    s_sub_u32 s27, s27, 1
    s_waitcnt lgkmcnt(0)
    v_max_u32 v112, v8, v12
    v_cmp_eq_u32 vcc, -1, v112
    s_cbranch_vccz Lbk_337
    s_waitcnt vmcnt(3)
    ds_read_b128 v[8:11], v118 offset:1024
    ds_read_b128 v[12:15], v118 offset:3072
    s_sub_u32 s27, s27, 1
    s_waitcnt lgkmcnt(0)
    v_max_u32 v112, v8, v12
    v_cmp_eq_u32 vcc, -1, v112
    s_cbranch_vccz Lbk_337
Lfl_339:
    s_mov_b32 s40, m0
    s_mov_b32 m0, 1024
    s_nop 0
    global_load_lds_dwordx4 v127, s[10:11] sc1
    global_load_lds_dwordx4 v127, s[10:11] offset:2048 sc1
    s_waitcnt vmcnt(0)
    s_mov_b32 m0, s40
    ds_read_b128 v[8:11], v118 offset:1024
    ds_read_b128 v[12:15], v118 offset:3072
    s_sub_u32 s27, s27, 1
    s_waitcnt lgkmcnt(0)
    v_max_u32 v112, v8, v12
    v_cmp_eq_u32 vcc, -1, v112
    s_cbranch_vccz Lbk_337
    s_cbranch_scc0 Lfl_339
    s_branch L_fin
Lfs_340:
Lfl_342:
    ds_read_b128 v[16:19], v118 offset:4096
    ds_read_b128 v[20:23], v118 offset:6144
    s_sub_u32 s27, s27, 1
    s_waitcnt lgkmcnt(0)
    v_max_u32 v112, v16, v20
    v_cmp_eq_u32 vcc, -1, v112
    s_cbranch_vccz Lbk_341
    s_cbranch_scc0 Lfl_342
    s_branch L_fin
Lfs_343:
Lfl_345:
    ds_read_b128 v[24:27], v118 offset:5120
    ds_read_b128 v[28:31], v118 offset:7168
    s_sub_u32 s27, s27, 1
    s_waitcnt lgkmcnt(0)
    v_max_u32 v112, v24, v28
    v_cmp_eq_u32 vcc, -1, v112
    s_cbranch_vccz Lbk_344
    s_cbranch_scc0 Lfl_345
    s_branch L_fin
Lkf_349:
    v_and_b32 v116, 12, v123
    global_load_dword v116, v116, s[36:37] offset:-4 sc1
    s_sub_u32 s27, s27, 1
    s_cbranch_scc1 L_fin
    s_waitcnt vmcnt(0)
    v_cmp_ge_u32 vcc, s40, v116
    s_cbranch_vccnz Lkf_349
    s_branch Lkr_350
Lfs_356:
Lfl_358:
    ds_read_b128 v[8:11], v118 offset:1024
    ds_read_b128 v[12:15], v118 offset:3072
    s_sub_u32 s27, s27, 1
    s_waitcnt lgkmcnt(0)
    v_max_u32 v112, v8, v12
    v_cmp_eq_u32 vcc, -1, v112
    s_cbranch_vccz Lbk_357
    s_waitcnt vmcnt(3)
    ds_read_b128 v[8:11], v118 offset:1024
    ds_read_b128 v[12:15], v118 offset:3072
    s_sub_u32 s27, s27, 1
    s_waitcnt lgkmcnt(0)
    v_max_u32 v112, v8, v12
    v_cmp_eq_u32 vcc, -1, v112
    s_cbranch_vccz Lbk_357
Lfl_359:
    s_mov_b32 s40, m0
    s_mov_b32 m0, 1024
    s_nop 0
    global_load_lds_dwordx4 v127, s[12:13] sc1
    global_load_lds_dwordx4 v127, s[12:13] offset:2048 sc1
    s_waitcnt vmcnt(0)
    s_mov_b32 m0, s40
    ds_read_b128 v[8:11], v118 offset:1024
    ds_read_b128 v[12:15], v118 offset:3072
    s_sub_u32 s27, s27, 1
    s_waitcnt lgkmcnt(0)
    v_max_u32 v112, v8, v12
    v_cmp_eq_u32 vcc, -1, v112
    s_cbranch_vccz Lbk_357
    s_cbranch_scc0 Lfl_359
    s_branch L_fin
Lfs_360:
Lfl_362:
    ds_read_b128 v[8:11], v118 offset:1024
    ds_read_b128 v[12:15], v118 offset:3072
    s_sub_u32 s27, s27, 1
    s_waitcnt lgkmcnt(0)
    v_max_u32 v112, v8, v12
    v_cmp_eq_u32 vcc, -1, v112
    s_cbranch_vccz Lbk_361
    s_waitcnt vmcnt(3)
    ds_read_b128 v[8:11], v118 offset:1024
    ds_read_b128 v[12:15], v118 offset:3072
    s_sub_u32 s27, s27, 1
    s_waitcnt lgkmcnt(0)
    v_max_u32 v112, v8, v12
    v_cmp_eq_u32 vcc, -1, v112
    s_cbranch_vccz Lbk_361
Lfl_363:
    s_mov_b32 s40, m0
    s_mov_b32 m0, 1024
    s_nop 0
    global_load_lds_dwordx4 v127, s[12:13] sc1
    global_load_lds_dwordx4 v127, s[12:13] offset:2048 sc1
    s_waitcnt vmcnt(0)
    s_mov_b32 m0, s40
    ds_read_b128 v[8:11], v118 offset:1024
    ds_read_b128 v[12:15], v118 offset:3072
    s_sub_u32 s27, s27, 1
    s_waitcnt lgkmcnt(0)
    v_max_u32 v112, v8, v12
    v_cmp_eq_u32 vcc, -1, v112
    s_cbranch_vccz Lbk_361
    s_cbranch_scc0 Lfl_363
    s_branch L_fin
Lfs_365:
Lfl_367:
    ds_read_b128 v[8:11], v118 offset:1024
    ds_read_b128 v[12:15], v118 offset:3072
    s_sub_u32 s27, s27, 1
    s_waitcnt lgkmcnt(0)
    v_max_u32 v112, v8, v12
    v_cmp_eq_u32 vcc, -1, v112
    s_cbranch_vccz Lbk_366
    s_waitcnt vmcnt(3)
    ds_read_b128 v[8:11], v118 offset:1024
    ds_read_b128 v[12:15], v118 offset:3072
    s_sub_u32 s27, s27, 1
    s_waitcnt lgkmcnt(0)
    v_max_u32 v112, v8, v12
    v_cmp_eq_u32 vcc, -1, v112
    s_cbranch_vccz Lbk_366
Lfl_368:
    s_mov_b32 s40, m0
    s_mov_b32 m0, 1024
    s_nop 0
    global_load_lds_dwordx4 v127, s[12:13] sc1
    global_load_lds_dwordx4 v127, s[12:13] offset:2048 sc1
    s_waitcnt vmcnt(0)
    s_mov_b32 m0, s40
    ds_read_b128 v[8:11], v118 offset:1024
    ds_read_b128 v[12:15], v118 offset:3072
    s_sub_u32 s27, s27, 1
    s_waitcnt lgkmcnt(0)
    v_max_u32 v112, v8, v12
    v_cmp_eq_u32 vcc, -1, v112
    s_cbranch_vccz Lbk_366
    s_cbranch_scc0 Lfl_368
    s_branch L_fin
Lfs_369:
Lfl_371:
    ds_read_b128 v[16:19], v118 offset:4096
    ds_read_b128 v[20:23], v118 offset:6144
    s_sub_u32 s27, s27, 1
    s_waitcnt lgkmcnt(0)
    v_max_u32 v112, v16, v20
    v_cmp_eq_u32 vcc, -1, v112
    s_cbranch_vccz Lbk_370
    s_cbranch_scc0 Lfl_371
    s_branch L_fin
Lfs_372:
Lfl_374:
    ds_read_b128 v[24:27], v118 offset:5120
    ds_read_b128 v[28:31], v118 offset:7168
    s_sub_u32 s27, s27, 1
    s_waitcnt lgkmcnt(0)
    v_max_u32 v112, v24, v28
    v_cmp_eq_u32 vcc, -1, v112
    s_cbranch_vccz Lbk_373
    s_cbranch_scc0 Lfl_374
    s_branch L_fin
Lwv_266:
    s_mov_b32 m0, 4096
    ds_read_b128 v[32:35], v125 offset:0
    ds_read_b128 v[36:39], v125 offset:1024
    ds_read_b128 v[40:43], v125 offset:8192
    ds_read_b128 v[44:47], v125 offset:9216
    ds_read_b128 v[48:51], v125 offset:2048
    ds_read_b128 v[52:55], v125 offset:3072
    ds_read_b128 v[96:99], v125 offset:10240
    ds_read_b128 v[100:103], v125 offset:11264
    v_mov_b64 v[64:65], 0
    v_mov_b64 v[66:67], 0
    v_mov_b64 v[68:69], 0
    v_mov_b64 v[70:71], 0
    v_mov_b64 v[72:73], 0
    v_mov_b64 v[74:75], 0
    v_mov_b64 v[76:77], 0
    v_mov_b64 v[78:79], 0
    v_mov_b64 v[80:81], 0
    v_mov_b64 v[82:83], 0
    v_mov_b64 v[84:85], 0
    v_mov_b64 v[86:87], 0
    v_xor_b32 v112, 8, v109
    ds_read_b64 v[90:91], v109 offset:27648
    ds_read_b64 v[88:89], v112 offset:26624
    ds_read_b64 v[94:95], v109 offset:28160
    ds_read_b64 v[92:93], v112 offset:27136
    ds_read_b128 v[56:59], v111 offset:24576
    ds_read_b128 v[60:63], v111 offset:25600
    s_waitcnt lgkmcnt(2)
    v_swap_b32 v89, v90
    v_swap_b32 v93, v94
Lhl2_378:
    s_waitcnt vmcnt(0)
    global_load_lds_dwordx4 v127, s[10:11] sc1
    global_load_lds_dwordx4 v127, s[10:11] offset:2048 sc1
    s_barrier
    ds_read_b128 v[0:3], v118 offset:0
    ds_read_b128 v[4:7], v118 offset:2048
    global_load_lds_dwordx4 v127, s[10:11] sc1
    global_load_lds_dwordx4 v127, s[10:11] offset:2048 sc1
    s_waitcnt lgkmcnt(1)
    v_smfmac_f32_16x16x64_bf16 v[64:67], v[0:3], v[128:135], v117
    ds_read_b128 v[24:27], v118 offset:0
    ds_read_b128 v[8:11], v118 offset:1024
    s_waitcnt lgkmcnt(2)
    v_smfmac_f32_16x16x64_bf16 v[64:67], v[4:7], v[144:151], v117
    ds_read_b128 v[28:31], v118 offset:2048
    ds_read_b128 v[12:15], v118 offset:3072
    v_cmp_u_f32 vcc, v0, v4
    v_smfmac_f32_16x16x64_bf16 v[68:71], v[0:3], v[136:143], v117
    v_smfmac_f32_16x16x64_bf16 v[68:71], v[4:7], v[152:159], v117
    s_cbranch_vccnz Lfa_380
    global_store_short v120, v108, s[12:13] sc1
    s_mov_b32 m0, 24576
    v_smfmac_f32_16x16x64_bf16 v[72:75], v[0:3], v[32:39], v117
    global_load_lds_dwordx4 v118, s[22:23] offset:0 sc1
    v_smfmac_f32_16x16x64_bf16 v[72:75], v[4:7], v[40:47], v117
    ds_read_b128 v[16:19], v118 offset:4096
    s_waitcnt lgkmcnt(1)
    v_cmp_u_f32 vcc, v8, v12
    v_smfmac_f32_16x16x64_bf16 v[76:79], v[0:3], v[48:55], v117
    global_store_short v120, v114, s[24:25] sc1
    ds_read_b128 v[20:23], v118 offset:6144
    v_smfmac_f32_16x16x64_bf16 v[76:79], v[4:7], v[96:103], v117
    s_cbranch_vccnz Lfs_385
Lbk_386:
Lqj_384:
    v_smfmac_f32_16x16x64_bf16 v[64:67], v[8:11], v[160:167], v117
    ds_read_b128 v[96:99], v125 offset:12288
    ds_read_b128 v[44:47], v125 offset:15360
    v_smfmac_f32_16x16x64_bf16 v[64:67], v[12:15], v[176:183], v117
    global_load_lds_dwordx4 v118, s[22:23] offset:1024 sc1
    ds_read_b128 v[100:103], v125 offset:13312
    v_smfmac_f32_16x16x64_bf16 v[68:71], v[8:11], v[168:175], v117
    ds_read_b128 v[24:27], v118 offset:5120
    s_waitcnt lgkmcnt(4)
    v_cmp_u_f32 vcc, v16, v20
    v_smfmac_f32_16x16x64_bf16 v[68:71], v[12:15], v[184:191], v117
    ds_read_b128 v[28:31], v118 offset:7168
    ds_read_b128 v[40:43], v125 offset:14336
    v_smfmac_f32_16x16x64_bf16 v[72:75], v[8:11], a[0:7], v117
    s_cbranch_vccnz Lfs_395
Lbk_396:
    ds_read_b128 v[32:35], v125 offset:20480
    v_smfmac_f32_16x16x64_bf16 v[64:67], v[16:19], v[192:199], v117
    s_add_u32 s24, s24, 8192
    s_addc_u32 s25, s25, 0
    ds_read_b128 v[36:39], v125 offset:21504
    v_smfmac_f32_16x16x64_bf16 v[64:67], v[20:23], v[208:215], v117
    global_load_lds_dwordx4 v118, s[22:23] offset:2048 sc1
    ds_read_b128 v[48:51], v125 offset:22528
    v_smfmac_f32_16x16x64_bf16 v[68:71], v[16:19], v[200:207], v117
    s_add_u32 s26, s26, 1
    s_waitcnt lgkmcnt(4)
    v_cmp_u_f32 vcc, v24, v28
    v_smfmac_f32_16x16x64_bf16 v[68:71], v[20:23], v[216:223], v117
    ds_read_b128 v[52:55], v125 offset:23552
    v_smfmac_f32_16x16x64_bf16 v[72:75], v[16:19], v[96:103], v117
    s_cbranch_vccnz Lfs_399
Lbk_400:
    v_smfmac_f32_16x16x64_bf16 v[64:67], v[24:27], v[224:231], v117
    s_mov_b64 vcc, s[64:65]
    v_smfmac_f32_16x16x64_bf16 v[64:67], v[28:31], v[240:247], v117
    global_load_lds_dwordx4 v118, s[22:23] offset:3072 sc1
    v_smfmac_f32_16x16x64_bf16 v[68:71], v[24:27], v[232:239], v117
    s_add_u32 s22, s22, 524288
    s_addc_u32 s23, s23, 0
    v_smfmac_f32_16x16x64_bf16 v[68:71], v[28:31], v[248:255], v117
    s_waitcnt lgkmcnt(2)
    v_add_f32 v64, v64, v66
    v_smfmac_f32_16x16x64_bf16 v[72:75], v[20:23], v[32:39], v117
    ds_read_b128 v[32:35], v125 offset:24576
    v_add_f32 v65, v65, v67
    v_smfmac_f32_16x16x64_bf16 v[72:75], v[12:15], a[16:23], v117
    ds_read_b128 v[36:39], v125 offset:25600
    v_cvt_pk_bf16_f32 v102, v64, v65
    v_add_f32 v68, v68, v70
    v_smfmac_f32_16x16x64_bf16 v[72:75], v[24:27], a[32:39], v117
    ds_write_b32 v121, v102 offset:8196
    v_add_f32 v69, v69, v71
    v_cvt_pk_bf16_f32 v103, v68, v69
    v_smfmac_f32_16x16x64_bf16 v[72:75], v[28:31], a[48:55], v117
    ds_write_b32 v121, v103 offset:8708
    v_smfmac_f32_16x16x64_bf16 v[76:79], v[16:19], v[40:47], v117
    ds_read_b128 v[40:43], v125 offset:26624
    s_waitcnt lgkmcnt(5)
    v_smfmac_f32_16x16x64_bf16 v[76:79], v[20:23], v[48:55], v117
    ds_read_b128 v[44:47], v125 offset:27648
    v_add_f32 v72, v72, v74
    v_smfmac_f32_16x16x64_bf16 v[76:79], v[8:11], a[8:15], v117
    ds_read_b128 v[48:51], v125 offset:4096
    v_smfmac_f32_16x16x64_bf16 v[76:79], v[12:15], a[24:31], v117
    s_waitcnt lgkmcnt(3)
    s_barrier
    v_smfmac_f32_16x16x64_bf16 v[76:79], v[24:27], a[40:47], v117
    ds_read_b64_tr_b16 v[64:65], v122 offset:8192
    ds_read_b64_tr_b16 v[66:67], v122 offset:8704
    v_smfmac_f32_16x16x64_bf16 v[76:79], v[28:31], a[56:63], v117
    ds_read_b64_tr_b16 v[68:69], v122 offset:9216
    ds_read_b64_tr_b16 v[70:71], v122 offset:9728
    v_add_f32 v73, v73, v75
    v_cvt_pk_bf16_f32 v100, v72, v73
    v_smfmac_f32_16x16x64_bf16 v[80:83], v[0:3], a[64:71], v117
    ds_write_b32 v121, v100 offset:10244
    v_smfmac_f32_16x16x64_bf16 v[84:87], v[0:3], a[72:79], v117
    s_waitcnt lgkmcnt(3)
    ds_read_b128 v[52:55], v125 offset:5120
    v_add_f32 v76, v76, v78
    v_mfma_f32_16x16x32_bf16 v[96:99], v[56:59], v[64:67], 0
    s_waitcnt lgkmcnt(2)
    v_add_f32 v77, v77, v79
    v_cvt_pk_bf16_f32 v101, v76, v77
    v_mfma_f32_16x16x32_bf16 v[96:99], v[60:63], v[68:71], v[96:99]
    ds_write_b32 v121, v101 offset:10756
    v_smfmac_f32_16x16x64_bf16 v[80:83], v[4:7], a[80:87], v117
    s_mov_b32 exec_hi, 0
    global_store_dword v110, v108, s[20:21] sc1
    s_mov_b32 exec_hi, -1
    v_smfmac_f32_16x16x64_bf16 v[84:87], v[4:7], a[88:95], v117
    v_add_f32_dpp v96, v98, v96 quad_perm:[2,3,2,3] row_mask:0xf bank_mask:0xf
    v_add_f32_dpp v97, v99, v97 quad_perm:[2,3,2,3] row_mask:0xf bank_mask:0xf
    v_smfmac_f32_16x16x64_bf16 v[80:83], v[8:11], a[96:103], v117
    ds_write_b64 v109, v[96:97] offset:13312
    v_smfmac_f32_16x16x64_bf16 v[84:87], v[8:11], a[104:111], v117
    s_waitcnt lgkmcnt(1)
    s_barrier
    v_smfmac_f32_16x16x64_bf16 v[80:83], v[12:15], a[112:119], v117
    s_waitcnt vmcnt(7)
    ds_read_b64_tr_b16 v[72:73], v122 offset:10240
    ds_read_b64_tr_b16 v[74:75], v122 offset:10752
    v_smfmac_f32_16x16x64_bf16 v[84:87], v[12:15], a[120:127], v117
    ds_read_b64_tr_b16 v[76:77], v122 offset:11264
    ds_read_b64_tr_b16 v[78:79], v122 offset:11776
    v_smfmac_f32_16x16x64_bf16 v[80:83], v[16:19], a[128:135], v117
    ds_read_b128 v[8:11], v125 offset:18432
    v_smfmac_f32_16x16x64_bf16 v[84:87], v[16:19], a[136:143], v117
    s_waitcnt lgkmcnt(5)
    s_barrier
    s_waitcnt lgkmcnt(3)
    v_mfma_f32_16x16x32_bf16 v[0:3], v[72:75], v[64:67], 0
    ds_read_b128 v[56:59], v124 offset:12288
    s_waitcnt lgkmcnt(2)
    v_mfma_f32_16x16x32_bf16 v[0:3], v[76:79], v[68:71], v[0:3]
    ds_read_b128 v[12:15], v125 offset:19456
    v_smfmac_f32_16x16x64_bf16 v[80:83], v[20:23], a[144:151], v117
    ds_write_b32 v118, v108 offset:4096
    v_smfmac_f32_16x16x64_bf16 v[84:87], v[20:23], a[152:159], v117
    ds_write_b32 v118, v108 offset:6144
    v_add_f32_dpp v2, v0, v2 quad_perm:[0,1,0,1] row_mask:0xf bank_mask:0xf
    v_smfmac_f32_16x16x64_bf16 v[80:83], v[24:27], a[160:167], v117
    s_waitcnt lgkmcnt(3)
    v_max3_f32 v60, v56, v57, v58
    v_add_f32_dpp v3, v1, v3 quad_perm:[0,1,0,1] row_mask:0xf bank_mask:0xf
    v_smfmac_f32_16x16x64_bf16 v[84:87], v[24:27], a[168:175], v117
    v_max_f32 v60, v60, v59
    v_smfmac_f32_16x16x64_bf16 v[80:83], v[28:31], v[32:39], v117
    s_nop 0
    v_max_f32_dpp v60, v60, v60 quad_perm:[2,3,0,1] row_mask:0xf bank_mask:0xf
    v_smfmac_f32_16x16x64_bf16 v[84:87], v[28:31], v[40:47], v117
    v_max3_f32 v61, v60, v2, v3
    v_max3_f32 v62, v60, v2, v3
    v_mov_b64 v[64:65], 0
    v_mov_b64 v[66:67], 0
    v_permlane16_swap_b32 v61, v62
    v_max_f32 v60, v61, v62
    v_max_f32 v63, v61, v62
    v_pk_add_f32 v[80:81], v[80:81], v[82:83]
    v_pk_add_f32 v[84:85], v[84:85], v[86:87]
    v_permlane32_swap_b32 v60, v63
    v_max_f32 v61, v60, v63
    v_cvt_pk_bf16_f32 v114, v80, v81
    v_cvt_pk_bf16_f32 v115, v84, v85
    v_mul_f32_dpp v62, v61, v126 quad_perm:[2,3,2,3] row_mask:0xf bank_mask:0xf
    v_pk_fma_f32 v[2:3], v[2:3], s[28:29], v[62:63] op_sel_hi:[1,1,0]
    v_pk_fma_f32 v[56:57], v[56:57], s[28:29], v[62:63] op_sel_hi:[1,1,0]
    v_exp_f32 v2, v2
    v_exp_f32 v3, v3
    v_pk_fma_f32 v[58:59], v[58:59], s[28:29], v[62:63] op_sel_hi:[1,1,0]
    v_cvt_pk_bf16_f32 v80, v2, v3
    v_exp_f32 v56, v56
    v_cndmask_b32 v5, v113, v80, vcc
    v_cndmask_b32_dpp v4, v80, v113, vcc quad_perm:[2,3,2,3] row_mask:0xf bank_mask:0xf
    v_exp_f32 v57, v57
    v_exp_f32 v58, v58
    v_mfma_f32_16x16x16_bf16 v[76:79], v[4:5], v[104:105], 0
    v_cvt_pk_bf16_f32 v84, v56, v57
    v_exp_f32 v59, v59
    v_mfma_f32_16x16x16_bf16 v[72:75], v[4:5], v[114:115], 0
    v_cvt_pk_bf16_f32 v85, v58, v59
    v_mov_b32_dpp v86, v84 quad_perm:[2,3,0,1] row_mask:0xf bank_mask:0xf
    v_mov_b64 v[68:69], 0
    v_mov_b32_dpp v87, v85 quad_perm:[2,3,0,1] row_mask:0xf bank_mask:0xf
    v_mov_b64 v[70:71], 0
    v_mov_b64 v[80:81], 0
    v_mfma_f32_16x16x32_bf16 v[76:79], v[84:87], v[104:107], v[76:79]
    ds_read_b128 v[32:35], v125 offset:6144
    v_smfmac_f32_16x16x64_bf16 v[72:75], v[84:87], v[88:95], v117
    ds_read_b128 v[36:39], v125 offset:7168
    s_nop 2
    v_rcp_f32_dpp v60, v76 quad_perm:[2,3,2,3] row_mask:0xf bank_mask:0xf
    v_rcp_f32_dpp v61, v77 quad_perm:[2,3,2,3] row_mask:0xf bank_mask:0xf
    s_nop 1
    v_pk_mul_f32 v[72:73], v[72:73], v[60:61]
    v_pk_mul_f32 v[74:75], v[74:75], v[60:61]
    v_cvt_pk_bf16_f32 v56, v72, v73
    v_cvt_pk_bf16_f32 v57, v74, v75
    ds_write_b64 v121, v[56:57] offset:15360
    v_mov_b64 v[82:83], 0
    v_mov_b64 v[84:85], 0
    v_mov_b64 v[86:87], 0
    v_mov_b64 v[72:73], 0
    v_mov_b64 v[74:75], 0
    v_mov_b64 v[76:77], 0
    v_mov_b64 v[78:79], 0
    v_mov_b64 v[88:89], 0
    v_mov_b64 v[90:91], 0
    v_mov_b64 v[92:93], 0
    v_mov_b64 v[94:95], 0
    s_waitcnt vmcnt(6)
    s_waitcnt lgkmcnt(0)
    s_barrier
    ds_read_b64_tr_b16 v[96:97], v122 offset:14336
    ds_read_b64_tr_b16 v[98:99], v122 offset:14848
    ds_read_b64_tr_b16 v[100:101], v122 offset:15360
    ds_read_b64_tr_b16 v[102:103], v122 offset:15872
    ds_read_b128 v[40:43], v125 offset:16384
    ds_read_b128 v[44:47], v125 offset:17408
    s_waitcnt lgkmcnt(4)
    v_smfmac_f32_16x16x64_bf16 v[72:75], v[96:99], a[176:183], v117
    ds_read_b128 v[24:27], v125 offset:28672
    s_waitcnt lgkmcnt(3)
    v_smfmac_f32_16x16x64_bf16 v[72:75], v[100:103], a[192:199], v117
    ds_read_b128 v[28:31], v125 offset:29696
    v_smfmac_f32_16x16x64_bf16 v[76:79], v[96:99], a[184:191], v117
    ds_read_b128 v[56:59], v125 offset:30720
    v_smfmac_f32_16x16x64_bf16 v[76:79], v[100:103], a[200:207], v117
    ds_read_b128 v[60:63], v125 offset:31744
    v_add_f32 v72, v72, v74
    v_add_f32 v73, v73, v75
    v_cvt_pk_bf16_f32 v72, v72, v73
    v_smfmac_f32_16x16x64_bf16 v[80:83], v[96:99], a[208:215], v117
    global_store_dword v119, v72, s[14:15] offset:-4096 sc1
    s_nop 1
    v_add_f32 v76, v76, v78
    v_add_f32 v77, v77, v79
    v_cvt_pk_bf16_f32 v76, v76, v77
    v_smfmac_f32_16x16x64_bf16 v[80:83], v[100:103], a[224:231], v117
    global_store_dword v119, v76, s[30:31] offset:-4096 sc1
    v_smfmac_f32_16x16x64_bf16 v[84:87], v[96:99], a[216:223], v117
    v_smfmac_f32_16x16x64_bf16 v[84:87], v[100:103], a[232:239], v117
    v_add_f32 v80, v80, v82
    v_smfmac_f32_16x16x64_bf16 v[64:67], v[96:99], a[240:247], v117
    v_add_f32 v81, v81, v83
    v_cvt_pk_bf16_f32 v80, v80, v81
    v_smfmac_f32_16x16x64_bf16 v[64:67], v[100:103], v[48:55], v117
    global_store_dword v119, v80, s[14:15] offset:-2048 sc1
    v_add_f32 v84, v84, v86
    v_smfmac_f32_16x16x64_bf16 v[68:71], v[96:99], a[248:255], v117
    v_add_f32 v85, v85, v87
    v_cvt_pk_bf16_f32 v84, v84, v85
    v_smfmac_f32_16x16x64_bf16 v[68:71], v[100:103], v[32:39], v117
    s_waitcnt lgkmcnt(4)
    global_store_dword v119, v84, s[30:31] offset:-2048 sc1
    v_add_f32 v64, v64, v66
    v_smfmac_f32_16x16x64_bf16 v[88:91], v[96:99], v[40:47], v117
    s_waitcnt lgkmcnt(2)
    v_add_f32 v65, v65, v67
    v_cvt_pk_bf16_f32 v64, v64, v65
    v_smfmac_f32_16x16x64_bf16 v[88:91], v[100:103], v[24:31], v117
    global_store_dword v119, v64, s[14:15] offset:0 sc1
    v_add_f32 v68, v68, v70
    v_smfmac_f32_16x16x64_bf16 v[92:95], v[96:99], v[8:15], v117
    s_waitcnt lgkmcnt(0)
    v_add_f32 v69, v69, v71
    v_cvt_pk_bf16_f32 v68, v68, v69
    v_smfmac_f32_16x16x64_bf16 v[92:95], v[100:103], v[56:63], v117
    global_store_dword v119, v68, s[30:31] offset:0 sc1
    v_add_f32 v88, v88, v90
    v_add_f32 v89, v89, v91
    v_cvt_pk_bf16_f32 v88, v88, v89
    global_store_dword v119, v88, s[14:15] offset:2048 sc1
    s_mov_b32 m0, 4096
    ds_read_b128 v[32:35], v125 offset:0
    ds_read_b128 v[36:39], v125 offset:1024
    v_add_f32 v92, v92, v94
    v_add_f32 v93, v93, v95
    v_cvt_pk_bf16_f32 v92, v92, v93
    global_store_dword v119, v92, s[30:31] offset:2048 sc1
    ds_read_b128 v[40:43], v125 offset:8192
    ds_read_b128 v[44:47], v125 offset:9216
    ds_read_b128 v[48:51], v125 offset:2048
    ds_read_b128 v[52:55], v125 offset:3072
    ds_read_b128 v[96:99], v125 offset:10240
    ds_read_b128 v[100:103], v125 offset:11264
    v_mov_b64 v[64:65], 0
    v_mov_b64 v[66:67], 0
    v_mov_b64 v[68:69], 0
    v_mov_b64 v[70:71], 0
    v_mov_b64 v[72:73], 0
    v_mov_b64 v[74:75], 0
    v_mov_b64 v[76:77], 0
    v_mov_b64 v[78:79], 0
    v_mov_b64 v[80:81], 0
    v_mov_b64 v[82:83], 0
    v_mov_b64 v[84:85], 0
    v_mov_b64 v[86:87], 0
    s_waitcnt vmcnt(8)
    v_xor_b32 v112, 8, v109
    global_load_dword v0, v123, s[18:19] offset:0 sc1
    global_load_dword v1, v123, s[18:19] offset:256 sc1
    global_load_dword v2, v123, s[18:19] offset:512 sc1
    global_load_dword v3, v123, s[18:19] offset:768 sc1
    global_load_dword v4, v123, s[18:19] offset:1024 sc1
    global_load_dword v5, v123, s[18:19] offset:1280 sc1
    global_load_dword v6, v123, s[18:19] offset:1536 sc1
    global_load_dword v7, v123, s[18:19] offset:1792 sc1
    ds_read_b64 v[90:91], v109 offset:27648
    ds_read_b64 v[88:89], v112 offset:26624
    ds_read_b64 v[94:95], v109 offset:28160
    ds_read_b64 v[92:93], v112 offset:27136
    ds_read_b128 v[56:59], v111 offset:24576
    ds_read_b128 v[60:63], v111 offset:25600
    s_waitcnt lgkmcnt(2)
    v_swap_b32 v89, v90
    v_swap_b32 v93, v94
    s_waitcnt vmcnt(4)
    v_mfma_f32_16x16x32_bf16 v[24:27], v[104:107], v[0:3], 0
    v_max3_u32 v28, v0, v1, v2
    s_waitcnt vmcnt(0)
    v_mfma_f32_16x16x32_bf16 v[24:27], v[104:107], v[4:7], v[24:27]
    v_max3_u32 v29, v4, v5, v6
    v_max3_u32 v28, v28, v3, v7
    v_cmp_u_f32 vcc, v28, v29
    s_nop 4
    v_cvt_pk_bf16_f32 v114, v24, v24
    s_cbranch_vccnz Lpf_402
Lpj_403:
    global_store_short v120, v114, s[12:13] sc1
    s_cmp_eq_u32 s26, 63
    s_cbranch_scc1 Llast_379
    s_waitcnt vmcnt(0)
    global_load_lds_dwordx4 v127, s[12:13] sc1
    global_load_lds_dwordx4 v127, s[12:13] offset:2048 sc1
    s_barrier
    ds_read_b128 v[0:3], v118 offset:0
    ds_read_b128 v[4:7], v118 offset:2048
    global_load_lds_dwordx4 v127, s[12:13] sc1
    global_load_lds_dwordx4 v127, s[12:13] offset:2048 sc1
    s_waitcnt lgkmcnt(1)
    v_smfmac_f32_16x16x64_bf16 v[64:67], v[0:3], v[128:135], v117
    ds_read_b128 v[24:27], v118 offset:0
    ds_read_b128 v[8:11], v118 offset:1024
    s_waitcnt lgkmcnt(2)
    v_smfmac_f32_16x16x64_bf16 v[64:67], v[4:7], v[144:151], v117
    ds_read_b128 v[28:31], v118 offset:2048
    ds_read_b128 v[12:15], v118 offset:3072
    v_cmp_u_f32 vcc, v0, v4
    v_smfmac_f32_16x16x64_bf16 v[68:71], v[0:3], v[136:143], v117
    v_smfmac_f32_16x16x64_bf16 v[68:71], v[4:7], v[152:159], v117
    s_cbranch_vccnz Lfa_405
    global_store_short v120, v108, s[10:11] sc1
    s_mov_b32 m0, 24576
    v_smfmac_f32_16x16x64_bf16 v[72:75], v[0:3], v[32:39], v117
    global_load_lds_dwordx4 v118, s[22:23] offset:0 sc1
    v_smfmac_f32_16x16x64_bf16 v[72:75], v[4:7], v[40:47], v117
    ds_read_b128 v[16:19], v118 offset:4096
    s_waitcnt lgkmcnt(1)
    v_cmp_u_f32 vcc, v8, v12
    v_smfmac_f32_16x16x64_bf16 v[76:79], v[0:3], v[48:55], v117
    global_store_short v120, v114, s[24:25] sc1
    ds_read_b128 v[20:23], v118 offset:6144
    v_smfmac_f32_16x16x64_bf16 v[76:79], v[4:7], v[96:103], v117
    s_cbranch_vccnz Lfs_410
Lbk_411:
Lqj_409:
    v_smfmac_f32_16x16x64_bf16 v[64:67], v[8:11], v[160:167], v117
    ds_read_b128 v[96:99], v125 offset:12288
    ds_read_b128 v[44:47], v125 offset:15360
    v_smfmac_f32_16x16x64_bf16 v[64:67], v[12:15], v[176:183], v117
    global_load_lds_dwordx4 v118, s[22:23] offset:1024 sc1
    ds_read_b128 v[100:103], v125 offset:13312
    v_smfmac_f32_16x16x64_bf16 v[68:71], v[8:11], v[168:175], v117
    ds_read_b128 v[24:27], v118 offset:5120
    s_waitcnt lgkmcnt(4)
    v_cmp_u_f32 vcc, v16, v20
    v_smfmac_f32_16x16x64_bf16 v[68:71], v[12:15], v[184:191], v117
    ds_read_b128 v[28:31], v118 offset:7168
    ds_read_b128 v[40:43], v125 offset:14336
    v_smfmac_f32_16x16x64_bf16 v[72:75], v[8:11], a[0:7], v117
    s_cbranch_vccnz Lfs_420
Lbk_421:
    ds_read_b128 v[32:35], v125 offset:20480
    v_smfmac_f32_16x16x64_bf16 v[64:67], v[16:19], v[192:199], v117
    s_add_u32 s24, s24, 8192
    s_addc_u32 s25, s25, 0
    ds_read_b128 v[36:39], v125 offset:21504
    v_smfmac_f32_16x16x64_bf16 v[64:67], v[20:23], v[208:215], v117
    global_load_lds_dwordx4 v118, s[22:23] offset:2048 sc1
    ds_read_b128 v[48:51], v125 offset:22528
    v_smfmac_f32_16x16x64_bf16 v[68:71], v[16:19], v[200:207], v117
    s_add_u32 s26, s26, 1
    s_waitcnt lgkmcnt(4)
    v_cmp_u_f32 vcc, v24, v28
    v_smfmac_f32_16x16x64_bf16 v[68:71], v[20:23], v[216:223], v117
    ds_read_b128 v[52:55], v125 offset:23552
    v_smfmac_f32_16x16x64_bf16 v[72:75], v[16:19], v[96:103], v117
    s_cbranch_vccnz Lfs_424
Lbk_425:
    v_smfmac_f32_16x16x64_bf16 v[64:67], v[24:27], v[224:231], v117
    s_mov_b64 vcc, s[64:65]
    v_smfmac_f32_16x16x64_bf16 v[64:67], v[28:31], v[240:247], v117
    global_load_lds_dwordx4 v118, s[22:23] offset:3072 sc1
    v_smfmac_f32_16x16x64_bf16 v[68:71], v[24:27], v[232:239], v117
    s_add_u32 s22, s22, 524288
    s_addc_u32 s23, s23, 0
    v_smfmac_f32_16x16x64_bf16 v[68:71], v[28:31], v[248:255], v117
    s_waitcnt lgkmcnt(2)
    v_add_f32 v64, v64, v66
    v_smfmac_f32_16x16x64_bf16 v[72:75], v[20:23], v[32:39], v117
    ds_read_b128 v[32:35], v125 offset:24576
    v_add_f32 v65, v65, v67
    v_smfmac_f32_16x16x64_bf16 v[72:75], v[12:15], a[16:23], v117
    ds_read_b128 v[36:39], v125 offset:25600
    v_cvt_pk_bf16_f32 v102, v64, v65
    v_add_f32 v68, v68, v70
    v_smfmac_f32_16x16x64_bf16 v[72:75], v[24:27], a[32:39], v117
    ds_write_b32 v121, v102 offset:8196
    v_add_f32 v69, v69, v71
    v_cvt_pk_bf16_f32 v103, v68, v69
    v_smfmac_f32_16x16x64_bf16 v[72:75], v[28:31], a[48:55], v117
    ds_write_b32 v121, v103 offset:8708
    v_smfmac_f32_16x16x64_bf16 v[76:79], v[16:19], v[40:47], v117
    ds_read_b128 v[40:43], v125 offset:26624
    s_waitcnt lgkmcnt(5)
    v_smfmac_f32_16x16x64_bf16 v[76:79], v[20:23], v[48:55], v117
    ds_read_b128 v[44:47], v125 offset:27648
    v_add_f32 v72, v72, v74
    v_smfmac_f32_16x16x64_bf16 v[76:79], v[8:11], a[8:15], v117
    ds_read_b128 v[48:51], v125 offset:4096
    v_smfmac_f32_16x16x64_bf16 v[76:79], v[12:15], a[24:31], v117
    s_waitcnt lgkmcnt(3)
    s_barrier
    v_smfmac_f32_16x16x64_bf16 v[76:79], v[24:27], a[40:47], v117
    ds_read_b64_tr_b16 v[64:65], v122 offset:8192
    ds_read_b64_tr_b16 v[66:67], v122 offset:8704
    v_smfmac_f32_16x16x64_bf16 v[76:79], v[28:31], a[56:63], v117
    ds_read_b64_tr_b16 v[68:69], v122 offset:9216
    ds_read_b64_tr_b16 v[70:71], v122 offset:9728
    v_add_f32 v73, v73, v75
    v_cvt_pk_bf16_f32 v100, v72, v73
    v_smfmac_f32_16x16x64_bf16 v[80:83], v[0:3], a[64:71], v117
    ds_write_b32 v121, v100 offset:10244
    v_smfmac_f32_16x16x64_bf16 v[84:87], v[0:3], a[72:79], v117
    s_waitcnt lgkmcnt(3)
    ds_read_b128 v[52:55], v125 offset:5120
    v_add_f32 v76, v76, v78
    v_mfma_f32_16x16x32_bf16 v[96:99], v[56:59], v[64:67], 0
    s_waitcnt lgkmcnt(2)
    v_add_f32 v77, v77, v79
    v_cvt_pk_bf16_f32 v101, v76, v77
    v_mfma_f32_16x16x32_bf16 v[96:99], v[60:63], v[68:71], v[96:99]
    ds_write_b32 v121, v101 offset:10756
    v_smfmac_f32_16x16x64_bf16 v[80:83], v[4:7], a[80:87], v117
    s_mov_b32 exec_hi, 0
    global_store_dword v110, v108, s[18:19] sc1
    s_mov_b32 exec_hi, -1
    v_smfmac_f32_16x16x64_bf16 v[84:87], v[4:7], a[88:95], v117
    v_add_f32_dpp v96, v98, v96 quad_perm:[2,3,2,3] row_mask:0xf bank_mask:0xf
    v_add_f32_dpp v97, v99, v97 quad_perm:[2,3,2,3] row_mask:0xf bank_mask:0xf
    v_smfmac_f32_16x16x64_bf16 v[80:83], v[8:11], a[96:103], v117
    ds_write_b64 v109, v[96:97] offset:13312
    v_smfmac_f32_16x16x64_bf16 v[84:87], v[8:11], a[104:111], v117
    s_waitcnt lgkmcnt(1)
    s_barrier
    v_smfmac_f32_16x16x64_bf16 v[80:83], v[12:15], a[112:119], v117
    s_waitcnt vmcnt(7)
    ds_read_b64_tr_b16 v[72:73], v122 offset:10240
    ds_read_b64_tr_b16 v[74:75], v122 offset:10752
    v_smfmac_f32_16x16x64_bf16 v[84:87], v[12:15], a[120:127], v117
    ds_read_b64_tr_b16 v[76:77], v122 offset:11264
    ds_read_b64_tr_b16 v[78:79], v122 offset:11776
    v_smfmac_f32_16x16x64_bf16 v[80:83], v[16:19], a[128:135], v117
    ds_read_b128 v[8:11], v125 offset:18432
    v_smfmac_f32_16x16x64_bf16 v[84:87], v[16:19], a[136:143], v117
    s_waitcnt lgkmcnt(5)
    s_barrier
    s_waitcnt lgkmcnt(3)
    v_mfma_f32_16x16x32_bf16 v[0:3], v[72:75], v[64:67], 0
    ds_read_b128 v[56:59], v124 offset:12288
    s_waitcnt lgkmcnt(2)
    v_mfma_f32_16x16x32_bf16 v[0:3], v[76:79], v[68:71], v[0:3]
    ds_read_b128 v[12:15], v125 offset:19456
    v_smfmac_f32_16x16x64_bf16 v[80:83], v[20:23], a[144:151], v117
    ds_write_b32 v118, v108 offset:4096
    v_smfmac_f32_16x16x64_bf16 v[84:87], v[20:23], a[152:159], v117
    ds_write_b32 v118, v108 offset:6144
    v_add_f32_dpp v2, v0, v2 quad_perm:[0,1,0,1] row_mask:0xf bank_mask:0xf
    v_smfmac_f32_16x16x64_bf16 v[80:83], v[24:27], a[160:167], v117
    s_waitcnt lgkmcnt(3)
    v_max3_f32 v60, v56, v57, v58
    v_add_f32_dpp v3, v1, v3 quad_perm:[0,1,0,1] row_mask:0xf bank_mask:0xf
    v_smfmac_f32_16x16x64_bf16 v[84:87], v[24:27], a[168:175], v117
    v_max_f32 v60, v60, v59
    v_smfmac_f32_16x16x64_bf16 v[80:83], v[28:31], v[32:39], v117
    s_nop 0
    v_max_f32_dpp v60, v60, v60 quad_perm:[2,3,0,1] row_mask:0xf bank_mask:0xf
    v_smfmac_f32_16x16x64_bf16 v[84:87], v[28:31], v[40:47], v117
    v_max3_f32 v61, v60, v2, v3
    v_max3_f32 v62, v60, v2, v3
    v_mov_b64 v[64:65], 0
    v_mov_b64 v[66:67], 0
    v_permlane16_swap_b32 v61, v62
    v_max_f32 v60, v61, v62
    v_max_f32 v63, v61, v62
    v_pk_add_f32 v[80:81], v[80:81], v[82:83]
    v_pk_add_f32 v[84:85], v[84:85], v[86:87]
    v_permlane32_swap_b32 v60, v63
    v_max_f32 v61, v60, v63
    v_cvt_pk_bf16_f32 v114, v80, v81
    v_cvt_pk_bf16_f32 v115, v84, v85
    v_mul_f32_dpp v62, v61, v126 quad_perm:[2,3,2,3] row_mask:0xf bank_mask:0xf
    v_pk_fma_f32 v[2:3], v[2:3], s[28:29], v[62:63] op_sel_hi:[1,1,0]
    v_pk_fma_f32 v[56:57], v[56:57], s[28:29], v[62:63] op_sel_hi:[1,1,0]
    v_exp_f32 v2, v2
    v_exp_f32 v3, v3
    v_pk_fma_f32 v[58:59], v[58:59], s[28:29], v[62:63] op_sel_hi:[1,1,0]
    v_cvt_pk_bf16_f32 v80, v2, v3
    v_exp_f32 v56, v56
    v_cndmask_b32 v5, v113, v80, vcc
    v_cndmask_b32_dpp v4, v80, v113, vcc quad_perm:[2,3,2,3] row_mask:0xf bank_mask:0xf
    v_exp_f32 v57, v57
    v_exp_f32 v58, v58
    v_mfma_f32_16x16x16_bf16 v[76:79], v[4:5], v[104:105], 0
    v_cvt_pk_bf16_f32 v84, v56, v57
    v_exp_f32 v59, v59
    v_mfma_f32_16x16x16_bf16 v[72:75], v[4:5], v[114:115], 0
    v_cvt_pk_bf16_f32 v85, v58, v59
    v_mov_b32_dpp v86, v84 quad_perm:[2,3,0,1] row_mask:0xf bank_mask:0xf
    v_mov_b64 v[68:69], 0
    v_mov_b32_dpp v87, v85 quad_perm:[2,3,0,1] row_mask:0xf bank_mask:0xf
    v_mov_b64 v[70:71], 0
    v_mov_b64 v[80:81], 0
    v_mfma_f32_16x16x32_bf16 v[76:79], v[84:87], v[104:107], v[76:79]
    ds_read_b128 v[32:35], v125 offset:6144
    v_smfmac_f32_16x16x64_bf16 v[72:75], v[84:87], v[88:95], v117
    ds_read_b128 v[36:39], v125 offset:7168
    s_nop 2
    v_rcp_f32_dpp v60, v76 quad_perm:[2,3,2,3] row_mask:0xf bank_mask:0xf
    v_rcp_f32_dpp v61, v77 quad_perm:[2,3,2,3] row_mask:0xf bank_mask:0xf
    s_nop 1
    v_pk_mul_f32 v[72:73], v[72:73], v[60:61]
    v_pk_mul_f32 v[74:75], v[74:75], v[60:61]
    v_cvt_pk_bf16_f32 v56, v72, v73
    v_cvt_pk_bf16_f32 v57, v74, v75
    ds_write_b64 v121, v[56:57] offset:15360
    v_mov_b64 v[82:83], 0
    v_mov_b64 v[84:85], 0
    v_mov_b64 v[86:87], 0
    v_mov_b64 v[72:73], 0
    v_mov_b64 v[74:75], 0
    v_mov_b64 v[76:77], 0
    v_mov_b64 v[78:79], 0
    v_mov_b64 v[88:89], 0
    v_mov_b64 v[90:91], 0
    v_mov_b64 v[92:93], 0
    v_mov_b64 v[94:95], 0
    s_waitcnt vmcnt(6)
    s_waitcnt lgkmcnt(0)
    s_barrier
    ds_read_b64_tr_b16 v[96:97], v122 offset:14336
    ds_read_b64_tr_b16 v[98:99], v122 offset:14848
    ds_read_b64_tr_b16 v[100:101], v122 offset:15360
    ds_read_b64_tr_b16 v[102:103], v122 offset:15872
    ds_read_b128 v[40:43], v125 offset:16384
    ds_read_b128 v[44:47], v125 offset:17408
    s_waitcnt lgkmcnt(4)
    v_smfmac_f32_16x16x64_bf16 v[72:75], v[96:99], a[176:183], v117
    ds_read_b128 v[24:27], v125 offset:28672
    s_waitcnt lgkmcnt(3)
    v_smfmac_f32_16x16x64_bf16 v[72:75], v[100:103], a[192:199], v117
    ds_read_b128 v[28:31], v125 offset:29696
    v_smfmac_f32_16x16x64_bf16 v[76:79], v[96:99], a[184:191], v117
    ds_read_b128 v[56:59], v125 offset:30720
    v_smfmac_f32_16x16x64_bf16 v[76:79], v[100:103], a[200:207], v117
    ds_read_b128 v[60:63], v125 offset:31744
    v_add_f32 v72, v72, v74
    v_add_f32 v73, v73, v75
    v_cvt_pk_bf16_f32 v72, v72, v73
    v_smfmac_f32_16x16x64_bf16 v[80:83], v[96:99], a[208:215], v117
    global_store_dword v119, v72, s[16:17] offset:-4096 sc1
    s_nop 1
    v_add_f32 v76, v76, v78
    v_add_f32 v77, v77, v79
    v_cvt_pk_bf16_f32 v76, v76, v77
    v_smfmac_f32_16x16x64_bf16 v[80:83], v[100:103], a[224:231], v117
    global_store_dword v119, v76, s[32:33] offset:-4096 sc1
    v_smfmac_f32_16x16x64_bf16 v[84:87], v[96:99], a[216:223], v117
    v_smfmac_f32_16x16x64_bf16 v[84:87], v[100:103], a[232:239], v117
    v_add_f32 v80, v80, v82
    v_smfmac_f32_16x16x64_bf16 v[64:67], v[96:99], a[240:247], v117
    v_add_f32 v81, v81, v83
    v_cvt_pk_bf16_f32 v80, v80, v81
    v_smfmac_f32_16x16x64_bf16 v[64:67], v[100:103], v[48:55], v117
    global_store_dword v119, v80, s[16:17] offset:-2048 sc1
    v_add_f32 v84, v84, v86
    v_smfmac_f32_16x16x64_bf16 v[68:71], v[96:99], a[248:255], v117
    v_add_f32 v85, v85, v87
    v_cvt_pk_bf16_f32 v84, v84, v85
    v_smfmac_f32_16x16x64_bf16 v[68:71], v[100:103], v[32:39], v117
    s_waitcnt lgkmcnt(4)
    global_store_dword v119, v84, s[32:33] offset:-2048 sc1
    v_add_f32 v64, v64, v66
    v_smfmac_f32_16x16x64_bf16 v[88:91], v[96:99], v[40:47], v117
    s_waitcnt lgkmcnt(2)
    v_add_f32 v65, v65, v67
    v_cvt_pk_bf16_f32 v64, v64, v65
    v_smfmac_f32_16x16x64_bf16 v[88:91], v[100:103], v[24:31], v117
    global_store_dword v119, v64, s[16:17] offset:0 sc1
    v_add_f32 v68, v68, v70
    v_smfmac_f32_16x16x64_bf16 v[92:95], v[96:99], v[8:15], v117
    s_waitcnt lgkmcnt(0)
    v_add_f32 v69, v69, v71
    v_cvt_pk_bf16_f32 v68, v68, v69
    v_smfmac_f32_16x16x64_bf16 v[92:95], v[100:103], v[56:63], v117
    global_store_dword v119, v68, s[32:33] offset:0 sc1
    v_add_f32 v88, v88, v90
    v_add_f32 v89, v89, v91
    v_cvt_pk_bf16_f32 v88, v88, v89
    global_store_dword v119, v88, s[16:17] offset:2048 sc1
    s_mov_b32 m0, 4096
    ds_read_b128 v[32:35], v125 offset:0
    ds_read_b128 v[36:39], v125 offset:1024
    v_add_f32 v92, v92, v94
    v_add_f32 v93, v93, v95
    v_cvt_pk_bf16_f32 v92, v92, v93
    global_store_dword v119, v92, s[32:33] offset:2048 sc1
    ds_read_b128 v[40:43], v125 offset:8192
    ds_read_b128 v[44:47], v125 offset:9216
    ds_read_b128 v[48:51], v125 offset:2048
    ds_read_b128 v[52:55], v125 offset:3072
    ds_read_b128 v[96:99], v125 offset:10240
    ds_read_b128 v[100:103], v125 offset:11264
    v_mov_b64 v[64:65], 0
    v_mov_b64 v[66:67], 0
    v_mov_b64 v[68:69], 0
    v_mov_b64 v[70:71], 0
    v_mov_b64 v[72:73], 0
    v_mov_b64 v[74:75], 0
    v_mov_b64 v[76:77], 0
    v_mov_b64 v[78:79], 0
    v_mov_b64 v[80:81], 0
    v_mov_b64 v[82:83], 0
    v_mov_b64 v[84:85], 0
    v_mov_b64 v[86:87], 0
    s_waitcnt vmcnt(8)
    v_xor_b32 v112, 8, v109
    global_load_dword v0, v123, s[20:21] offset:0 sc1
    global_load_dword v1, v123, s[20:21] offset:256 sc1
    global_load_dword v2, v123, s[20:21] offset:512 sc1
    global_load_dword v3, v123, s[20:21] offset:768 sc1
    global_load_dword v4, v123, s[20:21] offset:1024 sc1
    global_load_dword v5, v123, s[20:21] offset:1280 sc1
    global_load_dword v6, v123, s[20:21] offset:1536 sc1
    global_load_dword v7, v123, s[20:21] offset:1792 sc1
    ds_read_b64 v[90:91], v109 offset:27648
    ds_read_b64 v[88:89], v112 offset:26624
    ds_read_b64 v[94:95], v109 offset:28160
    ds_read_b64 v[92:93], v112 offset:27136
    ds_read_b128 v[56:59], v111 offset:24576
    ds_read_b128 v[60:63], v111 offset:25600
    s_waitcnt lgkmcnt(2)
    v_swap_b32 v89, v90
    v_swap_b32 v93, v94
    s_waitcnt vmcnt(4)
    v_mfma_f32_16x16x32_bf16 v[24:27], v[104:107], v[0:3], 0
    v_max3_u32 v28, v0, v1, v2
    s_waitcnt vmcnt(0)
    v_mfma_f32_16x16x32_bf16 v[24:27], v[104:107], v[4:7], v[24:27]
    v_max3_u32 v29, v4, v5, v6
    v_max3_u32 v28, v28, v3, v7
    v_cmp_u_f32 vcc, v28, v29
    s_nop 4
    v_cvt_pk_bf16_f32 v114, v24, v24
    s_cbranch_vccnz Lpf_427
Lpj_428:
    global_store_short v120, v114, s[10:11] sc1
    s_branch Lhl2_378
Llast_379:
    global_store_short v120, v114, s[24:25] sc1
    s_branch L_fin
Lfa_380:
    s_waitcnt lgkmcnt(1)
    ds_read_b128 v[0:3], v118 offset:0
    ds_read_b128 v[4:7], v118 offset:2048
    global_load_lds_dwordx4 v127, s[10:11] sc1
    global_load_lds_dwordx4 v127, s[10:11] offset:2048 sc1
Lqb_382:
    ds_read_b128 v[8:11], v118 offset:1024
    ds_read_b128 v[12:15], v118 offset:3072
    v_smfmac_f32_16x16x64_bf16 v[72:75], v[24:27], v[32:39], v117
    v_max_u32 v112, v24, v28
    v_cmp_eq_u32 vcc, -1, v112
    v_smfmac_f32_16x16x64_bf16 v[72:75], v[28:31], v[40:47], v117
    v_smfmac_f32_16x16x64_bf16 v[76:79], v[24:27], v[48:55], v117
    s_cbranch_vccnz Lfb_381
    v_mov_b64 v[64:65], 0
    v_mov_b64 v[66:67], 0
    v_smfmac_f32_16x16x64_bf16 v[76:79], v[28:31], v[96:103], v117
    global_store_short v120, v108, s[12:13] sc1
    s_mov_b32 m0, 24576
    v_mov_b64 v[68:69], 0
    v_mov_b64 v[70:71], 0
    v_smfmac_f32_16x16x64_bf16 v[64:67], v[24:27], v[128:135], v117
    global_load_lds_dwordx4 v118, s[22:23] offset:0 sc1
    v_smfmac_f32_16x16x64_bf16 v[64:67], v[28:31], v[144:151], v117
    ds_read_b128 v[16:19], v118 offset:4096
    s_waitcnt lgkmcnt(1)
    v_cmp_u_f32 vcc, v8, v12
    v_smfmac_f32_16x16x64_bf16 v[68:71], v[24:27], v[136:143], v117
    global_store_short v120, v114, s[24:25] sc1
    ds_read_b128 v[20:23], v118 offset:6144
    v_smfmac_f32_16x16x64_bf16 v[68:71], v[28:31], v[152:159], v117
    s_cbranch_vccnz Lfs_388
Lbk_389:
    s_branch Lqj_384
Lfb_381:
    v_mov_b64 v[64:65], 0
    v_mov_b64 v[66:67], 0
    v_mov_b64 v[68:69], 0
    v_mov_b64 v[70:71], 0
    v_mov_b64 v[72:73], 0
    v_mov_b64 v[74:75], 0
    s_nop 0
    v_mov_b64 v[76:77], 0
    v_mov_b64 v[78:79], 0
Lr0_391:
    ds_read_b128 v[24:27], v118 offset:0
    ds_read_b128 v[28:31], v118 offset:2048
    global_load_lds_dwordx4 v127, s[10:11] sc1
    global_load_lds_dwordx4 v127, s[10:11] offset:2048 sc1
    s_waitcnt lgkmcnt(2)
    v_max_u32 v112, v0, v4
    v_cmp_eq_u32 vcc, -1, v112
    s_cbranch_vccz Lqa_383
    ds_read_b128 v[0:3], v118 offset:0
    ds_read_b128 v[4:7], v118 offset:2048
    global_load_lds_dwordx4 v127, s[10:11] sc1
    global_load_lds_dwordx4 v127, s[10:11] offset:2048 sc1
    s_waitcnt lgkmcnt(2)
    v_max_u32 v112, v24, v28
    v_cmp_eq_u32 vcc, -1, v112
    s_cbranch_vccz Lqb_382
    s_sub_u32 s27, s27, 1
    s_cbranch_scc0 Lr0_391
    s_branch L_fin
Lqa_383:
    ds_read_b128 v[8:11], v118 offset:1024
    ds_read_b128 v[12:15], v118 offset:3072
    v_smfmac_f32_16x16x64_bf16 v[64:67], v[0:3], v[128:135], v117
    v_smfmac_f32_16x16x64_bf16 v[64:67], v[4:7], v[144:151], v117
    v_smfmac_f32_16x16x64_bf16 v[68:71], v[0:3], v[136:143], v117
    v_smfmac_f32_16x16x64_bf16 v[68:71], v[4:7], v[152:159], v117
    global_store_short v120, v108, s[12:13] sc1
    s_mov_b32 m0, 24576
    v_smfmac_f32_16x16x64_bf16 v[72:75], v[0:3], v[32:39], v117
    global_load_lds_dwordx4 v118, s[22:23] offset:0 sc1
    v_smfmac_f32_16x16x64_bf16 v[72:75], v[4:7], v[40:47], v117
    ds_read_b128 v[16:19], v118 offset:4096
    s_waitcnt lgkmcnt(1)
    v_cmp_u_f32 vcc, v8, v12
    v_smfmac_f32_16x16x64_bf16 v[76:79], v[0:3], v[48:55], v117
    global_store_short v120, v114, s[24:25] sc1
    ds_read_b128 v[20:23], v118 offset:6144
    v_smfmac_f32_16x16x64_bf16 v[76:79], v[4:7], v[96:103], v117
    s_cbranch_vccnz Lfs_392
Lbk_393:
    s_branch Lqj_384
Lpf_402:
    global_load_dword v16, v123, s[18:19] offset:0 sc1
    global_load_dword v17, v123, s[18:19] offset:256 sc1
    global_load_dword v18, v123, s[18:19] offset:512 sc1
    global_load_dword v19, v123, s[18:19] offset:768 sc1
    global_load_dword v20, v123, s[18:19] offset:1024 sc1
    global_load_dword v21, v123, s[18:19] offset:1280 sc1
    global_load_dword v22, v123, s[18:19] offset:1536 sc1
    global_load_dword v23, v123, s[18:19] offset:1792 sc1
    global_load_dword v8, v123, s[18:19] offset:0 sc1
    global_load_dword v9, v123, s[18:19] offset:256 sc1
    global_load_dword v10, v123, s[18:19] offset:512 sc1
    global_load_dword v11, v123, s[18:19] offset:768 sc1
    global_load_dword v12, v123, s[18:19] offset:1024 sc1
    global_load_dword v13, v123, s[18:19] offset:1280 sc1
    global_load_dword v14, v123, s[18:19] offset:1536 sc1
    global_load_dword v15, v123, s[18:19] offset:1792 sc1
    s_waitcnt vmcnt(12)
    v_mfma_f32_16x16x32_bf16 v[24:27], v[104:107], v[16:19], 0
    v_max3_u32 v28, v16, v17, v18
    s_waitcnt vmcnt(8)
    v_mfma_f32_16x16x32_bf16 v[24:27], v[104:107], v[20:23], v[24:27]
    v_max3_u32 v29, v20, v21, v22
    v_max3_u32 v28, v28, v19, v23
    v_max_u32 v28, v28, v29
    v_cmp_eq_u32 vcc, -1, v28
    s_nop 3
    v_cvt_pk_bf16_f32 v114, v24, v24
    s_cbranch_vccz Lpj_403
Lpl_404:
    global_load_dword v16, v123, s[18:19] offset:0 sc1
    global_load_dword v17, v123, s[18:19] offset:256 sc1
    global_load_dword v18, v123, s[18:19] offset:512 sc1
    global_load_dword v19, v123, s[18:19] offset:768 sc1
    global_load_dword v20, v123, s[18:19] offset:1024 sc1
    global_load_dword v21, v123, s[18:19] offset:1280 sc1
    global_load_dword v22, v123, s[18:19] offset:1536 sc1
    global_load_dword v23, v123, s[18:19] offset:1792 sc1
    s_waitcnt vmcnt(12)
    v_mfma_f32_16x16x32_bf16 v[24:27], v[104:107], v[8:11], 0
    v_max3_u32 v28, v8, v9, v10
    s_waitcnt vmcnt(8)
    v_mfma_f32_16x16x32_bf16 v[24:27], v[104:107], v[12:15], v[24:27]
    v_max3_u32 v29, v12, v13, v14
    v_max3_u32 v28, v28, v11, v15
    v_max_u32 v28, v28, v29
    v_cmp_eq_u32 vcc, -1, v28
    s_nop 3
    v_cvt_pk_bf16_f32 v114, v24, v24
    s_cbranch_vccz Lpj_403
    global_load_dword v8, v123, s[18:19] offset:0 sc1
    global_load_dword v9, v123, s[18:19] offset:256 sc1
    global_load_dword v10, v123, s[18:19] offset:512 sc1
    global_load_dword v11, v123, s[18:19] offset:768 sc1
    global_load_dword v12, v123, s[18:19] offset:1024 sc1
    global_load_dword v13, v123, s[18:19] offset:1280 sc1
    global_load_dword v14, v123, s[18:19] offset:1536 sc1
    global_load_dword v15, v123, s[18:19] offset:1792 sc1
    s_waitcnt vmcnt(12)
    v_mfma_f32_16x16x32_bf16 v[24:27], v[104:107], v[16:19], 0
    v_max3_u32 v28, v16, v17, v18
    s_waitcnt vmcnt(8)
    v_mfma_f32_16x16x32_bf16 v[24:27], v[104:107], v[20:23], v[24:27]
    v_max3_u32 v29, v20, v21, v22
    v_max3_u32 v28, v28, v19, v23
    v_max_u32 v28, v28, v29
    v_cmp_eq_u32 vcc, -1, v28
    s_nop 3
    v_cvt_pk_bf16_f32 v114, v24, v24
    s_cbranch_vccz Lpj_403
    s_sub_u32 s27, s27, 1
    s_cbranch_scc0 Lpl_404
    s_branch L_fin
Lfa_405:
    s_waitcnt lgkmcnt(1)
    ds_read_b128 v[0:3], v118 offset:0
    ds_read_b128 v[4:7], v118 offset:2048
    global_load_lds_dwordx4 v127, s[12:13] sc1
    global_load_lds_dwordx4 v127, s[12:13] offset:2048 sc1
Lqb_407:
    ds_read_b128 v[8:11], v118 offset:1024
    ds_read_b128 v[12:15], v118 offset:3072
    v_smfmac_f32_16x16x64_bf16 v[72:75], v[24:27], v[32:39], v117
    v_max_u32 v112, v24, v28
    v_cmp_eq_u32 vcc, -1, v112
    v_smfmac_f32_16x16x64_bf16 v[72:75], v[28:31], v[40:47], v117
    v_smfmac_f32_16x16x64_bf16 v[76:79], v[24:27], v[48:55], v117
    s_cbranch_vccnz Lfb_406
    v_mov_b64 v[64:65], 0
    v_mov_b64 v[66:67], 0
    v_smfmac_f32_16x16x64_bf16 v[76:79], v[28:31], v[96:103], v117
    global_store_short v120, v108, s[10:11] sc1
    s_mov_b32 m0, 24576
    v_mov_b64 v[68:69], 0
    v_mov_b64 v[70:71], 0
    v_smfmac_f32_16x16x64_bf16 v[64:67], v[24:27], v[128:135], v117
    global_load_lds_dwordx4 v118, s[22:23] offset:0 sc1
    v_smfmac_f32_16x16x64_bf16 v[64:67], v[28:31], v[144:151], v117
    ds_read_b128 v[16:19], v118 offset:4096
    s_waitcnt lgkmcnt(1)
    v_cmp_u_f32 vcc, v8, v12
    v_smfmac_f32_16x16x64_bf16 v[68:71], v[24:27], v[136:143], v117
    global_store_short v120, v114, s[24:25] sc1
    ds_read_b128 v[20:23], v118 offset:6144
    v_smfmac_f32_16x16x64_bf16 v[68:71], v[28:31], v[152:159], v117
    s_cbranch_vccnz Lfs_413
Lbk_414:
    s_branch Lqj_409
Lfb_406:
    v_mov_b64 v[64:65], 0
    v_mov_b64 v[66:67], 0
    v_mov_b64 v[68:69], 0
    v_mov_b64 v[70:71], 0
    v_mov_b64 v[72:73], 0
    v_mov_b64 v[74:75], 0
    s_nop 0
    v_mov_b64 v[76:77], 0
    v_mov_b64 v[78:79], 0
Lr0_416:
    ds_read_b128 v[24:27], v118 offset:0
    ds_read_b128 v[28:31], v118 offset:2048
    global_load_lds_dwordx4 v127, s[12:13] sc1
    global_load_lds_dwordx4 v127, s[12:13] offset:2048 sc1
    s_waitcnt lgkmcnt(2)
    v_max_u32 v112, v0, v4
    v_cmp_eq_u32 vcc, -1, v112
    s_cbranch_vccz Lqa_408
    ds_read_b128 v[0:3], v118 offset:0
    ds_read_b128 v[4:7], v118 offset:2048
    global_load_lds_dwordx4 v127, s[12:13] sc1
    global_load_lds_dwordx4 v127, s[12:13] offset:2048 sc1
    s_waitcnt lgkmcnt(2)
    v_max_u32 v112, v24, v28
    v_cmp_eq_u32 vcc, -1, v112
    s_cbranch_vccz Lqb_407
    s_sub_u32 s27, s27, 1
    s_cbranch_scc0 Lr0_416
    s_branch L_fin
Lqa_408:
    ds_read_b128 v[8:11], v118 offset:1024
    ds_read_b128 v[12:15], v118 offset:3072
    v_smfmac_f32_16x16x64_bf16 v[64:67], v[0:3], v[128:135], v117
    v_smfmac_f32_16x16x64_bf16 v[64:67], v[4:7], v[144:151], v117
    v_smfmac_f32_16x16x64_bf16 v[68:71], v[0:3], v[136:143], v117
    v_smfmac_f32_16x16x64_bf16 v[68:71], v[4:7], v[152:159], v117
    global_store_short v120, v108, s[10:11] sc1
    s_mov_b32 m0, 24576
    v_smfmac_f32_16x16x64_bf16 v[72:75], v[0:3], v[32:39], v117
    global_load_lds_dwordx4 v118, s[22:23] offset:0 sc1
    v_smfmac_f32_16x16x64_bf16 v[72:75], v[4:7], v[40:47], v117
    ds_read_b128 v[16:19], v118 offset:4096
    s_waitcnt lgkmcnt(1)
    v_cmp_u_f32 vcc, v8, v12
    v_smfmac_f32_16x16x64_bf16 v[76:79], v[0:3], v[48:55], v117
    global_store_short v120, v114, s[24:25] sc1
    ds_read_b128 v[20:23], v118 offset:6144
    v_smfmac_f32_16x16x64_bf16 v[76:79], v[4:7], v[96:103], v117
    s_cbranch_vccnz Lfs_417
Lbk_418:
    s_branch Lqj_409
Lpf_427:
    global_load_dword v16, v123, s[20:21] offset:0 sc1
    global_load_dword v17, v123, s[20:21] offset:256 sc1
    global_load_dword v18, v123, s[20:21] offset:512 sc1
    global_load_dword v19, v123, s[20:21] offset:768 sc1
    global_load_dword v20, v123, s[20:21] offset:1024 sc1
    global_load_dword v21, v123, s[20:21] offset:1280 sc1
    global_load_dword v22, v123, s[20:21] offset:1536 sc1
    global_load_dword v23, v123, s[20:21] offset:1792 sc1
    global_load_dword v8, v123, s[20:21] offset:0 sc1
    global_load_dword v9, v123, s[20:21] offset:256 sc1
    global_load_dword v10, v123, s[20:21] offset:512 sc1
    global_load_dword v11, v123, s[20:21] offset:768 sc1
    global_load_dword v12, v123, s[20:21] offset:1024 sc1
    global_load_dword v13, v123, s[20:21] offset:1280 sc1
    global_load_dword v14, v123, s[20:21] offset:1536 sc1
    global_load_dword v15, v123, s[20:21] offset:1792 sc1
    s_waitcnt vmcnt(12)
    v_mfma_f32_16x16x32_bf16 v[24:27], v[104:107], v[16:19], 0
    v_max3_u32 v28, v16, v17, v18
    s_waitcnt vmcnt(8)
    v_mfma_f32_16x16x32_bf16 v[24:27], v[104:107], v[20:23], v[24:27]
    v_max3_u32 v29, v20, v21, v22
    v_max3_u32 v28, v28, v19, v23
    v_max_u32 v28, v28, v29
    v_cmp_eq_u32 vcc, -1, v28
    s_nop 3
    v_cvt_pk_bf16_f32 v114, v24, v24
    s_cbranch_vccz Lpj_428
Lpl_429:
    global_load_dword v16, v123, s[20:21] offset:0 sc1
    global_load_dword v17, v123, s[20:21] offset:256 sc1
    global_load_dword v18, v123, s[20:21] offset:512 sc1
    global_load_dword v19, v123, s[20:21] offset:768 sc1
    global_load_dword v20, v123, s[20:21] offset:1024 sc1
    global_load_dword v21, v123, s[20:21] offset:1280 sc1
    global_load_dword v22, v123, s[20:21] offset:1536 sc1
    global_load_dword v23, v123, s[20:21] offset:1792 sc1
    s_waitcnt vmcnt(12)
    v_mfma_f32_16x16x32_bf16 v[24:27], v[104:107], v[8:11], 0
    v_max3_u32 v28, v8, v9, v10
    s_waitcnt vmcnt(8)
    v_mfma_f32_16x16x32_bf16 v[24:27], v[104:107], v[12:15], v[24:27]
    v_max3_u32 v29, v12, v13, v14
    v_max3_u32 v28, v28, v11, v15
    v_max_u32 v28, v28, v29
    v_cmp_eq_u32 vcc, -1, v28
    s_nop 3
    v_cvt_pk_bf16_f32 v114, v24, v24
    s_cbranch_vccz Lpj_428
    global_load_dword v8, v123, s[20:21] offset:0 sc1
    global_load_dword v9, v123, s[20:21] offset:256 sc1
    global_load_dword v10, v123, s[20:21] offset:512 sc1
    global_load_dword v11, v123, s[20:21] offset:768 sc1
    global_load_dword v12, v123, s[20:21] offset:1024 sc1
    global_load_dword v13, v123, s[20:21] offset:1280 sc1
    global_load_dword v14, v123, s[20:21] offset:1536 sc1
    global_load_dword v15, v123, s[20:21] offset:1792 sc1
    s_waitcnt vmcnt(12)
    v_mfma_f32_16x16x32_bf16 v[24:27], v[104:107], v[16:19], 0
    v_max3_u32 v28, v16, v17, v18
    s_waitcnt vmcnt(8)
    v_mfma_f32_16x16x32_bf16 v[24:27], v[104:107], v[20:23], v[24:27]
    v_max3_u32 v29, v20, v21, v22
    v_max3_u32 v28, v28, v19, v23
    v_max_u32 v28, v28, v29
    v_cmp_eq_u32 vcc, -1, v28
    s_nop 3
    v_cvt_pk_bf16_f32 v114, v24, v24
    s_cbranch_vccz Lpj_428
    s_sub_u32 s27, s27, 1
    s_cbranch_scc0 Lpl_429
    s_branch L_fin
Lfs_385:
Lfl_387:
    ds_read_b128 v[8:11], v118 offset:1024
    ds_read_b128 v[12:15], v118 offset:3072
    s_sub_u32 s27, s27, 1
    s_waitcnt lgkmcnt(0)
    v_max_u32 v112, v8, v12
    v_cmp_eq_u32 vcc, -1, v112
    s_cbranch_vccz Lbk_386
    s_cbranch_scc0 Lfl_387
    s_branch L_fin
Lfs_388:
Lfl_390:
    ds_read_b128 v[8:11], v118 offset:1024
    ds_read_b128 v[12:15], v118 offset:3072
    s_sub_u32 s27, s27, 1
    s_waitcnt lgkmcnt(0)
    v_max_u32 v112, v8, v12
    v_cmp_eq_u32 vcc, -1, v112
    s_cbranch_vccz Lbk_389
    s_cbranch_scc0 Lfl_390
    s_branch L_fin
Lfs_392:
Lfl_394:
    ds_read_b128 v[8:11], v118 offset:1024
    ds_read_b128 v[12:15], v118 offset:3072
    s_sub_u32 s27, s27, 1
    s_waitcnt lgkmcnt(0)
    v_max_u32 v112, v8, v12
    v_cmp_eq_u32 vcc, -1, v112
    s_cbranch_vccz Lbk_393
    s_cbranch_scc0 Lfl_394
    s_branch L_fin
Lfs_395:
Lfl_397:
    ds_read_b128 v[16:19], v118 offset:4096
    ds_read_b128 v[20:23], v118 offset:6144
    s_sub_u32 s27, s27, 1
    s_waitcnt lgkmcnt(0)
    v_max_u32 v112, v16, v20
    v_cmp_eq_u32 vcc, -1, v112
    s_cbranch_vccz Lbk_396
    s_waitcnt vmcnt(4)
    ds_read_b128 v[16:19], v118 offset:4096
    ds_read_b128 v[20:23], v118 offset:6144
    s_sub_u32 s27, s27, 1
    s_waitcnt lgkmcnt(0)
    v_max_u32 v112, v16, v20
    v_cmp_eq_u32 vcc, -1, v112
    s_cbranch_vccz Lbk_396
Lfl_398:
    s_mov_b32 s40, m0
    s_mov_b32 m0, 4096
    s_nop 0
    global_load_lds_dwordx4 v127, s[10:11] sc1
    global_load_lds_dwordx4 v127, s[10:11] offset:2048 sc1
    s_waitcnt vmcnt(0)
    s_mov_b32 m0, s40
    ds_read_b128 v[16:19], v118 offset:4096
    ds_read_b128 v[20:23], v118 offset:6144
    s_sub_u32 s27, s27, 1
    s_waitcnt lgkmcnt(0)
    v_max_u32 v112, v16, v20
    v_cmp_eq_u32 vcc, -1, v112
    s_cbranch_vccz Lbk_396
    s_cbranch_scc0 Lfl_398
    s_branch L_fin
Lfs_399:
Lfl_401:
    ds_read_b128 v[24:27], v118 offset:5120
    ds_read_b128 v[28:31], v118 offset:7168
    s_sub_u32 s27, s27, 1
    s_waitcnt lgkmcnt(0)
    v_max_u32 v112, v24, v28
    v_cmp_eq_u32 vcc, -1, v112
    s_cbranch_vccz Lbk_400
    s_cbranch_scc0 Lfl_401
    s_branch L_fin
Lfs_410:
Lfl_412:
    ds_read_b128 v[8:11], v118 offset:1024
    ds_read_b128 v[12:15], v118 offset:3072
    s_sub_u32 s27, s27, 1
    s_waitcnt lgkmcnt(0)
    v_max_u32 v112, v8, v12
    v_cmp_eq_u32 vcc, -1, v112
    s_cbranch_vccz Lbk_411
    s_cbranch_scc0 Lfl_412
    s_branch L_fin
Lfs_413:
Lfl_415:
    ds_read_b128 v[8:11], v118 offset:1024
    ds_read_b128 v[12:15], v118 offset:3072
    s_sub_u32 s27, s27, 1
    s_waitcnt lgkmcnt(0)
    v_max_u32 v112, v8, v12
    v_cmp_eq_u32 vcc, -1, v112
    s_cbranch_vccz Lbk_414
    s_cbranch_scc0 Lfl_415
    s_branch L_fin
Lfs_417:
Lfl_419:
    ds_read_b128 v[8:11], v118 offset:1024
    ds_read_b128 v[12:15], v118 offset:3072
    s_sub_u32 s27, s27, 1
    s_waitcnt lgkmcnt(0)
    v_max_u32 v112, v8, v12
    v_cmp_eq_u32 vcc, -1, v112
    s_cbranch_vccz Lbk_418
    s_cbranch_scc0 Lfl_419
    s_branch L_fin
Lfs_420:
Lfl_422:
    ds_read_b128 v[16:19], v118 offset:4096
    ds_read_b128 v[20:23], v118 offset:6144
    s_sub_u32 s27, s27, 1
    s_waitcnt lgkmcnt(0)
    v_max_u32 v112, v16, v20
    v_cmp_eq_u32 vcc, -1, v112
    s_cbranch_vccz Lbk_421
    s_waitcnt vmcnt(4)
    ds_read_b128 v[16:19], v118 offset:4096
    ds_read_b128 v[20:23], v118 offset:6144
    s_sub_u32 s27, s27, 1
    s_waitcnt lgkmcnt(0)
    v_max_u32 v112, v16, v20
    v_cmp_eq_u32 vcc, -1, v112
    s_cbranch_vccz Lbk_421
Lfl_423:
    s_mov_b32 s40, m0
    s_mov_b32 m0, 4096
    s_nop 0
    global_load_lds_dwordx4 v127, s[12:13] sc1
    global_load_lds_dwordx4 v127, s[12:13] offset:2048 sc1
    s_waitcnt vmcnt(0)
    s_mov_b32 m0, s40
    ds_read_b128 v[16:19], v118 offset:4096
    ds_read_b128 v[20:23], v118 offset:6144
    s_sub_u32 s27, s27, 1
    s_waitcnt lgkmcnt(0)
    v_max_u32 v112, v16, v20
    v_cmp_eq_u32 vcc, -1, v112
    s_cbranch_vccz Lbk_421
    s_cbranch_scc0 Lfl_423
    s_branch L_fin
Lfs_424:
Lfl_426:
    ds_read_b128 v[24:27], v118 offset:5120
    ds_read_b128 v[28:31], v118 offset:7168
    s_sub_u32 s27, s27, 1
    s_waitcnt lgkmcnt(0)
    v_max_u32 v112, v24, v28
    v_cmp_eq_u32 vcc, -1, v112
    s_cbranch_vccz Lbk_425
    s_cbranch_scc0 Lfl_426
    s_branch L_fin
Lwv_267:
    s_mov_b32 m0, 5120
    ds_read_b128 v[32:35], v125 offset:0
    ds_read_b128 v[36:39], v125 offset:1024
    ds_read_b128 v[40:43], v125 offset:8192
    ds_read_b128 v[44:47], v125 offset:9216
    ds_read_b128 v[48:51], v125 offset:2048
    ds_read_b128 v[52:55], v125 offset:3072
    ds_read_b128 v[96:99], v125 offset:10240
    ds_read_b128 v[100:103], v125 offset:11264
    v_mov_b64 v[64:65], 0
    v_mov_b64 v[66:67], 0
    v_mov_b64 v[68:69], 0
    v_mov_b64 v[70:71], 0
    v_mov_b64 v[72:73], 0
    v_mov_b64 v[74:75], 0
    v_mov_b64 v[76:77], 0
    v_mov_b64 v[78:79], 0
    v_mov_b64 v[80:81], 0
    v_mov_b64 v[82:83], 0
    v_mov_b64 v[84:85], 0
    v_mov_b64 v[86:87], 0
    v_xor_b32 v112, 8, v109
    ds_read_b64 v[90:91], v109 offset:31744
    ds_read_b64 v[88:89], v112 offset:30720
    ds_read_b64 v[94:95], v109 offset:32256
    ds_read_b64 v[92:93], v112 offset:31232
    ds_read_b128 v[56:59], v111 offset:28672
    ds_read_b128 v[60:63], v111 offset:29696
    s_waitcnt lgkmcnt(2)
    v_swap_b32 v89, v90
    v_swap_b32 v93, v94
    v_and_b32 v116, 768, v118
Lhl3_430:
    s_waitcnt vmcnt(0)
    global_load_lds_dwordx4 v127, s[10:11] sc1
    global_load_lds_dwordx4 v127, s[10:11] offset:2048 sc1
    s_barrier
    ds_read_b128 v[0:3], v118 offset:0
    ds_read_b128 v[4:7], v118 offset:2048
    global_load_lds_dwordx4 v127, s[10:11] sc1
    global_load_lds_dwordx4 v127, s[10:11] offset:2048 sc1
    s_waitcnt lgkmcnt(1)
    v_smfmac_f32_16x16x64_bf16 v[64:67], v[0:3], v[128:135], v117
    ds_read_b128 v[24:27], v118 offset:0
    ds_read_b128 v[8:11], v118 offset:1024
    s_waitcnt lgkmcnt(2)
    v_smfmac_f32_16x16x64_bf16 v[64:67], v[4:7], v[144:151], v117
    ds_read_b128 v[28:31], v118 offset:2048
    ds_read_b128 v[12:15], v118 offset:3072
    v_cmp_u_f32 vcc, v0, v4
    v_smfmac_f32_16x16x64_bf16 v[68:71], v[0:3], v[136:143], v117
    v_smfmac_f32_16x16x64_bf16 v[68:71], v[4:7], v[152:159], v117
    s_cbranch_vccnz Lfa_432
    global_store_short v120, v108, s[12:13] sc1
    s_mov_b32 m0, 28672
    v_smfmac_f32_16x16x64_bf16 v[72:75], v[0:3], v[32:39], v117
    global_load_lds_dwordx4 v118, s[22:23] offset:0 sc1
    v_smfmac_f32_16x16x64_bf16 v[72:75], v[4:7], v[40:47], v117
    ds_read_b128 v[16:19], v118 offset:4096
    s_waitcnt lgkmcnt(1)
    v_cmp_u_f32 vcc, v8, v12
    v_smfmac_f32_16x16x64_bf16 v[76:79], v[0:3], v[48:55], v117
    global_store_short v120, v114, s[24:25] sc1
    ds_read_b128 v[20:23], v118 offset:6144
    v_smfmac_f32_16x16x64_bf16 v[76:79], v[4:7], v[96:103], v117
    s_cbranch_vccnz Lfs_437
Lbk_438:
Lqj_436:
    v_smfmac_f32_16x16x64_bf16 v[64:67], v[8:11], v[160:167], v117
    ds_read_b128 v[96:99], v125 offset:12288
    ds_read_b128 v[44:47], v125 offset:15360
    v_smfmac_f32_16x16x64_bf16 v[64:67], v[12:15], v[176:183], v117
    global_load_lds_dwordx4 v118, s[22:23] offset:1024 sc1
    ds_read_b128 v[100:103], v125 offset:13312
    v_smfmac_f32_16x16x64_bf16 v[68:71], v[8:11], v[168:175], v117
    ds_read_b128 v[24:27], v118 offset:5120
    s_waitcnt lgkmcnt(4)
    v_cmp_u_f32 vcc, v16, v20
    v_smfmac_f32_16x16x64_bf16 v[68:71], v[12:15], v[184:191], v117
    ds_read_b128 v[28:31], v118 offset:7168
    ds_read_b128 v[40:43], v125 offset:14336
    v_smfmac_f32_16x16x64_bf16 v[72:75], v[8:11], a[0:7], v117
    s_cbranch_vccnz Lfs_447
Lbk_448:
    ds_read_b128 v[32:35], v125 offset:20480
    v_smfmac_f32_16x16x64_bf16 v[64:67], v[16:19], v[192:199], v117
    s_add_u32 s24, s24, 8192
    s_addc_u32 s25, s25, 0
    ds_read_b128 v[36:39], v125 offset:21504
    v_smfmac_f32_16x16x64_bf16 v[64:67], v[20:23], v[208:215], v117
    global_load_lds_dwordx4 v118, s[22:23] offset:2048 sc1
    ds_read_b128 v[48:51], v125 offset:22528
    v_smfmac_f32_16x16x64_bf16 v[68:71], v[16:19], v[200:207], v117
    s_add_u32 s26, s26, 1
    s_waitcnt lgkmcnt(4)
    v_cmp_u_f32 vcc, v24, v28
    v_smfmac_f32_16x16x64_bf16 v[68:71], v[20:23], v[216:223], v117
    ds_read_b128 v[52:55], v125 offset:23552
    v_smfmac_f32_16x16x64_bf16 v[72:75], v[16:19], v[96:103], v117
    s_cbranch_vccnz Lfs_450
Lbk_451:
    v_smfmac_f32_16x16x64_bf16 v[64:67], v[24:27], v[224:231], v117
    s_mov_b64 vcc, s[64:65]
    v_smfmac_f32_16x16x64_bf16 v[64:67], v[28:31], v[240:247], v117
    global_load_lds_dwordx4 v118, s[22:23] offset:3072 sc1
    v_smfmac_f32_16x16x64_bf16 v[68:71], v[24:27], v[232:239], v117
    s_add_u32 s22, s22, 524288
    s_addc_u32 s23, s23, 0
    v_smfmac_f32_16x16x64_bf16 v[68:71], v[28:31], v[248:255], v117
    s_waitcnt lgkmcnt(2)
    v_add_f32 v64, v64, v66
    v_smfmac_f32_16x16x64_bf16 v[72:75], v[20:23], v[32:39], v117
    ds_read_b128 v[32:35], v125 offset:24576
    v_add_f32 v65, v65, v67
    v_smfmac_f32_16x16x64_bf16 v[72:75], v[12:15], a[16:23], v117
    ds_read_b128 v[36:39], v125 offset:25600
    v_cvt_pk_bf16_f32 v102, v64, v65
    v_add_f32 v68, v68, v70
    v_smfmac_f32_16x16x64_bf16 v[72:75], v[24:27], a[32:39], v117
    ds_write_b32 v121, v102 offset:9220
    v_add_f32 v69, v69, v71
    v_cvt_pk_bf16_f32 v103, v68, v69
    v_smfmac_f32_16x16x64_bf16 v[72:75], v[28:31], a[48:55], v117
    ds_write_b32 v121, v103 offset:9732
    v_smfmac_f32_16x16x64_bf16 v[76:79], v[16:19], v[40:47], v117
    ds_read_b128 v[40:43], v125 offset:26624
    s_waitcnt lgkmcnt(5)
    v_smfmac_f32_16x16x64_bf16 v[76:79], v[20:23], v[48:55], v117
    ds_read_b128 v[44:47], v125 offset:27648
    v_add_f32 v72, v72, v74
    v_smfmac_f32_16x16x64_bf16 v[76:79], v[8:11], a[8:15], v117
    ds_read_b128 v[48:51], v125 offset:4096
    v_smfmac_f32_16x16x64_bf16 v[76:79], v[12:15], a[24:31], v117
    s_waitcnt lgkmcnt(3)
    s_barrier
    v_smfmac_f32_16x16x64_bf16 v[76:79], v[24:27], a[40:47], v117
    ds_read_b64_tr_b16 v[64:65], v122 offset:8192
    ds_read_b64_tr_b16 v[66:67], v122 offset:8704
    v_smfmac_f32_16x16x64_bf16 v[76:79], v[28:31], a[56:63], v117
    ds_read_b64_tr_b16 v[68:69], v122 offset:9216
    ds_read_b64_tr_b16 v[70:71], v122 offset:9728
    v_add_f32 v73, v73, v75
    v_cvt_pk_bf16_f32 v100, v72, v73
    v_smfmac_f32_16x16x64_bf16 v[80:83], v[0:3], a[64:71], v117
    ds_write_b32 v121, v100 offset:11268
    v_smfmac_f32_16x16x64_bf16 v[84:87], v[0:3], a[72:79], v117
    s_waitcnt lgkmcnt(3)
    ds_read_b128 v[52:55], v125 offset:5120
    v_add_f32 v76, v76, v78
    v_mfma_f32_16x16x32_bf16 v[96:99], v[56:59], v[64:67], 0
    s_waitcnt lgkmcnt(2)
    v_add_f32 v77, v77, v79
    v_cvt_pk_bf16_f32 v101, v76, v77
    v_mfma_f32_16x16x32_bf16 v[96:99], v[60:63], v[68:71], v[96:99]
    ds_write_b32 v121, v101 offset:11780
    v_smfmac_f32_16x16x64_bf16 v[80:83], v[4:7], a[80:87], v117
    s_mov_b32 exec_hi, 0
    global_store_dword v110, v108, s[20:21] sc1
    s_mov_b32 exec_hi, -1
    v_smfmac_f32_16x16x64_bf16 v[84:87], v[4:7], a[88:95], v117
    v_add_f32_dpp v96, v98, v96 quad_perm:[2,3,2,3] row_mask:0xf bank_mask:0xf
    v_add_f32_dpp v97, v99, v97 quad_perm:[2,3,2,3] row_mask:0xf bank_mask:0xf
    v_smfmac_f32_16x16x64_bf16 v[80:83], v[8:11], a[96:103], v117
    ds_write_b64 v109, v[96:97] offset:13824
    v_smfmac_f32_16x16x64_bf16 v[84:87], v[8:11], a[104:111], v117
    s_waitcnt lgkmcnt(1)
    s_barrier
    v_smfmac_f32_16x16x64_bf16 v[80:83], v[12:15], a[112:119], v117
    s_waitcnt vmcnt(7)
    ds_read_b64_tr_b16 v[72:73], v122 offset:10240
    ds_read_b64_tr_b16 v[74:75], v122 offset:10752
    v_smfmac_f32_16x16x64_bf16 v[84:87], v[12:15], a[120:127], v117
    ds_read_b64_tr_b16 v[76:77], v122 offset:11264
    ds_read_b64_tr_b16 v[78:79], v122 offset:11776
    v_smfmac_f32_16x16x64_bf16 v[80:83], v[16:19], a[128:135], v117
    ds_read_b128 v[8:11], v125 offset:18432
    v_smfmac_f32_16x16x64_bf16 v[84:87], v[16:19], a[136:143], v117
    s_waitcnt lgkmcnt(5)
    s_barrier
    s_waitcnt lgkmcnt(3)
    v_mfma_f32_16x16x32_bf16 v[0:3], v[72:75], v[64:67], 0
    ds_read_b128 v[56:59], v124 offset:12288
    s_waitcnt lgkmcnt(2)
    v_mfma_f32_16x16x32_bf16 v[0:3], v[76:79], v[68:71], v[0:3]
    ds_read_b128 v[12:15], v125 offset:19456
    v_smfmac_f32_16x16x64_bf16 v[80:83], v[20:23], a[144:151], v117
    ds_write_b32 v118, v108 offset:5120
    v_smfmac_f32_16x16x64_bf16 v[84:87], v[20:23], a[152:159], v117
    ds_write_b32 v118, v108 offset:7168
    v_add_f32_dpp v2, v0, v2 quad_perm:[0,1,0,1] row_mask:0xf bank_mask:0xf
    v_smfmac_f32_16x16x64_bf16 v[80:83], v[24:27], a[160:167], v117
    s_waitcnt lgkmcnt(3)
    v_max3_f32 v60, v56, v57, v58
    v_add_f32_dpp v3, v1, v3 quad_perm:[0,1,0,1] row_mask:0xf bank_mask:0xf
    v_smfmac_f32_16x16x64_bf16 v[84:87], v[24:27], a[168:175], v117
    v_max_f32 v60, v60, v59
    v_smfmac_f32_16x16x64_bf16 v[80:83], v[28:31], v[32:39], v117
    s_nop 0
    v_max_f32_dpp v60, v60, v60 quad_perm:[2,3,0,1] row_mask:0xf bank_mask:0xf
    v_smfmac_f32_16x16x64_bf16 v[84:87], v[28:31], v[40:47], v117
    v_max3_f32 v61, v60, v2, v3
    v_max3_f32 v62, v60, v2, v3
    v_mov_b64 v[64:65], 0
    v_mov_b64 v[66:67], 0
    v_permlane16_swap_b32 v61, v62
    v_max_f32 v60, v61, v62
    v_max_f32 v63, v61, v62
    v_pk_add_f32 v[80:81], v[80:81], v[82:83]
    v_pk_add_f32 v[84:85], v[84:85], v[86:87]
    v_permlane32_swap_b32 v60, v63
    v_max_f32 v61, v60, v63
    v_cvt_pk_bf16_f32 v114, v80, v81
    v_cvt_pk_bf16_f32 v115, v84, v85
    v_mul_f32_dpp v62, v61, v126 quad_perm:[2,3,2,3] row_mask:0xf bank_mask:0xf
    v_pk_fma_f32 v[2:3], v[2:3], s[28:29], v[62:63] op_sel_hi:[1,1,0]
    v_pk_fma_f32 v[56:57], v[56:57], s[28:29], v[62:63] op_sel_hi:[1,1,0]
    v_exp_f32 v2, v2
    v_exp_f32 v3, v3
    v_pk_fma_f32 v[58:59], v[58:59], s[28:29], v[62:63] op_sel_hi:[1,1,0]
    v_cvt_pk_bf16_f32 v80, v2, v3
    v_exp_f32 v56, v56
    v_cndmask_b32 v5, v113, v80, vcc
    v_cndmask_b32_dpp v4, v80, v113, vcc quad_perm:[2,3,2,3] row_mask:0xf bank_mask:0xf
    v_exp_f32 v57, v57
    v_exp_f32 v58, v58
    v_mfma_f32_16x16x16_bf16 v[76:79], v[4:5], v[104:105], 0
    v_cvt_pk_bf16_f32 v84, v56, v57
    v_exp_f32 v59, v59
    v_mfma_f32_16x16x16_bf16 v[72:75], v[4:5], v[114:115], 0
    v_cvt_pk_bf16_f32 v85, v58, v59
    v_mov_b32_dpp v86, v84 quad_perm:[2,3,0,1] row_mask:0xf bank_mask:0xf
    v_mov_b64 v[68:69], 0
    v_mov_b32_dpp v87, v85 quad_perm:[2,3,0,1] row_mask:0xf bank_mask:0xf
    v_mov_b64 v[70:71], 0
    v_mov_b64 v[80:81], 0
    v_mfma_f32_16x16x32_bf16 v[76:79], v[84:87], v[104:107], v[76:79]
    ds_read_b128 v[32:35], v125 offset:6144
    v_smfmac_f32_16x16x64_bf16 v[72:75], v[84:87], v[88:95], v117
    ds_read_b128 v[36:39], v125 offset:7168
    s_nop 2
    v_rcp_f32_dpp v60, v76 quad_perm:[2,3,2,3] row_mask:0xf bank_mask:0xf
    v_rcp_f32_dpp v61, v77 quad_perm:[2,3,2,3] row_mask:0xf bank_mask:0xf
    s_nop 1
    v_pk_mul_f32 v[72:73], v[72:73], v[60:61]
    v_pk_mul_f32 v[74:75], v[74:75], v[60:61]
    v_cvt_pk_bf16_f32 v56, v72, v73
    v_cvt_pk_bf16_f32 v57, v74, v75
    ds_write_b64 v121, v[56:57] offset:15872
    v_mov_b64 v[82:83], 0
    v_mov_b64 v[84:85], 0
    v_mov_b64 v[86:87], 0
    v_mov_b64 v[72:73], 0
    v_mov_b64 v[74:75], 0
    v_mov_b64 v[76:77], 0
    v_mov_b64 v[78:79], 0
    v_mov_b64 v[88:89], 0
    v_mov_b64 v[90:91], 0
    v_mov_b64 v[92:93], 0
    v_mov_b64 v[94:95], 0
    s_waitcnt vmcnt(6)
    s_waitcnt lgkmcnt(0)
    s_barrier
    ds_read_b64_tr_b16 v[96:97], v122 offset:14336
    ds_read_b64_tr_b16 v[98:99], v122 offset:14848
    ds_read_b64_tr_b16 v[100:101], v122 offset:15360
    ds_read_b64_tr_b16 v[102:103], v122 offset:15872
    ds_read_b128 v[40:43], v125 offset:16384
    ds_read_b128 v[44:47], v125 offset:17408
    s_waitcnt lgkmcnt(4)
    v_smfmac_f32_16x16x64_bf16 v[72:75], v[96:99], a[176:183], v117
    s_waitcnt lgkmcnt(2)
    v_smfmac_f32_16x16x64_bf16 v[72:75], v[100:103], a[192:199], v117
    ds_read_b128 v[24:27], v125 offset:28672
    v_smfmac_f32_16x16x64_bf16 v[76:79], v[96:99], a[184:191], v117
    ds_read_b128 v[28:31], v125 offset:29696
    v_smfmac_f32_16x16x64_bf16 v[76:79], v[100:103], a[200:207], v117
    ds_read_b128 v[56:59], v125 offset:30720
    v_add_f32 v72, v72, v74
    v_add_f32 v73, v73, v75
    v_cvt_pk_bf16_f32 v72, v72, v73
    v_smfmac_f32_16x16x64_bf16 v[80:83], v[96:99], a[208:215], v117
    global_store_dword v119, v72, s[14:15] offset:-4096 sc1
    ds_read_b128 v[60:63], v125 offset:31744
    s_nop 0
    v_add_f32 v76, v76, v78
    v_add_f32 v77, v77, v79
    v_cvt_pk_bf16_f32 v76, v76, v77
    v_smfmac_f32_16x16x64_bf16 v[80:83], v[100:103], a[224:231], v117
    global_store_dword v119, v76, s[30:31] offset:-4096 sc1
    v_smfmac_f32_16x16x64_bf16 v[84:87], v[96:99], a[216:223], v117
    v_smfmac_f32_16x16x64_bf16 v[84:87], v[100:103], a[232:239], v117
    v_add_f32 v80, v80, v82
    v_smfmac_f32_16x16x64_bf16 v[64:67], v[96:99], a[240:247], v117
    v_add_f32 v81, v81, v83
    v_cvt_pk_bf16_f32 v80, v80, v81
    v_smfmac_f32_16x16x64_bf16 v[64:67], v[100:103], v[48:55], v117
    global_store_dword v119, v80, s[14:15] offset:-2048 sc1
    v_add_f32 v84, v84, v86
    v_smfmac_f32_16x16x64_bf16 v[68:71], v[96:99], a[248:255], v117
    v_add_f32 v85, v85, v87
    v_cvt_pk_bf16_f32 v84, v84, v85
    v_smfmac_f32_16x16x64_bf16 v[68:71], v[100:103], v[32:39], v117
    s_waitcnt lgkmcnt(4)
    global_store_dword v119, v84, s[30:31] offset:-2048 sc1
    v_add_f32 v64, v64, v66
    v_smfmac_f32_16x16x64_bf16 v[88:91], v[96:99], v[40:47], v117
    s_waitcnt lgkmcnt(2)
    v_add_f32 v65, v65, v67
    v_cvt_pk_bf16_f32 v64, v64, v65
    v_smfmac_f32_16x16x64_bf16 v[88:91], v[100:103], v[24:31], v117
    global_store_dword v119, v64, s[14:15] offset:0 sc1
    v_add_f32 v68, v68, v70
    v_smfmac_f32_16x16x64_bf16 v[92:95], v[96:99], v[8:15], v117
    s_waitcnt lgkmcnt(0)
    v_add_f32 v69, v69, v71
    v_cvt_pk_bf16_f32 v68, v68, v69
    v_smfmac_f32_16x16x64_bf16 v[92:95], v[100:103], v[56:63], v117
    global_store_dword v119, v68, s[30:31] offset:0 sc1
    v_add_f32 v88, v88, v90
    v_add_f32 v89, v89, v91
    v_cvt_pk_bf16_f32 v88, v88, v89
    global_store_dword v119, v88, s[14:15] offset:2048 sc1
    s_mov_b32 m0, 5120
    ds_read_b128 v[32:35], v125 offset:0
    ds_read_b128 v[36:39], v125 offset:1024
    v_add_f32 v92, v92, v94
    v_add_f32 v93, v93, v95
    v_cvt_pk_bf16_f32 v92, v92, v93
    global_store_dword v119, v92, s[30:31] offset:2048 sc1
    ds_read_b128 v[40:43], v125 offset:8192
    ds_read_b128 v[44:47], v125 offset:9216
    ds_read_b128 v[48:51], v125 offset:2048
    ds_read_b128 v[52:55], v125 offset:3072
    ds_read_b128 v[96:99], v125 offset:10240
    ds_read_b128 v[100:103], v125 offset:11264
    v_mov_b64 v[64:65], 0
    v_mov_b64 v[66:67], 0
    v_mov_b64 v[68:69], 0
    v_mov_b64 v[70:71], 0
    v_mov_b64 v[72:73], 0
    v_mov_b64 v[74:75], 0
    v_mov_b64 v[76:77], 0
    v_mov_b64 v[78:79], 0
    v_mov_b64 v[80:81], 0
    v_mov_b64 v[82:83], 0
    v_mov_b64 v[84:85], 0
    v_mov_b64 v[86:87], 0
    s_waitcnt vmcnt(8)
    v_xor_b32 v112, 8, v109
    ds_read_b64 v[90:91], v109 offset:31744
    ds_read_b64 v[88:89], v112 offset:30720
    ds_read_b64 v[94:95], v109 offset:32256
    ds_read_b64 v[92:93], v112 offset:31232
    ds_read_b128 v[56:59], v111 offset:28672
    ds_read_b128 v[60:63], v111 offset:29696
    s_waitcnt lgkmcnt(2)
    v_swap_b32 v89, v90
    v_swap_b32 v93, v94
    global_load_dword v0, v123, s[18:19] offset:0 sc1
    global_load_dword v1, v123, s[18:19] offset:256 sc1
    global_load_dword v2, v123, s[18:19] offset:512 sc1
    global_load_dword v3, v123, s[18:19] offset:768 sc1
    global_load_dword v4, v123, s[18:19] offset:1024 sc1
    global_load_dword v5, v123, s[18:19] offset:1280 sc1
    global_load_dword v6, v123, s[18:19] offset:1536 sc1
    global_load_dword v7, v123, s[18:19] offset:1792 sc1
    s_waitcnt vmcnt(4)
    v_mfma_f32_16x16x32_bf16 v[24:27], v[104:107], v[0:3], 0
    v_max3_u32 v28, v0, v1, v2
    s_waitcnt vmcnt(0)
    v_mfma_f32_16x16x32_bf16 v[24:27], v[104:107], v[4:7], v[24:27]
    v_max3_u32 v29, v4, v5, v6
    v_max3_u32 v28, v28, v3, v7
    v_cmp_u_f32 vcc, v28, v29
    s_nop 4
    v_cvt_pk_bf16_f32 v114, v24, v24
    s_cbranch_vccnz Lpf_454
Lpj_455:
    global_store_short v120, v114, s[12:13] sc1
    s_cmp_eq_u32 s26, 63
    s_cbranch_scc1 Llast_431
    s_waitcnt vmcnt(0)
    global_load_lds_dwordx4 v127, s[12:13] sc1
    global_load_lds_dwordx4 v127, s[12:13] offset:2048 sc1
    s_barrier
    ds_read_b128 v[0:3], v118 offset:0
    ds_read_b128 v[4:7], v118 offset:2048
    global_load_lds_dwordx4 v127, s[12:13] sc1
    global_load_lds_dwordx4 v127, s[12:13] offset:2048 sc1
    s_waitcnt lgkmcnt(1)
    v_smfmac_f32_16x16x64_bf16 v[64:67], v[0:3], v[128:135], v117
    ds_read_b128 v[24:27], v118 offset:0
    ds_read_b128 v[8:11], v118 offset:1024
    s_waitcnt lgkmcnt(2)
    v_smfmac_f32_16x16x64_bf16 v[64:67], v[4:7], v[144:151], v117
    ds_read_b128 v[28:31], v118 offset:2048
    ds_read_b128 v[12:15], v118 offset:3072
    v_cmp_u_f32 vcc, v0, v4
    v_smfmac_f32_16x16x64_bf16 v[68:71], v[0:3], v[136:143], v117
    v_smfmac_f32_16x16x64_bf16 v[68:71], v[4:7], v[152:159], v117
    s_cbranch_vccnz Lfa_457
    global_store_short v120, v108, s[10:11] sc1
    s_mov_b32 m0, 28672
    v_smfmac_f32_16x16x64_bf16 v[72:75], v[0:3], v[32:39], v117
    global_load_lds_dwordx4 v118, s[22:23] offset:0 sc1
    v_smfmac_f32_16x16x64_bf16 v[72:75], v[4:7], v[40:47], v117
    ds_read_b128 v[16:19], v118 offset:4096
    s_waitcnt lgkmcnt(1)
    v_cmp_u_f32 vcc, v8, v12
    v_smfmac_f32_16x16x64_bf16 v[76:79], v[0:3], v[48:55], v117
    global_store_short v120, v114, s[24:25] sc1
    ds_read_b128 v[20:23], v118 offset:6144
    v_smfmac_f32_16x16x64_bf16 v[76:79], v[4:7], v[96:103], v117
    s_cbranch_vccnz Lfs_462
Lbk_463:
Lqj_461:
    v_smfmac_f32_16x16x64_bf16 v[64:67], v[8:11], v[160:167], v117
    ds_read_b128 v[96:99], v125 offset:12288
    ds_read_b128 v[44:47], v125 offset:15360
    v_smfmac_f32_16x16x64_bf16 v[64:67], v[12:15], v[176:183], v117
    global_load_lds_dwordx4 v118, s[22:23] offset:1024 sc1
    ds_read_b128 v[100:103], v125 offset:13312
    v_smfmac_f32_16x16x64_bf16 v[68:71], v[8:11], v[168:175], v117
    ds_read_b128 v[24:27], v118 offset:5120
    s_waitcnt lgkmcnt(4)
    v_cmp_u_f32 vcc, v16, v20
    v_smfmac_f32_16x16x64_bf16 v[68:71], v[12:15], v[184:191], v117
    ds_read_b128 v[28:31], v118 offset:7168
    ds_read_b128 v[40:43], v125 offset:14336
    v_smfmac_f32_16x16x64_bf16 v[72:75], v[8:11], a[0:7], v117
    s_cbranch_vccnz Lfs_472
Lbk_473:
    ds_read_b128 v[32:35], v125 offset:20480
    v_smfmac_f32_16x16x64_bf16 v[64:67], v[16:19], v[192:199], v117
    s_add_u32 s24, s24, 8192
    s_addc_u32 s25, s25, 0
    ds_read_b128 v[36:39], v125 offset:21504
    v_smfmac_f32_16x16x64_bf16 v[64:67], v[20:23], v[208:215], v117
    global_load_lds_dwordx4 v118, s[22:23] offset:2048 sc1
    ds_read_b128 v[48:51], v125 offset:22528
    v_smfmac_f32_16x16x64_bf16 v[68:71], v[16:19], v[200:207], v117
    s_add_u32 s26, s26, 1
    s_waitcnt lgkmcnt(4)
    v_cmp_u_f32 vcc, v24, v28
    v_smfmac_f32_16x16x64_bf16 v[68:71], v[20:23], v[216:223], v117
    ds_read_b128 v[52:55], v125 offset:23552
    v_smfmac_f32_16x16x64_bf16 v[72:75], v[16:19], v[96:103], v117
    s_cbranch_vccnz Lfs_475
Lbk_476:
    v_smfmac_f32_16x16x64_bf16 v[64:67], v[24:27], v[224:231], v117
    s_mov_b64 vcc, s[64:65]
    v_smfmac_f32_16x16x64_bf16 v[64:67], v[28:31], v[240:247], v117
    global_load_lds_dwordx4 v118, s[22:23] offset:3072 sc1
    v_smfmac_f32_16x16x64_bf16 v[68:71], v[24:27], v[232:239], v117
    s_add_u32 s22, s22, 524288
    s_addc_u32 s23, s23, 0
    v_smfmac_f32_16x16x64_bf16 v[68:71], v[28:31], v[248:255], v117
    s_waitcnt lgkmcnt(2)
    v_add_f32 v64, v64, v66
    v_smfmac_f32_16x16x64_bf16 v[72:75], v[20:23], v[32:39], v117
    ds_read_b128 v[32:35], v125 offset:24576
    v_add_f32 v65, v65, v67
    v_smfmac_f32_16x16x64_bf16 v[72:75], v[12:15], a[16:23], v117
    ds_read_b128 v[36:39], v125 offset:25600
    v_cvt_pk_bf16_f32 v102, v64, v65
    v_add_f32 v68, v68, v70
    v_smfmac_f32_16x16x64_bf16 v[72:75], v[24:27], a[32:39], v117
    ds_write_b32 v121, v102 offset:9220
    v_add_f32 v69, v69, v71
    v_cvt_pk_bf16_f32 v103, v68, v69
    v_smfmac_f32_16x16x64_bf16 v[72:75], v[28:31], a[48:55], v117
    ds_write_b32 v121, v103 offset:9732
    v_smfmac_f32_16x16x64_bf16 v[76:79], v[16:19], v[40:47], v117
    ds_read_b128 v[40:43], v125 offset:26624
    s_waitcnt lgkmcnt(5)
    v_smfmac_f32_16x16x64_bf16 v[76:79], v[20:23], v[48:55], v117
    ds_read_b128 v[44:47], v125 offset:27648
    v_add_f32 v72, v72, v74
    v_smfmac_f32_16x16x64_bf16 v[76:79], v[8:11], a[8:15], v117
    ds_read_b128 v[48:51], v125 offset:4096
    v_smfmac_f32_16x16x64_bf16 v[76:79], v[12:15], a[24:31], v117
    s_waitcnt lgkmcnt(3)
    s_barrier
    v_smfmac_f32_16x16x64_bf16 v[76:79], v[24:27], a[40:47], v117
    ds_read_b64_tr_b16 v[64:65], v122 offset:8192
    ds_read_b64_tr_b16 v[66:67], v122 offset:8704
    v_smfmac_f32_16x16x64_bf16 v[76:79], v[28:31], a[56:63], v117
    ds_read_b64_tr_b16 v[68:69], v122 offset:9216
    ds_read_b64_tr_b16 v[70:71], v122 offset:9728
    v_add_f32 v73, v73, v75
    v_cvt_pk_bf16_f32 v100, v72, v73
    v_smfmac_f32_16x16x64_bf16 v[80:83], v[0:3], a[64:71], v117
    ds_write_b32 v121, v100 offset:11268
    v_smfmac_f32_16x16x64_bf16 v[84:87], v[0:3], a[72:79], v117
    s_waitcnt lgkmcnt(3)
    ds_read_b128 v[52:55], v125 offset:5120
    v_add_f32 v76, v76, v78
    v_mfma_f32_16x16x32_bf16 v[96:99], v[56:59], v[64:67], 0
    s_waitcnt lgkmcnt(2)
    v_add_f32 v77, v77, v79
    v_cvt_pk_bf16_f32 v101, v76, v77
    v_mfma_f32_16x16x32_bf16 v[96:99], v[60:63], v[68:71], v[96:99]
    ds_write_b32 v121, v101 offset:11780
    v_smfmac_f32_16x16x64_bf16 v[80:83], v[4:7], a[80:87], v117
    s_mov_b32 exec_hi, 0
    global_store_dword v110, v108, s[18:19] sc1
    s_mov_b32 exec_hi, -1
    v_smfmac_f32_16x16x64_bf16 v[84:87], v[4:7], a[88:95], v117
    v_add_f32_dpp v96, v98, v96 quad_perm:[2,3,2,3] row_mask:0xf bank_mask:0xf
    v_add_f32_dpp v97, v99, v97 quad_perm:[2,3,2,3] row_mask:0xf bank_mask:0xf
    v_smfmac_f32_16x16x64_bf16 v[80:83], v[8:11], a[96:103], v117
    ds_write_b64 v109, v[96:97] offset:13824
    v_smfmac_f32_16x16x64_bf16 v[84:87], v[8:11], a[104:111], v117
    s_waitcnt lgkmcnt(1)
    s_barrier
    v_smfmac_f32_16x16x64_bf16 v[80:83], v[12:15], a[112:119], v117
    s_waitcnt vmcnt(7)
    ds_read_b64_tr_b16 v[72:73], v122 offset:10240
    ds_read_b64_tr_b16 v[74:75], v122 offset:10752
    v_smfmac_f32_16x16x64_bf16 v[84:87], v[12:15], a[120:127], v117
    ds_read_b64_tr_b16 v[76:77], v122 offset:11264
    ds_read_b64_tr_b16 v[78:79], v122 offset:11776
    v_smfmac_f32_16x16x64_bf16 v[80:83], v[16:19], a[128:135], v117
    ds_read_b128 v[8:11], v125 offset:18432
    v_smfmac_f32_16x16x64_bf16 v[84:87], v[16:19], a[136:143], v117
    s_waitcnt lgkmcnt(5)
    s_barrier
    s_waitcnt lgkmcnt(3)
    v_mfma_f32_16x16x32_bf16 v[0:3], v[72:75], v[64:67], 0
    ds_read_b128 v[56:59], v124 offset:12288
    s_waitcnt lgkmcnt(2)
    v_mfma_f32_16x16x32_bf16 v[0:3], v[76:79], v[68:71], v[0:3]
    ds_read_b128 v[12:15], v125 offset:19456
    v_smfmac_f32_16x16x64_bf16 v[80:83], v[20:23], a[144:151], v117
    ds_write_b32 v118, v108 offset:5120
    v_smfmac_f32_16x16x64_bf16 v[84:87], v[20:23], a[152:159], v117
    ds_write_b32 v118, v108 offset:7168
    v_add_f32_dpp v2, v0, v2 quad_perm:[0,1,0,1] row_mask:0xf bank_mask:0xf
    v_smfmac_f32_16x16x64_bf16 v[80:83], v[24:27], a[160:167], v117
    s_waitcnt lgkmcnt(3)
    v_max3_f32 v60, v56, v57, v58
    v_add_f32_dpp v3, v1, v3 quad_perm:[0,1,0,1] row_mask:0xf bank_mask:0xf
    v_smfmac_f32_16x16x64_bf16 v[84:87], v[24:27], a[168:175], v117
    v_max_f32 v60, v60, v59
    v_smfmac_f32_16x16x64_bf16 v[80:83], v[28:31], v[32:39], v117
    s_nop 0
    v_max_f32_dpp v60, v60, v60 quad_perm:[2,3,0,1] row_mask:0xf bank_mask:0xf
    v_smfmac_f32_16x16x64_bf16 v[84:87], v[28:31], v[40:47], v117
    v_max3_f32 v61, v60, v2, v3
    v_max3_f32 v62, v60, v2, v3
    v_mov_b64 v[64:65], 0
    v_mov_b64 v[66:67], 0
    v_permlane16_swap_b32 v61, v62
    v_max_f32 v60, v61, v62
    v_max_f32 v63, v61, v62
    v_pk_add_f32 v[80:81], v[80:81], v[82:83]
    v_pk_add_f32 v[84:85], v[84:85], v[86:87]
    v_permlane32_swap_b32 v60, v63
    v_max_f32 v61, v60, v63
    v_cvt_pk_bf16_f32 v114, v80, v81
    v_cvt_pk_bf16_f32 v115, v84, v85
    v_mul_f32_dpp v62, v61, v126 quad_perm:[2,3,2,3] row_mask:0xf bank_mask:0xf
    v_pk_fma_f32 v[2:3], v[2:3], s[28:29], v[62:63] op_sel_hi:[1,1,0]
    v_pk_fma_f32 v[56:57], v[56:57], s[28:29], v[62:63] op_sel_hi:[1,1,0]
    v_exp_f32 v2, v2
    v_exp_f32 v3, v3
    v_pk_fma_f32 v[58:59], v[58:59], s[28:29], v[62:63] op_sel_hi:[1,1,0]
    v_cvt_pk_bf16_f32 v80, v2, v3
    v_exp_f32 v56, v56
    v_cndmask_b32 v5, v113, v80, vcc
    v_cndmask_b32_dpp v4, v80, v113, vcc quad_perm:[2,3,2,3] row_mask:0xf bank_mask:0xf
    v_exp_f32 v57, v57
    v_exp_f32 v58, v58
    v_mfma_f32_16x16x16_bf16 v[76:79], v[4:5], v[104:105], 0
    v_cvt_pk_bf16_f32 v84, v56, v57
    v_exp_f32 v59, v59
    v_mfma_f32_16x16x16_bf16 v[72:75], v[4:5], v[114:115], 0
    v_cvt_pk_bf16_f32 v85, v58, v59
    v_mov_b32_dpp v86, v84 quad_perm:[2,3,0,1] row_mask:0xf bank_mask:0xf
    v_mov_b64 v[68:69], 0
    v_mov_b32_dpp v87, v85 quad_perm:[2,3,0,1] row_mask:0xf bank_mask:0xf
    v_mov_b64 v[70:71], 0
    v_mov_b64 v[80:81], 0
    v_mfma_f32_16x16x32_bf16 v[76:79], v[84:87], v[104:107], v[76:79]
    ds_read_b128 v[32:35], v125 offset:6144
    v_smfmac_f32_16x16x64_bf16 v[72:75], v[84:87], v[88:95], v117
    ds_read_b128 v[36:39], v125 offset:7168
    s_nop 2
    v_rcp_f32_dpp v60, v76 quad_perm:[2,3,2,3] row_mask:0xf bank_mask:0xf
    v_rcp_f32_dpp v61, v77 quad_perm:[2,3,2,3] row_mask:0xf bank_mask:0xf
    s_nop 1
    v_pk_mul_f32 v[72:73], v[72:73], v[60:61]
    v_pk_mul_f32 v[74:75], v[74:75], v[60:61]
    v_cvt_pk_bf16_f32 v56, v72, v73
    v_cvt_pk_bf16_f32 v57, v74, v75
    ds_write_b64 v121, v[56:57] offset:15872
    v_mov_b64 v[82:83], 0
    v_mov_b64 v[84:85], 0
    v_mov_b64 v[86:87], 0
    v_mov_b64 v[72:73], 0
    v_mov_b64 v[74:75], 0
    v_mov_b64 v[76:77], 0
    v_mov_b64 v[78:79], 0
    v_mov_b64 v[88:89], 0
    v_mov_b64 v[90:91], 0
    v_mov_b64 v[92:93], 0
    v_mov_b64 v[94:95], 0
    s_waitcnt vmcnt(6)
    s_waitcnt lgkmcnt(0)
    s_barrier
    ds_read_b64_tr_b16 v[96:97], v122 offset:14336
    ds_read_b64_tr_b16 v[98:99], v122 offset:14848
    ds_read_b64_tr_b16 v[100:101], v122 offset:15360
    ds_read_b64_tr_b16 v[102:103], v122 offset:15872
    ds_read_b128 v[40:43], v125 offset:16384
    ds_read_b128 v[44:47], v125 offset:17408
    s_waitcnt lgkmcnt(4)
    v_smfmac_f32_16x16x64_bf16 v[72:75], v[96:99], a[176:183], v117
    s_waitcnt lgkmcnt(2)
    v_smfmac_f32_16x16x64_bf16 v[72:75], v[100:103], a[192:199], v117
    ds_read_b128 v[24:27], v125 offset:28672
    v_smfmac_f32_16x16x64_bf16 v[76:79], v[96:99], a[184:191], v117
    ds_read_b128 v[28:31], v125 offset:29696
    v_smfmac_f32_16x16x64_bf16 v[76:79], v[100:103], a[200:207], v117
    ds_read_b128 v[56:59], v125 offset:30720
    v_add_f32 v72, v72, v74
    v_add_f32 v73, v73, v75
    v_cvt_pk_bf16_f32 v72, v72, v73
    v_smfmac_f32_16x16x64_bf16 v[80:83], v[96:99], a[208:215], v117
    global_store_dword v119, v72, s[16:17] offset:-4096 sc1
    ds_read_b128 v[60:63], v125 offset:31744
    s_nop 0
    v_add_f32 v76, v76, v78
    v_add_f32 v77, v77, v79
    v_cvt_pk_bf16_f32 v76, v76, v77
    v_smfmac_f32_16x16x64_bf16 v[80:83], v[100:103], a[224:231], v117
    global_store_dword v119, v76, s[32:33] offset:-4096 sc1
    v_smfmac_f32_16x16x64_bf16 v[84:87], v[96:99], a[216:223], v117
    v_smfmac_f32_16x16x64_bf16 v[84:87], v[100:103], a[232:239], v117
    v_add_f32 v80, v80, v82
    v_smfmac_f32_16x16x64_bf16 v[64:67], v[96:99], a[240:247], v117
    v_add_f32 v81, v81, v83
    v_cvt_pk_bf16_f32 v80, v80, v81
    v_smfmac_f32_16x16x64_bf16 v[64:67], v[100:103], v[48:55], v117
    global_store_dword v119, v80, s[16:17] offset:-2048 sc1
    v_add_f32 v84, v84, v86
    v_smfmac_f32_16x16x64_bf16 v[68:71], v[96:99], a[248:255], v117
    v_add_f32 v85, v85, v87
    v_cvt_pk_bf16_f32 v84, v84, v85
    v_smfmac_f32_16x16x64_bf16 v[68:71], v[100:103], v[32:39], v117
    s_waitcnt lgkmcnt(4)
    global_store_dword v119, v84, s[32:33] offset:-2048 sc1
    v_add_f32 v64, v64, v66
    v_smfmac_f32_16x16x64_bf16 v[88:91], v[96:99], v[40:47], v117
    s_waitcnt lgkmcnt(2)
    v_add_f32 v65, v65, v67
    v_cvt_pk_bf16_f32 v64, v64, v65
    v_smfmac_f32_16x16x64_bf16 v[88:91], v[100:103], v[24:31], v117
    global_store_dword v119, v64, s[16:17] offset:0 sc1
    v_add_f32 v68, v68, v70
    v_smfmac_f32_16x16x64_bf16 v[92:95], v[96:99], v[8:15], v117
    s_waitcnt lgkmcnt(0)
    v_add_f32 v69, v69, v71
    v_cvt_pk_bf16_f32 v68, v68, v69
    v_smfmac_f32_16x16x64_bf16 v[92:95], v[100:103], v[56:63], v117
    global_store_dword v119, v68, s[32:33] offset:0 sc1
    v_add_f32 v88, v88, v90
    v_add_f32 v89, v89, v91
    v_cvt_pk_bf16_f32 v88, v88, v89
    global_store_dword v119, v88, s[16:17] offset:2048 sc1
    s_mov_b32 m0, 5120
    ds_read_b128 v[32:35], v125 offset:0
    ds_read_b128 v[36:39], v125 offset:1024
    v_add_f32 v92, v92, v94
    v_add_f32 v93, v93, v95
    v_cvt_pk_bf16_f32 v92, v92, v93
    global_store_dword v119, v92, s[32:33] offset:2048 sc1
    ds_read_b128 v[40:43], v125 offset:8192
    ds_read_b128 v[44:47], v125 offset:9216
    ds_read_b128 v[48:51], v125 offset:2048
    ds_read_b128 v[52:55], v125 offset:3072
    ds_read_b128 v[96:99], v125 offset:10240
    ds_read_b128 v[100:103], v125 offset:11264
    v_mov_b64 v[64:65], 0
    v_mov_b64 v[66:67], 0
    v_mov_b64 v[68:69], 0
    v_mov_b64 v[70:71], 0
    v_mov_b64 v[72:73], 0
    v_mov_b64 v[74:75], 0
    v_mov_b64 v[76:77], 0
    v_mov_b64 v[78:79], 0
    v_mov_b64 v[80:81], 0
    v_mov_b64 v[82:83], 0
    v_mov_b64 v[84:85], 0
    v_mov_b64 v[86:87], 0
    s_waitcnt vmcnt(8)
    v_xor_b32 v112, 8, v109
    ds_read_b64 v[90:91], v109 offset:31744
    ds_read_b64 v[88:89], v112 offset:30720
    ds_read_b64 v[94:95], v109 offset:32256
    ds_read_b64 v[92:93], v112 offset:31232
    ds_read_b128 v[56:59], v111 offset:28672
    ds_read_b128 v[60:63], v111 offset:29696
    s_waitcnt lgkmcnt(2)
    v_swap_b32 v89, v90
    v_swap_b32 v93, v94
    global_load_dword v0, v123, s[20:21] offset:0 sc1
    global_load_dword v1, v123, s[20:21] offset:256 sc1
    global_load_dword v2, v123, s[20:21] offset:512 sc1
    global_load_dword v3, v123, s[20:21] offset:768 sc1
    global_load_dword v4, v123, s[20:21] offset:1024 sc1
    global_load_dword v5, v123, s[20:21] offset:1280 sc1
    global_load_dword v6, v123, s[20:21] offset:1536 sc1
    global_load_dword v7, v123, s[20:21] offset:1792 sc1
    s_waitcnt vmcnt(4)
    v_mfma_f32_16x16x32_bf16 v[24:27], v[104:107], v[0:3], 0
    v_max3_u32 v28, v0, v1, v2
    s_waitcnt vmcnt(0)
    v_mfma_f32_16x16x32_bf16 v[24:27], v[104:107], v[4:7], v[24:27]
    v_max3_u32 v29, v4, v5, v6
    v_max3_u32 v28, v28, v3, v7
    v_cmp_u_f32 vcc, v28, v29
    s_nop 4
    v_cvt_pk_bf16_f32 v114, v24, v24
    s_cbranch_vccnz Lpf_479
Lpj_480:
    global_store_short v120, v114, s[10:11] sc1
    s_branch Lhl3_430
Llast_431:
    global_store_short v120, v114, s[24:25] sc1
    s_branch L_fin
Lfa_432:
    s_waitcnt lgkmcnt(1)
    ds_read_b128 v[0:3], v118 offset:0
    ds_read_b128 v[4:7], v118 offset:2048
    global_load_lds_dwordx4 v127, s[10:11] sc1
    global_load_lds_dwordx4 v127, s[10:11] offset:2048 sc1
Lqb_434:
    ds_read_b128 v[8:11], v118 offset:1024
    ds_read_b128 v[12:15], v118 offset:3072
    v_smfmac_f32_16x16x64_bf16 v[72:75], v[24:27], v[32:39], v117
    v_max_u32 v112, v24, v28
    v_cmp_eq_u32 vcc, -1, v112
    v_smfmac_f32_16x16x64_bf16 v[72:75], v[28:31], v[40:47], v117
    v_smfmac_f32_16x16x64_bf16 v[76:79], v[24:27], v[48:55], v117
    s_cbranch_vccnz Lfb_433
    v_mov_b64 v[64:65], 0
    v_mov_b64 v[66:67], 0
    v_smfmac_f32_16x16x64_bf16 v[76:79], v[28:31], v[96:103], v117
    global_store_short v120, v108, s[12:13] sc1
    s_mov_b32 m0, 28672
    v_mov_b64 v[68:69], 0
    v_mov_b64 v[70:71], 0
    v_smfmac_f32_16x16x64_bf16 v[64:67], v[24:27], v[128:135], v117
    global_load_lds_dwordx4 v118, s[22:23] offset:0 sc1
    v_smfmac_f32_16x16x64_bf16 v[64:67], v[28:31], v[144:151], v117
    ds_read_b128 v[16:19], v118 offset:4096
    s_waitcnt lgkmcnt(1)
    v_cmp_u_f32 vcc, v8, v12
    v_smfmac_f32_16x16x64_bf16 v[68:71], v[24:27], v[136:143], v117
    global_store_short v120, v114, s[24:25] sc1
    ds_read_b128 v[20:23], v118 offset:6144
    v_smfmac_f32_16x16x64_bf16 v[68:71], v[28:31], v[152:159], v117
    s_cbranch_vccnz Lfs_440
Lbk_441:
    s_branch Lqj_436
Lfb_433:
    v_mov_b64 v[64:65], 0
    v_mov_b64 v[66:67], 0
    v_mov_b64 v[68:69], 0
    v_mov_b64 v[70:71], 0
    v_mov_b64 v[72:73], 0
    v_mov_b64 v[74:75], 0
    s_nop 0
    v_mov_b64 v[76:77], 0
    v_mov_b64 v[78:79], 0
Lr0_443:
    ds_read_b128 v[24:27], v118 offset:0
    ds_read_b128 v[28:31], v118 offset:2048
    global_load_lds_dwordx4 v127, s[10:11] sc1
    global_load_lds_dwordx4 v127, s[10:11] offset:2048 sc1
    s_waitcnt lgkmcnt(2)
    v_max_u32 v112, v0, v4
    v_cmp_eq_u32 vcc, -1, v112
    s_cbranch_vccz Lqa_435
    ds_read_b128 v[0:3], v118 offset:0
    ds_read_b128 v[4:7], v118 offset:2048
    global_load_lds_dwordx4 v127, s[10:11] sc1
    global_load_lds_dwordx4 v127, s[10:11] offset:2048 sc1
    s_waitcnt lgkmcnt(2)
    v_max_u32 v112, v24, v28
    v_cmp_eq_u32 vcc, -1, v112
    s_cbranch_vccz Lqb_434
    s_sub_u32 s27, s27, 1
    s_cbranch_scc0 Lr0_443
    s_branch L_fin
Lqa_435:
    ds_read_b128 v[8:11], v118 offset:1024
    ds_read_b128 v[12:15], v118 offset:3072
    v_smfmac_f32_16x16x64_bf16 v[64:67], v[0:3], v[128:135], v117
    v_smfmac_f32_16x16x64_bf16 v[64:67], v[4:7], v[144:151], v117
    v_smfmac_f32_16x16x64_bf16 v[68:71], v[0:3], v[136:143], v117
    v_smfmac_f32_16x16x64_bf16 v[68:71], v[4:7], v[152:159], v117
    global_store_short v120, v108, s[12:13] sc1
    s_mov_b32 m0, 28672
    v_smfmac_f32_16x16x64_bf16 v[72:75], v[0:3], v[32:39], v117
    global_load_lds_dwordx4 v118, s[22:23] offset:0 sc1
    v_smfmac_f32_16x16x64_bf16 v[72:75], v[4:7], v[40:47], v117
    ds_read_b128 v[16:19], v118 offset:4096
    s_waitcnt lgkmcnt(1)
    v_cmp_u_f32 vcc, v8, v12
    v_smfmac_f32_16x16x64_bf16 v[76:79], v[0:3], v[48:55], v117
    global_store_short v120, v114, s[24:25] sc1
    ds_read_b128 v[20:23], v118 offset:6144
    v_smfmac_f32_16x16x64_bf16 v[76:79], v[4:7], v[96:103], v117
    s_cbranch_vccnz Lfs_444
Lbk_445:
    s_branch Lqj_436
Lpf_454:
    global_load_dword v16, v123, s[18:19] offset:0 sc1
    global_load_dword v17, v123, s[18:19] offset:256 sc1
    global_load_dword v18, v123, s[18:19] offset:512 sc1
    global_load_dword v19, v123, s[18:19] offset:768 sc1
    global_load_dword v20, v123, s[18:19] offset:1024 sc1
    global_load_dword v21, v123, s[18:19] offset:1280 sc1
    global_load_dword v22, v123, s[18:19] offset:1536 sc1
    global_load_dword v23, v123, s[18:19] offset:1792 sc1
    global_load_dword v8, v123, s[18:19] offset:0 sc1
    global_load_dword v9, v123, s[18:19] offset:256 sc1
    global_load_dword v10, v123, s[18:19] offset:512 sc1
    global_load_dword v11, v123, s[18:19] offset:768 sc1
    global_load_dword v12, v123, s[18:19] offset:1024 sc1
    global_load_dword v13, v123, s[18:19] offset:1280 sc1
    global_load_dword v14, v123, s[18:19] offset:1536 sc1
    global_load_dword v15, v123, s[18:19] offset:1792 sc1
    s_waitcnt vmcnt(12)
    v_mfma_f32_16x16x32_bf16 v[24:27], v[104:107], v[16:19], 0
    v_max3_u32 v28, v16, v17, v18
    s_waitcnt vmcnt(8)
    v_mfma_f32_16x16x32_bf16 v[24:27], v[104:107], v[20:23], v[24:27]
    v_max3_u32 v29, v20, v21, v22
    v_max3_u32 v28, v28, v19, v23
    v_max_u32 v28, v28, v29
    v_cmp_eq_u32 vcc, -1, v28
    s_nop 3
    v_cvt_pk_bf16_f32 v114, v24, v24
    s_cbranch_vccz Lpj_455
Lpl_456:
    global_load_dword v16, v123, s[18:19] offset:0 sc1
    global_load_dword v17, v123, s[18:19] offset:256 sc1
    global_load_dword v18, v123, s[18:19] offset:512 sc1
    global_load_dword v19, v123, s[18:19] offset:768 sc1
    global_load_dword v20, v123, s[18:19] offset:1024 sc1
    global_load_dword v21, v123, s[18:19] offset:1280 sc1
    global_load_dword v22, v123, s[18:19] offset:1536 sc1
    global_load_dword v23, v123, s[18:19] offset:1792 sc1
    s_waitcnt vmcnt(12)
    v_mfma_f32_16x16x32_bf16 v[24:27], v[104:107], v[8:11], 0
    v_max3_u32 v28, v8, v9, v10
    s_waitcnt vmcnt(8)
    v_mfma_f32_16x16x32_bf16 v[24:27], v[104:107], v[12:15], v[24:27]
    v_max3_u32 v29, v12, v13, v14
    v_max3_u32 v28, v28, v11, v15
    v_max_u32 v28, v28, v29
    v_cmp_eq_u32 vcc, -1, v28
    s_nop 3
    v_cvt_pk_bf16_f32 v114, v24, v24
    s_cbranch_vccz Lpj_455
    global_load_dword v8, v123, s[18:19] offset:0 sc1
    global_load_dword v9, v123, s[18:19] offset:256 sc1
    global_load_dword v10, v123, s[18:19] offset:512 sc1
    global_load_dword v11, v123, s[18:19] offset:768 sc1
    global_load_dword v12, v123, s[18:19] offset:1024 sc1
    global_load_dword v13, v123, s[18:19] offset:1280 sc1
    global_load_dword v14, v123, s[18:19] offset:1536 sc1
    global_load_dword v15, v123, s[18:19] offset:1792 sc1
    s_waitcnt vmcnt(12)
    v_mfma_f32_16x16x32_bf16 v[24:27], v[104:107], v[16:19], 0
    v_max3_u32 v28, v16, v17, v18
    s_waitcnt vmcnt(8)
    v_mfma_f32_16x16x32_bf16 v[24:27], v[104:107], v[20:23], v[24:27]
    v_max3_u32 v29, v20, v21, v22
    v_max3_u32 v28, v28, v19, v23
    v_max_u32 v28, v28, v29
    v_cmp_eq_u32 vcc, -1, v28
    s_nop 3
    v_cvt_pk_bf16_f32 v114, v24, v24
    s_cbranch_vccz Lpj_455
    s_sub_u32 s27, s27, 1
    s_cbranch_scc0 Lpl_456
    s_branch L_fin
Lfa_457:
    s_waitcnt lgkmcnt(1)
    ds_read_b128 v[0:3], v118 offset:0
    ds_read_b128 v[4:7], v118 offset:2048
    global_load_lds_dwordx4 v127, s[12:13] sc1
    global_load_lds_dwordx4 v127, s[12:13] offset:2048 sc1
Lqb_459:
    ds_read_b128 v[8:11], v118 offset:1024
    ds_read_b128 v[12:15], v118 offset:3072
    v_smfmac_f32_16x16x64_bf16 v[72:75], v[24:27], v[32:39], v117
    v_max_u32 v112, v24, v28
    v_cmp_eq_u32 vcc, -1, v112
    v_smfmac_f32_16x16x64_bf16 v[72:75], v[28:31], v[40:47], v117
    v_smfmac_f32_16x16x64_bf16 v[76:79], v[24:27], v[48:55], v117
    s_cbranch_vccnz Lfb_458
    v_mov_b64 v[64:65], 0
    v_mov_b64 v[66:67], 0
    v_smfmac_f32_16x16x64_bf16 v[76:79], v[28:31], v[96:103], v117
    global_store_short v120, v108, s[10:11] sc1
    s_mov_b32 m0, 28672
    v_mov_b64 v[68:69], 0
    v_mov_b64 v[70:71], 0
    v_smfmac_f32_16x16x64_bf16 v[64:67], v[24:27], v[128:135], v117
    global_load_lds_dwordx4 v118, s[22:23] offset:0 sc1
    v_smfmac_f32_16x16x64_bf16 v[64:67], v[28:31], v[144:151], v117
    ds_read_b128 v[16:19], v118 offset:4096
    s_waitcnt lgkmcnt(1)
    v_cmp_u_f32 vcc, v8, v12
    v_smfmac_f32_16x16x64_bf16 v[68:71], v[24:27], v[136:143], v117
    global_store_short v120, v114, s[24:25] sc1
    ds_read_b128 v[20:23], v118 offset:6144
    v_smfmac_f32_16x16x64_bf16 v[68:71], v[28:31], v[152:159], v117
    s_cbranch_vccnz Lfs_465
Lbk_466:
    s_branch Lqj_461
Lfb_458:
    v_mov_b64 v[64:65], 0
    v_mov_b64 v[66:67], 0
    v_mov_b64 v[68:69], 0
    v_mov_b64 v[70:71], 0
    v_mov_b64 v[72:73], 0
    v_mov_b64 v[74:75], 0
    s_nop 0
    v_mov_b64 v[76:77], 0
    v_mov_b64 v[78:79], 0
Lr0_468:
    ds_read_b128 v[24:27], v118 offset:0
    ds_read_b128 v[28:31], v118 offset:2048
    global_load_lds_dwordx4 v127, s[12:13] sc1
    global_load_lds_dwordx4 v127, s[12:13] offset:2048 sc1
    s_waitcnt lgkmcnt(2)
    v_max_u32 v112, v0, v4
    v_cmp_eq_u32 vcc, -1, v112
    s_cbranch_vccz Lqa_460
    ds_read_b128 v[0:3], v118 offset:0
    ds_read_b128 v[4:7], v118 offset:2048
    global_load_lds_dwordx4 v127, s[12:13] sc1
    global_load_lds_dwordx4 v127, s[12:13] offset:2048 sc1
    s_waitcnt lgkmcnt(2)
    v_max_u32 v112, v24, v28
    v_cmp_eq_u32 vcc, -1, v112
    s_cbranch_vccz Lqb_459
    s_sub_u32 s27, s27, 1
    s_cbranch_scc0 Lr0_468
    s_branch L_fin
Lqa_460:
    ds_read_b128 v[8:11], v118 offset:1024
    ds_read_b128 v[12:15], v118 offset:3072
    v_smfmac_f32_16x16x64_bf16 v[64:67], v[0:3], v[128:135], v117
    v_smfmac_f32_16x16x64_bf16 v[64:67], v[4:7], v[144:151], v117
    v_smfmac_f32_16x16x64_bf16 v[68:71], v[0:3], v[136:143], v117
    v_smfmac_f32_16x16x64_bf16 v[68:71], v[4:7], v[152:159], v117
    global_store_short v120, v108, s[10:11] sc1
    s_mov_b32 m0, 28672
    v_smfmac_f32_16x16x64_bf16 v[72:75], v[0:3], v[32:39], v117
    global_load_lds_dwordx4 v118, s[22:23] offset:0 sc1
    v_smfmac_f32_16x16x64_bf16 v[72:75], v[4:7], v[40:47], v117
    ds_read_b128 v[16:19], v118 offset:4096
    s_waitcnt lgkmcnt(1)
    v_cmp_u_f32 vcc, v8, v12
    v_smfmac_f32_16x16x64_bf16 v[76:79], v[0:3], v[48:55], v117
    global_store_short v120, v114, s[24:25] sc1
    ds_read_b128 v[20:23], v118 offset:6144
    v_smfmac_f32_16x16x64_bf16 v[76:79], v[4:7], v[96:103], v117
    s_cbranch_vccnz Lfs_469
Lbk_470:
    s_branch Lqj_461
Lpf_479:
    global_load_dword v16, v123, s[20:21] offset:0 sc1
    global_load_dword v17, v123, s[20:21] offset:256 sc1
    global_load_dword v18, v123, s[20:21] offset:512 sc1
    global_load_dword v19, v123, s[20:21] offset:768 sc1
    global_load_dword v20, v123, s[20:21] offset:1024 sc1
    global_load_dword v21, v123, s[20:21] offset:1280 sc1
    global_load_dword v22, v123, s[20:21] offset:1536 sc1
    global_load_dword v23, v123, s[20:21] offset:1792 sc1
    global_load_dword v8, v123, s[20:21] offset:0 sc1
    global_load_dword v9, v123, s[20:21] offset:256 sc1
    global_load_dword v10, v123, s[20:21] offset:512 sc1
    global_load_dword v11, v123, s[20:21] offset:768 sc1
    global_load_dword v12, v123, s[20:21] offset:1024 sc1
    global_load_dword v13, v123, s[20:21] offset:1280 sc1
    global_load_dword v14, v123, s[20:21] offset:1536 sc1
    global_load_dword v15, v123, s[20:21] offset:1792 sc1
    s_waitcnt vmcnt(12)
    v_mfma_f32_16x16x32_bf16 v[24:27], v[104:107], v[16:19], 0
    v_max3_u32 v28, v16, v17, v18
    s_waitcnt vmcnt(8)
    v_mfma_f32_16x16x32_bf16 v[24:27], v[104:107], v[20:23], v[24:27]
    v_max3_u32 v29, v20, v21, v22
    v_max3_u32 v28, v28, v19, v23
    v_max_u32 v28, v28, v29
    v_cmp_eq_u32 vcc, -1, v28
    s_nop 3
    v_cvt_pk_bf16_f32 v114, v24, v24
    s_cbranch_vccz Lpj_480
Lpl_481:
    global_load_dword v16, v123, s[20:21] offset:0 sc1
    global_load_dword v17, v123, s[20:21] offset:256 sc1
    global_load_dword v18, v123, s[20:21] offset:512 sc1
    global_load_dword v19, v123, s[20:21] offset:768 sc1
    global_load_dword v20, v123, s[20:21] offset:1024 sc1
    global_load_dword v21, v123, s[20:21] offset:1280 sc1
    global_load_dword v22, v123, s[20:21] offset:1536 sc1
    global_load_dword v23, v123, s[20:21] offset:1792 sc1
    s_waitcnt vmcnt(12)
    v_mfma_f32_16x16x32_bf16 v[24:27], v[104:107], v[8:11], 0
    v_max3_u32 v28, v8, v9, v10
    s_waitcnt vmcnt(8)
    v_mfma_f32_16x16x32_bf16 v[24:27], v[104:107], v[12:15], v[24:27]
    v_max3_u32 v29, v12, v13, v14
    v_max3_u32 v28, v28, v11, v15
    v_max_u32 v28, v28, v29
    v_cmp_eq_u32 vcc, -1, v28
    s_nop 3
    v_cvt_pk_bf16_f32 v114, v24, v24
    s_cbranch_vccz Lpj_480
    global_load_dword v8, v123, s[20:21] offset:0 sc1
    global_load_dword v9, v123, s[20:21] offset:256 sc1
    global_load_dword v10, v123, s[20:21] offset:512 sc1
    global_load_dword v11, v123, s[20:21] offset:768 sc1
    global_load_dword v12, v123, s[20:21] offset:1024 sc1
    global_load_dword v13, v123, s[20:21] offset:1280 sc1
    global_load_dword v14, v123, s[20:21] offset:1536 sc1
    global_load_dword v15, v123, s[20:21] offset:1792 sc1
    s_waitcnt vmcnt(12)
    v_mfma_f32_16x16x32_bf16 v[24:27], v[104:107], v[16:19], 0
    v_max3_u32 v28, v16, v17, v18
    s_waitcnt vmcnt(8)
    v_mfma_f32_16x16x32_bf16 v[24:27], v[104:107], v[20:23], v[24:27]
    v_max3_u32 v29, v20, v21, v22
    v_max3_u32 v28, v28, v19, v23
    v_max_u32 v28, v28, v29
    v_cmp_eq_u32 vcc, -1, v28
    s_nop 3
    v_cvt_pk_bf16_f32 v114, v24, v24
    s_cbranch_vccz Lpj_480
    s_sub_u32 s27, s27, 1
    s_cbranch_scc0 Lpl_481
    s_branch L_fin
Lfs_437:
Lfl_439:
    ds_read_b128 v[8:11], v118 offset:1024
    ds_read_b128 v[12:15], v118 offset:3072
    s_sub_u32 s27, s27, 1
    s_waitcnt lgkmcnt(0)
    v_max_u32 v112, v8, v12
    v_cmp_eq_u32 vcc, -1, v112
    s_cbranch_vccz Lbk_438
    s_cbranch_scc0 Lfl_439
    s_branch L_fin
Lfs_440:
Lfl_442:
    ds_read_b128 v[8:11], v118 offset:1024
    ds_read_b128 v[12:15], v118 offset:3072
    s_sub_u32 s27, s27, 1
    s_waitcnt lgkmcnt(0)
    v_max_u32 v112, v8, v12
    v_cmp_eq_u32 vcc, -1, v112
    s_cbranch_vccz Lbk_441
    s_cbranch_scc0 Lfl_442
    s_branch L_fin
Lfs_444:
Lfl_446:
    ds_read_b128 v[8:11], v118 offset:1024
    ds_read_b128 v[12:15], v118 offset:3072
    s_sub_u32 s27, s27, 1
    s_waitcnt lgkmcnt(0)
    v_max_u32 v112, v8, v12
    v_cmp_eq_u32 vcc, -1, v112
    s_cbranch_vccz Lbk_445
    s_cbranch_scc0 Lfl_446
    s_branch L_fin
Lfs_447:
Lfl_449:
    ds_read_b128 v[16:19], v118 offset:4096
    ds_read_b128 v[20:23], v118 offset:6144
    s_sub_u32 s27, s27, 1
    s_waitcnt lgkmcnt(0)
    v_max_u32 v112, v16, v20
    v_cmp_eq_u32 vcc, -1, v112
    s_cbranch_vccz Lbk_448
    s_cbranch_scc0 Lfl_449
    s_branch L_fin
Lfs_450:
Lfl_452:
    ds_read_b128 v[24:27], v118 offset:5120
    ds_read_b128 v[28:31], v118 offset:7168
    s_sub_u32 s27, s27, 1
    s_waitcnt lgkmcnt(0)
    v_max_u32 v112, v24, v28
    v_cmp_eq_u32 vcc, -1, v112
    s_cbranch_vccz Lbk_451
    s_waitcnt vmcnt(5)
    ds_read_b128 v[24:27], v118 offset:5120
    ds_read_b128 v[28:31], v118 offset:7168
    s_sub_u32 s27, s27, 1
    s_waitcnt lgkmcnt(0)
    v_max_u32 v112, v24, v28
    v_cmp_eq_u32 vcc, -1, v112
    s_cbranch_vccz Lbk_451
Lfl_453:
    s_mov_b32 s40, m0
    s_mov_b32 m0, 5120
    s_nop 0
    global_load_lds_dwordx4 v127, s[10:11] sc1
    global_load_lds_dwordx4 v127, s[10:11] offset:2048 sc1
    s_waitcnt vmcnt(0)
    s_mov_b32 m0, s40
    ds_read_b128 v[24:27], v118 offset:5120
    ds_read_b128 v[28:31], v118 offset:7168
    s_sub_u32 s27, s27, 1
    s_waitcnt lgkmcnt(0)
    v_max_u32 v112, v24, v28
    v_cmp_eq_u32 vcc, -1, v112
    s_cbranch_vccz Lbk_451
    s_cbranch_scc0 Lfl_453
    s_branch L_fin
Lfs_462:
Lfl_464:
    ds_read_b128 v[8:11], v118 offset:1024
    ds_read_b128 v[12:15], v118 offset:3072
    s_sub_u32 s27, s27, 1
    s_waitcnt lgkmcnt(0)
    v_max_u32 v112, v8, v12
    v_cmp_eq_u32 vcc, -1, v112
    s_cbranch_vccz Lbk_463
    s_cbranch_scc0 Lfl_464
    s_branch L_fin
Lfs_465:
Lfl_467:
    ds_read_b128 v[8:11], v118 offset:1024
    ds_read_b128 v[12:15], v118 offset:3072
    s_sub_u32 s27, s27, 1
    s_waitcnt lgkmcnt(0)
    v_max_u32 v112, v8, v12
    v_cmp_eq_u32 vcc, -1, v112
    s_cbranch_vccz Lbk_466
    s_cbranch_scc0 Lfl_467
    s_branch L_fin
Lfs_469:
Lfl_471:
    ds_read_b128 v[8:11], v118 offset:1024
    ds_read_b128 v[12:15], v118 offset:3072
    s_sub_u32 s27, s27, 1
    s_waitcnt lgkmcnt(0)
    v_max_u32 v112, v8, v12
    v_cmp_eq_u32 vcc, -1, v112
    s_cbranch_vccz Lbk_470
    s_cbranch_scc0 Lfl_471
    s_branch L_fin
Lfs_472:
Lfl_474:
    ds_read_b128 v[16:19], v118 offset:4096
    ds_read_b128 v[20:23], v118 offset:6144
    s_sub_u32 s27, s27, 1
    s_waitcnt lgkmcnt(0)
    v_max_u32 v112, v16, v20
    v_cmp_eq_u32 vcc, -1, v112
    s_cbranch_vccz Lbk_473
    s_cbranch_scc0 Lfl_474
    s_branch L_fin
Lfs_475:
Lfl_477:
    ds_read_b128 v[24:27], v118 offset:5120
    ds_read_b128 v[28:31], v118 offset:7168
    s_sub_u32 s27, s27, 1
    s_waitcnt lgkmcnt(0)
    v_max_u32 v112, v24, v28
    v_cmp_eq_u32 vcc, -1, v112
    s_cbranch_vccz Lbk_476
    s_waitcnt vmcnt(5)
    ds_read_b128 v[24:27], v118 offset:5120
    ds_read_b128 v[28:31], v118 offset:7168
    s_sub_u32 s27, s27, 1
    s_waitcnt lgkmcnt(0)
    v_max_u32 v112, v24, v28
    v_cmp_eq_u32 vcc, -1, v112
    s_cbranch_vccz Lbk_476
Lfl_478:
    s_mov_b32 s40, m0
    s_mov_b32 m0, 5120
    s_nop 0
    global_load_lds_dwordx4 v127, s[12:13] sc1
    global_load_lds_dwordx4 v127, s[12:13] offset:2048 sc1
    s_waitcnt vmcnt(0)
    s_mov_b32 m0, s40
    ds_read_b128 v[24:27], v118 offset:5120
    ds_read_b128 v[28:31], v118 offset:7168
    s_sub_u32 s27, s27, 1
    s_waitcnt lgkmcnt(0)
    v_max_u32 v112, v24, v28
    v_cmp_eq_u32 vcc, -1, v112
    s_cbranch_vccz Lbk_476
    s_cbranch_scc0 Lfl_478
    s_branch L_fin
L_fin:
L_end:
    s_endpgm

.section .rodata,"a"
.p2align 6
.amdhsa_kernel recurrent_scan__memory_aug_recurrent_mem_tr__glu_gated_geglu__prompt_kernel
  .amdhsa_next_free_vgpr 512
  .amdhsa_next_free_sgpr 102
  .amdhsa_accum_offset 256
  .amdhsa_group_segment_fixed_size 0
  .amdhsa_kernarg_size 112
  .amdhsa_user_sgpr_count 2
  .amdhsa_user_sgpr_kernarg_segment_ptr 1
  .amdhsa_system_sgpr_workgroup_id_x 1
.end_amdhsa_kernel
```
